```python
import torch

def _softmax(x, axis=-1):
    return torch.softmax(x, dim=axis)

def _gelu(x):
    return torch.nn.functional.gelu(x, approximate='tanh')

def _silu(x):
    return torch.nn.functional.silu(x)

def _sigmoid(x):
    return torch.sigmoid(x)

def _layernorm(x, axis=-1, eps=1e-05):
    m = x.mean(dim=axis, keepdim=True)
    v = x.var(dim=axis, keepdim=True, unbiased=False)
    return (x - m) / torch.sqrt(v + eps)

def _scatter_add(tgt, idx, src, axis=0):
    return tgt.clone().index_add_(axis, idx, src)

def _segment_sum(src, seg, n):
    out = torch.zeros((n,) + src.shape[1:], dtype=src.dtype)
    return out.index_add_(0, seg, src)

def _pad(x, pw):
    flat = tuple((v for pair in reversed(pw) for v in pair))
    return torch.nn.functional.pad(x, flat)
kernel_name = 'adaLN_cond__mha_block__geglu_ffn__prompt'

def setup_inputs():

    _w = lambda a: (lambda t: t.to(torch.bfloat16) if t.is_floating_point() else t)(torch.as_tensor(a))

    def _A_setup():
        B, S, D, H = (1, 2048, 1024, 32)
        return {'x': _w((lambda *s: torch.randn(*s, dtype=torch.bfloat16) * 0.05)(B, S, D)), 'wqkv': _w((lambda *s: torch.randn(*s, dtype=torch.bfloat16) * 0.05)(D, 3 * D)), 'wo': _w((lambda *s: torch.randn(*s, dtype=torch.bfloat16) * 0.05)(D, D))}
    _A_in = _A_setup()

    def _B_setup():
        B, S, D, F = (1, 2048, 1024, 3584)
        return {'x': _w((lambda *s: torch.randn(*s, dtype=torch.bfloat16) * 0.05)(B, S, D)), 'w_gate': _w((lambda *s: torch.randn(*s, dtype=torch.bfloat16) * 0.05)(D, F)), 'w_up': _w((lambda *s: torch.randn(*s, dtype=torch.bfloat16) * 0.05)(D, F)), 'w_down': _w((lambda *s: torch.randn(*s, dtype=torch.bfloat16) * 0.05)(F, D))}
    _B_in = _B_setup()
    return {'A_x': _A_in['x'], 'A_wqkv': _A_in['wqkv'], 'A_wo': _A_in['wo'], 'B_x': _B_in['x'], 'B_w_gate': _B_in['w_gate'], 'B_w_up': _B_in['w_up'], 'B_w_down': _B_in['w_down'], 'c': _w((lambda *s: torch.randn(*s, dtype=torch.bfloat16) * 0.1)(1, 1024) * 8.0), 'w_mod': _w((lambda *s: torch.randn(*s, dtype=torch.bfloat16) * 0.1)(1024, 6 * 1024) * 1024 ** (-0.5) * 8.0)}

def reference(A_x, A_wqkv, A_wo, B_x, B_w_gate, B_w_up, B_w_down, c, w_mod):

    def _A_ref(x, wqkv, wo):
        B, S, D = x.shape
        H = 32
        Dh = D // H
        qkv = (lambda x, *d: x.permute(*d))((x @ wqkv).reshape(B, S, 3, H, Dh), 2, 0, 3, 1, 4)
        q, k, v = (qkv[0], qkv[1], qkv[2])
        scores = torch.einsum('bhqd,bhkd->bhqk', q, k) * Dh ** (-0.5)
        p = _softmax(scores, axis=-1)
        o = torch.einsum('bhqk,bhkd->bhqd', p, v)
        return (lambda x, *d: x.permute(*d))(o, 0, 2, 1, 3).reshape(B, S, D) @ wo

    def _B_ref(x, w_gate, w_up, w_down):
        return _gelu(x @ w_gate) * (x @ w_up) @ w_down
    x = A_x
    mod = (_silu(c) @ w_mod).reshape(c.shape[0], 6, 1, -1)
    sa, ca, ga, sb, cb, gb = (mod[:, 0].clone(), mod[:, 1].clone(), mod[:, 2].clone(), mod[:, 3].clone(), mod[:, 4].clone(), mod[:, 5].clone())
    h = _layernorm(x, axis=-1) * (1 + ca) + sa
    x = x + ga * _A_ref(h, A_wqkv, A_wo)
    h = _layernorm(x, axis=-1) * (1 + cb) + sb
    x = x + gb * _B_ref(h, B_w_gate, B_w_up, B_w_down)
    return x
```

```asm
; @launch kernel=front_kernel grid=(512,1,1) block=(512,1,1) lds=59392
; @launch kernel=qkv_kernel grid=(256,1,1) block=(256,1,1) lds=65536
; @launch kernel=attn_kernel grid=(512,1,1) block=(256,1,1) lds=81920
; @launch kernel=wo_kernel grid=(256,1,1) block=(256,1,1) lds=118784
.amdgcn_target "amdgcn-amd-amdhsa--gfx950"
.text
.globl front_kernel
.p2align 8
.type front_kernel,@function
front_kernel:
  s_getpc_b64 s[56:57]
L_pc_5:
  v_cmp_le_u32 vcc, 448, v0
  s_mov_b32 s58, qkv_kernel-L_pc_5
  s_mov_b32 s59, 0x20000
  v_and_b32 v73, 63, v0
  v_lshlrev_b32 v73, 7, v73
  s_cmp_eq_u64 vcc, 0
  s_cbranch_scc1 L_nopf_6
  buffer_load_dword v74, v73, s[56:59], 0 offen
L_nopf_6:
  s_cmp_ge_u32 s2, 256
  s_cbranch_scc1 L_pack_2
  s_load_dwordx4 s[8:11], s[0:1], 56
  s_load_dwordx4 s[4:7], s[0:1], 80
  s_load_dwordx2 s[16:17], s[0:1], 0
  s_memrealtime s[44:45]
  v_lshrrev_b32 v1, 6, v0
  v_and_b32 v2, 63, v0
  v_readfirstlane_b32 s21, v1
  v_lshrrev_b32 v3, 3, v2
  v_and_b32 v4, 7, v2
  v_mul_u32_u24 v3, 12288, v3
  v_lshl_add_u32 v3, v4, 4, v3
  v_lshrrev_b32 v7, 4, v2
  v_lshlrev_b32 v5, 4, v7
  v_lshrrev_b32 v8, 2, v2
  v_and_b32 v9, 3, v2
  v_lshlrev_b32 v6, 6, v8
  v_lshl_add_u32 v6, v9, 3, v6
  v_mov_b32 v71, 0
  s_lshl_b32 s22, s2, 3
  s_add_u32 s22, s22, s21
  s_lshl_b32 s23, s22, 11
  s_lshl_b32 s24, s21, 12
  s_waitcnt lgkmcnt(0)
  s_mov_b32 s12, s10
  s_mov_b32 s13, s11
  s_mov_b32 s40, s4
  s_mov_b32 s41, s5
  s_mov_b32 s4, s6
  s_mov_b32 s5, s7
  s_mov_b32 s10, 0x800
  s_mov_b32 s11, 0x20000
  s_mov_b32 s14, 0xc00000
  s_mov_b32 s15, 0x20000
  s_mov_b32 s18, 0x400000
  s_mov_b32 s19, 0x20000
  s_mov_b32 s42, 0x100
  s_mov_b32 s43, 0x20000
  s_add_u32 s52, s4, 0x8000
  s_addc_u32 s53, s5, 0
  s_mov_b32 s54, 0x8000
  s_mov_b32 s55, 0x20000
  s_add_u32 s32, s4, 0x20000
  s_addc_u32 s33, s5, 0
  s_mov_b32 s34, 0x4000
  s_mov_b32 s35, 0x20000
  s_add_u32 s36, s4, 0x100000
  s_addc_u32 s37, s5, 0
  s_mov_b32 s38, 0x400000
  s_mov_b32 s39, 0x20000
  s_or_b32 s46, s2, s21
  s_cmp_lg_u32 s46, 0
  s_cbranch_scc1 L_nononce_7
  s_or_b32 s44, s44, 1
  v_mov_b32 v72, s44
  buffer_store_dword v72, v71, s[40:43], 0 offen sc1
L_nononce_7:
  s_cmp_ge_u32 s2, 128
  s_cbranch_scc1 L_typeB_3
  s_and_b32 s25, s2, 3
  s_lshl_b32 s29, s25, 13
  s_lshl_b32 s25, s25, 8
  s_lshl_b32 s26, s21, 5
  s_add_u32 s25, s25, s26
  s_lshr_b32 s26, s2, 2
  s_bfe_u32 s30, s26, 0x10003
  s_xor_b32 s26, s26, s30
  s_lshl_b32 s30, s26, 8
  s_add_u32 s29, s29, s30
  s_lshl_b32 s26, s26, 7
  s_lshl_b32 s27, s25, 1
  s_mul_i32 s28, s25, 12288
  s_add_u32 s28, s28, s26
  buffer_load_dwordx4 v[32:35], v5, s[8:11], s27 offen offset:0
  s_add_u32 m0, s24, 0
  s_nop 0
  buffer_load_dwordx4 v3, s[12:15], s28 offen offset:0 nt lds
  s_add_u32 s28, s28, 97280
  buffer_load_dwordx4 v3, s[12:15], s28 offen offset:1024 nt lds
  s_add_u32 s28, s28, 97280
  buffer_load_dwordx4 v3, s[12:15], s28 offen offset:2048 nt lds
  s_add_u32 s28, s28, 97280
  buffer_load_dwordx4 v3, s[12:15], s28 offen offset:3072 nt lds
  s_add_u32 s28, s28, 101376
  buffer_load_dwordx2 v[8:9], v6, s[16:19], s23 offen offset:0 nt
  buffer_load_dwordx2 v[10:11], v6, s[16:19], s23 offen offset:32 nt
  buffer_load_dwordx2 v[12:13], v6, s[16:19], s23 offen offset:1024 nt
  buffer_load_dwordx2 v[14:15], v6, s[16:19], s23 offen offset:1056 nt
  v_bfe_u32 v64, v2, 2, 2
  v_lshl_add_u32 v64, v7, 3, v64
  v_lshlrev_b32 v64, 7, v64
  v_and_b32 v65, 3, v2
  v_lshl_add_u32 v64, v65, 3, v64
  v_add_u32 v64, s24, v64
  s_waitcnt vmcnt(8)
  buffer_load_dword v72, v71, s[40:43], 0 offen sc1
  v_lshlrev_b32 v40, 16, v32
  v_and_b32 v41, 0xffff0000, v32
  v_lshlrev_b32 v42, 16, v33
  v_and_b32 v43, 0xffff0000, v33
  v_lshlrev_b32 v44, 16, v34
  v_and_b32 v45, 0xffff0000, v34
  v_lshlrev_b32 v46, 16, v35
  v_and_b32 v47, 0xffff0000, v35
  v_mul_f32 v48, 0xbfb8aa3b, v40
  v_mul_f32 v49, 0xbfb8aa3b, v41
  v_mul_f32 v50, 0xbfb8aa3b, v42
  v_mul_f32 v51, 0xbfb8aa3b, v43
  v_mul_f32 v52, 0xbfb8aa3b, v44
  v_mul_f32 v53, 0xbfb8aa3b, v45
  v_mul_f32 v54, 0xbfb8aa3b, v46
  v_mul_f32 v55, 0xbfb8aa3b, v47
  v_exp_f32 v48, v48
  v_exp_f32 v49, v49
  v_exp_f32 v50, v50
  v_exp_f32 v51, v51
  v_exp_f32 v52, v52
  v_exp_f32 v53, v53
  v_exp_f32 v54, v54
  v_exp_f32 v55, v55
  v_add_f32 v48, 1.0, v48
  v_add_f32 v49, 1.0, v49
  v_add_f32 v50, 1.0, v50
  v_add_f32 v51, 1.0, v51
  v_add_f32 v52, 1.0, v52
  v_add_f32 v53, 1.0, v53
  v_add_f32 v54, 1.0, v54
  v_add_f32 v55, 1.0, v55
  v_rcp_f32 v48, v48
  v_rcp_f32 v49, v49
  v_rcp_f32 v50, v50
  v_rcp_f32 v51, v51
  v_rcp_f32 v52, v52
  v_rcp_f32 v53, v53
  v_rcp_f32 v54, v54
  v_rcp_f32 v55, v55
  v_mul_f32 v48, v40, v48
  v_mul_f32 v49, v41, v49
  v_mul_f32 v50, v42, v50
  v_mul_f32 v51, v43, v51
  v_mul_f32 v52, v44, v52
  v_mul_f32 v53, v45, v53
  v_mul_f32 v54, v46, v54
  v_mul_f32 v55, v47, v55
  v_cvt_pk_bf16_f32 v32, v48, v49
  v_cvt_pk_bf16_f32 v33, v50, v51
  v_cvt_pk_bf16_f32 v34, v52, v53
  v_cvt_pk_bf16_f32 v35, v54, v55
  s_waitcnt vmcnt(5)
  ds_read_b64_tr_b16 v[40:41], v64 offset:0
  ds_read_b64_tr_b16 v[42:43], v64 offset:512
  ds_read_b64_tr_b16 v[44:45], v64 offset:32
  ds_read_b64_tr_b16 v[46:47], v64 offset:544
  ds_read_b64_tr_b16 v[48:49], v64 offset:64
  ds_read_b64_tr_b16 v[50:51], v64 offset:576
  ds_read_b64_tr_b16 v[52:53], v64 offset:96
  ds_read_b64_tr_b16 v[54:55], v64 offset:608
  s_waitcnt lgkmcnt(0)
  v_mfma_f32_16x16x32_bf16 v[16:19], v[40:43], v[32:35], 0
  v_mfma_f32_16x16x32_bf16 v[20:23], v[44:47], v[32:35], 0
  v_mfma_f32_16x16x32_bf16 v[24:27], v[48:51], v[32:35], 0
  v_mfma_f32_16x16x32_bf16 v[28:31], v[52:55], v[32:35], 0
  s_nop 7
  s_lshl_b32 s30, s21, 8
  s_add_u32 s30, s30, 49152
  v_add_u32 v65, s30, v5
  v_and_b32 v66, 15, v2
  v_cmp_eq_u32 vcc, 0, v66
  s_and_saveexec_b64 s[46:47], vcc
  ds_write_b128 v65, v[16:19]
  ds_write_b128 v65, v[20:23] offset:64
  ds_write_b128 v65, v[24:27] offset:128
  ds_write_b128 v65, v[28:31] offset:192
  s_mov_b64 exec, s[46:47]
  v_lshlrev_b32 v65, 2, v2
  v_add_u32 v66, 49152, v65
  s_waitcnt lgkmcnt(0)
  s_barrier
  s_cmp_lg_u32 s21, 0
  s_cbranch_scc1 L_notw0_8
  ds_read_b32 v40, v66 offset:0
  ds_read_b32 v41, v66 offset:256
  ds_read_b32 v42, v66 offset:512
  ds_read_b32 v43, v66 offset:768
  ds_read_b32 v44, v66 offset:1024
  ds_read_b32 v45, v66 offset:1280
  ds_read_b32 v46, v66 offset:1536
  ds_read_b32 v47, v66 offset:1792
  s_waitcnt lgkmcnt(0)
  v_add_f32 v40, v40, v44
  v_add_f32 v41, v41, v45
  v_add_f32 v42, v42, v46
  v_add_f32 v43, v43, v47
  v_add_f32 v40, v40, v42
  v_add_f32 v41, v41, v43
  v_add_f32 v40, v40, v41
  buffer_store_dword v40, v65, s[52:55], s29 offen sc1
  s_waitcnt vmcnt(0)
  v_readfirstlane_b32 s44, v72
  s_nop 3
  s_cmp_lg_u32 s44, 0
  s_cbranch_scc1 L_got_11
  s_mov_b32 s48, 0x100000
L_pnonce_12:
  buffer_load_dword v72, v71, s[40:43], 0 offen sc1
  s_sub_u32 s48, s48, 1
  s_cselect_b32 s49, 1, 0
  s_waitcnt vmcnt(0)
  v_readfirstlane_b32 s44, v72
  s_nop 3
  s_or_b32 s49, s49, s44
  s_cmp_eq_u32 s49, 0
  s_cbranch_scc1 L_pnonce_12
L_got_11:
  s_lshl_b32 s30, s2, 7
  buffer_store_dword v72, v71, s[32:35], s30 offen sc1
  s_barrier
  s_branch L_join_4
L_notw0_8:
  s_barrier
  s_branch L_join_4
L_typeB_3:
  buffer_load_dwordx2 v[8:9], v6, s[16:19], s23 offen offset:0 nt
  buffer_load_dwordx2 v[10:11], v6, s[16:19], s23 offen offset:32 nt
  buffer_load_dwordx2 v[12:13], v6, s[16:19], s23 offen offset:1024 nt
  buffer_load_dwordx2 v[14:15], v6, s[16:19], s23 offen offset:1056 nt
  s_cmp_lg_u32 s21, 0
  s_cbranch_scc1 L_join_4
  s_mov_b32 s48, 0x100000
L_pnonce_13:
  buffer_load_dword v72, v71, s[40:43], 0 offen sc1
  s_sub_u32 s48, s48, 1
  s_cselect_b32 s49, 1, 0
  s_waitcnt vmcnt(0)
  v_readfirstlane_b32 s44, v72
  s_nop 3
  s_or_b32 s49, s49, s44
  s_cmp_eq_u32 s49, 0
  s_cbranch_scc1 L_pnonce_13
L_join_4:
  s_waitcnt vmcnt(0)
  v_lshlrev_b32 v16, 16, v8
  v_and_b32 v17, 0xffff0000, v8
  v_lshlrev_b32 v18, 16, v9
  v_and_b32 v19, 0xffff0000, v9
  v_lshlrev_b32 v20, 16, v10
  v_and_b32 v21, 0xffff0000, v10
  v_lshlrev_b32 v22, 16, v11
  v_and_b32 v23, 0xffff0000, v11
  v_lshlrev_b32 v24, 16, v12
  v_and_b32 v25, 0xffff0000, v12
  v_lshlrev_b32 v26, 16, v13
  v_and_b32 v27, 0xffff0000, v13
  v_lshlrev_b32 v28, 16, v14
  v_and_b32 v29, 0xffff0000, v14
  v_lshlrev_b32 v30, 16, v15
  v_and_b32 v31, 0xffff0000, v15
  v_add_f32 v64, v16, v17
  v_add_f32 v64, v64, v18
  v_add_f32 v64, v64, v19
  v_add_f32 v64, v64, v20
  v_add_f32 v64, v64, v21
  v_add_f32 v64, v64, v22
  v_add_f32 v64, v64, v23
  v_add_f32 v64, v64, v24
  v_add_f32 v64, v64, v25
  v_add_f32 v64, v64, v26
  v_add_f32 v64, v64, v27
  v_add_f32 v64, v64, v28
  v_add_f32 v64, v64, v29
  v_add_f32 v64, v64, v30
  v_add_f32 v64, v64, v31
  s_nop 1
  v_add_f32_dpp v64, v64, v64 quad_perm:[1,0,3,2] row_mask:0xf bank_mask:0xf
  s_nop 1
  v_add_f32_dpp v64, v64, v64 quad_perm:[2,3,0,1] row_mask:0xf bank_mask:0xf
  s_nop 1
  v_add_f32_dpp v64, v64, v64 row_half_mirror row_mask:0xf bank_mask:0xf
  s_nop 1
  v_add_f32_dpp v64, v64, v64 row_mirror row_mask:0xf bank_mask:0xf
  v_mov_b32 v65, v64
  s_nop 1
  v_permlane16_swap_b32 v64, v65
  s_nop 1
  v_add_f32 v64, v64, v65
  v_mov_b32 v65, v64
  s_nop 1
  v_permlane32_swap_b32 v64, v65
  s_nop 1
  v_add_f32 v64, v64, v65
  v_mul_f32 v64, 0x3a800000, v64
  v_sub_f32 v16, v16, v64
  v_sub_f32 v17, v17, v64
  v_sub_f32 v18, v18, v64
  v_sub_f32 v19, v19, v64
  v_sub_f32 v20, v20, v64
  v_sub_f32 v21, v21, v64
  v_sub_f32 v22, v22, v64
  v_sub_f32 v23, v23, v64
  v_sub_f32 v24, v24, v64
  v_sub_f32 v25, v25, v64
  v_sub_f32 v26, v26, v64
  v_sub_f32 v27, v27, v64
  v_sub_f32 v28, v28, v64
  v_sub_f32 v29, v29, v64
  v_sub_f32 v30, v30, v64
  v_sub_f32 v31, v31, v64
  v_mul_f32 v66, v16, v16
  v_fmac_f32 v66, v17, v17
  v_fmac_f32 v66, v18, v18
  v_fmac_f32 v66, v19, v19
  v_fmac_f32 v66, v20, v20
  v_fmac_f32 v66, v21, v21
  v_fmac_f32 v66, v22, v22
  v_fmac_f32 v66, v23, v23
  v_fmac_f32 v66, v24, v24
  v_fmac_f32 v66, v25, v25
  v_fmac_f32 v66, v26, v26
  v_fmac_f32 v66, v27, v27
  v_fmac_f32 v66, v28, v28
  v_fmac_f32 v66, v29, v29
  v_fmac_f32 v66, v30, v30
  v_fmac_f32 v66, v31, v31
  s_nop 1
  v_add_f32_dpp v66, v66, v66 quad_perm:[1,0,3,2] row_mask:0xf bank_mask:0xf
  s_nop 1
  v_add_f32_dpp v66, v66, v66 quad_perm:[2,3,0,1] row_mask:0xf bank_mask:0xf
  s_nop 1
  v_add_f32_dpp v66, v66, v66 row_half_mirror row_mask:0xf bank_mask:0xf
  s_nop 1
  v_add_f32_dpp v66, v66, v66 row_mirror row_mask:0xf bank_mask:0xf
  v_mov_b32 v65, v66
  s_nop 1
  v_permlane16_swap_b32 v66, v65
  s_nop 1
  v_add_f32 v66, v66, v65
  v_mov_b32 v65, v66
  s_nop 1
  v_permlane32_swap_b32 v66, v65
  s_nop 1
  v_add_f32 v66, v66, v65
  v_mov_b32 v67, 0x3727c5ac
  v_fmac_f32 v67, 0x3a800000, v66
  v_rsq_f32 v67, v67
  v_lshlrev_b32 v70, 4, v0
  v_lshlrev_b32 v68, 7, v2
  s_movk_i32 s30, 8192
  s_movk_i32 s31, 16384
  s_movk_i32 s50, 24576
  s_cmp_ge_u32 s21, 4
  s_cselect_b32 s27, 1.0, 0
  v_mul_f32 v16, v16, v67
  v_mul_f32 v17, v17, v67
  v_mul_f32 v18, v18, v67
  v_mul_f32 v19, v19, v67
  v_mul_f32 v20, v20, v67
  v_mul_f32 v21, v21, v67
  v_mul_f32 v22, v22, v67
  v_mul_f32 v23, v23, v67
  v_mul_f32 v24, v24, v67
  v_mul_f32 v25, v25, v67
  v_mul_f32 v26, v26, v67
  v_mul_f32 v27, v27, v67
  v_mul_f32 v28, v28, v67
  v_mul_f32 v29, v29, v67
  v_mul_f32 v30, v30, v67
  v_mul_f32 v31, v31, v67
  s_cmp_lg_u32 s21, 0
  s_cbranch_scc1 L_notw0b_15
  s_mov_b32 s48, 0x100000
L_pflag_14:
  buffer_load_dword v40, v68, s[32:35], 0 offen sc1
  buffer_load_dword v41, v68, s[32:35], s30 offen sc1
  s_waitcnt vmcnt(0)
  v_cmp_ne_u32 vcc, s44, v40
  v_cmp_ne_u32 s[46:47], s44, v41
  s_nop 3
  s_or_b64 s[46:47], vcc, s[46:47]
  s_sub_u32 s48, s48, 1
  s_cselect_b64 s[46:47], 0, s[46:47]
  s_cmp_lg_u64 s[46:47], 0
  s_cbranch_scc1 L_pflag_14
L_notw0b_15:
  s_barrier
  buffer_load_dwordx4 v[32:35], v70, s[52:55], 0 offen sc1
  buffer_load_dwordx4 v[36:39], v70, s[52:55], s30 offen sc1
  buffer_load_dwordx4 v[40:43], v70, s[52:55], s31 offen sc1
  buffer_load_dwordx4 v[44:47], v70, s[52:55], s50 offen sc1
  v_add_u32 v69, 51200, v70
  v_lshlrev_b32 v6, 1, v6
  v_add_u32 v6, 51200, v6
  v_and_b32 v64, 7, v2
  v_xor_b32 v64, s21, v64
  v_lshlrev_b32 v64, 4, v64
  v_lshl_add_u32 v64, v2, 7, v64
  v_lshrrev_b32 v65, 3, v0
  v_xor_b32 v66, v65, v0
  v_and_b32 v66, 7, v66
  v_lshlrev_b32 v66, 4, v66
  v_and_b32 v7, 3, v65
  v_lshl_add_u32 v7, v7, 8, v66
  v_lshrrev_b32 v65, 2, v65
  v_lshl_add_u32 v7, v65, 13, v7
  s_lshr_b32 s25, s2, 4
  s_lshl_b32 s25, s25, 18
  s_bfe_u32 s26, s2, 0x30001
  s_lshl_b32 s26, s26, 10
  s_add_u32 s25, s25, s26
  s_and_b32 s26, s2, 1
  s_lshl_b32 s26, s26, 7
  s_add_u32 s25, s25, s26
  s_add_u32 s26, s25, 131072
  s_waitcnt vmcnt(0)
  v_add_f32 v32, v32, v36
  v_add_f32 v33, v33, v37
  v_add_f32 v34, v34, v38
  v_add_f32 v35, v35, v39
  v_add_f32 v40, v40, v44
  v_add_f32 v41, v41, v45
  v_add_f32 v42, v42, v46
  v_add_f32 v43, v43, v47
  v_add_f32 v32, v32, v40
  v_add_f32 v33, v33, v41
  v_add_f32 v34, v34, v42
  v_add_f32 v35, v35, v43
  v_cvt_pk_bf16_f32 v36, v32, v33
  v_cvt_pk_bf16_f32 v37, v34, v35
  v_lshlrev_b32 v32, 16, v36
  v_and_b32 v33, 0xffff0000, v36
  v_lshlrev_b32 v34, 16, v37
  v_and_b32 v35, 0xffff0000, v37
  v_add_f32 v32, s27, v32
  v_add_f32 v33, s27, v33
  v_add_f32 v34, s27, v34
  v_add_f32 v35, s27, v35
  v_cvt_pk_bf16_f32 v36, v32, v33
  v_cvt_pk_bf16_f32 v37, v34, v35
  v_lshlrev_b32 v32, 16, v36
  v_and_b32 v33, 0xffff0000, v36
  v_lshlrev_b32 v34, 16, v37
  v_and_b32 v35, 0xffff0000, v37
  ds_write_b128 v69, v[32:35]
  s_waitcnt lgkmcnt(0)
  s_barrier
  ds_read_b128 v[32:35], v6 offset:4096
  ds_read_b128 v[48:51], v6 offset:0
  ds_read_b128 v[36:39], v6 offset:4160
  ds_read_b128 v[52:55], v6 offset:64
  ds_read_b128 v[40:43], v6 offset:6144
  ds_read_b128 v[56:59], v6 offset:2048
  ds_read_b128 v[44:47], v6 offset:6208
  ds_read_b128 v[60:63], v6 offset:2112
  s_waitcnt lgkmcnt(0)
  v_fma_f32 v16, v16, v32, v48
  v_fma_f32 v17, v17, v33, v49
  v_fma_f32 v18, v18, v34, v50
  v_fma_f32 v19, v19, v35, v51
  v_fma_f32 v20, v20, v36, v52
  v_fma_f32 v21, v21, v37, v53
  v_fma_f32 v22, v22, v38, v54
  v_fma_f32 v23, v23, v39, v55
  v_fma_f32 v24, v24, v40, v56
  v_fma_f32 v25, v25, v41, v57
  v_fma_f32 v26, v26, v42, v58
  v_fma_f32 v27, v27, v43, v59
  v_fma_f32 v28, v28, v44, v60
  v_fma_f32 v29, v29, v45, v61
  v_fma_f32 v30, v30, v46, v62
  v_fma_f32 v31, v31, v47, v63
  v_cvt_pk_bf16_f32 v8, v16, v17
  v_cvt_pk_bf16_f32 v9, v18, v19
  v_cvt_pk_bf16_f32 v10, v20, v21
  v_cvt_pk_bf16_f32 v11, v22, v23
  v_cvt_pk_bf16_f32 v12, v24, v25
  v_cvt_pk_bf16_f32 v13, v26, v27
  v_cvt_pk_bf16_f32 v14, v28, v29
  v_cvt_pk_bf16_f32 v15, v30, v31
  ds_write_b128 v64, v[8:11]
  ds_write_b128 v64, v[12:15] offset:8192
  s_waitcnt lgkmcnt(0)
  s_barrier
  ds_read_b128 v[8:11], v70
  ds_read_b128 v[12:15], v70 offset:8192
  s_waitcnt lgkmcnt(1)
  buffer_store_dwordx4 v[8:11], v7, s[36:39], s25 offen sc1
  s_waitcnt lgkmcnt(0)
  buffer_store_dwordx4 v[12:15], v7, s[36:39], s26 offen sc1
  s_endpgm
L_pack_2:
  s_cmp_ge_u32 s2, 512
  s_cbranch_scc1 L_end_1
  s_load_dwordx2 s[28:29], s[0:1], 8
  s_load_dwordx2 s[4:5], s[0:1], 88
  s_load_dwordx2 s[52:53], s[0:1], 80
  v_mov_b32 v71, 0
  v_lshrrev_b32 v1, 6, v0
  s_sub_u32 s20, s2, 256
  v_readfirstlane_b32 s21, v1
  s_nop 3
  s_cmp_eq_u32 s21, 7
  s_cbranch_scc1 L_codepf_16
  s_mul_i32 s24, s20, 5
  s_add_u32 s24, s24, s21
  s_sub_u32 s24, s24, 512
  s_bfe_u32 s26, s20, 0x20003
  s_xor_b32 s26, s26, s20
  s_cmp_ge_u32 s20, 128
  s_cselect_b32 s24, s24, s26
  s_cselect_b32 s25, 5, 1
  s_mul_i32 s24, s20, 6
  s_add_u32 s24, s24, s21
  s_sub_u32 s24, s24, 768
  s_cmp_ge_u32 s20, 128
  s_cselect_b32 s25, 6, 0
  s_cmp_ge_u32 s21, s25
  s_cbranch_scc1 L_zero_17
  s_lshl_b32 s22, s21, 13
  v_and_b32 v46, 63, v0
  v_lshlrev_b32 v44, 4, v46
  v_lshrrev_b32 v45, 4, v46
  v_mul_u32_u24 v40, 6144, v45
  v_lshlrev_b32 v45, 1, v45
  v_and_b32 v41, 15, v46
  v_xor_b32 v45, v45, v41
  v_xor_b32 v41, 8, v45
  v_lshl_add_u32 v41, v41, 4, v40
  v_lshl_add_u32 v40, v45, 4, v40
  s_waitcnt lgkmcnt(0)
  s_mov_b32 s30, 0x600000
  s_mov_b32 s31, 0x20000
  s_add_u32 s32, s4, 0x2b00000
  s_addc_u32 s33, s5, 0
  s_mov_b32 s34, 0x600000
  s_mov_b32 s35, 0x20000
  s_mov_b32 s54, 0x100
  s_mov_b32 s55, 0x20000
  s_mul_i32 s60, s24, 2731
  s_lshr_b32 s60, s60, 16
  s_mul_i32 s61, s60, 24
  s_sub_u32 s61, s24, s61
  s_mul_i32 s62, s60, 196608
  s_lshl_b32 s63, s61, 8
  s_add_u32 s62, s62, s63
  s_add_u32 m0, s22, 0
  s_nop 0
  buffer_load_dwordx4 v40, s[28:31], s62 offen offset:0 nt lds
  s_add_u32 s62, s62, 23552
  buffer_load_dwordx4 v41, s[28:31], s62 offen offset:1024 nt lds
  s_add_u32 s62, s62, 23552
  buffer_load_dwordx4 v40, s[28:31], s62 offen offset:2048 nt lds
  s_add_u32 s62, s62, 23552
  buffer_load_dwordx4 v41, s[28:31], s62 offen offset:3072 nt lds
  s_add_u32 s62, s62, 27648
  s_add_u32 m0, s22, 4096
  s_nop 0
  buffer_load_dwordx4 v40, s[28:31], s62 offen offset:0 nt lds
  s_add_u32 s62, s62, 23552
  buffer_load_dwordx4 v41, s[28:31], s62 offen offset:1024 nt lds
  s_add_u32 s62, s62, 23552
  buffer_load_dwordx4 v40, s[28:31], s62 offen offset:2048 nt lds
  s_add_u32 s62, s62, 23552
  buffer_load_dwordx4 v41, s[28:31], s62 offen offset:3072 nt lds
  s_and_b32 s62, s61, 7
  s_mul_i32 s62, s62, 24
  s_lshr_b32 s63, s61, 3
  s_mul_i32 s64, s63, 6
  s_cmp_eq_u32 s63, 2
  s_cselect_b32 s64, 2, s64
  s_cselect_b32 s65, 3, 1
  s_cselect_b32 s66, 3, 2
  s_cselect_b32 s67, 3, 8
  s_add_u32 s62, s62, s64
  s_lshl_b32 s62, s62, 15
  s_lshl_b32 s63, s60, 10
  s_add_u32 s62, s62, s63
  s_lshl_b32 s65, s65, 15
  s_lshl_b32 s66, s66, 15
  s_lshl_b32 s67, s67, 15
  v_lshrrev_b32 v42, 2, v46
  v_and_b32 v45, 7, v42
  v_lshlrev_b32 v42, 8, v42
  v_lshl_add_u32 v42, v45, 5, v42
  v_and_b32 v45, 3, v46
  v_lshl_add_u32 v42, v45, 3, v42
  v_add_u32 v42, s22, v42
  v_lshrrev_b32 v43, 2, v46
  v_add_u32 v43, 16, v43
  v_and_b32 v45, 7, v43
  v_lshlrev_b32 v43, 8, v43
  v_lshl_add_u32 v43, v45, 5, v43
  v_and_b32 v45, 3, v46
  v_lshl_add_u32 v43, v45, 3, v43
  v_add_u32 v43, s22, v43
  s_waitcnt vmcnt(0)
  ds_read_b64_tr_b16 v[48:49], v42
  ds_read_b64_tr_b16 v[50:51], v43
  v_xor_b32 v45, 32, v42
  ds_read_b64_tr_b16 v[52:53], v45
  v_xor_b32 v45, 32, v43
  ds_read_b64_tr_b16 v[54:55], v45
  v_xor_b32 v45, 64, v42
  ds_read_b64_tr_b16 v[56:57], v45
  v_xor_b32 v45, 64, v43
  ds_read_b64_tr_b16 v[58:59], v45
  v_xor_b32 v45, 96, v42
  ds_read_b64_tr_b16 v[60:61], v45
  v_xor_b32 v45, 96, v43
  ds_read_b64_tr_b16 v[62:63], v45
  s_waitcnt lgkmcnt(4)
  v_xor_b32 v45, 128, v42
  ds_read_b64_tr_b16 v[64:65], v45
  v_xor_b32 v45, 128, v43
  ds_read_b64_tr_b16 v[66:67], v45
  v_xor_b32 v45, 160, v42
  ds_read_b64_tr_b16 v[68:69], v45
  v_xor_b32 v45, 160, v43
  ds_read_b64_tr_b16 v[70:71], v45
  v_xor_b32 v45, 192, v42
  ds_read_b64_tr_b16 v[72:73], v45
  v_xor_b32 v45, 192, v43
  ds_read_b64_tr_b16 v[74:75], v45
  v_xor_b32 v45, 224, v42
  ds_read_b64_tr_b16 v[76:77], v45
  v_xor_b32 v45, 224, v43
  ds_read_b64_tr_b16 v[78:79], v45
  s_waitcnt lgkmcnt(0)
  buffer_store_dwordx4 v[48:51], v44, s[32:35], s62 offen offset:0 sc1
  s_add_u32 s62, s62, s65
  buffer_store_dwordx4 v[52:55], v44, s[32:35], s62 offen offset:0 sc1
  s_add_u32 s62, s62, s66
  buffer_store_dwordx4 v[56:59], v44, s[32:35], s62 offen offset:0 sc1
  s_add_u32 s62, s62, s65
  buffer_store_dwordx4 v[60:63], v44, s[32:35], s62 offen offset:0 sc1
  s_add_u32 s62, s62, s67
  buffer_store_dwordx4 v[64:67], v44, s[32:35], s62 offen offset:0 sc1
  s_add_u32 s62, s62, s65
  buffer_store_dwordx4 v[68:71], v44, s[32:35], s62 offen offset:0 sc1
  s_add_u32 s62, s62, s66
  buffer_store_dwordx4 v[72:75], v44, s[32:35], s62 offen offset:0 sc1
  s_add_u32 s62, s62, s65
  buffer_store_dwordx4 v[76:79], v44, s[32:35], s62 offen offset:0 sc1
  s_endpgm
L_zero_17:
  s_cmp_ge_u32 s20, 128
  s_cbranch_scc1 L_end_1
  s_cmp_ge_u32 s21, 4
  s_cbranch_scc1 L_tlb_18
  s_lshl_b32 s24, s20, 11
  s_lshl_b32 s25, s21, 10
  s_add_u32 s24, s24, s25
  s_add_u32 s24, s24, 786432
  s_lshl_b32 s25, s20, 10
  s_add_u32 s26, s25, 98304
  s_add_u32 s25, s25, 196608
  s_cmp_lt_u32 s20, 32
  s_cselect_b32 s25, s26, s25
  s_cmp_lt_u32 s20, 64
  s_cselect_b32 s25, s25, 0x7fffffff
  s_cmp_eq_u32 s21, 2
  s_cselect_b32 s24, s25, s24
  s_lshl_b32 s25, s20, 10
  s_add_u32 s25, s25, 83886080
  s_cmp_eq_u32 s21, 3
  s_cselect_b32 s24, s25, s24
  v_and_b32 v8, 63, v0
  v_lshlrev_b32 v8, 4, v8
  v_mov_b32 v4, 0
  v_mov_b32 v5, 0
  v_mov_b32 v6, 0
  v_mov_b32 v7, 0
  s_waitcnt lgkmcnt(0)
  s_mov_b32 s6, 84017152
  s_mov_b32 s7, 0x20000
  buffer_store_dwordx4 v[4:7], v8, s[4:7], s24 offen sc1
  s_endpgm
L_tlb_18:
  s_endpgm
L_codepf_16:
  s_lshr_b32 s23, s20, 3
  s_getpc_b64 s[40:41]
L_pc_19:
  s_add_u32 s40, s40, qkv_kernel-L_pc_19
  s_addc_u32 s41, s41, 0
  s_mov_b32 s42, L_code_end-qkv_kernel
  s_mov_b32 s43, 0x20000
  s_lshl_b32 s44, s23, 12
  v_and_b32 v20, 31, v0
  v_lshlrev_b32 v20, 7, v20
  buffer_load_dword v21, v20, s[40:43], s44 offen
L_end_1:
  s_endpgm
.text
.globl qkv_kernel
.p2align 8
.type qkv_kernel,@function
qkv_kernel:
  s_cmp_ge_u32 s2, 256
  s_cbranch_scc1 L_end_20
  s_load_dwordx2 s[4:5], s[0:1], 88
  v_lshrrev_b32 v1, 6, v0
  v_and_b32 v0, 63, v0
  v_readfirstlane_b32 s20, v1
  s_and_b32 s23, s2, 7
  s_lshr_b32 s24, s2, 3
  v_lshlrev_b32 v2, 4, v0
  v_add_u32 v3, 65536, v2
  v_mov_b32 v4, v2
  v_add_u32 v5, 4096, v2
  s_and_b32 s21, s23, 1
  s_lshl_b32 s21, s21, 3
  s_and_b32 s25, s24, 7
  s_add_u32 s21, s21, s25
  s_lshr_b32 s22, s23, 1
  s_lshl_b32 s22, s22, 2
  s_lshr_b32 s25, s24, 3
  s_add_u32 s22, s22, s25
  s_lshl_b32 s25, s22, 2
  s_add_u32 s26, s25, s20
  s_mul_i32 s26, s26, 3
  v_add_u32 v8, 0, v2
  v_add_u32 v9, 32768, v2
  v_add_u32 v10, 65536, v2
  s_mul_i32 s18, s20, 4096
  s_mul_i32 s16, s21, 262144
  s_add_u32 s16, s16, s18
  s_mul_i32 s25, s26, 32768
  s_add_u32 s25, s25, 45088768
  s_mov_b32 s17, 0
  s_waitcnt lgkmcnt(0)
  s_add_u32 s8, s4, 0x100000
  s_addc_u32 s9, s5, 0
  s_mov_b32 s10, 0x400000
  s_mov_b32 s11, 0x20000
  s_add_u32 s12, s4, s25
  s_addc_u32 s13, s5, 0
  s_mov_b32 s14, 0x18000
  s_mov_b32 s15, 0x20000
  s_add_u32 m0, s18, 0
  s_nop 0
  buffer_load_dwordx4 v4, s[8:11], s16 offen offset:0  lds
  buffer_load_dwordx4 v4, s[8:11], s16 offen offset:1024  lds
  buffer_load_dwordx4 v4, s[8:11], s16 offen offset:2048  lds
  buffer_load_dwordx4 v4, s[8:11], s16 offen offset:3072  lds
  s_add_u32 s16, s16, 16384
  buffer_load_dwordx4 a[0:3], v8, s[12:15], s17 offen offset:0
  buffer_load_dwordx4 a[4:7], v9, s[12:15], s17 offen offset:0
  buffer_load_dwordx4 a[8:11], v10, s[12:15], s17 offen offset:0
  buffer_load_dwordx4 a[12:15], v8, s[12:15], s17 offen offset:1024
  buffer_load_dwordx4 a[16:19], v9, s[12:15], s17 offen offset:1024
  buffer_load_dwordx4 a[20:23], v10, s[12:15], s17 offen offset:1024
  s_add_u32 s17, s17, 2048
  s_add_u32 m0, s18, 16384
  s_nop 0
  buffer_load_dwordx4 v4, s[8:11], s16 offen offset:0  lds
  buffer_load_dwordx4 v4, s[8:11], s16 offen offset:1024  lds
  buffer_load_dwordx4 v4, s[8:11], s16 offen offset:2048  lds
  buffer_load_dwordx4 v4, s[8:11], s16 offen offset:3072  lds
  s_add_u32 s16, s16, 16384
  buffer_load_dwordx4 a[24:27], v8, s[12:15], s17 offen offset:0
  buffer_load_dwordx4 a[28:31], v9, s[12:15], s17 offen offset:0
  buffer_load_dwordx4 a[32:35], v10, s[12:15], s17 offen offset:0
  buffer_load_dwordx4 a[36:39], v8, s[12:15], s17 offen offset:1024
  buffer_load_dwordx4 a[40:43], v9, s[12:15], s17 offen offset:1024
  buffer_load_dwordx4 a[44:47], v10, s[12:15], s17 offen offset:1024
  s_add_u32 s17, s17, 2048
  s_add_u32 s28, s4, 0x500000
  s_addc_u32 s29, s5, 0
  s_mov_b32 s30, 0xc00000
  s_mov_b32 s31, 0x20000
  v_lshrrev_b32 v24, 4, v0
  v_and_b32 v25, 15, v0
  v_lshlrev_b32 v26, 9, v24
  v_lshl_add_u32 v27, v25, 4, v26
  v_and_b32 v28, 1, v24
  v_lshlrev_b32 v28, 10, v28
  v_lshrrev_b32 v29, 1, v24
  v_lshl_add_u32 v28, v29, 9, v28
  v_lshl_add_u32 v28, v25, 4, v28
  s_lshl_b32 s25, s22, 7
  s_lshl_b32 s27, s21, 2
  s_add_u32 s25, s25, s27
  s_and_b32 s27, s20, 1
  s_lshl_b32 s36, s27, 6
  s_add_u32 s36, s36, s25
  s_lshr_b32 s37, s20, 1
  s_lshl_b32 s38, s37, 6
  s_add_u32 s38, s38, s25
  s_lshl_b32 s38, s38, 12
  s_lshl_b32 s27, s27, 8
  s_add_u32 s38, s38, s27
  s_add_u32 s38, s38, 4196352
  s_add_u32 s39, s37, 11
  s_lshl_b32 s36, s36, s39
  s_lshl_b32 s39, 1, s39
  s_mov_b32 s41, 0x3e8293ee
  s_cmp_eq_u32 s37, 0
  s_cselect_b32 s40, s41, 1.0
  s_cselect_b32 s41, 0, 4194304
  s_add_u32 s36, s36, s41
  s_waitcnt vmcnt(10) lgkmcnt(0)
  s_barrier
  ds_read_b128 a[96:99], v2 offset:0
  s_add_u32 m0, s18, 32768
  s_nop 0
  buffer_load_dwordx4 v4, s[8:11], s16 offen offset:0  lds
  ds_read_b128 a[100:103], v2 offset:1024
  buffer_load_dwordx4 v4, s[8:11], s16 offen offset:1024  lds
  ds_read_b128 a[104:107], v2 offset:2048
  buffer_load_dwordx4 v4, s[8:11], s16 offen offset:2048  lds
  ds_read_b128 a[108:111], v2 offset:3072
  buffer_load_dwordx4 v4, s[8:11], s16 offen offset:3072  lds
  s_add_u32 s16, s16, 16384
  s_waitcnt lgkmcnt(2)
  v_mfma_f32_16x16x32_bf16 v[32:35], a[0:3], a[96:99], 0
  ds_read_b128 a[112:115], v2 offset:4096
  v_mfma_f32_16x16x32_bf16 v[36:39], a[4:7], a[96:99], 0
  buffer_load_dwordx4 a[48:51], v8, s[12:15], s17 offen offset:0
  v_mfma_f32_16x16x32_bf16 v[40:43], a[96:99], a[8:11], 0
  v_mfma_f32_16x16x32_bf16 v[44:47], a[0:3], a[100:103], 0
  ds_read_b128 a[116:119], v2 offset:5120
  buffer_load_dwordx4 a[52:55], v9, s[12:15], s17 offen offset:0
  v_mfma_f32_16x16x32_bf16 v[48:51], a[4:7], a[100:103], 0
  v_mfma_f32_16x16x32_bf16 v[52:55], a[100:103], a[8:11], 0
  ds_read_b128 a[120:123], v2 offset:6144
  buffer_load_dwordx4 a[56:59], v10, s[12:15], s17 offen offset:0
  s_waitcnt lgkmcnt(2)
  v_mfma_f32_16x16x32_bf16 v[56:59], a[0:3], a[104:107], 0
  v_mfma_f32_16x16x32_bf16 v[60:63], a[4:7], a[104:107], 0
  v_mfma_f32_16x16x32_bf16 v[64:67], a[104:107], a[8:11], 0
  ds_read_b128 a[124:127], v2 offset:7168
  buffer_load_dwordx4 a[60:63], v8, s[12:15], s17 offen offset:1024
  v_mfma_f32_16x16x32_bf16 v[68:71], a[0:3], a[108:111], 0
  v_mfma_f32_16x16x32_bf16 v[72:75], a[4:7], a[108:111], 0
  ds_read_b128 a[96:99], v2 offset:8192
  buffer_load_dwordx4 a[64:67], v9, s[12:15], s17 offen offset:1024
  v_mfma_f32_16x16x32_bf16 v[76:79], a[108:111], a[8:11], 0
  v_mfma_f32_16x16x32_bf16 v[80:83], a[0:3], a[112:115], 0
  ds_read_b128 a[100:103], v2 offset:9216
  buffer_load_dwordx4 a[68:71], v10, s[12:15], s17 offen offset:1024
  s_add_u32 s17, s17, 2048
  v_mfma_f32_16x16x32_bf16 v[84:87], a[4:7], a[112:115], 0
  v_mfma_f32_16x16x32_bf16 v[88:91], a[112:115], a[8:11], 0
  s_add_u32 m0, s18, 49152
  s_waitcnt lgkmcnt(2)
  v_mfma_f32_16x16x32_bf16 v[92:95], a[0:3], a[116:119], 0
  ds_read_b128 a[104:107], v2 offset:10240
  buffer_load_dwordx4 v4, s[8:11], s16 offen offset:0  lds
  v_mfma_f32_16x16x32_bf16 v[96:99], a[4:7], a[116:119], 0
  v_mfma_f32_16x16x32_bf16 v[100:103], a[116:119], a[8:11], 0
  ds_read_b128 a[108:111], v2 offset:11264
  buffer_load_dwordx4 v4, s[8:11], s16 offen offset:1024  lds
  v_mfma_f32_16x16x32_bf16 v[104:107], a[0:3], a[120:123], 0
  v_mfma_f32_16x16x32_bf16 v[108:111], a[4:7], a[120:123], 0
  buffer_load_dwordx4 v4, s[8:11], s16 offen offset:2048  lds
  v_mfma_f32_16x16x32_bf16 v[112:115], a[120:123], a[8:11], 0
  ds_read_b128 a[112:115], v2 offset:12288
  v_mfma_f32_16x16x32_bf16 v[116:119], a[0:3], a[124:127], 0
  v_mfma_f32_16x16x32_bf16 v[120:123], a[4:7], a[124:127], 0
  ds_read_b128 a[116:119], v2 offset:13312
  buffer_load_dwordx4 v4, s[8:11], s16 offen offset:3072  lds
  s_add_u32 s16, s16, 16384
  v_mfma_f32_16x16x32_bf16 v[124:127], a[124:127], a[8:11], 0
  s_waitcnt lgkmcnt(2)
  v_mfma_f32_16x16x32_bf16 v[32:35], a[12:15], a[96:99], v[32:35]
  buffer_load_dwordx4 a[72:75], v8, s[12:15], s17 offen offset:0
  v_mfma_f32_16x16x32_bf16 v[36:39], a[16:19], a[96:99], v[36:39]
  ds_read_b128 a[120:123], v2 offset:14336
  v_mfma_f32_16x16x32_bf16 v[40:43], a[96:99], a[20:23], v[40:43]
  buffer_load_dwordx4 a[76:79], v9, s[12:15], s17 offen offset:0
  v_mfma_f32_16x16x32_bf16 v[44:47], a[12:15], a[100:103], v[44:47]
  ds_read_b128 a[124:127], v2 offset:15360
  v_mfma_f32_16x16x32_bf16 v[48:51], a[16:19], a[100:103], v[48:51]
  buffer_load_dwordx4 a[80:83], v10, s[12:15], s17 offen offset:0
  v_mfma_f32_16x16x32_bf16 v[52:55], a[100:103], a[20:23], v[52:55]
  v_mfma_f32_16x16x32_bf16 v[56:59], a[12:15], a[104:107], v[56:59]
  v_mfma_f32_16x16x32_bf16 v[60:63], a[16:19], a[104:107], v[60:63]
  buffer_load_dwordx4 a[84:87], v8, s[12:15], s17 offen offset:1024
  v_mfma_f32_16x16x32_bf16 v[64:67], a[104:107], a[20:23], v[64:67]
  v_mfma_f32_16x16x32_bf16 v[68:71], a[12:15], a[108:111], v[68:71]
  buffer_load_dwordx4 a[88:91], v9, s[12:15], s17 offen offset:1024
  v_mfma_f32_16x16x32_bf16 v[72:75], a[16:19], a[108:111], v[72:75]
  v_mfma_f32_16x16x32_bf16 v[76:79], a[108:111], a[20:23], v[76:79]
  buffer_load_dwordx4 a[92:95], v10, s[12:15], s17 offen offset:1024
  s_add_u32 s17, s17, 2048
  s_waitcnt lgkmcnt(0)
  v_mfma_f32_16x16x32_bf16 v[80:83], a[12:15], a[112:115], v[80:83]
  v_mfma_f32_16x16x32_bf16 v[84:87], a[16:19], a[112:115], v[84:87]
  v_mfma_f32_16x16x32_bf16 v[88:91], a[112:115], a[20:23], v[88:91]
  s_waitcnt vmcnt(20) lgkmcnt(0)
  s_barrier
  v_mfma_f32_16x16x32_bf16 v[92:95], a[12:15], a[116:119], v[92:95]
  ds_read_b128 a[96:99], v2 offset:16384
  v_mfma_f32_16x16x32_bf16 v[96:99], a[16:19], a[116:119], v[96:99]
  s_add_u32 m0, s18, 0
  v_mfma_f32_16x16x32_bf16 v[100:103], a[116:119], a[20:23], v[100:103]
  ds_read_b128 a[100:103], v2 offset:17408
  buffer_load_dwordx4 v4, s[8:11], s16 offen offset:0  lds
  v_mfma_f32_16x16x32_bf16 v[104:107], a[12:15], a[120:123], v[104:107]
  v_mfma_f32_16x16x32_bf16 v[108:111], a[16:19], a[120:123], v[108:111]
  ds_read_b128 a[104:107], v2 offset:18432
  v_mfma_f32_16x16x32_bf16 v[112:115], a[120:123], a[20:23], v[112:115]
  v_mfma_f32_16x16x32_bf16 v[116:119], a[12:15], a[124:127], v[116:119]
  buffer_load_dwordx4 v4, s[8:11], s16 offen offset:1024  lds
  v_mfma_f32_16x16x32_bf16 v[120:123], a[16:19], a[124:127], v[120:123]
  ds_read_b128 a[108:111], v2 offset:19456
  v_mfma_f32_16x16x32_bf16 v[124:127], a[124:127], a[20:23], v[124:127]
  s_waitcnt lgkmcnt(2)
  v_mfma_f32_16x16x32_bf16 v[32:35], a[24:27], a[96:99], v[32:35]
  ds_read_b128 a[112:115], v2 offset:20480
  v_mfma_f32_16x16x32_bf16 v[36:39], a[28:31], a[96:99], v[36:39]
  v_mfma_f32_16x16x32_bf16 v[40:43], a[96:99], a[32:35], v[40:43]
  buffer_load_dwordx4 v4, s[8:11], s16 offen offset:2048  lds
  v_mfma_f32_16x16x32_bf16 v[44:47], a[24:27], a[100:103], v[44:47]
  ds_read_b128 a[116:119], v2 offset:21504
  v_mfma_f32_16x16x32_bf16 v[48:51], a[28:31], a[100:103], v[48:51]
  v_mfma_f32_16x16x32_bf16 v[52:55], a[100:103], a[32:35], v[52:55]
  ds_read_b128 a[120:123], v2 offset:22528
  s_waitcnt lgkmcnt(2)
  v_mfma_f32_16x16x32_bf16 v[56:59], a[24:27], a[104:107], v[56:59]
  v_mfma_f32_16x16x32_bf16 v[60:63], a[28:31], a[104:107], v[60:63]
  buffer_load_dwordx4 v4, s[8:11], s16 offen offset:3072  lds
  s_add_u32 s16, s16, 16384
  v_mfma_f32_16x16x32_bf16 v[64:67], a[104:107], a[32:35], v[64:67]
  ds_read_b128 a[124:127], v2 offset:23552
  v_mfma_f32_16x16x32_bf16 v[68:71], a[24:27], a[108:111], v[68:71]
  v_mfma_f32_16x16x32_bf16 v[72:75], a[28:31], a[108:111], v[72:75]
  ds_read_b128 a[96:99], v2 offset:24576
  v_mfma_f32_16x16x32_bf16 v[76:79], a[108:111], a[32:35], v[76:79]
  buffer_load_dwordx4 a[0:3], v8, s[12:15], s17 offen offset:0
  v_mfma_f32_16x16x32_bf16 v[80:83], a[24:27], a[112:115], v[80:83]
  ds_read_b128 a[100:103], v2 offset:25600
  v_mfma_f32_16x16x32_bf16 v[84:87], a[28:31], a[112:115], v[84:87]
  v_mfma_f32_16x16x32_bf16 v[88:91], a[112:115], a[32:35], v[88:91]
  s_waitcnt lgkmcnt(2)
  v_mfma_f32_16x16x32_bf16 v[92:95], a[24:27], a[116:119], v[92:95]
  ds_read_b128 a[104:107], v2 offset:26624
  v_mfma_f32_16x16x32_bf16 v[96:99], a[28:31], a[116:119], v[96:99]
  buffer_load_dwordx4 a[4:7], v9, s[12:15], s17 offen offset:0
  v_mfma_f32_16x16x32_bf16 v[100:103], a[116:119], a[32:35], v[100:103]
  ds_read_b128 a[108:111], v2 offset:27648
  v_mfma_f32_16x16x32_bf16 v[104:107], a[24:27], a[120:123], v[104:107]
  v_mfma_f32_16x16x32_bf16 v[108:111], a[28:31], a[120:123], v[108:111]
  v_mfma_f32_16x16x32_bf16 v[112:115], a[120:123], a[32:35], v[112:115]
  ds_read_b128 a[112:115], v2 offset:28672
  buffer_load_dwordx4 a[8:11], v10, s[12:15], s17 offen offset:0
  v_mfma_f32_16x16x32_bf16 v[116:119], a[24:27], a[124:127], v[116:119]
  v_mfma_f32_16x16x32_bf16 v[120:123], a[28:31], a[124:127], v[120:123]
  ds_read_b128 a[116:119], v2 offset:29696
  v_mfma_f32_16x16x32_bf16 v[124:127], a[124:127], a[32:35], v[124:127]
  s_waitcnt lgkmcnt(2)
  v_mfma_f32_16x16x32_bf16 v[32:35], a[36:39], a[96:99], v[32:35]
  v_mfma_f32_16x16x32_bf16 v[36:39], a[40:43], a[96:99], v[36:39]
  ds_read_b128 a[120:123], v2 offset:30720
  buffer_load_dwordx4 a[12:15], v8, s[12:15], s17 offen offset:1024
  v_mfma_f32_16x16x32_bf16 v[40:43], a[96:99], a[44:47], v[40:43]
  v_mfma_f32_16x16x32_bf16 v[44:47], a[36:39], a[100:103], v[44:47]
  ds_read_b128 a[124:127], v2 offset:31744
  v_mfma_f32_16x16x32_bf16 v[48:51], a[40:43], a[100:103], v[48:51]
  v_mfma_f32_16x16x32_bf16 v[52:55], a[100:103], a[44:47], v[52:55]
  v_mfma_f32_16x16x32_bf16 v[56:59], a[36:39], a[104:107], v[56:59]
  buffer_load_dwordx4 a[16:19], v9, s[12:15], s17 offen offset:1024
  v_mfma_f32_16x16x32_bf16 v[60:63], a[40:43], a[104:107], v[60:63]
  v_mfma_f32_16x16x32_bf16 v[64:67], a[104:107], a[44:47], v[64:67]
  v_mfma_f32_16x16x32_bf16 v[68:71], a[36:39], a[108:111], v[68:71]
  v_mfma_f32_16x16x32_bf16 v[72:75], a[40:43], a[108:111], v[72:75]
  buffer_load_dwordx4 a[20:23], v10, s[12:15], s17 offen offset:1024
  s_add_u32 s17, s17, 2048
  v_mfma_f32_16x16x32_bf16 v[76:79], a[108:111], a[44:47], v[76:79]
  s_waitcnt lgkmcnt(0)
  v_mfma_f32_16x16x32_bf16 v[80:83], a[36:39], a[112:115], v[80:83]
  v_mfma_f32_16x16x32_bf16 v[84:87], a[40:43], a[112:115], v[84:87]
  v_mfma_f32_16x16x32_bf16 v[88:91], a[112:115], a[44:47], v[88:91]
  s_waitcnt vmcnt(20) lgkmcnt(0)
  s_barrier
  v_mfma_f32_16x16x32_bf16 v[92:95], a[36:39], a[116:119], v[92:95]
  ds_read_b128 a[96:99], v2 offset:32768
  v_mfma_f32_16x16x32_bf16 v[96:99], a[40:43], a[116:119], v[96:99]
  s_add_u32 m0, s18, 16384
  v_mfma_f32_16x16x32_bf16 v[100:103], a[116:119], a[44:47], v[100:103]
  ds_read_b128 a[100:103], v2 offset:33792
  buffer_load_dwordx4 v4, s[8:11], s16 offen offset:0  lds
  v_mfma_f32_16x16x32_bf16 v[104:107], a[36:39], a[120:123], v[104:107]
  v_mfma_f32_16x16x32_bf16 v[108:111], a[40:43], a[120:123], v[108:111]
  ds_read_b128 a[104:107], v2 offset:34816
  v_mfma_f32_16x16x32_bf16 v[112:115], a[120:123], a[44:47], v[112:115]
  v_mfma_f32_16x16x32_bf16 v[116:119], a[36:39], a[124:127], v[116:119]
  buffer_load_dwordx4 v4, s[8:11], s16 offen offset:1024  lds
  v_mfma_f32_16x16x32_bf16 v[120:123], a[40:43], a[124:127], v[120:123]
  ds_read_b128 a[108:111], v2 offset:35840
  v_mfma_f32_16x16x32_bf16 v[124:127], a[124:127], a[44:47], v[124:127]
  s_waitcnt lgkmcnt(2)
  v_mfma_f32_16x16x32_bf16 v[32:35], a[48:51], a[96:99], v[32:35]
  ds_read_b128 a[112:115], v2 offset:36864
  v_mfma_f32_16x16x32_bf16 v[36:39], a[52:55], a[96:99], v[36:39]
  v_mfma_f32_16x16x32_bf16 v[40:43], a[96:99], a[56:59], v[40:43]
  buffer_load_dwordx4 v4, s[8:11], s16 offen offset:2048  lds
  v_mfma_f32_16x16x32_bf16 v[44:47], a[48:51], a[100:103], v[44:47]
  ds_read_b128 a[116:119], v2 offset:37888
  v_mfma_f32_16x16x32_bf16 v[48:51], a[52:55], a[100:103], v[48:51]
  v_mfma_f32_16x16x32_bf16 v[52:55], a[100:103], a[56:59], v[52:55]
  ds_read_b128 a[120:123], v2 offset:38912
  s_waitcnt lgkmcnt(2)
  v_mfma_f32_16x16x32_bf16 v[56:59], a[48:51], a[104:107], v[56:59]
  v_mfma_f32_16x16x32_bf16 v[60:63], a[52:55], a[104:107], v[60:63]
  buffer_load_dwordx4 v4, s[8:11], s16 offen offset:3072  lds
  s_add_u32 s16, s16, 16384
  v_mfma_f32_16x16x32_bf16 v[64:67], a[104:107], a[56:59], v[64:67]
  ds_read_b128 a[124:127], v2 offset:39936
  v_mfma_f32_16x16x32_bf16 v[68:71], a[48:51], a[108:111], v[68:71]
  v_mfma_f32_16x16x32_bf16 v[72:75], a[52:55], a[108:111], v[72:75]
  ds_read_b128 a[96:99], v2 offset:40960
  v_mfma_f32_16x16x32_bf16 v[76:79], a[108:111], a[56:59], v[76:79]
  buffer_load_dwordx4 a[24:27], v8, s[12:15], s17 offen offset:0
  v_mfma_f32_16x16x32_bf16 v[80:83], a[48:51], a[112:115], v[80:83]
  ds_read_b128 a[100:103], v2 offset:41984
  v_mfma_f32_16x16x32_bf16 v[84:87], a[52:55], a[112:115], v[84:87]
  v_mfma_f32_16x16x32_bf16 v[88:91], a[112:115], a[56:59], v[88:91]
  s_waitcnt lgkmcnt(2)
  v_mfma_f32_16x16x32_bf16 v[92:95], a[48:51], a[116:119], v[92:95]
  ds_read_b128 a[104:107], v2 offset:43008
  v_mfma_f32_16x16x32_bf16 v[96:99], a[52:55], a[116:119], v[96:99]
  buffer_load_dwordx4 a[28:31], v9, s[12:15], s17 offen offset:0
  v_mfma_f32_16x16x32_bf16 v[100:103], a[116:119], a[56:59], v[100:103]
  ds_read_b128 a[108:111], v2 offset:44032
  v_mfma_f32_16x16x32_bf16 v[104:107], a[48:51], a[120:123], v[104:107]
  v_mfma_f32_16x16x32_bf16 v[108:111], a[52:55], a[120:123], v[108:111]
  v_mfma_f32_16x16x32_bf16 v[112:115], a[120:123], a[56:59], v[112:115]
  ds_read_b128 a[112:115], v2 offset:45056
  buffer_load_dwordx4 a[32:35], v10, s[12:15], s17 offen offset:0
  v_mfma_f32_16x16x32_bf16 v[116:119], a[48:51], a[124:127], v[116:119]
  v_mfma_f32_16x16x32_bf16 v[120:123], a[52:55], a[124:127], v[120:123]
  ds_read_b128 a[116:119], v2 offset:46080
  v_mfma_f32_16x16x32_bf16 v[124:127], a[124:127], a[56:59], v[124:127]
  s_waitcnt lgkmcnt(2)
  v_mfma_f32_16x16x32_bf16 v[32:35], a[60:63], a[96:99], v[32:35]
  v_mfma_f32_16x16x32_bf16 v[36:39], a[64:67], a[96:99], v[36:39]
  ds_read_b128 a[120:123], v2 offset:47104
  buffer_load_dwordx4 a[36:39], v8, s[12:15], s17 offen offset:1024
  v_mfma_f32_16x16x32_bf16 v[40:43], a[96:99], a[68:71], v[40:43]
  v_mfma_f32_16x16x32_bf16 v[44:47], a[60:63], a[100:103], v[44:47]
  ds_read_b128 a[124:127], v2 offset:48128
  v_mfma_f32_16x16x32_bf16 v[48:51], a[64:67], a[100:103], v[48:51]
  v_mfma_f32_16x16x32_bf16 v[52:55], a[100:103], a[68:71], v[52:55]
  v_mfma_f32_16x16x32_bf16 v[56:59], a[60:63], a[104:107], v[56:59]
  buffer_load_dwordx4 a[40:43], v9, s[12:15], s17 offen offset:1024
  v_mfma_f32_16x16x32_bf16 v[60:63], a[64:67], a[104:107], v[60:63]
  v_mfma_f32_16x16x32_bf16 v[64:67], a[104:107], a[68:71], v[64:67]
  v_mfma_f32_16x16x32_bf16 v[68:71], a[60:63], a[108:111], v[68:71]
  v_mfma_f32_16x16x32_bf16 v[72:75], a[64:67], a[108:111], v[72:75]
  buffer_load_dwordx4 a[44:47], v10, s[12:15], s17 offen offset:1024
  s_add_u32 s17, s17, 2048
  v_mfma_f32_16x16x32_bf16 v[76:79], a[108:111], a[68:71], v[76:79]
  s_waitcnt lgkmcnt(0)
  v_mfma_f32_16x16x32_bf16 v[80:83], a[60:63], a[112:115], v[80:83]
  v_mfma_f32_16x16x32_bf16 v[84:87], a[64:67], a[112:115], v[84:87]
  v_mfma_f32_16x16x32_bf16 v[88:91], a[112:115], a[68:71], v[88:91]
  s_waitcnt vmcnt(20) lgkmcnt(0)
  s_barrier
  v_mfma_f32_16x16x32_bf16 v[92:95], a[60:63], a[116:119], v[92:95]
  ds_read_b128 a[96:99], v2 offset:49152
  v_mfma_f32_16x16x32_bf16 v[96:99], a[64:67], a[116:119], v[96:99]
  s_add_u32 m0, s18, 32768
  v_mfma_f32_16x16x32_bf16 v[100:103], a[116:119], a[68:71], v[100:103]
  ds_read_b128 a[100:103], v2 offset:50176
  buffer_load_dwordx4 v4, s[8:11], s16 offen offset:0  lds
  v_mfma_f32_16x16x32_bf16 v[104:107], a[60:63], a[120:123], v[104:107]
  v_mfma_f32_16x16x32_bf16 v[108:111], a[64:67], a[120:123], v[108:111]
  ds_read_b128 a[104:107], v2 offset:51200
  v_mfma_f32_16x16x32_bf16 v[112:115], a[120:123], a[68:71], v[112:115]
  v_mfma_f32_16x16x32_bf16 v[116:119], a[60:63], a[124:127], v[116:119]
  buffer_load_dwordx4 v4, s[8:11], s16 offen offset:1024  lds
  v_mfma_f32_16x16x32_bf16 v[120:123], a[64:67], a[124:127], v[120:123]
  ds_read_b128 a[108:111], v2 offset:52224
  v_mfma_f32_16x16x32_bf16 v[124:127], a[124:127], a[68:71], v[124:127]
  s_waitcnt lgkmcnt(2)
  v_mfma_f32_16x16x32_bf16 v[32:35], a[72:75], a[96:99], v[32:35]
  ds_read_b128 a[112:115], v2 offset:53248
  v_mfma_f32_16x16x32_bf16 v[36:39], a[76:79], a[96:99], v[36:39]
  v_mfma_f32_16x16x32_bf16 v[40:43], a[96:99], a[80:83], v[40:43]
  buffer_load_dwordx4 v4, s[8:11], s16 offen offset:2048  lds
  v_mfma_f32_16x16x32_bf16 v[44:47], a[72:75], a[100:103], v[44:47]
  ds_read_b128 a[116:119], v2 offset:54272
  v_mfma_f32_16x16x32_bf16 v[48:51], a[76:79], a[100:103], v[48:51]
  v_mfma_f32_16x16x32_bf16 v[52:55], a[100:103], a[80:83], v[52:55]
  ds_read_b128 a[120:123], v2 offset:55296
  s_waitcnt lgkmcnt(2)
  v_mfma_f32_16x16x32_bf16 v[56:59], a[72:75], a[104:107], v[56:59]
  v_mfma_f32_16x16x32_bf16 v[60:63], a[76:79], a[104:107], v[60:63]
  buffer_load_dwordx4 v4, s[8:11], s16 offen offset:3072  lds
  s_add_u32 s16, s16, 16384
  v_mfma_f32_16x16x32_bf16 v[64:67], a[104:107], a[80:83], v[64:67]
  ds_read_b128 a[124:127], v2 offset:56320
  v_mfma_f32_16x16x32_bf16 v[68:71], a[72:75], a[108:111], v[68:71]
  v_mfma_f32_16x16x32_bf16 v[72:75], a[76:79], a[108:111], v[72:75]
  ds_read_b128 a[96:99], v2 offset:57344
  v_mfma_f32_16x16x32_bf16 v[76:79], a[108:111], a[80:83], v[76:79]
  buffer_load_dwordx4 a[48:51], v8, s[12:15], s17 offen offset:0
  v_mfma_f32_16x16x32_bf16 v[80:83], a[72:75], a[112:115], v[80:83]
  ds_read_b128 a[100:103], v2 offset:58368
  v_mfma_f32_16x16x32_bf16 v[84:87], a[76:79], a[112:115], v[84:87]
  v_mfma_f32_16x16x32_bf16 v[88:91], a[112:115], a[80:83], v[88:91]
  s_waitcnt lgkmcnt(2)
  v_mfma_f32_16x16x32_bf16 v[92:95], a[72:75], a[116:119], v[92:95]
  ds_read_b128 a[104:107], v2 offset:59392
  v_mfma_f32_16x16x32_bf16 v[96:99], a[76:79], a[116:119], v[96:99]
  buffer_load_dwordx4 a[52:55], v9, s[12:15], s17 offen offset:0
  v_mfma_f32_16x16x32_bf16 v[100:103], a[116:119], a[80:83], v[100:103]
  ds_read_b128 a[108:111], v2 offset:60416
  v_mfma_f32_16x16x32_bf16 v[104:107], a[72:75], a[120:123], v[104:107]
  v_mfma_f32_16x16x32_bf16 v[108:111], a[76:79], a[120:123], v[108:111]
  v_mfma_f32_16x16x32_bf16 v[112:115], a[120:123], a[80:83], v[112:115]
  ds_read_b128 a[112:115], v2 offset:61440
  buffer_load_dwordx4 a[56:59], v10, s[12:15], s17 offen offset:0
  v_mfma_f32_16x16x32_bf16 v[116:119], a[72:75], a[124:127], v[116:119]
  v_mfma_f32_16x16x32_bf16 v[120:123], a[76:79], a[124:127], v[120:123]
  ds_read_b128 a[116:119], v2 offset:62464
  v_mfma_f32_16x16x32_bf16 v[124:127], a[124:127], a[80:83], v[124:127]
  s_waitcnt lgkmcnt(2)
  v_mfma_f32_16x16x32_bf16 v[32:35], a[84:87], a[96:99], v[32:35]
  v_mfma_f32_16x16x32_bf16 v[36:39], a[88:91], a[96:99], v[36:39]
  ds_read_b128 a[120:123], v2 offset:63488
  buffer_load_dwordx4 a[60:63], v8, s[12:15], s17 offen offset:1024
  v_mfma_f32_16x16x32_bf16 v[40:43], a[96:99], a[92:95], v[40:43]
  v_mfma_f32_16x16x32_bf16 v[44:47], a[84:87], a[100:103], v[44:47]
  ds_read_b128 a[124:127], v2 offset:64512
  v_mfma_f32_16x16x32_bf16 v[48:51], a[88:91], a[100:103], v[48:51]
  v_mfma_f32_16x16x32_bf16 v[52:55], a[100:103], a[92:95], v[52:55]
  v_mfma_f32_16x16x32_bf16 v[56:59], a[84:87], a[104:107], v[56:59]
  buffer_load_dwordx4 a[64:67], v9, s[12:15], s17 offen offset:1024
  v_mfma_f32_16x16x32_bf16 v[60:63], a[88:91], a[104:107], v[60:63]
  v_mfma_f32_16x16x32_bf16 v[64:67], a[104:107], a[92:95], v[64:67]
  v_mfma_f32_16x16x32_bf16 v[68:71], a[84:87], a[108:111], v[68:71]
  v_mfma_f32_16x16x32_bf16 v[72:75], a[88:91], a[108:111], v[72:75]
  buffer_load_dwordx4 a[68:71], v10, s[12:15], s17 offen offset:1024
  s_add_u32 s17, s17, 2048
  v_mfma_f32_16x16x32_bf16 v[76:79], a[108:111], a[92:95], v[76:79]
  s_waitcnt lgkmcnt(0)
  v_mfma_f32_16x16x32_bf16 v[80:83], a[84:87], a[112:115], v[80:83]
  v_mfma_f32_16x16x32_bf16 v[84:87], a[88:91], a[112:115], v[84:87]
  v_mfma_f32_16x16x32_bf16 v[88:91], a[112:115], a[92:95], v[88:91]
  s_waitcnt vmcnt(20) lgkmcnt(0)
  s_barrier
  v_mfma_f32_16x16x32_bf16 v[92:95], a[84:87], a[116:119], v[92:95]
  ds_read_b128 a[96:99], v2 offset:0
  v_mfma_f32_16x16x32_bf16 v[96:99], a[88:91], a[116:119], v[96:99]
  s_add_u32 m0, s18, 49152
  v_mfma_f32_16x16x32_bf16 v[100:103], a[116:119], a[92:95], v[100:103]
  ds_read_b128 a[100:103], v2 offset:1024
  buffer_load_dwordx4 v4, s[8:11], s16 offen offset:0  lds
  v_mfma_f32_16x16x32_bf16 v[104:107], a[84:87], a[120:123], v[104:107]
  v_mfma_f32_16x16x32_bf16 v[108:111], a[88:91], a[120:123], v[108:111]
  ds_read_b128 a[104:107], v2 offset:2048
  v_mfma_f32_16x16x32_bf16 v[112:115], a[120:123], a[92:95], v[112:115]
  v_mfma_f32_16x16x32_bf16 v[116:119], a[84:87], a[124:127], v[116:119]
  buffer_load_dwordx4 v4, s[8:11], s16 offen offset:1024  lds
  v_mfma_f32_16x16x32_bf16 v[120:123], a[88:91], a[124:127], v[120:123]
  ds_read_b128 a[108:111], v2 offset:3072
  v_mfma_f32_16x16x32_bf16 v[124:127], a[124:127], a[92:95], v[124:127]
  s_mov_b32 s19, 2
.p2align 4
L_gemm_21:
  s_waitcnt lgkmcnt(2)
  v_mfma_f32_16x16x32_bf16 v[32:35], a[0:3], a[96:99], v[32:35]
  ds_read_b128 a[112:115], v2 offset:4096
  v_mfma_f32_16x16x32_bf16 v[36:39], a[4:7], a[96:99], v[36:39]
  v_mfma_f32_16x16x32_bf16 v[40:43], a[96:99], a[8:11], v[40:43]
  buffer_load_dwordx4 v4, s[8:11], s16 offen offset:2048  lds
  v_mfma_f32_16x16x32_bf16 v[44:47], a[0:3], a[100:103], v[44:47]
  ds_read_b128 a[116:119], v2 offset:5120
  v_mfma_f32_16x16x32_bf16 v[48:51], a[4:7], a[100:103], v[48:51]
  v_mfma_f32_16x16x32_bf16 v[52:55], a[100:103], a[8:11], v[52:55]
  ds_read_b128 a[120:123], v2 offset:6144
  s_waitcnt lgkmcnt(2)
  v_mfma_f32_16x16x32_bf16 v[56:59], a[0:3], a[104:107], v[56:59]
  v_mfma_f32_16x16x32_bf16 v[60:63], a[4:7], a[104:107], v[60:63]
  buffer_load_dwordx4 v4, s[8:11], s16 offen offset:3072  lds
  s_add_u32 s16, s16, 16384
  v_mfma_f32_16x16x32_bf16 v[64:67], a[104:107], a[8:11], v[64:67]
  ds_read_b128 a[124:127], v2 offset:7168
  v_mfma_f32_16x16x32_bf16 v[68:71], a[0:3], a[108:111], v[68:71]
  v_mfma_f32_16x16x32_bf16 v[72:75], a[4:7], a[108:111], v[72:75]
  ds_read_b128 a[96:99], v2 offset:8192
  v_mfma_f32_16x16x32_bf16 v[76:79], a[108:111], a[8:11], v[76:79]
  buffer_load_dwordx4 a[72:75], v8, s[12:15], s17 offen offset:0
  v_mfma_f32_16x16x32_bf16 v[80:83], a[0:3], a[112:115], v[80:83]
  ds_read_b128 a[100:103], v2 offset:9216
  v_mfma_f32_16x16x32_bf16 v[84:87], a[4:7], a[112:115], v[84:87]
  v_mfma_f32_16x16x32_bf16 v[88:91], a[112:115], a[8:11], v[88:91]
  s_waitcnt lgkmcnt(2)
  v_mfma_f32_16x16x32_bf16 v[92:95], a[0:3], a[116:119], v[92:95]
  ds_read_b128 a[104:107], v2 offset:10240
  v_mfma_f32_16x16x32_bf16 v[96:99], a[4:7], a[116:119], v[96:99]
  buffer_load_dwordx4 a[76:79], v9, s[12:15], s17 offen offset:0
  v_mfma_f32_16x16x32_bf16 v[100:103], a[116:119], a[8:11], v[100:103]
  ds_read_b128 a[108:111], v2 offset:11264
  v_mfma_f32_16x16x32_bf16 v[104:107], a[0:3], a[120:123], v[104:107]
  v_mfma_f32_16x16x32_bf16 v[108:111], a[4:7], a[120:123], v[108:111]
  v_mfma_f32_16x16x32_bf16 v[112:115], a[120:123], a[8:11], v[112:115]
  ds_read_b128 a[112:115], v2 offset:12288
  buffer_load_dwordx4 a[80:83], v10, s[12:15], s17 offen offset:0
  v_mfma_f32_16x16x32_bf16 v[116:119], a[0:3], a[124:127], v[116:119]
  v_mfma_f32_16x16x32_bf16 v[120:123], a[4:7], a[124:127], v[120:123]
  ds_read_b128 a[116:119], v2 offset:13312
  v_mfma_f32_16x16x32_bf16 v[124:127], a[124:127], a[8:11], v[124:127]
  s_waitcnt lgkmcnt(2)
  v_mfma_f32_16x16x32_bf16 v[32:35], a[12:15], a[96:99], v[32:35]
  v_mfma_f32_16x16x32_bf16 v[36:39], a[16:19], a[96:99], v[36:39]
  ds_read_b128 a[120:123], v2 offset:14336
  buffer_load_dwordx4 a[84:87], v8, s[12:15], s17 offen offset:1024
  v_mfma_f32_16x16x32_bf16 v[40:43], a[96:99], a[20:23], v[40:43]
  v_mfma_f32_16x16x32_bf16 v[44:47], a[12:15], a[100:103], v[44:47]
  ds_read_b128 a[124:127], v2 offset:15360
  v_mfma_f32_16x16x32_bf16 v[48:51], a[16:19], a[100:103], v[48:51]
  v_mfma_f32_16x16x32_bf16 v[52:55], a[100:103], a[20:23], v[52:55]
  v_mfma_f32_16x16x32_bf16 v[56:59], a[12:15], a[104:107], v[56:59]
  buffer_load_dwordx4 a[88:91], v9, s[12:15], s17 offen offset:1024
  v_mfma_f32_16x16x32_bf16 v[60:63], a[16:19], a[104:107], v[60:63]
  v_mfma_f32_16x16x32_bf16 v[64:67], a[104:107], a[20:23], v[64:67]
  v_mfma_f32_16x16x32_bf16 v[68:71], a[12:15], a[108:111], v[68:71]
  v_mfma_f32_16x16x32_bf16 v[72:75], a[16:19], a[108:111], v[72:75]
  buffer_load_dwordx4 a[92:95], v10, s[12:15], s17 offen offset:1024
  s_add_u32 s17, s17, 2048
  v_mfma_f32_16x16x32_bf16 v[76:79], a[108:111], a[20:23], v[76:79]
  s_waitcnt lgkmcnt(0)
  v_mfma_f32_16x16x32_bf16 v[80:83], a[12:15], a[112:115], v[80:83]
  v_mfma_f32_16x16x32_bf16 v[84:87], a[16:19], a[112:115], v[84:87]
  v_mfma_f32_16x16x32_bf16 v[88:91], a[112:115], a[20:23], v[88:91]
  s_waitcnt vmcnt(20) lgkmcnt(0)
  s_barrier
  v_mfma_f32_16x16x32_bf16 v[92:95], a[12:15], a[116:119], v[92:95]
  ds_read_b128 a[96:99], v2 offset:16384
  v_mfma_f32_16x16x32_bf16 v[96:99], a[16:19], a[116:119], v[96:99]
  s_add_u32 m0, s18, 0
  v_mfma_f32_16x16x32_bf16 v[100:103], a[116:119], a[20:23], v[100:103]
  ds_read_b128 a[100:103], v2 offset:17408
  buffer_load_dwordx4 v4, s[8:11], s16 offen offset:0  lds
  v_mfma_f32_16x16x32_bf16 v[104:107], a[12:15], a[120:123], v[104:107]
  v_mfma_f32_16x16x32_bf16 v[108:111], a[16:19], a[120:123], v[108:111]
  ds_read_b128 a[104:107], v2 offset:18432
  v_mfma_f32_16x16x32_bf16 v[112:115], a[120:123], a[20:23], v[112:115]
  v_mfma_f32_16x16x32_bf16 v[116:119], a[12:15], a[124:127], v[116:119]
  buffer_load_dwordx4 v4, s[8:11], s16 offen offset:1024  lds
  v_mfma_f32_16x16x32_bf16 v[120:123], a[16:19], a[124:127], v[120:123]
  ds_read_b128 a[108:111], v2 offset:19456
  v_mfma_f32_16x16x32_bf16 v[124:127], a[124:127], a[20:23], v[124:127]
  s_waitcnt lgkmcnt(2)
  v_mfma_f32_16x16x32_bf16 v[32:35], a[24:27], a[96:99], v[32:35]
  ds_read_b128 a[112:115], v2 offset:20480
  v_mfma_f32_16x16x32_bf16 v[36:39], a[28:31], a[96:99], v[36:39]
  v_mfma_f32_16x16x32_bf16 v[40:43], a[96:99], a[32:35], v[40:43]
  buffer_load_dwordx4 v4, s[8:11], s16 offen offset:2048  lds
  v_mfma_f32_16x16x32_bf16 v[44:47], a[24:27], a[100:103], v[44:47]
  ds_read_b128 a[116:119], v2 offset:21504
  v_mfma_f32_16x16x32_bf16 v[48:51], a[28:31], a[100:103], v[48:51]
  v_mfma_f32_16x16x32_bf16 v[52:55], a[100:103], a[32:35], v[52:55]
  ds_read_b128 a[120:123], v2 offset:22528
  s_waitcnt lgkmcnt(2)
  v_mfma_f32_16x16x32_bf16 v[56:59], a[24:27], a[104:107], v[56:59]
  v_mfma_f32_16x16x32_bf16 v[60:63], a[28:31], a[104:107], v[60:63]
  buffer_load_dwordx4 v4, s[8:11], s16 offen offset:3072  lds
  s_add_u32 s16, s16, 16384
  v_mfma_f32_16x16x32_bf16 v[64:67], a[104:107], a[32:35], v[64:67]
  ds_read_b128 a[124:127], v2 offset:23552
  v_mfma_f32_16x16x32_bf16 v[68:71], a[24:27], a[108:111], v[68:71]
  v_mfma_f32_16x16x32_bf16 v[72:75], a[28:31], a[108:111], v[72:75]
  ds_read_b128 a[96:99], v2 offset:24576
  v_mfma_f32_16x16x32_bf16 v[76:79], a[108:111], a[32:35], v[76:79]
  buffer_load_dwordx4 a[0:3], v8, s[12:15], s17 offen offset:0
  v_mfma_f32_16x16x32_bf16 v[80:83], a[24:27], a[112:115], v[80:83]
  ds_read_b128 a[100:103], v2 offset:25600
  v_mfma_f32_16x16x32_bf16 v[84:87], a[28:31], a[112:115], v[84:87]
  v_mfma_f32_16x16x32_bf16 v[88:91], a[112:115], a[32:35], v[88:91]
  s_waitcnt lgkmcnt(2)
  v_mfma_f32_16x16x32_bf16 v[92:95], a[24:27], a[116:119], v[92:95]
  ds_read_b128 a[104:107], v2 offset:26624
  v_mfma_f32_16x16x32_bf16 v[96:99], a[28:31], a[116:119], v[96:99]
  buffer_load_dwordx4 a[4:7], v9, s[12:15], s17 offen offset:0
  v_mfma_f32_16x16x32_bf16 v[100:103], a[116:119], a[32:35], v[100:103]
  ds_read_b128 a[108:111], v2 offset:27648
  v_mfma_f32_16x16x32_bf16 v[104:107], a[24:27], a[120:123], v[104:107]
  v_mfma_f32_16x16x32_bf16 v[108:111], a[28:31], a[120:123], v[108:111]
  v_mfma_f32_16x16x32_bf16 v[112:115], a[120:123], a[32:35], v[112:115]
  ds_read_b128 a[112:115], v2 offset:28672
  buffer_load_dwordx4 a[8:11], v10, s[12:15], s17 offen offset:0
  v_mfma_f32_16x16x32_bf16 v[116:119], a[24:27], a[124:127], v[116:119]
  v_mfma_f32_16x16x32_bf16 v[120:123], a[28:31], a[124:127], v[120:123]
  ds_read_b128 a[116:119], v2 offset:29696
  v_mfma_f32_16x16x32_bf16 v[124:127], a[124:127], a[32:35], v[124:127]
  s_waitcnt lgkmcnt(2)
  v_mfma_f32_16x16x32_bf16 v[32:35], a[36:39], a[96:99], v[32:35]
  v_mfma_f32_16x16x32_bf16 v[36:39], a[40:43], a[96:99], v[36:39]
  ds_read_b128 a[120:123], v2 offset:30720
  buffer_load_dwordx4 a[12:15], v8, s[12:15], s17 offen offset:1024
  v_mfma_f32_16x16x32_bf16 v[40:43], a[96:99], a[44:47], v[40:43]
  v_mfma_f32_16x16x32_bf16 v[44:47], a[36:39], a[100:103], v[44:47]
  ds_read_b128 a[124:127], v2 offset:31744
  v_mfma_f32_16x16x32_bf16 v[48:51], a[40:43], a[100:103], v[48:51]
  v_mfma_f32_16x16x32_bf16 v[52:55], a[100:103], a[44:47], v[52:55]
  v_mfma_f32_16x16x32_bf16 v[56:59], a[36:39], a[104:107], v[56:59]
  buffer_load_dwordx4 a[16:19], v9, s[12:15], s17 offen offset:1024
  v_mfma_f32_16x16x32_bf16 v[60:63], a[40:43], a[104:107], v[60:63]
  v_mfma_f32_16x16x32_bf16 v[64:67], a[104:107], a[44:47], v[64:67]
  v_mfma_f32_16x16x32_bf16 v[68:71], a[36:39], a[108:111], v[68:71]
  v_mfma_f32_16x16x32_bf16 v[72:75], a[40:43], a[108:111], v[72:75]
  buffer_load_dwordx4 a[20:23], v10, s[12:15], s17 offen offset:1024
  s_add_u32 s17, s17, 2048
  v_mfma_f32_16x16x32_bf16 v[76:79], a[108:111], a[44:47], v[76:79]
  s_waitcnt lgkmcnt(0)
  v_mfma_f32_16x16x32_bf16 v[80:83], a[36:39], a[112:115], v[80:83]
  v_mfma_f32_16x16x32_bf16 v[84:87], a[40:43], a[112:115], v[84:87]
  v_mfma_f32_16x16x32_bf16 v[88:91], a[112:115], a[44:47], v[88:91]
  s_waitcnt vmcnt(20) lgkmcnt(0)
  s_barrier
  v_mfma_f32_16x16x32_bf16 v[92:95], a[36:39], a[116:119], v[92:95]
  ds_read_b128 a[96:99], v2 offset:32768
  v_mfma_f32_16x16x32_bf16 v[96:99], a[40:43], a[116:119], v[96:99]
  s_add_u32 m0, s18, 16384
  v_mfma_f32_16x16x32_bf16 v[100:103], a[116:119], a[44:47], v[100:103]
  ds_read_b128 a[100:103], v2 offset:33792
  buffer_load_dwordx4 v4, s[8:11], s16 offen offset:0  lds
  v_mfma_f32_16x16x32_bf16 v[104:107], a[36:39], a[120:123], v[104:107]
  v_mfma_f32_16x16x32_bf16 v[108:111], a[40:43], a[120:123], v[108:111]
  ds_read_b128 a[104:107], v2 offset:34816
  v_mfma_f32_16x16x32_bf16 v[112:115], a[120:123], a[44:47], v[112:115]
  v_mfma_f32_16x16x32_bf16 v[116:119], a[36:39], a[124:127], v[116:119]
  buffer_load_dwordx4 v4, s[8:11], s16 offen offset:1024  lds
  v_mfma_f32_16x16x32_bf16 v[120:123], a[40:43], a[124:127], v[120:123]
  ds_read_b128 a[108:111], v2 offset:35840
  v_mfma_f32_16x16x32_bf16 v[124:127], a[124:127], a[44:47], v[124:127]
  s_waitcnt lgkmcnt(2)
  v_mfma_f32_16x16x32_bf16 v[32:35], a[48:51], a[96:99], v[32:35]
  ds_read_b128 a[112:115], v2 offset:36864
  v_mfma_f32_16x16x32_bf16 v[36:39], a[52:55], a[96:99], v[36:39]
  v_mfma_f32_16x16x32_bf16 v[40:43], a[96:99], a[56:59], v[40:43]
  buffer_load_dwordx4 v4, s[8:11], s16 offen offset:2048  lds
  v_mfma_f32_16x16x32_bf16 v[44:47], a[48:51], a[100:103], v[44:47]
  ds_read_b128 a[116:119], v2 offset:37888
  v_mfma_f32_16x16x32_bf16 v[48:51], a[52:55], a[100:103], v[48:51]
  v_mfma_f32_16x16x32_bf16 v[52:55], a[100:103], a[56:59], v[52:55]
  ds_read_b128 a[120:123], v2 offset:38912
  s_waitcnt lgkmcnt(2)
  v_mfma_f32_16x16x32_bf16 v[56:59], a[48:51], a[104:107], v[56:59]
  v_mfma_f32_16x16x32_bf16 v[60:63], a[52:55], a[104:107], v[60:63]
  buffer_load_dwordx4 v4, s[8:11], s16 offen offset:3072  lds
  s_add_u32 s16, s16, 16384
  v_mfma_f32_16x16x32_bf16 v[64:67], a[104:107], a[56:59], v[64:67]
  ds_read_b128 a[124:127], v2 offset:39936
  v_mfma_f32_16x16x32_bf16 v[68:71], a[48:51], a[108:111], v[68:71]
  v_mfma_f32_16x16x32_bf16 v[72:75], a[52:55], a[108:111], v[72:75]
  ds_read_b128 a[96:99], v2 offset:40960
  v_mfma_f32_16x16x32_bf16 v[76:79], a[108:111], a[56:59], v[76:79]
  buffer_load_dwordx4 a[24:27], v8, s[12:15], s17 offen offset:0
  v_mfma_f32_16x16x32_bf16 v[80:83], a[48:51], a[112:115], v[80:83]
  ds_read_b128 a[100:103], v2 offset:41984
  v_mfma_f32_16x16x32_bf16 v[84:87], a[52:55], a[112:115], v[84:87]
  v_mfma_f32_16x16x32_bf16 v[88:91], a[112:115], a[56:59], v[88:91]
  s_waitcnt lgkmcnt(2)
  v_mfma_f32_16x16x32_bf16 v[92:95], a[48:51], a[116:119], v[92:95]
  ds_read_b128 a[104:107], v2 offset:43008
  v_mfma_f32_16x16x32_bf16 v[96:99], a[52:55], a[116:119], v[96:99]
  buffer_load_dwordx4 a[28:31], v9, s[12:15], s17 offen offset:0
  v_mfma_f32_16x16x32_bf16 v[100:103], a[116:119], a[56:59], v[100:103]
  ds_read_b128 a[108:111], v2 offset:44032
  v_mfma_f32_16x16x32_bf16 v[104:107], a[48:51], a[120:123], v[104:107]
  v_mfma_f32_16x16x32_bf16 v[108:111], a[52:55], a[120:123], v[108:111]
  v_mfma_f32_16x16x32_bf16 v[112:115], a[120:123], a[56:59], v[112:115]
  ds_read_b128 a[112:115], v2 offset:45056
  buffer_load_dwordx4 a[32:35], v10, s[12:15], s17 offen offset:0
  v_mfma_f32_16x16x32_bf16 v[116:119], a[48:51], a[124:127], v[116:119]
  v_mfma_f32_16x16x32_bf16 v[120:123], a[52:55], a[124:127], v[120:123]
  ds_read_b128 a[116:119], v2 offset:46080
  v_mfma_f32_16x16x32_bf16 v[124:127], a[124:127], a[56:59], v[124:127]
  s_waitcnt lgkmcnt(2)
  v_mfma_f32_16x16x32_bf16 v[32:35], a[60:63], a[96:99], v[32:35]
  v_mfma_f32_16x16x32_bf16 v[36:39], a[64:67], a[96:99], v[36:39]
  ds_read_b128 a[120:123], v2 offset:47104
  buffer_load_dwordx4 a[36:39], v8, s[12:15], s17 offen offset:1024
  v_mfma_f32_16x16x32_bf16 v[40:43], a[96:99], a[68:71], v[40:43]
  v_mfma_f32_16x16x32_bf16 v[44:47], a[60:63], a[100:103], v[44:47]
  ds_read_b128 a[124:127], v2 offset:48128
  v_mfma_f32_16x16x32_bf16 v[48:51], a[64:67], a[100:103], v[48:51]
  v_mfma_f32_16x16x32_bf16 v[52:55], a[100:103], a[68:71], v[52:55]
  v_mfma_f32_16x16x32_bf16 v[56:59], a[60:63], a[104:107], v[56:59]
  buffer_load_dwordx4 a[40:43], v9, s[12:15], s17 offen offset:1024
  v_mfma_f32_16x16x32_bf16 v[60:63], a[64:67], a[104:107], v[60:63]
  v_mfma_f32_16x16x32_bf16 v[64:67], a[104:107], a[68:71], v[64:67]
  v_mfma_f32_16x16x32_bf16 v[68:71], a[60:63], a[108:111], v[68:71]
  v_mfma_f32_16x16x32_bf16 v[72:75], a[64:67], a[108:111], v[72:75]
  buffer_load_dwordx4 a[44:47], v10, s[12:15], s17 offen offset:1024
  s_add_u32 s17, s17, 2048
  v_mfma_f32_16x16x32_bf16 v[76:79], a[108:111], a[68:71], v[76:79]
  s_waitcnt lgkmcnt(0)
  v_mfma_f32_16x16x32_bf16 v[80:83], a[60:63], a[112:115], v[80:83]
  v_mfma_f32_16x16x32_bf16 v[84:87], a[64:67], a[112:115], v[84:87]
  v_mfma_f32_16x16x32_bf16 v[88:91], a[112:115], a[68:71], v[88:91]
  s_waitcnt vmcnt(20) lgkmcnt(0)
  s_barrier
  v_mfma_f32_16x16x32_bf16 v[92:95], a[60:63], a[116:119], v[92:95]
  ds_read_b128 a[96:99], v2 offset:49152
  v_mfma_f32_16x16x32_bf16 v[96:99], a[64:67], a[116:119], v[96:99]
  s_add_u32 m0, s18, 32768
  v_mfma_f32_16x16x32_bf16 v[100:103], a[116:119], a[68:71], v[100:103]
  ds_read_b128 a[100:103], v2 offset:50176
  buffer_load_dwordx4 v4, s[8:11], s16 offen offset:0  lds
  v_mfma_f32_16x16x32_bf16 v[104:107], a[60:63], a[120:123], v[104:107]
  v_mfma_f32_16x16x32_bf16 v[108:111], a[64:67], a[120:123], v[108:111]
  ds_read_b128 a[104:107], v2 offset:51200
  v_mfma_f32_16x16x32_bf16 v[112:115], a[120:123], a[68:71], v[112:115]
  v_mfma_f32_16x16x32_bf16 v[116:119], a[60:63], a[124:127], v[116:119]
  buffer_load_dwordx4 v4, s[8:11], s16 offen offset:1024  lds
  v_mfma_f32_16x16x32_bf16 v[120:123], a[64:67], a[124:127], v[120:123]
  ds_read_b128 a[108:111], v2 offset:52224
  v_mfma_f32_16x16x32_bf16 v[124:127], a[124:127], a[68:71], v[124:127]
  s_waitcnt lgkmcnt(2)
  v_mfma_f32_16x16x32_bf16 v[32:35], a[72:75], a[96:99], v[32:35]
  ds_read_b128 a[112:115], v2 offset:53248
  v_mfma_f32_16x16x32_bf16 v[36:39], a[76:79], a[96:99], v[36:39]
  v_mfma_f32_16x16x32_bf16 v[40:43], a[96:99], a[80:83], v[40:43]
  buffer_load_dwordx4 v4, s[8:11], s16 offen offset:2048  lds
  v_mfma_f32_16x16x32_bf16 v[44:47], a[72:75], a[100:103], v[44:47]
  ds_read_b128 a[116:119], v2 offset:54272
  v_mfma_f32_16x16x32_bf16 v[48:51], a[76:79], a[100:103], v[48:51]
  v_mfma_f32_16x16x32_bf16 v[52:55], a[100:103], a[80:83], v[52:55]
  ds_read_b128 a[120:123], v2 offset:55296
  s_waitcnt lgkmcnt(2)
  v_mfma_f32_16x16x32_bf16 v[56:59], a[72:75], a[104:107], v[56:59]
  v_mfma_f32_16x16x32_bf16 v[60:63], a[76:79], a[104:107], v[60:63]
  buffer_load_dwordx4 v4, s[8:11], s16 offen offset:3072  lds
  s_add_u32 s16, s16, 16384
  v_mfma_f32_16x16x32_bf16 v[64:67], a[104:107], a[80:83], v[64:67]
  ds_read_b128 a[124:127], v2 offset:56320
  v_mfma_f32_16x16x32_bf16 v[68:71], a[72:75], a[108:111], v[68:71]
  v_mfma_f32_16x16x32_bf16 v[72:75], a[76:79], a[108:111], v[72:75]
  ds_read_b128 a[96:99], v2 offset:57344
  v_mfma_f32_16x16x32_bf16 v[76:79], a[108:111], a[80:83], v[76:79]
  buffer_load_dwordx4 a[48:51], v8, s[12:15], s17 offen offset:0
  v_mfma_f32_16x16x32_bf16 v[80:83], a[72:75], a[112:115], v[80:83]
  ds_read_b128 a[100:103], v2 offset:58368
  v_mfma_f32_16x16x32_bf16 v[84:87], a[76:79], a[112:115], v[84:87]
  v_mfma_f32_16x16x32_bf16 v[88:91], a[112:115], a[80:83], v[88:91]
  s_waitcnt lgkmcnt(2)
  v_mfma_f32_16x16x32_bf16 v[92:95], a[72:75], a[116:119], v[92:95]
  ds_read_b128 a[104:107], v2 offset:59392
  v_mfma_f32_16x16x32_bf16 v[96:99], a[76:79], a[116:119], v[96:99]
  buffer_load_dwordx4 a[52:55], v9, s[12:15], s17 offen offset:0
  v_mfma_f32_16x16x32_bf16 v[100:103], a[116:119], a[80:83], v[100:103]
  ds_read_b128 a[108:111], v2 offset:60416
  v_mfma_f32_16x16x32_bf16 v[104:107], a[72:75], a[120:123], v[104:107]
  v_mfma_f32_16x16x32_bf16 v[108:111], a[76:79], a[120:123], v[108:111]
  v_mfma_f32_16x16x32_bf16 v[112:115], a[120:123], a[80:83], v[112:115]
  ds_read_b128 a[112:115], v2 offset:61440
  buffer_load_dwordx4 a[56:59], v10, s[12:15], s17 offen offset:0
  v_mfma_f32_16x16x32_bf16 v[116:119], a[72:75], a[124:127], v[116:119]
  v_mfma_f32_16x16x32_bf16 v[120:123], a[76:79], a[124:127], v[120:123]
  ds_read_b128 a[116:119], v2 offset:62464
  v_mfma_f32_16x16x32_bf16 v[124:127], a[124:127], a[80:83], v[124:127]
  s_waitcnt lgkmcnt(2)
  v_mfma_f32_16x16x32_bf16 v[32:35], a[84:87], a[96:99], v[32:35]
  v_mfma_f32_16x16x32_bf16 v[36:39], a[88:91], a[96:99], v[36:39]
  ds_read_b128 a[120:123], v2 offset:63488
  buffer_load_dwordx4 a[60:63], v8, s[12:15], s17 offen offset:1024
  v_mfma_f32_16x16x32_bf16 v[40:43], a[96:99], a[92:95], v[40:43]
  v_mfma_f32_16x16x32_bf16 v[44:47], a[84:87], a[100:103], v[44:47]
  ds_read_b128 a[124:127], v2 offset:64512
  v_mfma_f32_16x16x32_bf16 v[48:51], a[88:91], a[100:103], v[48:51]
  v_mfma_f32_16x16x32_bf16 v[52:55], a[100:103], a[92:95], v[52:55]
  v_mfma_f32_16x16x32_bf16 v[56:59], a[84:87], a[104:107], v[56:59]
  buffer_load_dwordx4 a[64:67], v9, s[12:15], s17 offen offset:1024
  v_mfma_f32_16x16x32_bf16 v[60:63], a[88:91], a[104:107], v[60:63]
  v_mfma_f32_16x16x32_bf16 v[64:67], a[104:107], a[92:95], v[64:67]
  v_mfma_f32_16x16x32_bf16 v[68:71], a[84:87], a[108:111], v[68:71]
  v_mfma_f32_16x16x32_bf16 v[72:75], a[88:91], a[108:111], v[72:75]
  buffer_load_dwordx4 a[68:71], v10, s[12:15], s17 offen offset:1024
  s_add_u32 s17, s17, 2048
  v_mfma_f32_16x16x32_bf16 v[76:79], a[108:111], a[92:95], v[76:79]
  s_waitcnt lgkmcnt(0)
  v_mfma_f32_16x16x32_bf16 v[80:83], a[84:87], a[112:115], v[80:83]
  v_mfma_f32_16x16x32_bf16 v[84:87], a[88:91], a[112:115], v[84:87]
  v_mfma_f32_16x16x32_bf16 v[88:91], a[112:115], a[92:95], v[88:91]
  s_waitcnt vmcnt(20) lgkmcnt(0)
  s_barrier
  v_mfma_f32_16x16x32_bf16 v[92:95], a[84:87], a[116:119], v[92:95]
  ds_read_b128 a[96:99], v2 offset:0
  v_mfma_f32_16x16x32_bf16 v[96:99], a[88:91], a[116:119], v[96:99]
  s_add_u32 m0, s18, 49152
  v_mfma_f32_16x16x32_bf16 v[100:103], a[116:119], a[92:95], v[100:103]
  ds_read_b128 a[100:103], v2 offset:1024
  buffer_load_dwordx4 v4, s[8:11], s16 offen offset:0  lds
  v_mfma_f32_16x16x32_bf16 v[104:107], a[84:87], a[120:123], v[104:107]
  v_mfma_f32_16x16x32_bf16 v[108:111], a[88:91], a[120:123], v[108:111]
  ds_read_b128 a[104:107], v2 offset:2048
  v_mfma_f32_16x16x32_bf16 v[112:115], a[120:123], a[92:95], v[112:115]
  v_mfma_f32_16x16x32_bf16 v[116:119], a[84:87], a[124:127], v[116:119]
  buffer_load_dwordx4 v4, s[8:11], s16 offen offset:1024  lds
  v_mfma_f32_16x16x32_bf16 v[120:123], a[88:91], a[124:127], v[120:123]
  ds_read_b128 a[108:111], v2 offset:3072
  v_mfma_f32_16x16x32_bf16 v[124:127], a[124:127], a[92:95], v[124:127]
  s_sub_u32 s19, s19, 1
  s_cmp_lg_u32 s19, 0
  s_cbranch_scc1 L_gemm_21
  s_waitcnt lgkmcnt(2)
  v_mfma_f32_16x16x32_bf16 v[32:35], a[0:3], a[96:99], v[32:35]
  ds_read_b128 a[112:115], v2 offset:4096
  v_mfma_f32_16x16x32_bf16 v[36:39], a[4:7], a[96:99], v[36:39]
  v_mfma_f32_16x16x32_bf16 v[40:43], a[96:99], a[8:11], v[40:43]
  buffer_load_dwordx4 v4, s[8:11], s16 offen offset:2048  lds
  v_mfma_f32_16x16x32_bf16 v[44:47], a[0:3], a[100:103], v[44:47]
  ds_read_b128 a[116:119], v2 offset:5120
  v_mfma_f32_16x16x32_bf16 v[48:51], a[4:7], a[100:103], v[48:51]
  v_mfma_f32_16x16x32_bf16 v[52:55], a[100:103], a[8:11], v[52:55]
  ds_read_b128 a[120:123], v2 offset:6144
  s_waitcnt lgkmcnt(2)
  v_mfma_f32_16x16x32_bf16 v[56:59], a[0:3], a[104:107], v[56:59]
  v_mfma_f32_16x16x32_bf16 v[60:63], a[4:7], a[104:107], v[60:63]
  buffer_load_dwordx4 v4, s[8:11], s16 offen offset:3072  lds
  s_add_u32 s16, s16, 16384
  v_mfma_f32_16x16x32_bf16 v[64:67], a[104:107], a[8:11], v[64:67]
  ds_read_b128 a[124:127], v2 offset:7168
  v_mfma_f32_16x16x32_bf16 v[68:71], a[0:3], a[108:111], v[68:71]
  v_mfma_f32_16x16x32_bf16 v[72:75], a[4:7], a[108:111], v[72:75]
  ds_read_b128 a[96:99], v2 offset:8192
  v_mfma_f32_16x16x32_bf16 v[76:79], a[108:111], a[8:11], v[76:79]
  buffer_load_dwordx4 a[72:75], v8, s[12:15], s17 offen offset:0
  v_mfma_f32_16x16x32_bf16 v[80:83], a[0:3], a[112:115], v[80:83]
  ds_read_b128 a[100:103], v2 offset:9216
  v_mfma_f32_16x16x32_bf16 v[84:87], a[4:7], a[112:115], v[84:87]
  v_mfma_f32_16x16x32_bf16 v[88:91], a[112:115], a[8:11], v[88:91]
  s_waitcnt lgkmcnt(2)
  v_mfma_f32_16x16x32_bf16 v[92:95], a[0:3], a[116:119], v[92:95]
  ds_read_b128 a[104:107], v2 offset:10240
  v_mfma_f32_16x16x32_bf16 v[96:99], a[4:7], a[116:119], v[96:99]
  buffer_load_dwordx4 a[76:79], v9, s[12:15], s17 offen offset:0
  v_mfma_f32_16x16x32_bf16 v[100:103], a[116:119], a[8:11], v[100:103]
  ds_read_b128 a[108:111], v2 offset:11264
  v_mfma_f32_16x16x32_bf16 v[104:107], a[0:3], a[120:123], v[104:107]
  v_mfma_f32_16x16x32_bf16 v[108:111], a[4:7], a[120:123], v[108:111]
  v_mfma_f32_16x16x32_bf16 v[112:115], a[120:123], a[8:11], v[112:115]
  ds_read_b128 a[112:115], v2 offset:12288
  buffer_load_dwordx4 a[80:83], v10, s[12:15], s17 offen offset:0
  v_mfma_f32_16x16x32_bf16 v[116:119], a[0:3], a[124:127], v[116:119]
  v_mfma_f32_16x16x32_bf16 v[120:123], a[4:7], a[124:127], v[120:123]
  ds_read_b128 a[116:119], v2 offset:13312
  v_mfma_f32_16x16x32_bf16 v[124:127], a[124:127], a[8:11], v[124:127]
  s_waitcnt lgkmcnt(2)
  v_mfma_f32_16x16x32_bf16 v[32:35], a[12:15], a[96:99], v[32:35]
  v_mfma_f32_16x16x32_bf16 v[36:39], a[16:19], a[96:99], v[36:39]
  ds_read_b128 a[120:123], v2 offset:14336
  buffer_load_dwordx4 a[84:87], v8, s[12:15], s17 offen offset:1024
  v_mfma_f32_16x16x32_bf16 v[40:43], a[96:99], a[20:23], v[40:43]
  v_mfma_f32_16x16x32_bf16 v[44:47], a[12:15], a[100:103], v[44:47]
  ds_read_b128 a[124:127], v2 offset:15360
  v_mfma_f32_16x16x32_bf16 v[48:51], a[16:19], a[100:103], v[48:51]
  v_mfma_f32_16x16x32_bf16 v[52:55], a[100:103], a[20:23], v[52:55]
  v_mfma_f32_16x16x32_bf16 v[56:59], a[12:15], a[104:107], v[56:59]
  buffer_load_dwordx4 a[88:91], v9, s[12:15], s17 offen offset:1024
  v_mfma_f32_16x16x32_bf16 v[60:63], a[16:19], a[104:107], v[60:63]
  v_mfma_f32_16x16x32_bf16 v[64:67], a[104:107], a[20:23], v[64:67]
  v_mfma_f32_16x16x32_bf16 v[68:71], a[12:15], a[108:111], v[68:71]
  v_mfma_f32_16x16x32_bf16 v[72:75], a[16:19], a[108:111], v[72:75]
  buffer_load_dwordx4 a[92:95], v10, s[12:15], s17 offen offset:1024
  s_add_u32 s17, s17, 2048
  v_mfma_f32_16x16x32_bf16 v[76:79], a[108:111], a[20:23], v[76:79]
  s_waitcnt lgkmcnt(0)
  v_mfma_f32_16x16x32_bf16 v[80:83], a[12:15], a[112:115], v[80:83]
  v_mfma_f32_16x16x32_bf16 v[84:87], a[16:19], a[112:115], v[84:87]
  v_mfma_f32_16x16x32_bf16 v[88:91], a[112:115], a[20:23], v[88:91]
  s_waitcnt vmcnt(20) lgkmcnt(0)
  s_barrier
  v_mfma_f32_16x16x32_bf16 v[92:95], a[12:15], a[116:119], v[92:95]
  ds_read_b128 a[96:99], v2 offset:16384
  v_mfma_f32_16x16x32_bf16 v[96:99], a[16:19], a[116:119], v[96:99]
  v_mfma_f32_16x16x32_bf16 v[100:103], a[116:119], a[20:23], v[100:103]
  ds_read_b128 a[100:103], v2 offset:17408
  v_mfma_f32_16x16x32_bf16 v[104:107], a[12:15], a[120:123], v[104:107]
  v_mfma_f32_16x16x32_bf16 v[108:111], a[16:19], a[120:123], v[108:111]
  ds_read_b128 a[104:107], v2 offset:18432
  v_mfma_f32_16x16x32_bf16 v[112:115], a[120:123], a[20:23], v[112:115]
  v_mfma_f32_16x16x32_bf16 v[116:119], a[12:15], a[124:127], v[116:119]
  v_mfma_f32_16x16x32_bf16 v[120:123], a[16:19], a[124:127], v[120:123]
  ds_read_b128 a[108:111], v2 offset:19456
  v_mfma_f32_16x16x32_bf16 v[124:127], a[124:127], a[20:23], v[124:127]
  s_waitcnt lgkmcnt(2)
  v_mfma_f32_16x16x32_bf16 v[32:35], a[24:27], a[96:99], v[32:35]
  ds_read_b128 a[112:115], v2 offset:20480
  v_mfma_f32_16x16x32_bf16 v[36:39], a[28:31], a[96:99], v[36:39]
  v_mfma_f32_16x16x32_bf16 v[40:43], a[96:99], a[32:35], v[40:43]
  v_mfma_f32_16x16x32_bf16 v[44:47], a[24:27], a[100:103], v[44:47]
  ds_read_b128 a[116:119], v2 offset:21504
  v_mfma_f32_16x16x32_bf16 v[48:51], a[28:31], a[100:103], v[48:51]
  v_mfma_f32_16x16x32_bf16 v[52:55], a[100:103], a[32:35], v[52:55]
  ds_read_b128 a[120:123], v2 offset:22528
  s_waitcnt lgkmcnt(2)
  v_mfma_f32_16x16x32_bf16 v[56:59], a[24:27], a[104:107], v[56:59]
  v_mfma_f32_16x16x32_bf16 v[60:63], a[28:31], a[104:107], v[60:63]
  v_mfma_f32_16x16x32_bf16 v[64:67], a[104:107], a[32:35], v[64:67]
  ds_read_b128 a[124:127], v2 offset:23552
  v_mfma_f32_16x16x32_bf16 v[68:71], a[24:27], a[108:111], v[68:71]
  v_mfma_f32_16x16x32_bf16 v[72:75], a[28:31], a[108:111], v[72:75]
  ds_read_b128 a[96:99], v2 offset:24576
  v_mfma_f32_16x16x32_bf16 v[76:79], a[108:111], a[32:35], v[76:79]
  v_mfma_f32_16x16x32_bf16 v[80:83], a[24:27], a[112:115], v[80:83]
  ds_read_b128 a[100:103], v2 offset:25600
  v_mfma_f32_16x16x32_bf16 v[84:87], a[28:31], a[112:115], v[84:87]
  v_mfma_f32_16x16x32_bf16 v[88:91], a[112:115], a[32:35], v[88:91]
  s_waitcnt lgkmcnt(2)
  v_mfma_f32_16x16x32_bf16 v[92:95], a[24:27], a[116:119], v[92:95]
  ds_read_b128 a[104:107], v2 offset:26624
  v_mfma_f32_16x16x32_bf16 v[96:99], a[28:31], a[116:119], v[96:99]
  v_mfma_f32_16x16x32_bf16 v[100:103], a[116:119], a[32:35], v[100:103]
  ds_read_b128 a[108:111], v2 offset:27648
  v_mfma_f32_16x16x32_bf16 v[104:107], a[24:27], a[120:123], v[104:107]
  v_mfma_f32_16x16x32_bf16 v[108:111], a[28:31], a[120:123], v[108:111]
  v_mfma_f32_16x16x32_bf16 v[112:115], a[120:123], a[32:35], v[112:115]
  ds_read_b128 a[112:115], v2 offset:28672
  v_mfma_f32_16x16x32_bf16 v[116:119], a[24:27], a[124:127], v[116:119]
  v_mfma_f32_16x16x32_bf16 v[120:123], a[28:31], a[124:127], v[120:123]
  ds_read_b128 a[116:119], v2 offset:29696
  v_mfma_f32_16x16x32_bf16 v[124:127], a[124:127], a[32:35], v[124:127]
  s_waitcnt lgkmcnt(2)
  v_mfma_f32_16x16x32_bf16 v[32:35], a[36:39], a[96:99], v[32:35]
  v_mfma_f32_16x16x32_bf16 v[36:39], a[40:43], a[96:99], v[36:39]
  ds_read_b128 a[120:123], v2 offset:30720
  v_mfma_f32_16x16x32_bf16 v[40:43], a[96:99], a[44:47], v[40:43]
  v_mfma_f32_16x16x32_bf16 v[44:47], a[36:39], a[100:103], v[44:47]
  ds_read_b128 a[124:127], v2 offset:31744
  v_mfma_f32_16x16x32_bf16 v[48:51], a[40:43], a[100:103], v[48:51]
  v_mfma_f32_16x16x32_bf16 v[52:55], a[100:103], a[44:47], v[52:55]
  v_mfma_f32_16x16x32_bf16 v[56:59], a[36:39], a[104:107], v[56:59]
  v_mfma_f32_16x16x32_bf16 v[60:63], a[40:43], a[104:107], v[60:63]
  v_mfma_f32_16x16x32_bf16 v[64:67], a[104:107], a[44:47], v[64:67]
  v_mfma_f32_16x16x32_bf16 v[68:71], a[36:39], a[108:111], v[68:71]
  v_mfma_f32_16x16x32_bf16 v[72:75], a[40:43], a[108:111], v[72:75]
  v_mfma_f32_16x16x32_bf16 v[76:79], a[108:111], a[44:47], v[76:79]
  s_waitcnt lgkmcnt(0)
  v_mfma_f32_16x16x32_bf16 v[80:83], a[36:39], a[112:115], v[80:83]
  v_mfma_f32_16x16x32_bf16 v[84:87], a[40:43], a[112:115], v[84:87]
  v_mfma_f32_16x16x32_bf16 v[88:91], a[112:115], a[44:47], v[88:91]
  s_waitcnt vmcnt(0) lgkmcnt(0)
  s_barrier
  v_mfma_f32_16x16x32_bf16 v[92:95], a[36:39], a[116:119], v[92:95]
  ds_read_b128 a[96:99], v2 offset:32768
  v_mfma_f32_16x16x32_bf16 v[96:99], a[40:43], a[116:119], v[96:99]
  v_mfma_f32_16x16x32_bf16 v[100:103], a[116:119], a[44:47], v[100:103]
  v_mfma_f32_16x16x32_bf16 v[104:107], a[36:39], a[120:123], v[104:107]
  ds_read_b128 a[100:103], v2 offset:33792
  v_mfma_f32_16x16x32_bf16 v[108:111], a[40:43], a[120:123], v[108:111]
  v_mfma_f32_16x16x32_bf16 v[112:115], a[120:123], a[44:47], v[112:115]
  v_mfma_f32_16x16x32_bf16 v[116:119], a[36:39], a[124:127], v[116:119]
  ds_read_b128 a[104:107], v2 offset:40960
  v_mfma_f32_16x16x32_bf16 v[120:123], a[40:43], a[124:127], v[120:123]
  v_mfma_f32_16x16x32_bf16 v[124:127], a[124:127], a[44:47], v[124:127]
  s_waitcnt lgkmcnt(1)
  v_mfma_f32_16x16x32_bf16 v[32:35], a[48:51], a[96:99], v[32:35]
  ds_read_b128 a[108:111], v2 offset:41984
  v_mfma_f32_16x16x32_bf16 v[36:39], a[52:55], a[96:99], v[36:39]
  v_mfma_f32_16x16x32_bf16 v[40:43], a[96:99], a[56:59], v[40:43]
  v_mfma_f32_16x16x32_bf16 v[44:47], a[48:51], a[100:103], v[44:47]
  ds_read_b128 a[112:115], v2 offset:49152
  v_mfma_f32_16x16x32_bf16 v[48:51], a[52:55], a[100:103], v[48:51]
  v_mfma_f32_16x16x32_bf16 v[52:55], a[100:103], a[56:59], v[52:55]
  s_waitcnt lgkmcnt(1)
  v_mfma_f32_16x16x32_bf16 v[32:35], a[60:63], a[104:107], v[32:35]
  ds_read_b128 a[116:119], v2 offset:50176
  v_mfma_f32_16x16x32_bf16 v[36:39], a[64:67], a[104:107], v[36:39]
  v_mfma_f32_16x16x32_bf16 v[40:43], a[104:107], a[68:71], v[40:43]
  v_mfma_f32_16x16x32_bf16 v[44:47], a[60:63], a[108:111], v[44:47]
  ds_read_b128 a[120:123], v2 offset:57344
  v_mfma_f32_16x16x32_bf16 v[48:51], a[64:67], a[108:111], v[48:51]
  v_mfma_f32_16x16x32_bf16 v[52:55], a[108:111], a[68:71], v[52:55]
  s_waitcnt lgkmcnt(1)
  v_mfma_f32_16x16x32_bf16 v[32:35], a[72:75], a[112:115], v[32:35]
  ds_read_b128 a[124:127], v2 offset:58368
  v_mfma_f32_16x16x32_bf16 v[36:39], a[76:79], a[112:115], v[36:39]
  v_mfma_f32_16x16x32_bf16 v[40:43], a[112:115], a[80:83], v[40:43]
  v_mfma_f32_16x16x32_bf16 v[44:47], a[72:75], a[116:119], v[44:47]
  ds_read_b128 a[96:99], v2 offset:34816
  v_mfma_f32_16x16x32_bf16 v[48:51], a[76:79], a[116:119], v[48:51]
  v_mfma_f32_16x16x32_bf16 v[52:55], a[116:119], a[80:83], v[52:55]
  s_waitcnt lgkmcnt(1)
  v_mfma_f32_16x16x32_bf16 v[32:35], a[84:87], a[120:123], v[32:35]
  ds_read_b128 a[100:103], v2 offset:35840
  v_mfma_f32_16x16x32_bf16 v[36:39], a[88:91], a[120:123], v[36:39]
  v_mfma_f32_16x16x32_bf16 v[40:43], a[120:123], a[92:95], v[40:43]
  v_mfma_f32_16x16x32_bf16 v[44:47], a[84:87], a[124:127], v[44:47]
  ds_read_b128 a[104:107], v2 offset:43008
  v_mfma_f32_16x16x32_bf16 v[48:51], a[88:91], a[124:127], v[48:51]
  v_mfma_f32_16x16x32_bf16 v[52:55], a[124:127], a[92:95], v[52:55]
  s_waitcnt lgkmcnt(1)
  v_mfma_f32_16x16x32_bf16 v[56:59], a[48:51], a[96:99], v[56:59]
  ds_read_b128 a[108:111], v2 offset:44032
  v_mfma_f32_16x16x32_bf16 v[60:63], a[52:55], a[96:99], v[60:63]
  v_mfma_f32_16x16x32_bf16 v[64:67], a[96:99], a[56:59], v[64:67]
  v_mfma_f32_16x16x32_bf16 v[68:71], a[48:51], a[100:103], v[68:71]
  ds_read_b128 a[112:115], v2 offset:51200
  v_mfma_f32_16x16x32_bf16 v[72:75], a[52:55], a[100:103], v[72:75]
  v_mfma_f32_16x16x32_bf16 v[76:79], a[100:103], a[56:59], v[76:79]
  s_waitcnt lgkmcnt(1)
  v_mfma_f32_16x16x32_bf16 v[56:59], a[60:63], a[104:107], v[56:59]
  ds_read_b128 a[116:119], v2 offset:52224
  v_mfma_f32_16x16x32_bf16 v[60:63], a[64:67], a[104:107], v[60:63]
  v_mfma_f32_16x16x32_bf16 v[64:67], a[104:107], a[68:71], v[64:67]
  v_mul_f32 v32, s40, v32
  v_mul_f32 v33, s40, v33
  v_mfma_f32_16x16x32_bf16 v[68:71], a[60:63], a[108:111], v[68:71]
  ds_read_b128 a[120:123], v2 offset:59392
  v_mul_f32 v34, s40, v34
  v_mul_f32 v35, s40, v35
  v_mfma_f32_16x16x32_bf16 v[72:75], a[64:67], a[108:111], v[72:75]
  v_mul_f32 v36, s40, v36
  v_mfma_f32_16x16x32_bf16 v[76:79], a[108:111], a[68:71], v[76:79]
  v_mul_f32 v37, s40, v37
  v_mul_f32 v38, s40, v38
  s_waitcnt lgkmcnt(1)
  v_mfma_f32_16x16x32_bf16 v[56:59], a[72:75], a[112:115], v[56:59]
  ds_read_b128 a[124:127], v2 offset:60416
  v_mul_f32 v39, s40, v39
  v_mfma_f32_16x16x32_bf16 v[60:63], a[76:79], a[112:115], v[60:63]
  v_cvt_pk_bf16_f32 v128, v32, v33
  v_cvt_pk_bf16_f32 v129, v34, v35
  v_mfma_f32_16x16x32_bf16 v[64:67], a[112:115], a[80:83], v[64:67]
  v_cvt_pk_bf16_f32 v130, v36, v37
  v_mfma_f32_16x16x32_bf16 v[68:71], a[72:75], a[116:119], v[68:71]
  ds_read_b128 a[96:99], v2 offset:36864
  v_cvt_pk_bf16_f32 v131, v38, v39
  buffer_store_dwordx4 v[128:131], v27, s[28:31], s36 offen offset:0 sc1
  v_mfma_f32_16x16x32_bf16 v[72:75], a[76:79], a[116:119], v[72:75]
  v_mul_f32 v44, s40, v44
  v_mfma_f32_16x16x32_bf16 v[76:79], a[116:119], a[80:83], v[76:79]
  v_mul_f32 v45, s40, v45
  v_mul_f32 v46, s40, v46
  s_waitcnt lgkmcnt(1)
  v_mfma_f32_16x16x32_bf16 v[56:59], a[84:87], a[120:123], v[56:59]
  ds_read_b128 a[100:103], v2 offset:37888
  v_mul_f32 v47, s40, v47
  v_mfma_f32_16x16x32_bf16 v[60:63], a[88:91], a[120:123], v[60:63]
  v_mul_f32 v48, s40, v48
  v_mul_f32 v49, s40, v49
  v_mfma_f32_16x16x32_bf16 v[64:67], a[120:123], a[92:95], v[64:67]
  v_mul_f32 v50, s40, v50
  v_mul_f32 v51, s40, v51
  v_mfma_f32_16x16x32_bf16 v[68:71], a[84:87], a[124:127], v[68:71]
  ds_read_b128 a[104:107], v2 offset:45056
  v_cvt_pk_bf16_f32 v132, v44, v45
  v_mfma_f32_16x16x32_bf16 v[72:75], a[88:91], a[124:127], v[72:75]
  v_cvt_pk_bf16_f32 v133, v46, v47
  v_cvt_pk_bf16_f32 v134, v48, v49
  v_mfma_f32_16x16x32_bf16 v[76:79], a[124:127], a[92:95], v[76:79]
  v_cvt_pk_bf16_f32 v135, v50, v51
  s_waitcnt lgkmcnt(1)
  v_mfma_f32_16x16x32_bf16 v[80:83], a[48:51], a[96:99], v[80:83]
  ds_read_b128 a[108:111], v2 offset:46080
  buffer_store_dwordx4 v[132:135], v27, s[28:31], s36 offen offset:256 sc1
  v_cvt_pk_bf16_f32 v136, v40, v41
  v_mfma_f32_16x16x32_bf16 v[84:87], a[52:55], a[96:99], v[84:87]
  v_cvt_pk_bf16_f32 v137, v42, v43
  v_mfma_f32_16x16x32_bf16 v[88:91], a[96:99], a[56:59], v[88:91]
  v_cvt_pk_bf16_f32 v138, v52, v53
  v_cvt_pk_bf16_f32 v139, v54, v55
  v_mfma_f32_16x16x32_bf16 v[92:95], a[48:51], a[100:103], v[92:95]
  ds_read_b128 a[112:115], v2 offset:53248
  s_nop 1
  v_mfma_f32_16x16x32_bf16 v[96:99], a[52:55], a[100:103], v[96:99]
  v_permlane16_swap_b32 v136, v138
  v_permlane16_swap_b32 v137, v139
  v_mfma_f32_16x16x32_bf16 v[100:103], a[100:103], a[56:59], v[100:103]
  s_nop 0
  s_waitcnt lgkmcnt(1)
  v_mfma_f32_16x16x32_bf16 v[80:83], a[60:63], a[104:107], v[80:83]
  ds_read_b128 a[116:119], v2 offset:54272
  buffer_store_dwordx4 v[136:139], v28, s[28:31], s38 offen offset:0 sc1
  s_add_u32 s36, s36, s39
  v_mfma_f32_16x16x32_bf16 v[84:87], a[64:67], a[104:107], v[84:87]
  s_add_u32 s38, s38, 4096
  v_mfma_f32_16x16x32_bf16 v[88:91], a[104:107], a[68:71], v[88:91]
  v_mul_f32 v56, s40, v56
  v_mul_f32 v57, s40, v57
  v_mfma_f32_16x16x32_bf16 v[92:95], a[60:63], a[108:111], v[92:95]
  ds_read_b128 a[120:123], v2 offset:61440
  v_mul_f32 v58, s40, v58
  v_mul_f32 v59, s40, v59
  v_mfma_f32_16x16x32_bf16 v[96:99], a[64:67], a[108:111], v[96:99]
  v_mul_f32 v60, s40, v60
  v_mfma_f32_16x16x32_bf16 v[100:103], a[108:111], a[68:71], v[100:103]
  v_mul_f32 v61, s40, v61
  v_mul_f32 v62, s40, v62
  s_waitcnt lgkmcnt(1)
  v_mfma_f32_16x16x32_bf16 v[80:83], a[72:75], a[112:115], v[80:83]
  ds_read_b128 a[124:127], v2 offset:62464
  v_mul_f32 v63, s40, v63
  v_mfma_f32_16x16x32_bf16 v[84:87], a[76:79], a[112:115], v[84:87]
  v_cvt_pk_bf16_f32 v140, v56, v57
  v_cvt_pk_bf16_f32 v141, v58, v59
  v_mfma_f32_16x16x32_bf16 v[88:91], a[112:115], a[80:83], v[88:91]
  v_cvt_pk_bf16_f32 v142, v60, v61
  v_mfma_f32_16x16x32_bf16 v[92:95], a[72:75], a[116:119], v[92:95]
  ds_read_b128 a[96:99], v2 offset:38912
  v_cvt_pk_bf16_f32 v143, v62, v63
  buffer_store_dwordx4 v[140:143], v27, s[28:31], s36 offen offset:0 sc1
  v_mfma_f32_16x16x32_bf16 v[96:99], a[76:79], a[116:119], v[96:99]
  v_mul_f32 v68, s40, v68
  v_mfma_f32_16x16x32_bf16 v[100:103], a[116:119], a[80:83], v[100:103]
  v_mul_f32 v69, s40, v69
  v_mul_f32 v70, s40, v70
  s_waitcnt lgkmcnt(1)
  v_mfma_f32_16x16x32_bf16 v[80:83], a[84:87], a[120:123], v[80:83]
  ds_read_b128 a[100:103], v2 offset:39936
  v_mul_f32 v71, s40, v71
  v_mfma_f32_16x16x32_bf16 v[84:87], a[88:91], a[120:123], v[84:87]
  v_mul_f32 v72, s40, v72
  v_mul_f32 v73, s40, v73
  v_mfma_f32_16x16x32_bf16 v[88:91], a[120:123], a[92:95], v[88:91]
  v_mul_f32 v74, s40, v74
  v_mul_f32 v75, s40, v75
  v_mfma_f32_16x16x32_bf16 v[92:95], a[84:87], a[124:127], v[92:95]
  ds_read_b128 a[104:107], v2 offset:47104
  v_cvt_pk_bf16_f32 v128, v68, v69
  v_mfma_f32_16x16x32_bf16 v[96:99], a[88:91], a[124:127], v[96:99]
  v_cvt_pk_bf16_f32 v129, v70, v71
  v_cvt_pk_bf16_f32 v130, v72, v73
  v_mfma_f32_16x16x32_bf16 v[100:103], a[124:127], a[92:95], v[100:103]
  v_cvt_pk_bf16_f32 v131, v74, v75
  s_waitcnt lgkmcnt(1)
  v_mfma_f32_16x16x32_bf16 v[104:107], a[48:51], a[96:99], v[104:107]
  ds_read_b128 a[108:111], v2 offset:48128
  buffer_store_dwordx4 v[128:131], v27, s[28:31], s36 offen offset:256 sc1
  v_cvt_pk_bf16_f32 v132, v64, v65
  v_mfma_f32_16x16x32_bf16 v[108:111], a[52:55], a[96:99], v[108:111]
  v_cvt_pk_bf16_f32 v133, v66, v67
  v_mfma_f32_16x16x32_bf16 v[112:115], a[96:99], a[56:59], v[112:115]
  v_cvt_pk_bf16_f32 v134, v76, v77
  v_cvt_pk_bf16_f32 v135, v78, v79
  v_mfma_f32_16x16x32_bf16 v[116:119], a[48:51], a[100:103], v[116:119]
  ds_read_b128 a[112:115], v2 offset:55296
  s_nop 1
  v_mfma_f32_16x16x32_bf16 v[120:123], a[52:55], a[100:103], v[120:123]
  v_permlane16_swap_b32 v132, v134
  v_permlane16_swap_b32 v133, v135
  v_mfma_f32_16x16x32_bf16 v[124:127], a[100:103], a[56:59], v[124:127]
  s_nop 0
  s_waitcnt lgkmcnt(1)
  v_mfma_f32_16x16x32_bf16 v[104:107], a[60:63], a[104:107], v[104:107]
  ds_read_b128 a[116:119], v2 offset:56320
  buffer_store_dwordx4 v[132:135], v28, s[28:31], s38 offen offset:0 sc1
  s_add_u32 s36, s36, s39
  v_mfma_f32_16x16x32_bf16 v[108:111], a[64:67], a[104:107], v[108:111]
  s_add_u32 s38, s38, 4096
  v_mfma_f32_16x16x32_bf16 v[112:115], a[104:107], a[68:71], v[112:115]
  v_mul_f32 v80, s40, v80
  v_mul_f32 v81, s40, v81
  v_mul_f32 v82, s40, v82
  v_mfma_f32_16x16x32_bf16 v[116:119], a[60:63], a[108:111], v[116:119]
  ds_read_b128 a[120:123], v2 offset:63488
  v_mul_f32 v83, s40, v83
  v_mul_f32 v84, s40, v84
  v_mfma_f32_16x16x32_bf16 v[120:123], a[64:67], a[108:111], v[120:123]
  v_mul_f32 v85, s40, v85
  v_mul_f32 v86, s40, v86
  v_mfma_f32_16x16x32_bf16 v[124:127], a[108:111], a[68:71], v[124:127]
  v_mul_f32 v87, s40, v87
  v_cvt_pk_bf16_f32 v136, v80, v81
  v_cvt_pk_bf16_f32 v137, v82, v83
  s_waitcnt lgkmcnt(1)
  v_mfma_f32_16x16x32_bf16 v[104:107], a[72:75], a[112:115], v[104:107]
  ds_read_b128 a[124:127], v2 offset:64512
  v_cvt_pk_bf16_f32 v138, v84, v85
  v_cvt_pk_bf16_f32 v139, v86, v87
  v_mfma_f32_16x16x32_bf16 v[108:111], a[76:79], a[112:115], v[108:111]
  buffer_store_dwordx4 v[136:139], v27, s[28:31], s36 offen offset:0 sc1
  v_mul_f32 v92, s40, v92
  v_mfma_f32_16x16x32_bf16 v[112:115], a[112:115], a[80:83], v[112:115]
  v_mul_f32 v93, s40, v93
  v_mul_f32 v94, s40, v94
  v_mul_f32 v95, s40, v95
  v_mfma_f32_16x16x32_bf16 v[116:119], a[72:75], a[116:119], v[116:119]
  v_mul_f32 v96, s40, v96
  v_mul_f32 v97, s40, v97
  v_mfma_f32_16x16x32_bf16 v[120:123], a[76:79], a[116:119], v[120:123]
  v_mul_f32 v98, s40, v98
  v_mul_f32 v99, s40, v99
  v_mfma_f32_16x16x32_bf16 v[124:127], a[116:119], a[80:83], v[124:127]
  v_cvt_pk_bf16_f32 v140, v92, v93
  v_cvt_pk_bf16_f32 v141, v94, v95
  v_cvt_pk_bf16_f32 v142, v96, v97
  s_waitcnt lgkmcnt(0)
  v_mfma_f32_16x16x32_bf16 v[104:107], a[84:87], a[120:123], v[104:107]
  v_cvt_pk_bf16_f32 v143, v98, v99
  buffer_store_dwordx4 v[140:143], v27, s[28:31], s36 offen offset:256 sc1
  v_mfma_f32_16x16x32_bf16 v[108:111], a[88:91], a[120:123], v[108:111]
  v_cvt_pk_bf16_f32 v128, v88, v89
  v_cvt_pk_bf16_f32 v129, v90, v91
  v_mfma_f32_16x16x32_bf16 v[112:115], a[120:123], a[92:95], v[112:115]
  v_cvt_pk_bf16_f32 v130, v100, v101
  v_cvt_pk_bf16_f32 v131, v102, v103
  s_nop 1
  v_mfma_f32_16x16x32_bf16 v[116:119], a[84:87], a[124:127], v[116:119]
  v_permlane16_swap_b32 v128, v130
  v_permlane16_swap_b32 v129, v131
  v_mfma_f32_16x16x32_bf16 v[120:123], a[88:91], a[124:127], v[120:123]
  s_nop 0
  buffer_store_dwordx4 v[128:131], v28, s[28:31], s38 offen offset:0 sc1
  v_mfma_f32_16x16x32_bf16 v[124:127], a[124:127], a[92:95], v[124:127]
  s_add_u32 s36, s36, s39
  s_add_u32 s38, s38, 4096
  s_nop 7
  v_mul_f32 v104, s40, v104
  v_mul_f32 v105, s40, v105
  v_mul_f32 v106, s40, v106
  v_mul_f32 v107, s40, v107
  v_mul_f32 v108, s40, v108
  v_mul_f32 v109, s40, v109
  v_mul_f32 v110, s40, v110
  v_mul_f32 v111, s40, v111
  v_cvt_pk_bf16_f32 v132, v104, v105
  v_cvt_pk_bf16_f32 v133, v106, v107
  v_cvt_pk_bf16_f32 v134, v108, v109
  v_cvt_pk_bf16_f32 v135, v110, v111
  buffer_store_dwordx4 v[132:135], v27, s[28:31], s36 offen offset:0 sc1
  v_mul_f32 v116, s40, v116
  v_mul_f32 v117, s40, v117
  v_mul_f32 v118, s40, v118
  v_mul_f32 v119, s40, v119
  v_mul_f32 v120, s40, v120
  v_mul_f32 v121, s40, v121
  v_mul_f32 v122, s40, v122
  v_mul_f32 v123, s40, v123
  v_cvt_pk_bf16_f32 v136, v116, v117
  v_cvt_pk_bf16_f32 v137, v118, v119
  v_cvt_pk_bf16_f32 v138, v120, v121
  v_cvt_pk_bf16_f32 v139, v122, v123
  buffer_store_dwordx4 v[136:139], v27, s[28:31], s36 offen offset:256 sc1
  v_cvt_pk_bf16_f32 v140, v112, v113
  v_cvt_pk_bf16_f32 v141, v114, v115
  v_cvt_pk_bf16_f32 v142, v124, v125
  v_cvt_pk_bf16_f32 v143, v126, v127
  s_nop 1
  v_permlane16_swap_b32 v140, v142
  v_permlane16_swap_b32 v141, v143
  s_nop 0
  buffer_store_dwordx4 v[140:143], v28, s[28:31], s38 offen offset:0 sc1
  s_add_u32 s36, s36, s39
  s_add_u32 s38, s38, 4096
L_end_20:
  s_endpgm
.text
.globl attn_kernel
.p2align 8
.type attn_kernel,@function
attn_kernel:
  s_cmp_ge_u32 s2, 256
  s_cbranch_scc1 L_side_23
  s_load_dwordx2 s[4:5], s[0:1], 88
  v_lshrrev_b32 v1, 6, v0
  v_and_b32 v0, 63, v0
  v_readfirstlane_b32 s20, v1
  s_and_b32 s23, s2, 7
  s_lshr_b32 s24, s2, 3
  v_lshlrev_b32 v2, 4, v0
  s_lshl_b32 s21, s23, 2
  s_lshr_b32 s25, s24, 3
  s_add_u32 s21, s21, s25
  s_and_b32 s22, s24, 7
  s_lshl_b32 s22, s22, 3
  s_lshl_b32 s25, s20, 1
  s_add_u32 s22, s22, s25
  s_lshl_b32 s25, s21, 18
  s_add_u32 s25, s25, 9437184
  s_lshl_b32 s26, s21, 6
  s_add_u32 s26, s26, s22
  s_lshl_b32 s26, s26, 11
  s_lshl_b32 s18, s20, 12
  s_mov_b32 s27, 0
  s_waitcnt lgkmcnt(0)
  s_add_u32 s8, s4, s25
  s_addc_u32 s9, s5, 0
  s_mov_b32 s10, 0x40000
  s_mov_b32 s11, 0x20000
  s_add_u32 s12, s4, 0x500000
  s_addc_u32 s13, s5, 0
  s_mov_b32 s14, 0x400000
  s_mov_b32 s15, 0x20000
  buffer_load_dwordx4 a[0:3], v2, s[12:15], s26 offen offset:0
  buffer_load_dwordx4 a[4:7], v2, s[12:15], s26 offen offset:1024
  buffer_load_dwordx4 a[8:11], v2, s[12:15], s26 offen offset:2048
  buffer_load_dwordx4 a[12:15], v2, s[12:15], s26 offen offset:3072
L_start_24:
  s_mov_b32 s16, s18
  s_add_u32 m0, s18, 0
  s_nop 0
  buffer_load_dwordx4 v2, s[8:11], s16 offen offset:0 lds
  buffer_load_dwordx4 v2, s[8:11], s16 offen offset:1024 lds
  buffer_load_dwordx4 v2, s[8:11], s16 offen offset:2048 lds
  buffer_load_dwordx4 v2, s[8:11], s16 offen offset:3072 lds
  s_add_u32 s16, s16, 16384
  s_add_u32 m0, s18, 16384
  s_nop 0
  buffer_load_dwordx4 v2, s[8:11], s16 offen offset:0 lds
  buffer_load_dwordx4 v2, s[8:11], s16 offen offset:1024 lds
  buffer_load_dwordx4 v2, s[8:11], s16 offen offset:2048 lds
  buffer_load_dwordx4 v2, s[8:11], s16 offen offset:3072 lds
  s_add_u32 s16, s16, 16384
  s_add_u32 s28, s4, 0x1100000
  s_addc_u32 s29, s5, 0
  s_mov_b32 s30, 0x400000
  s_mov_b32 s31, 0x20000
  v_add_u32 v3, 65536, v2
  v_and_b32 v4, 7, v0
  v_mov_b32 v5, 0x3f803f80
  v_cmp_eq_u32 vcc, 0, v4
  v_cmp_eq_u32 s[32:33], 4, v4
  v_mov_b32 v88, 0xdddddddd
  s_nop 0
  v_cndmask_b32 v6, 0, v5, vcc
  v_cndmask_b32 v7, 0, v5, s[32:33]
  v_accvgpr_write_b32 a48, v6
  v_accvgpr_write_b32 a49, v6
  v_accvgpr_write_b32 a50, v7
  v_accvgpr_write_b32 a51, v7
  v_mov_b32 v48, 0
  v_mov_b32 v49, 0
  v_mov_b32 v50, 0
  v_mov_b32 v51, 0
  v_mov_b32 v52, 0
  v_mov_b32 v53, 0
  v_mov_b32 v54, 0
  v_mov_b32 v55, 0
  v_mov_b32 v56, 0
  v_mov_b32 v57, 0
  v_mov_b32 v58, 0
  v_mov_b32 v59, 0
  v_mov_b32 v60, 0
  v_mov_b32 v61, 0
  v_mov_b32 v62, 0
  v_mov_b32 v63, 0
  v_mov_b32 v64, 0
  v_mov_b32 v65, 0
  v_mov_b32 v66, 0
  v_mov_b32 v67, 0
  v_mov_b32 v68, 0
  v_mov_b32 v69, 0
  v_mov_b32 v70, 0
  v_mov_b32 v71, 0
  v_mov_b32 v72, 0
  v_mov_b32 v73, 0
  v_mov_b32 v74, 0
  v_mov_b32 v75, 0
  v_mov_b32 v76, 0
  v_mov_b32 v77, 0
  v_mov_b32 v78, 0
  v_mov_b32 v79, 0
  v_mov_b32 v80, 0
  v_mov_b32 v81, 0
  v_mov_b32 v82, 0
  v_mov_b32 v83, 0
  v_mov_b32 v84, 0
  v_mov_b32 v85, 0
  v_mov_b32 v86, 0
  v_mov_b32 v87, 0
  v_accvgpr_write_b32 a44, 0
  v_accvgpr_write_b32 a45, 0
  v_accvgpr_write_b32 a46, 0
  v_accvgpr_write_b32 a47, 0
  v_mov_b32 v148, 0
  v_mov_b32 v149, 0
  v_mov_b32 v150, 0
  v_mov_b32 v151, 0
  v_mov_b32 v152, 0
  v_mov_b32 v153, 0
  v_mov_b32 v154, 0
  v_mov_b32 v155, 0
  s_getpc_b64 s[36:37]
L_pc_27:
  s_mov_b32 s38, L_code_end-L_pc_27
  s_mov_b32 s39, 0x20000
  s_lshl_b32 s40, s24, 2
  s_add_u32 s40, s40, s20
  s_lshl_b32 s41, s40, 10
  s_add_u32 s41, s41, L_tail_code-L_pc_27
  s_lshl_b32 s40, s40, 8
  v_and_b32 v8, 1, v0
  v_lshlrev_b32 v8, 7, v8
  v_lshlrev_b32 v9, 7, v4
  buffer_load_dword v89, v8, s[36:39], s40 offen
  s_waitcnt vmcnt(5)
  s_barrier
  ds_read_b128 a[16:19], v2
  ds_read_b128 a[20:23], v2 offset:1024
  ds_read_b128 a[32:35], v2 offset:2048
  ds_read_b128 a[36:39], v2 offset:3072
  s_add_u32 m0, s18, 32768
  s_nop 0
  buffer_load_dwordx4 v2, s[8:11], s16 offen offset:0 lds
  buffer_load_dwordx4 v2, s[8:11], s16 offen offset:1024 lds
  buffer_load_dwordx4 v2, s[8:11], s16 offen offset:2048 lds
  buffer_load_dwordx4 v2, s[8:11], s16 offen offset:3072 lds
  s_add_u32 s16, s16, 16384
  s_cmp_lg_u32 s27, 0
  s_waitcnt lgkmcnt(2)
  s_cbranch_scc1 L_skipm_26
  v_mfma_f32_32x32x16_bf16 v[108:123], a[16:19], a[0:3], 0
  v_mfma_f32_32x32x16_bf16 v[108:123], a[20:23], a[4:7], v[108:123]
  v_mfma_f32_32x32x16_bf16 v[124:139], a[16:19], a[8:11], 0
  v_mfma_f32_32x32x16_bf16 v[124:139], a[20:23], a[12:15], v[124:139]
  s_nop 9
  v_max3_f32 v4, v108, v109, v110
  v_max3_f32 v4, v111, v112, v4
  v_max3_f32 v4, v113, v114, v4
  v_max3_f32 v4, v115, v116, v4
  v_max3_f32 v4, v117, v118, v4
  v_max3_f32 v4, v119, v120, v4
  v_max3_f32 v4, v121, v122, v4
  v_max_f32 v4, v123, v4
  v_max3_f32 v5, v124, v125, v126
  v_max3_f32 v5, v127, v128, v5
  v_max3_f32 v5, v129, v130, v5
  v_max3_f32 v5, v131, v132, v5
  v_max3_f32 v5, v133, v134, v5
  v_max3_f32 v5, v135, v136, v5
  v_max3_f32 v5, v137, v138, v5
  v_max_f32 v5, v139, v5
  v_mov_b32 v6, v4
  v_mov_b32 v7, v5
  s_nop 1
  v_permlane32_swap_b32 v4, v6
  v_permlane32_swap_b32 v5, v7
  s_nop 1
  v_max_f32 v4, v4, v6
  v_max_f32 v5, v5, v7
  v_sub_f32 v16, 0, v4
  v_sub_f32 v17, 0, v4
  v_sub_f32 v18, 0, v4
  v_sub_f32 v19, 0, v4
  v_sub_f32 v20, 0, v4
  v_sub_f32 v21, 0, v4
  v_sub_f32 v22, 0, v4
  v_sub_f32 v23, 0, v4
  v_sub_f32 v24, 0, v4
  v_sub_f32 v25, 0, v4
  v_sub_f32 v26, 0, v4
  v_sub_f32 v27, 0, v4
  v_sub_f32 v28, 0, v4
  v_sub_f32 v29, 0, v4
  v_sub_f32 v30, 0, v4
  v_sub_f32 v31, 0, v4
  v_sub_f32 v32, 0, v5
  v_sub_f32 v33, 0, v5
  v_sub_f32 v34, 0, v5
  v_sub_f32 v35, 0, v5
  v_sub_f32 v36, 0, v5
  v_sub_f32 v37, 0, v5
  v_sub_f32 v38, 0, v5
  v_sub_f32 v39, 0, v5
  v_sub_f32 v40, 0, v5
  v_sub_f32 v41, 0, v5
  v_sub_f32 v42, 0, v5
  v_sub_f32 v43, 0, v5
  v_sub_f32 v44, 0, v5
  v_sub_f32 v45, 0, v5
  v_sub_f32 v46, 0, v5
  v_sub_f32 v47, 0, v5
L_skipm_26:
  s_nop 1
  v_mfma_f32_32x32x16_bf16 v[92:107], a[16:19], a[0:3], v[16:31]
  v_mfma_f32_32x32x16_bf16 v[92:107], a[20:23], a[4:7], v[92:107]
  s_add_u32 m0, s18, 49152
  s_nop 0
  buffer_load_dwordx4 v2, s[8:11], s16 offen offset:0 lds
  buffer_load_dwordx4 v2, s[8:11], s16 offen offset:1024 lds
  buffer_load_dwordx4 v2, s[8:11], s16 offen offset:2048 lds
  buffer_load_dwordx4 v2, s[8:11], s16 offen offset:3072 lds
  s_add_u32 s16, s16, 16384
  s_waitcnt lgkmcnt(0)
  s_nop 3
  v_mfma_f32_32x32x16_bf16 v[108:123], a[16:19], a[8:11], v[32:47]
  v_exp_f32 v92, v92
  v_exp_f32 v93, v93
  v_exp_f32 v94, v94
  v_smfmac_f32_32x32x32_bf16 v[64:79], a[44:47], v[148:155], v88
  ds_read_b128 a[24:27], v2 offset:4096
  v_exp_f32 v95, v95
  v_exp_f32 v96, v96
  v_mfma_f32_32x32x16_bf16 v[108:123], a[20:23], a[12:15], v[108:123]
  ds_read_b128 a[28:31], v2 offset:5120
  s_add_u32 m0, s18, 65536
  v_exp_f32 v97, v97
  v_exp_f32 v98, v98
  v_exp_f32 v99, v99
  v_smfmac_f32_16x16x64_bf16 v[84:87], a[48:51], v[148:155], v88
  buffer_load_dwordx4 v2, s[8:11], s16 offen offset:0 lds
  v_exp_f32 v100, v100
  v_exp_f32 v101, v101
  v_smfmac_f32_32x32x32_bf16 v[48:63], a[32:35], v[92:99], v88
  v_exp_f32 v102, v102
  v_exp_f32 v103, v103
  v_exp_f32 v104, v104
  v_smfmac_f32_16x16x64_bf16 v[80:83], a[48:51], v[92:99], v88
  buffer_load_dwordx4 v2, s[8:11], s16 offen offset:1024 lds
  v_exp_f32 v105, v105
  v_exp_f32 v106, v106
  v_exp_f32 v107, v107
  s_waitcnt lgkmcnt(0)
  v_mfma_f32_32x32x16_bf16 v[124:139], a[24:27], a[0:3], v[16:31]
  v_exp_f32 v108, v108
  v_exp_f32 v109, v109
  v_exp_f32 v110, v110
  v_smfmac_f32_32x32x32_bf16 v[48:63], a[36:39], v[100:107], v88
  ds_read_b128 a[40:43], v2 offset:6144
  v_exp_f32 v111, v111
  v_exp_f32 v112, v112
  v_mfma_f32_32x32x16_bf16 v[124:139], a[28:31], a[4:7], v[124:139]
  ds_read_b128 a[44:47], v2 offset:7168
  buffer_load_dwordx4 v2, s[8:11], s16 offen offset:2048 lds
  v_exp_f32 v113, v113
  v_exp_f32 v114, v114
  v_exp_f32 v115, v115
  v_smfmac_f32_16x16x64_bf16 v[80:83], a[48:51], v[100:107], v88
  buffer_load_dwordx4 v2, s[8:11], s16 offen offset:3072 lds
  v_exp_f32 v116, v116
  v_exp_f32 v117, v117
  v_smfmac_f32_32x32x32_bf16 v[64:79], a[32:35], v[108:115], v88
  v_exp_f32 v118, v118
  v_exp_f32 v119, v119
  v_exp_f32 v120, v120
  v_smfmac_f32_16x16x64_bf16 v[84:87], a[48:51], v[108:115], v88
  s_add_u32 s16, s16, 16384
  v_exp_f32 v121, v121
  v_exp_f32 v122, v122
  v_exp_f32 v123, v123
  s_waitcnt lgkmcnt(0)
  v_mfma_f32_32x32x16_bf16 v[140:155], a[24:27], a[8:11], v[32:47]
  v_exp_f32 v124, v124
  v_exp_f32 v125, v125
  v_exp_f32 v126, v126
  v_smfmac_f32_32x32x32_bf16 v[64:79], a[36:39], v[116:123], v88
  ds_read_b128 a[16:19], v2 offset:8192
  v_exp_f32 v127, v127
  v_exp_f32 v128, v128
  v_mfma_f32_32x32x16_bf16 v[140:155], a[28:31], a[12:15], v[140:155]
  ds_read_b128 a[20:23], v2 offset:9216
  v_exp_f32 v129, v129
  v_exp_f32 v130, v130
  v_exp_f32 v131, v131
  v_smfmac_f32_16x16x64_bf16 v[84:87], a[48:51], v[116:123], v88
  v_exp_f32 v132, v132
  v_exp_f32 v133, v133
  v_smfmac_f32_32x32x32_bf16 v[48:63], a[40:43], v[124:131], v88
  v_exp_f32 v134, v134
  v_exp_f32 v135, v135
  v_exp_f32 v136, v136
  v_smfmac_f32_16x16x64_bf16 v[80:83], a[48:51], v[124:131], v88
  v_exp_f32 v137, v137
  v_exp_f32 v138, v138
  v_exp_f32 v139, v139
  s_waitcnt lgkmcnt(0)
  v_mfma_f32_32x32x16_bf16 v[92:107], a[16:19], a[0:3], v[16:31]
  v_exp_f32 v140, v140
  v_exp_f32 v141, v141
  v_exp_f32 v142, v142
  v_smfmac_f32_32x32x32_bf16 v[48:63], a[44:47], v[132:139], v88
  ds_read_b128 a[32:35], v2 offset:10240
  v_exp_f32 v143, v143
  v_exp_f32 v144, v144
  v_mfma_f32_32x32x16_bf16 v[92:107], a[20:23], a[4:7], v[92:107]
  ds_read_b128 a[36:39], v2 offset:11264
  v_exp_f32 v145, v145
  v_exp_f32 v146, v146
  v_exp_f32 v147, v147
  v_smfmac_f32_16x16x64_bf16 v[80:83], a[48:51], v[132:139], v88
  v_exp_f32 v148, v148
  v_exp_f32 v149, v149
  v_smfmac_f32_32x32x32_bf16 v[64:79], a[40:43], v[140:147], v88
  v_exp_f32 v150, v150
  v_exp_f32 v151, v151
  v_exp_f32 v152, v152
  v_smfmac_f32_16x16x64_bf16 v[84:87], a[48:51], v[140:147], v88
  v_exp_f32 v153, v153
  v_exp_f32 v154, v154
  v_exp_f32 v155, v155
  s_waitcnt lgkmcnt(0)
  v_mfma_f32_32x32x16_bf16 v[108:123], a[16:19], a[8:11], v[32:47]
  v_exp_f32 v92, v92
  v_exp_f32 v93, v93
  v_exp_f32 v94, v94
  v_smfmac_f32_32x32x32_bf16 v[64:79], a[44:47], v[148:155], v88
  ds_read_b128 a[24:27], v2 offset:12288
  v_exp_f32 v95, v95
  v_exp_f32 v96, v96
  v_mfma_f32_32x32x16_bf16 v[108:123], a[20:23], a[12:15], v[108:123]
  ds_read_b128 a[28:31], v2 offset:13312
  v_exp_f32 v97, v97
  v_exp_f32 v98, v98
  v_exp_f32 v99, v99
  v_smfmac_f32_16x16x64_bf16 v[84:87], a[48:51], v[148:155], v88
  v_exp_f32 v100, v100
  v_exp_f32 v101, v101
  v_smfmac_f32_32x32x32_bf16 v[48:63], a[32:35], v[92:99], v88
  v_exp_f32 v102, v102
  v_exp_f32 v103, v103
  v_exp_f32 v104, v104
  v_smfmac_f32_16x16x64_bf16 v[80:83], a[48:51], v[92:99], v88
  v_exp_f32 v105, v105
  v_exp_f32 v106, v106
  v_exp_f32 v107, v107
  s_waitcnt lgkmcnt(0)
  v_mfma_f32_32x32x16_bf16 v[124:139], a[24:27], a[0:3], v[16:31]
  v_exp_f32 v108, v108
  v_exp_f32 v109, v109
  v_exp_f32 v110, v110
  v_smfmac_f32_32x32x32_bf16 v[48:63], a[36:39], v[100:107], v88
  ds_read_b128 a[40:43], v2 offset:14336
  v_exp_f32 v111, v111
  v_exp_f32 v112, v112
  v_mfma_f32_32x32x16_bf16 v[124:139], a[28:31], a[4:7], v[124:139]
  ds_read_b128 a[44:47], v2 offset:15360
  v_exp_f32 v113, v113
  v_exp_f32 v114, v114
  v_exp_f32 v115, v115
  v_smfmac_f32_16x16x64_bf16 v[80:83], a[48:51], v[100:107], v88
  v_exp_f32 v116, v116
  v_exp_f32 v117, v117
  v_smfmac_f32_32x32x32_bf16 v[64:79], a[32:35], v[108:115], v88
  v_exp_f32 v118, v118
  v_exp_f32 v119, v119
  v_exp_f32 v120, v120
  v_smfmac_f32_16x16x64_bf16 v[84:87], a[48:51], v[108:115], v88
  v_exp_f32 v121, v121
  v_exp_f32 v122, v122
  v_exp_f32 v123, v123
  s_waitcnt vmcnt(13) lgkmcnt(0)
  v_mfma_f32_32x32x16_bf16 v[140:155], a[24:27], a[8:11], v[32:47]
  s_barrier
  v_exp_f32 v124, v124
  v_exp_f32 v125, v125
  v_exp_f32 v126, v126
  v_smfmac_f32_32x32x32_bf16 v[64:79], a[36:39], v[116:123], v88
  ds_read_b128 a[16:19], v2 offset:16384
  v_exp_f32 v127, v127
  v_exp_f32 v128, v128
  v_mfma_f32_32x32x16_bf16 v[140:155], a[28:31], a[12:15], v[140:155]
  ds_read_b128 a[20:23], v2 offset:17408
  v_exp_f32 v129, v129
  v_exp_f32 v130, v130
  v_exp_f32 v131, v131
  v_smfmac_f32_16x16x64_bf16 v[84:87], a[48:51], v[116:123], v88
  s_add_u32 m0, s18, 0
  v_exp_f32 v132, v132
  v_exp_f32 v133, v133
  v_smfmac_f32_32x32x32_bf16 v[48:63], a[40:43], v[124:131], v88
  v_exp_f32 v134, v134
  v_exp_f32 v135, v135
  v_exp_f32 v136, v136
  v_smfmac_f32_16x16x64_bf16 v[80:83], a[48:51], v[124:131], v88
  buffer_load_dwordx4 v2, s[8:11], s16 offen offset:0 lds
  v_exp_f32 v137, v137
  v_exp_f32 v138, v138
  v_exp_f32 v139, v139
  s_waitcnt lgkmcnt(0)
  v_mfma_f32_32x32x16_bf16 v[92:107], a[16:19], a[0:3], v[16:31]
  v_exp_f32 v140, v140
  v_exp_f32 v141, v141
  v_exp_f32 v142, v142
  v_smfmac_f32_32x32x32_bf16 v[48:63], a[44:47], v[132:139], v88
  ds_read_b128 a[32:35], v2 offset:18432
  v_exp_f32 v143, v143
  v_exp_f32 v144, v144
  v_mfma_f32_32x32x16_bf16 v[92:107], a[20:23], a[4:7], v[92:107]
  ds_read_b128 a[36:39], v2 offset:19456
  buffer_load_dwordx4 v2, s[8:11], s16 offen offset:1024 lds
  v_exp_f32 v145, v145
  v_exp_f32 v146, v146
  v_exp_f32 v147, v147
  v_smfmac_f32_16x16x64_bf16 v[80:83], a[48:51], v[132:139], v88
  v_exp_f32 v148, v148
  v_exp_f32 v149, v149
  v_smfmac_f32_32x32x32_bf16 v[64:79], a[40:43], v[140:147], v88
  v_exp_f32 v150, v150
  v_exp_f32 v151, v151
  v_exp_f32 v152, v152
  v_smfmac_f32_16x16x64_bf16 v[84:87], a[48:51], v[140:147], v88
  buffer_load_dwordx4 v2, s[8:11], s16 offen offset:2048 lds
  v_exp_f32 v153, v153
  v_exp_f32 v154, v154
  v_exp_f32 v155, v155
  s_waitcnt lgkmcnt(0)
  v_mfma_f32_32x32x16_bf16 v[108:123], a[16:19], a[8:11], v[32:47]
  v_exp_f32 v92, v92
  v_exp_f32 v93, v93
  v_exp_f32 v94, v94
  v_smfmac_f32_32x32x32_bf16 v[64:79], a[44:47], v[148:155], v88
  ds_read_b128 a[24:27], v2 offset:20480
  v_exp_f32 v95, v95
  v_exp_f32 v96, v96
  v_mfma_f32_32x32x16_bf16 v[108:123], a[20:23], a[12:15], v[108:123]
  ds_read_b128 a[28:31], v2 offset:21504
  buffer_load_dwordx4 v2, s[8:11], s16 offen offset:3072 lds
  v_exp_f32 v97, v97
  v_exp_f32 v98, v98
  v_exp_f32 v99, v99
  v_smfmac_f32_16x16x64_bf16 v[84:87], a[48:51], v[148:155], v88
  s_add_u32 s16, s16, 16384
  v_exp_f32 v100, v100
  v_exp_f32 v101, v101
  v_smfmac_f32_32x32x32_bf16 v[48:63], a[32:35], v[92:99], v88
  v_exp_f32 v102, v102
  v_exp_f32 v103, v103
  v_exp_f32 v104, v104
  v_smfmac_f32_16x16x64_bf16 v[80:83], a[48:51], v[92:99], v88
  v_exp_f32 v105, v105
  v_exp_f32 v106, v106
  v_exp_f32 v107, v107
  s_waitcnt lgkmcnt(0)
  v_mfma_f32_32x32x16_bf16 v[124:139], a[24:27], a[0:3], v[16:31]
  v_exp_f32 v108, v108
  v_exp_f32 v109, v109
  v_exp_f32 v110, v110
  v_smfmac_f32_32x32x32_bf16 v[48:63], a[36:39], v[100:107], v88
  ds_read_b128 a[40:43], v2 offset:22528
  v_exp_f32 v111, v111
  v_exp_f32 v112, v112
  v_mfma_f32_32x32x16_bf16 v[124:139], a[28:31], a[4:7], v[124:139]
  ds_read_b128 a[44:47], v2 offset:23552
  v_exp_f32 v113, v113
  v_exp_f32 v114, v114
  v_exp_f32 v115, v115
  v_smfmac_f32_16x16x64_bf16 v[80:83], a[48:51], v[100:107], v88
  v_exp_f32 v116, v116
  v_exp_f32 v117, v117
  v_smfmac_f32_32x32x32_bf16 v[64:79], a[32:35], v[108:115], v88
  v_exp_f32 v118, v118
  v_exp_f32 v119, v119
  v_exp_f32 v120, v120
  v_smfmac_f32_16x16x64_bf16 v[84:87], a[48:51], v[108:115], v88
  v_exp_f32 v121, v121
  v_exp_f32 v122, v122
  v_exp_f32 v123, v123
  s_waitcnt lgkmcnt(0)
  v_mfma_f32_32x32x16_bf16 v[140:155], a[24:27], a[8:11], v[32:47]
  v_exp_f32 v124, v124
  v_exp_f32 v125, v125
  v_exp_f32 v126, v126
  v_smfmac_f32_32x32x32_bf16 v[64:79], a[36:39], v[116:123], v88
  ds_read_b128 a[16:19], v2 offset:24576
  v_exp_f32 v127, v127
  v_exp_f32 v128, v128
  v_mfma_f32_32x32x16_bf16 v[140:155], a[28:31], a[12:15], v[140:155]
  ds_read_b128 a[20:23], v2 offset:25600
  v_exp_f32 v129, v129
  v_exp_f32 v130, v130
  v_exp_f32 v131, v131
  v_smfmac_f32_16x16x64_bf16 v[84:87], a[48:51], v[116:123], v88
  v_exp_f32 v132, v132
  v_exp_f32 v133, v133
  v_smfmac_f32_32x32x32_bf16 v[48:63], a[40:43], v[124:131], v88
  v_exp_f32 v134, v134
  v_exp_f32 v135, v135
  v_exp_f32 v136, v136
  v_smfmac_f32_16x16x64_bf16 v[80:83], a[48:51], v[124:131], v88
  v_exp_f32 v137, v137
  v_exp_f32 v138, v138
  v_exp_f32 v139, v139
  s_waitcnt lgkmcnt(0)
  v_mfma_f32_32x32x16_bf16 v[92:107], a[16:19], a[0:3], v[16:31]
  v_exp_f32 v140, v140
  v_exp_f32 v141, v141
  v_exp_f32 v142, v142
  v_smfmac_f32_32x32x32_bf16 v[48:63], a[44:47], v[132:139], v88
  ds_read_b128 a[32:35], v2 offset:26624
  v_exp_f32 v143, v143
  v_exp_f32 v144, v144
  v_mfma_f32_32x32x16_bf16 v[92:107], a[20:23], a[4:7], v[92:107]
  ds_read_b128 a[36:39], v2 offset:27648
  v_exp_f32 v145, v145
  v_exp_f32 v146, v146
  v_exp_f32 v147, v147
  v_smfmac_f32_16x16x64_bf16 v[80:83], a[48:51], v[132:139], v88
  v_exp_f32 v148, v148
  v_exp_f32 v149, v149
  v_smfmac_f32_32x32x32_bf16 v[64:79], a[40:43], v[140:147], v88
  v_exp_f32 v150, v150
  v_exp_f32 v151, v151
  v_exp_f32 v152, v152
  v_smfmac_f32_16x16x64_bf16 v[84:87], a[48:51], v[140:147], v88
  v_exp_f32 v153, v153
  v_exp_f32 v154, v154
  v_exp_f32 v155, v155
  s_waitcnt lgkmcnt(0)
  v_mfma_f32_32x32x16_bf16 v[108:123], a[16:19], a[8:11], v[32:47]
  v_exp_f32 v92, v92
  v_exp_f32 v93, v93
  v_exp_f32 v94, v94
  v_smfmac_f32_32x32x32_bf16 v[64:79], a[44:47], v[148:155], v88
  ds_read_b128 a[24:27], v2 offset:28672
  v_exp_f32 v95, v95
  v_exp_f32 v96, v96
  v_mfma_f32_32x32x16_bf16 v[108:123], a[20:23], a[12:15], v[108:123]
  ds_read_b128 a[28:31], v2 offset:29696
  v_exp_f32 v97, v97
  v_exp_f32 v98, v98
  v_exp_f32 v99, v99
  v_smfmac_f32_16x16x64_bf16 v[84:87], a[48:51], v[148:155], v88
  v_exp_f32 v100, v100
  v_exp_f32 v101, v101
  v_smfmac_f32_32x32x32_bf16 v[48:63], a[32:35], v[92:99], v88
  v_exp_f32 v102, v102
  v_exp_f32 v103, v103
  v_exp_f32 v104, v104
  v_smfmac_f32_16x16x64_bf16 v[80:83], a[48:51], v[92:99], v88
  v_exp_f32 v105, v105
  v_exp_f32 v106, v106
  v_exp_f32 v107, v107
  s_waitcnt lgkmcnt(0)
  v_mfma_f32_32x32x16_bf16 v[124:139], a[24:27], a[0:3], v[16:31]
  v_exp_f32 v108, v108
  v_exp_f32 v109, v109
  v_exp_f32 v110, v110
  v_smfmac_f32_32x32x32_bf16 v[48:63], a[36:39], v[100:107], v88
  ds_read_b128 a[40:43], v2 offset:30720
  v_exp_f32 v111, v111
  v_exp_f32 v112, v112
  v_mfma_f32_32x32x16_bf16 v[124:139], a[28:31], a[4:7], v[124:139]
  ds_read_b128 a[44:47], v2 offset:31744
  v_exp_f32 v113, v113
  v_exp_f32 v114, v114
  v_exp_f32 v115, v115
  v_smfmac_f32_16x16x64_bf16 v[80:83], a[48:51], v[100:107], v88
  v_exp_f32 v116, v116
  v_exp_f32 v117, v117
  v_smfmac_f32_32x32x32_bf16 v[64:79], a[32:35], v[108:115], v88
  v_exp_f32 v118, v118
  v_exp_f32 v119, v119
  v_exp_f32 v120, v120
  v_smfmac_f32_16x16x64_bf16 v[84:87], a[48:51], v[108:115], v88
  v_exp_f32 v121, v121
  v_exp_f32 v122, v122
  v_exp_f32 v123, v123
  s_waitcnt vmcnt(12) lgkmcnt(0)
  v_mfma_f32_32x32x16_bf16 v[140:155], a[24:27], a[8:11], v[32:47]
  s_barrier
  v_exp_f32 v124, v124
  v_exp_f32 v125, v125
  v_exp_f32 v126, v126
  v_smfmac_f32_32x32x32_bf16 v[64:79], a[36:39], v[116:123], v88
  ds_read_b128 a[16:19], v2 offset:32768
  v_exp_f32 v127, v127
  v_exp_f32 v128, v128
  v_mfma_f32_32x32x16_bf16 v[140:155], a[28:31], a[12:15], v[140:155]
  ds_read_b128 a[20:23], v2 offset:33792
  v_exp_f32 v129, v129
  v_exp_f32 v130, v130
  v_exp_f32 v131, v131
  v_smfmac_f32_16x16x64_bf16 v[84:87], a[48:51], v[116:123], v88
  s_add_u32 m0, s18, 16384
  v_exp_f32 v132, v132
  v_exp_f32 v133, v133
  v_smfmac_f32_32x32x32_bf16 v[48:63], a[40:43], v[124:131], v88
  v_exp_f32 v134, v134
  v_exp_f32 v135, v135
  v_exp_f32 v136, v136
  v_smfmac_f32_16x16x64_bf16 v[80:83], a[48:51], v[124:131], v88
  buffer_load_dwordx4 v2, s[8:11], s16 offen offset:0 lds
  v_exp_f32 v137, v137
  v_exp_f32 v138, v138
  v_exp_f32 v139, v139
  s_waitcnt lgkmcnt(0)
  v_mfma_f32_32x32x16_bf16 v[92:107], a[16:19], a[0:3], v[16:31]
  v_exp_f32 v140, v140
  v_exp_f32 v141, v141
  v_exp_f32 v142, v142
  v_smfmac_f32_32x32x32_bf16 v[48:63], a[44:47], v[132:139], v88
  ds_read_b128 a[32:35], v2 offset:34816
  v_exp_f32 v143, v143
  v_exp_f32 v144, v144
  v_mfma_f32_32x32x16_bf16 v[92:107], a[20:23], a[4:7], v[92:107]
  ds_read_b128 a[36:39], v2 offset:35840
  buffer_load_dwordx4 v2, s[8:11], s16 offen offset:1024 lds
  v_exp_f32 v145, v145
  v_exp_f32 v146, v146
  v_exp_f32 v147, v147
  v_smfmac_f32_16x16x64_bf16 v[80:83], a[48:51], v[132:139], v88
  v_exp_f32 v148, v148
  v_exp_f32 v149, v149
  v_smfmac_f32_32x32x32_bf16 v[64:79], a[40:43], v[140:147], v88
  v_exp_f32 v150, v150
  v_exp_f32 v151, v151
  v_exp_f32 v152, v152
  v_smfmac_f32_16x16x64_bf16 v[84:87], a[48:51], v[140:147], v88
  buffer_load_dwordx4 v2, s[8:11], s16 offen offset:2048 lds
  v_exp_f32 v153, v153
  v_exp_f32 v154, v154
  v_exp_f32 v155, v155
  s_waitcnt lgkmcnt(0)
  v_mfma_f32_32x32x16_bf16 v[108:123], a[16:19], a[8:11], v[32:47]
  v_exp_f32 v92, v92
  v_exp_f32 v93, v93
  v_exp_f32 v94, v94
  v_smfmac_f32_32x32x32_bf16 v[64:79], a[44:47], v[148:155], v88
  ds_read_b128 a[24:27], v2 offset:36864
  v_exp_f32 v95, v95
  v_exp_f32 v96, v96
  v_mfma_f32_32x32x16_bf16 v[108:123], a[20:23], a[12:15], v[108:123]
  ds_read_b128 a[28:31], v2 offset:37888
  buffer_load_dwordx4 v2, s[8:11], s16 offen offset:3072 lds
  v_exp_f32 v97, v97
  v_exp_f32 v98, v98
  v_exp_f32 v99, v99
  v_smfmac_f32_16x16x64_bf16 v[84:87], a[48:51], v[148:155], v88
  s_add_u32 s16, s16, 16384
  v_exp_f32 v100, v100
  v_exp_f32 v101, v101
  v_smfmac_f32_32x32x32_bf16 v[48:63], a[32:35], v[92:99], v88
  v_exp_f32 v102, v102
  v_exp_f32 v103, v103
  v_exp_f32 v104, v104
  v_smfmac_f32_16x16x64_bf16 v[80:83], a[48:51], v[92:99], v88
  v_exp_f32 v105, v105
  v_exp_f32 v106, v106
  v_exp_f32 v107, v107
  s_waitcnt lgkmcnt(0)
  v_mfma_f32_32x32x16_bf16 v[124:139], a[24:27], a[0:3], v[16:31]
  v_exp_f32 v108, v108
  v_exp_f32 v109, v109
  v_exp_f32 v110, v110
  v_smfmac_f32_32x32x32_bf16 v[48:63], a[36:39], v[100:107], v88
  ds_read_b128 a[40:43], v2 offset:38912
  v_exp_f32 v111, v111
  v_exp_f32 v112, v112
  v_mfma_f32_32x32x16_bf16 v[124:139], a[28:31], a[4:7], v[124:139]
  ds_read_b128 a[44:47], v2 offset:39936
  v_exp_f32 v113, v113
  v_exp_f32 v114, v114
  v_exp_f32 v115, v115
  v_smfmac_f32_16x16x64_bf16 v[80:83], a[48:51], v[100:107], v88
  v_exp_f32 v116, v116
  v_exp_f32 v117, v117
  v_smfmac_f32_32x32x32_bf16 v[64:79], a[32:35], v[108:115], v88
  v_exp_f32 v118, v118
  v_exp_f32 v119, v119
  v_exp_f32 v120, v120
  v_smfmac_f32_16x16x64_bf16 v[84:87], a[48:51], v[108:115], v88
  v_exp_f32 v121, v121
  v_exp_f32 v122, v122
  v_exp_f32 v123, v123
  s_waitcnt lgkmcnt(0)
  v_mfma_f32_32x32x16_bf16 v[140:155], a[24:27], a[8:11], v[32:47]
  v_exp_f32 v124, v124
  v_exp_f32 v125, v125
  v_exp_f32 v126, v126
  v_smfmac_f32_32x32x32_bf16 v[64:79], a[36:39], v[116:123], v88
  ds_read_b128 a[16:19], v2 offset:40960
  v_exp_f32 v127, v127
  v_exp_f32 v128, v128
  v_mfma_f32_32x32x16_bf16 v[140:155], a[28:31], a[12:15], v[140:155]
  ds_read_b128 a[20:23], v2 offset:41984
  v_exp_f32 v129, v129
  v_exp_f32 v130, v130
  v_exp_f32 v131, v131
  v_smfmac_f32_16x16x64_bf16 v[84:87], a[48:51], v[116:123], v88
  v_exp_f32 v132, v132
  v_exp_f32 v133, v133
  v_smfmac_f32_32x32x32_bf16 v[48:63], a[40:43], v[124:131], v88
  v_exp_f32 v134, v134
  v_exp_f32 v135, v135
  v_exp_f32 v136, v136
  v_smfmac_f32_16x16x64_bf16 v[80:83], a[48:51], v[124:131], v88
  v_exp_f32 v137, v137
  v_exp_f32 v138, v138
  v_exp_f32 v139, v139
  s_waitcnt lgkmcnt(0)
  v_mfma_f32_32x32x16_bf16 v[92:107], a[16:19], a[0:3], v[16:31]
  v_exp_f32 v140, v140
  v_exp_f32 v141, v141
  v_exp_f32 v142, v142
  v_smfmac_f32_32x32x32_bf16 v[48:63], a[44:47], v[132:139], v88
  ds_read_b128 a[32:35], v2 offset:43008
  v_exp_f32 v143, v143
  v_exp_f32 v144, v144
  v_mfma_f32_32x32x16_bf16 v[92:107], a[20:23], a[4:7], v[92:107]
  ds_read_b128 a[36:39], v2 offset:44032
  v_exp_f32 v145, v145
  v_exp_f32 v146, v146
  v_exp_f32 v147, v147
  v_smfmac_f32_16x16x64_bf16 v[80:83], a[48:51], v[132:139], v88
  v_exp_f32 v148, v148
  v_exp_f32 v149, v149
  v_smfmac_f32_32x32x32_bf16 v[64:79], a[40:43], v[140:147], v88
  v_exp_f32 v150, v150
  v_exp_f32 v151, v151
  v_exp_f32 v152, v152
  v_smfmac_f32_16x16x64_bf16 v[84:87], a[48:51], v[140:147], v88
  v_exp_f32 v153, v153
  v_exp_f32 v154, v154
  v_exp_f32 v155, v155
  s_waitcnt lgkmcnt(0)
  v_mfma_f32_32x32x16_bf16 v[108:123], a[16:19], a[8:11], v[32:47]
  v_exp_f32 v92, v92
  v_exp_f32 v93, v93
  v_exp_f32 v94, v94
  v_smfmac_f32_32x32x32_bf16 v[64:79], a[44:47], v[148:155], v88
  ds_read_b128 a[24:27], v2 offset:45056
  v_exp_f32 v95, v95
  v_exp_f32 v96, v96
  v_mfma_f32_32x32x16_bf16 v[108:123], a[20:23], a[12:15], v[108:123]
  ds_read_b128 a[28:31], v2 offset:46080
  v_exp_f32 v97, v97
  v_exp_f32 v98, v98
  v_exp_f32 v99, v99
  v_smfmac_f32_16x16x64_bf16 v[84:87], a[48:51], v[148:155], v88
  v_exp_f32 v100, v100
  v_exp_f32 v101, v101
  v_smfmac_f32_32x32x32_bf16 v[48:63], a[32:35], v[92:99], v88
  v_exp_f32 v102, v102
  v_exp_f32 v103, v103
  v_exp_f32 v104, v104
  v_smfmac_f32_16x16x64_bf16 v[80:83], a[48:51], v[92:99], v88
  v_exp_f32 v105, v105
  v_exp_f32 v106, v106
  v_exp_f32 v107, v107
  s_waitcnt lgkmcnt(0)
  v_mfma_f32_32x32x16_bf16 v[124:139], a[24:27], a[0:3], v[16:31]
  v_exp_f32 v108, v108
  v_exp_f32 v109, v109
  v_exp_f32 v110, v110
  v_smfmac_f32_32x32x32_bf16 v[48:63], a[36:39], v[100:107], v88
  ds_read_b128 a[40:43], v2 offset:47104
  v_exp_f32 v111, v111
  v_exp_f32 v112, v112
  v_mfma_f32_32x32x16_bf16 v[124:139], a[28:31], a[4:7], v[124:139]
  ds_read_b128 a[44:47], v2 offset:48128
  v_exp_f32 v113, v113
  v_exp_f32 v114, v114
  v_exp_f32 v115, v115
  v_smfmac_f32_16x16x64_bf16 v[80:83], a[48:51], v[100:107], v88
  v_exp_f32 v116, v116
  v_exp_f32 v117, v117
  v_smfmac_f32_32x32x32_bf16 v[64:79], a[32:35], v[108:115], v88
  v_exp_f32 v118, v118
  v_exp_f32 v119, v119
  v_exp_f32 v120, v120
  v_smfmac_f32_16x16x64_bf16 v[84:87], a[48:51], v[108:115], v88
  v_exp_f32 v121, v121
  v_exp_f32 v122, v122
  v_exp_f32 v123, v123
  s_waitcnt vmcnt(12) lgkmcnt(0)
  v_mfma_f32_32x32x16_bf16 v[140:155], a[24:27], a[8:11], v[32:47]
  s_barrier
  v_exp_f32 v124, v124
  v_exp_f32 v125, v125
  v_exp_f32 v126, v126
  v_smfmac_f32_32x32x32_bf16 v[64:79], a[36:39], v[116:123], v88
  ds_read_b128 a[16:19], v2 offset:49152
  v_exp_f32 v127, v127
  v_exp_f32 v128, v128
  v_mfma_f32_32x32x16_bf16 v[140:155], a[28:31], a[12:15], v[140:155]
  ds_read_b128 a[20:23], v2 offset:50176
  v_exp_f32 v129, v129
  v_exp_f32 v130, v130
  v_exp_f32 v131, v131
  v_smfmac_f32_16x16x64_bf16 v[84:87], a[48:51], v[116:123], v88
  s_add_u32 m0, s18, 32768
  v_exp_f32 v132, v132
  v_exp_f32 v133, v133
  v_smfmac_f32_32x32x32_bf16 v[48:63], a[40:43], v[124:131], v88
  v_exp_f32 v134, v134
  v_exp_f32 v135, v135
  v_exp_f32 v136, v136
  v_smfmac_f32_16x16x64_bf16 v[80:83], a[48:51], v[124:131], v88
  buffer_load_dwordx4 v2, s[8:11], s16 offen offset:0 lds
  v_exp_f32 v137, v137
  v_exp_f32 v138, v138
  v_exp_f32 v139, v139
  s_waitcnt lgkmcnt(0)
  v_mfma_f32_32x32x16_bf16 v[92:107], a[16:19], a[0:3], v[16:31]
  v_exp_f32 v140, v140
  v_exp_f32 v141, v141
  v_exp_f32 v142, v142
  v_smfmac_f32_32x32x32_bf16 v[48:63], a[44:47], v[132:139], v88
  ds_read_b128 a[32:35], v2 offset:51200
  v_exp_f32 v143, v143
  v_exp_f32 v144, v144
  v_mfma_f32_32x32x16_bf16 v[92:107], a[20:23], a[4:7], v[92:107]
  ds_read_b128 a[36:39], v2 offset:52224
  buffer_load_dwordx4 v2, s[8:11], s16 offen offset:1024 lds
  v_exp_f32 v145, v145
  v_exp_f32 v146, v146
  v_exp_f32 v147, v147
  v_smfmac_f32_16x16x64_bf16 v[80:83], a[48:51], v[132:139], v88
  v_exp_f32 v148, v148
  v_exp_f32 v149, v149
  v_smfmac_f32_32x32x32_bf16 v[64:79], a[40:43], v[140:147], v88
  v_exp_f32 v150, v150
  v_exp_f32 v151, v151
  v_exp_f32 v152, v152
  v_smfmac_f32_16x16x64_bf16 v[84:87], a[48:51], v[140:147], v88
  buffer_load_dwordx4 v2, s[8:11], s16 offen offset:2048 lds
  v_exp_f32 v153, v153
  v_exp_f32 v154, v154
  v_exp_f32 v155, v155
  s_waitcnt lgkmcnt(0)
  v_mfma_f32_32x32x16_bf16 v[108:123], a[16:19], a[8:11], v[32:47]
  v_exp_f32 v92, v92
  v_exp_f32 v93, v93
  v_exp_f32 v94, v94
  v_smfmac_f32_32x32x32_bf16 v[64:79], a[44:47], v[148:155], v88
  ds_read_b128 a[24:27], v2 offset:53248
  v_exp_f32 v95, v95
  v_exp_f32 v96, v96
  v_mfma_f32_32x32x16_bf16 v[108:123], a[20:23], a[12:15], v[108:123]
  ds_read_b128 a[28:31], v2 offset:54272
  buffer_load_dwordx4 v2, s[8:11], s16 offen offset:3072 lds
  v_exp_f32 v97, v97
  v_exp_f32 v98, v98
  v_exp_f32 v99, v99
  v_smfmac_f32_16x16x64_bf16 v[84:87], a[48:51], v[148:155], v88
  s_add_u32 s16, s16, 16384
  v_exp_f32 v100, v100
  v_exp_f32 v101, v101
  v_smfmac_f32_32x32x32_bf16 v[48:63], a[32:35], v[92:99], v88
  v_exp_f32 v102, v102
  v_exp_f32 v103, v103
  v_exp_f32 v104, v104
  v_smfmac_f32_16x16x64_bf16 v[80:83], a[48:51], v[92:99], v88
  v_exp_f32 v105, v105
  v_exp_f32 v106, v106
  v_exp_f32 v107, v107
  s_waitcnt lgkmcnt(0)
  v_mfma_f32_32x32x16_bf16 v[124:139], a[24:27], a[0:3], v[16:31]
  v_exp_f32 v108, v108
  v_exp_f32 v109, v109
  v_exp_f32 v110, v110
  v_smfmac_f32_32x32x32_bf16 v[48:63], a[36:39], v[100:107], v88
  ds_read_b128 a[40:43], v2 offset:55296
  v_exp_f32 v111, v111
  v_exp_f32 v112, v112
  v_mfma_f32_32x32x16_bf16 v[124:139], a[28:31], a[4:7], v[124:139]
  ds_read_b128 a[44:47], v2 offset:56320
  v_exp_f32 v113, v113
  v_exp_f32 v114, v114
  v_exp_f32 v115, v115
  v_smfmac_f32_16x16x64_bf16 v[80:83], a[48:51], v[100:107], v88
  v_exp_f32 v116, v116
  v_exp_f32 v117, v117
  v_smfmac_f32_32x32x32_bf16 v[64:79], a[32:35], v[108:115], v88
  v_exp_f32 v118, v118
  v_exp_f32 v119, v119
  v_exp_f32 v120, v120
  v_smfmac_f32_16x16x64_bf16 v[84:87], a[48:51], v[108:115], v88
  v_exp_f32 v121, v121
  v_exp_f32 v122, v122
  v_exp_f32 v123, v123
  s_waitcnt lgkmcnt(0)
  v_mfma_f32_32x32x16_bf16 v[140:155], a[24:27], a[8:11], v[32:47]
  v_exp_f32 v124, v124
  v_exp_f32 v125, v125
  v_exp_f32 v126, v126
  v_smfmac_f32_32x32x32_bf16 v[64:79], a[36:39], v[116:123], v88
  ds_read_b128 a[16:19], v2 offset:57344
  v_exp_f32 v127, v127
  v_exp_f32 v128, v128
  v_mfma_f32_32x32x16_bf16 v[140:155], a[28:31], a[12:15], v[140:155]
  ds_read_b128 a[20:23], v2 offset:58368
  v_exp_f32 v129, v129
  v_exp_f32 v130, v130
  v_exp_f32 v131, v131
  v_smfmac_f32_16x16x64_bf16 v[84:87], a[48:51], v[116:123], v88
  v_exp_f32 v132, v132
  v_exp_f32 v133, v133
  v_smfmac_f32_32x32x32_bf16 v[48:63], a[40:43], v[124:131], v88
  v_exp_f32 v134, v134
  v_exp_f32 v135, v135
  v_exp_f32 v136, v136
  v_smfmac_f32_16x16x64_bf16 v[80:83], a[48:51], v[124:131], v88
  v_exp_f32 v137, v137
  v_exp_f32 v138, v138
  v_exp_f32 v139, v139
  s_waitcnt lgkmcnt(0)
  v_mfma_f32_32x32x16_bf16 v[92:107], a[16:19], a[0:3], v[16:31]
  v_exp_f32 v140, v140
  v_exp_f32 v141, v141
  v_exp_f32 v142, v142
  v_smfmac_f32_32x32x32_bf16 v[48:63], a[44:47], v[132:139], v88
  ds_read_b128 a[32:35], v2 offset:59392
  v_exp_f32 v143, v143
  v_exp_f32 v144, v144
  v_mfma_f32_32x32x16_bf16 v[92:107], a[20:23], a[4:7], v[92:107]
  ds_read_b128 a[36:39], v2 offset:60416
  v_exp_f32 v145, v145
  v_exp_f32 v146, v146
  v_exp_f32 v147, v147
  v_smfmac_f32_16x16x64_bf16 v[80:83], a[48:51], v[132:139], v88
  v_exp_f32 v148, v148
  v_exp_f32 v149, v149
  v_smfmac_f32_32x32x32_bf16 v[64:79], a[40:43], v[140:147], v88
  v_exp_f32 v150, v150
  v_exp_f32 v151, v151
  v_exp_f32 v152, v152
  v_smfmac_f32_16x16x64_bf16 v[84:87], a[48:51], v[140:147], v88
  v_exp_f32 v153, v153
  v_exp_f32 v154, v154
  v_exp_f32 v155, v155
  s_waitcnt lgkmcnt(0)
  v_mfma_f32_32x32x16_bf16 v[108:123], a[16:19], a[8:11], v[32:47]
  v_exp_f32 v92, v92
  v_exp_f32 v93, v93
  v_exp_f32 v94, v94
  v_smfmac_f32_32x32x32_bf16 v[64:79], a[44:47], v[148:155], v88
  ds_read_b128 a[24:27], v2 offset:61440
  v_exp_f32 v95, v95
  v_exp_f32 v96, v96
  v_mfma_f32_32x32x16_bf16 v[108:123], a[20:23], a[12:15], v[108:123]
  ds_read_b128 a[28:31], v2 offset:62464
  v_exp_f32 v97, v97
  v_exp_f32 v98, v98
  v_exp_f32 v99, v99
  v_smfmac_f32_16x16x64_bf16 v[84:87], a[48:51], v[148:155], v88
  v_exp_f32 v100, v100
  v_exp_f32 v101, v101
  v_smfmac_f32_32x32x32_bf16 v[48:63], a[32:35], v[92:99], v88
  v_exp_f32 v102, v102
  v_exp_f32 v103, v103
  v_exp_f32 v104, v104
  v_smfmac_f32_16x16x64_bf16 v[80:83], a[48:51], v[92:99], v88
  v_exp_f32 v105, v105
  v_exp_f32 v106, v106
  v_exp_f32 v107, v107
  s_waitcnt lgkmcnt(0)
  v_mfma_f32_32x32x16_bf16 v[124:139], a[24:27], a[0:3], v[16:31]
  v_exp_f32 v108, v108
  v_exp_f32 v109, v109
  v_exp_f32 v110, v110
  v_smfmac_f32_32x32x32_bf16 v[48:63], a[36:39], v[100:107], v88
  ds_read_b128 a[40:43], v2 offset:63488
  v_exp_f32 v111, v111
  v_exp_f32 v112, v112
  v_mfma_f32_32x32x16_bf16 v[124:139], a[28:31], a[4:7], v[124:139]
  ds_read_b128 a[44:47], v2 offset:64512
  v_exp_f32 v113, v113
  v_exp_f32 v114, v114
  v_exp_f32 v115, v115
  v_smfmac_f32_16x16x64_bf16 v[80:83], a[48:51], v[100:107], v88
  v_exp_f32 v116, v116
  v_exp_f32 v117, v117
  v_smfmac_f32_32x32x32_bf16 v[64:79], a[32:35], v[108:115], v88
  v_exp_f32 v118, v118
  v_exp_f32 v119, v119
  v_exp_f32 v120, v120
  v_smfmac_f32_16x16x64_bf16 v[84:87], a[48:51], v[108:115], v88
  v_exp_f32 v121, v121
  v_exp_f32 v122, v122
  v_exp_f32 v123, v123
  s_waitcnt vmcnt(12) lgkmcnt(0)
  v_mfma_f32_32x32x16_bf16 v[140:155], a[24:27], a[8:11], v[32:47]
  s_barrier
  v_exp_f32 v124, v124
  v_exp_f32 v125, v125
  v_exp_f32 v126, v126
  v_smfmac_f32_32x32x32_bf16 v[64:79], a[36:39], v[116:123], v88
  ds_read_b128 a[16:19], v3 offset:0
  v_exp_f32 v127, v127
  v_exp_f32 v128, v128
  v_mfma_f32_32x32x16_bf16 v[140:155], a[28:31], a[12:15], v[140:155]
  ds_read_b128 a[20:23], v3 offset:1024
  v_exp_f32 v129, v129
  v_exp_f32 v130, v130
  v_exp_f32 v131, v131
  v_smfmac_f32_16x16x64_bf16 v[84:87], a[48:51], v[116:123], v88
  s_add_u32 m0, s18, 49152
  v_exp_f32 v132, v132
  v_exp_f32 v133, v133
  v_smfmac_f32_32x32x32_bf16 v[48:63], a[40:43], v[124:131], v88
  v_exp_f32 v134, v134
  v_exp_f32 v135, v135
  v_exp_f32 v136, v136
  v_smfmac_f32_16x16x64_bf16 v[80:83], a[48:51], v[124:131], v88
  buffer_load_dwordx4 v2, s[8:11], s16 offen offset:0 lds
  v_exp_f32 v137, v137
  v_exp_f32 v138, v138
  v_exp_f32 v139, v139
  s_waitcnt lgkmcnt(0)
  v_mfma_f32_32x32x16_bf16 v[92:107], a[16:19], a[0:3], v[16:31]
  v_exp_f32 v140, v140
  v_exp_f32 v141, v141
  v_exp_f32 v142, v142
  v_smfmac_f32_32x32x32_bf16 v[48:63], a[44:47], v[132:139], v88
  ds_read_b128 a[32:35], v3 offset:2048
  v_exp_f32 v143, v143
  v_exp_f32 v144, v144
  v_mfma_f32_32x32x16_bf16 v[92:107], a[20:23], a[4:7], v[92:107]
  ds_read_b128 a[36:39], v3 offset:3072
  buffer_load_dwordx4 v2, s[8:11], s16 offen offset:1024 lds
  v_exp_f32 v145, v145
  v_exp_f32 v146, v146
  v_exp_f32 v147, v147
  v_smfmac_f32_16x16x64_bf16 v[80:83], a[48:51], v[132:139], v88
  v_exp_f32 v148, v148
  v_exp_f32 v149, v149
  v_smfmac_f32_32x32x32_bf16 v[64:79], a[40:43], v[140:147], v88
  v_exp_f32 v150, v150
  v_exp_f32 v151, v151
  v_exp_f32 v152, v152
  v_smfmac_f32_16x16x64_bf16 v[84:87], a[48:51], v[140:147], v88
  buffer_load_dwordx4 v2, s[8:11], s16 offen offset:2048 lds
  v_exp_f32 v153, v153
  v_exp_f32 v154, v154
  v_exp_f32 v155, v155
  s_waitcnt lgkmcnt(0)
  v_mfma_f32_32x32x16_bf16 v[108:123], a[16:19], a[8:11], v[32:47]
  v_exp_f32 v92, v92
  v_exp_f32 v93, v93
  v_exp_f32 v94, v94
  v_smfmac_f32_32x32x32_bf16 v[64:79], a[44:47], v[148:155], v88
  ds_read_b128 a[24:27], v3 offset:4096
  v_exp_f32 v95, v95
  v_exp_f32 v96, v96
  v_mfma_f32_32x32x16_bf16 v[108:123], a[20:23], a[12:15], v[108:123]
  ds_read_b128 a[28:31], v3 offset:5120
  buffer_load_dwordx4 v2, s[8:11], s16 offen offset:3072 lds
  v_exp_f32 v97, v97
  v_exp_f32 v98, v98
  v_exp_f32 v99, v99
  v_smfmac_f32_16x16x64_bf16 v[84:87], a[48:51], v[148:155], v88
  s_add_u32 s16, s16, 16384
  v_exp_f32 v100, v100
  v_exp_f32 v101, v101
  v_smfmac_f32_32x32x32_bf16 v[48:63], a[32:35], v[92:99], v88
  v_exp_f32 v102, v102
  v_exp_f32 v103, v103
  v_exp_f32 v104, v104
  v_smfmac_f32_16x16x64_bf16 v[80:83], a[48:51], v[92:99], v88
  v_exp_f32 v105, v105
  v_exp_f32 v106, v106
  v_exp_f32 v107, v107
  s_waitcnt lgkmcnt(0)
  v_mfma_f32_32x32x16_bf16 v[124:139], a[24:27], a[0:3], v[16:31]
  v_exp_f32 v108, v108
  v_exp_f32 v109, v109
  v_exp_f32 v110, v110
  v_smfmac_f32_32x32x32_bf16 v[48:63], a[36:39], v[100:107], v88
  ds_read_b128 a[40:43], v3 offset:6144
  v_exp_f32 v111, v111
  v_exp_f32 v112, v112
  v_mfma_f32_32x32x16_bf16 v[124:139], a[28:31], a[4:7], v[124:139]
  ds_read_b128 a[44:47], v3 offset:7168
  v_exp_f32 v113, v113
  v_exp_f32 v114, v114
  v_exp_f32 v115, v115
  v_smfmac_f32_16x16x64_bf16 v[80:83], a[48:51], v[100:107], v88
  v_exp_f32 v116, v116
  v_exp_f32 v117, v117
  v_smfmac_f32_32x32x32_bf16 v[64:79], a[32:35], v[108:115], v88
  v_exp_f32 v118, v118
  v_exp_f32 v119, v119
  v_exp_f32 v120, v120
  v_smfmac_f32_16x16x64_bf16 v[84:87], a[48:51], v[108:115], v88
  v_exp_f32 v121, v121
  v_exp_f32 v122, v122
  v_exp_f32 v123, v123
  s_waitcnt lgkmcnt(0)
  v_mfma_f32_32x32x16_bf16 v[140:155], a[24:27], a[8:11], v[32:47]
  v_exp_f32 v124, v124
  v_exp_f32 v125, v125
  v_exp_f32 v126, v126
  v_smfmac_f32_32x32x32_bf16 v[64:79], a[36:39], v[116:123], v88
  ds_read_b128 a[16:19], v3 offset:8192
  v_exp_f32 v127, v127
  v_exp_f32 v128, v128
  v_mfma_f32_32x32x16_bf16 v[140:155], a[28:31], a[12:15], v[140:155]
  ds_read_b128 a[20:23], v3 offset:9216
  v_exp_f32 v129, v129
  v_exp_f32 v130, v130
  v_exp_f32 v131, v131
  v_smfmac_f32_16x16x64_bf16 v[84:87], a[48:51], v[116:123], v88
  v_exp_f32 v132, v132
  v_exp_f32 v133, v133
  v_smfmac_f32_32x32x32_bf16 v[48:63], a[40:43], v[124:131], v88
  v_exp_f32 v134, v134
  v_exp_f32 v135, v135
  v_exp_f32 v136, v136
  v_smfmac_f32_16x16x64_bf16 v[80:83], a[48:51], v[124:131], v88
  v_exp_f32 v137, v137
  v_exp_f32 v138, v138
  v_exp_f32 v139, v139
  s_waitcnt lgkmcnt(0)
  v_mfma_f32_32x32x16_bf16 v[92:107], a[16:19], a[0:3], v[16:31]
  v_exp_f32 v140, v140
  v_exp_f32 v141, v141
  v_exp_f32 v142, v142
  v_smfmac_f32_32x32x32_bf16 v[48:63], a[44:47], v[132:139], v88
  ds_read_b128 a[32:35], v3 offset:10240
  v_exp_f32 v143, v143
  v_exp_f32 v144, v144
  v_mfma_f32_32x32x16_bf16 v[92:107], a[20:23], a[4:7], v[92:107]
  ds_read_b128 a[36:39], v3 offset:11264
  v_exp_f32 v145, v145
  v_exp_f32 v146, v146
  v_exp_f32 v147, v147
  v_smfmac_f32_16x16x64_bf16 v[80:83], a[48:51], v[132:139], v88
  v_exp_f32 v148, v148
  v_exp_f32 v149, v149
  v_smfmac_f32_32x32x32_bf16 v[64:79], a[40:43], v[140:147], v88
  v_exp_f32 v150, v150
  v_exp_f32 v151, v151
  v_exp_f32 v152, v152
  v_smfmac_f32_16x16x64_bf16 v[84:87], a[48:51], v[140:147], v88
  v_exp_f32 v153, v153
  v_exp_f32 v154, v154
  v_exp_f32 v155, v155
  s_waitcnt lgkmcnt(0)
  v_mfma_f32_32x32x16_bf16 v[108:123], a[16:19], a[8:11], v[32:47]
  v_exp_f32 v92, v92
  v_exp_f32 v93, v93
  v_exp_f32 v94, v94
  v_smfmac_f32_32x32x32_bf16 v[64:79], a[44:47], v[148:155], v88
  ds_read_b128 a[24:27], v3 offset:12288
  v_exp_f32 v95, v95
  v_exp_f32 v96, v96
  v_mfma_f32_32x32x16_bf16 v[108:123], a[20:23], a[12:15], v[108:123]
  ds_read_b128 a[28:31], v3 offset:13312
  v_exp_f32 v97, v97
  v_exp_f32 v98, v98
  v_exp_f32 v99, v99
  v_smfmac_f32_16x16x64_bf16 v[84:87], a[48:51], v[148:155], v88
  v_exp_f32 v100, v100
  v_exp_f32 v101, v101
  v_smfmac_f32_32x32x32_bf16 v[48:63], a[32:35], v[92:99], v88
  v_exp_f32 v102, v102
  v_exp_f32 v103, v103
  v_exp_f32 v104, v104
  v_smfmac_f32_16x16x64_bf16 v[80:83], a[48:51], v[92:99], v88
  v_exp_f32 v105, v105
  v_exp_f32 v106, v106
  v_exp_f32 v107, v107
  s_waitcnt lgkmcnt(0)
  v_mfma_f32_32x32x16_bf16 v[124:139], a[24:27], a[0:3], v[16:31]
  v_exp_f32 v108, v108
  v_exp_f32 v109, v109
  v_exp_f32 v110, v110
  v_smfmac_f32_32x32x32_bf16 v[48:63], a[36:39], v[100:107], v88
  ds_read_b128 a[40:43], v3 offset:14336
  v_exp_f32 v111, v111
  v_exp_f32 v112, v112
  v_mfma_f32_32x32x16_bf16 v[124:139], a[28:31], a[4:7], v[124:139]
  ds_read_b128 a[44:47], v3 offset:15360
  v_exp_f32 v113, v113
  v_exp_f32 v114, v114
  v_exp_f32 v115, v115
  v_smfmac_f32_16x16x64_bf16 v[80:83], a[48:51], v[100:107], v88
  v_exp_f32 v116, v116
  v_exp_f32 v117, v117
  v_smfmac_f32_32x32x32_bf16 v[64:79], a[32:35], v[108:115], v88
  v_exp_f32 v118, v118
  v_exp_f32 v119, v119
  v_exp_f32 v120, v120
  v_smfmac_f32_16x16x64_bf16 v[84:87], a[48:51], v[108:115], v88
  v_exp_f32 v121, v121
  v_exp_f32 v122, v122
  v_exp_f32 v123, v123
  s_waitcnt vmcnt(12) lgkmcnt(0)
  v_mfma_f32_32x32x16_bf16 v[140:155], a[24:27], a[8:11], v[32:47]
  s_barrier
  v_exp_f32 v124, v124
  v_exp_f32 v125, v125
  v_exp_f32 v126, v126
  v_smfmac_f32_32x32x32_bf16 v[64:79], a[36:39], v[116:123], v88
  ds_read_b128 a[16:19], v2 offset:0
  v_exp_f32 v127, v127
  v_exp_f32 v128, v128
  v_mfma_f32_32x32x16_bf16 v[140:155], a[28:31], a[12:15], v[140:155]
  ds_read_b128 a[20:23], v2 offset:1024
  v_exp_f32 v129, v129
  v_exp_f32 v130, v130
  v_exp_f32 v131, v131
  v_smfmac_f32_16x16x64_bf16 v[84:87], a[48:51], v[116:123], v88
  s_add_u32 m0, s18, 65536
  v_exp_f32 v132, v132
  v_exp_f32 v133, v133
  v_smfmac_f32_32x32x32_bf16 v[48:63], a[40:43], v[124:131], v88
  v_exp_f32 v134, v134
  v_exp_f32 v135, v135
  v_exp_f32 v136, v136
  v_smfmac_f32_16x16x64_bf16 v[80:83], a[48:51], v[124:131], v88
  buffer_load_dwordx4 v2, s[8:11], s16 offen offset:0 lds
  v_exp_f32 v137, v137
  v_exp_f32 v138, v138
  v_exp_f32 v139, v139
  s_waitcnt lgkmcnt(0)
  v_mfma_f32_32x32x16_bf16 v[92:107], a[16:19], a[0:3], v[16:31]
  v_exp_f32 v140, v140
  v_exp_f32 v141, v141
  v_exp_f32 v142, v142
  v_smfmac_f32_32x32x32_bf16 v[48:63], a[44:47], v[132:139], v88
  ds_read_b128 a[32:35], v2 offset:2048
  v_exp_f32 v143, v143
  v_exp_f32 v144, v144
  v_mfma_f32_32x32x16_bf16 v[92:107], a[20:23], a[4:7], v[92:107]
  ds_read_b128 a[36:39], v2 offset:3072
  buffer_load_dwordx4 v2, s[8:11], s16 offen offset:1024 lds
  v_exp_f32 v145, v145
  v_exp_f32 v146, v146
  v_exp_f32 v147, v147
  v_smfmac_f32_16x16x64_bf16 v[80:83], a[48:51], v[132:139], v88
  v_exp_f32 v148, v148
  v_exp_f32 v149, v149
  v_smfmac_f32_32x32x32_bf16 v[64:79], a[40:43], v[140:147], v88
  v_exp_f32 v150, v150
  v_exp_f32 v151, v151
  v_exp_f32 v152, v152
  v_smfmac_f32_16x16x64_bf16 v[84:87], a[48:51], v[140:147], v88
  buffer_load_dwordx4 v2, s[8:11], s16 offen offset:2048 lds
  v_exp_f32 v153, v153
  v_exp_f32 v154, v154
  v_exp_f32 v155, v155
  s_waitcnt lgkmcnt(0)
  v_mfma_f32_32x32x16_bf16 v[108:123], a[16:19], a[8:11], v[32:47]
  v_exp_f32 v92, v92
  v_exp_f32 v93, v93
  v_exp_f32 v94, v94
  v_smfmac_f32_32x32x32_bf16 v[64:79], a[44:47], v[148:155], v88
  ds_read_b128 a[24:27], v2 offset:4096
  v_exp_f32 v95, v95
  v_exp_f32 v96, v96
  v_mfma_f32_32x32x16_bf16 v[108:123], a[20:23], a[12:15], v[108:123]
  ds_read_b128 a[28:31], v2 offset:5120
  buffer_load_dwordx4 v2, s[8:11], s16 offen offset:3072 lds
  v_exp_f32 v97, v97
  v_exp_f32 v98, v98
  v_exp_f32 v99, v99
  v_smfmac_f32_16x16x64_bf16 v[84:87], a[48:51], v[148:155], v88
  s_add_u32 s16, s16, 16384
  v_exp_f32 v100, v100
  v_exp_f32 v101, v101
  v_smfmac_f32_32x32x32_bf16 v[48:63], a[32:35], v[92:99], v88
  v_exp_f32 v102, v102
  v_exp_f32 v103, v103
  v_exp_f32 v104, v104
  v_smfmac_f32_16x16x64_bf16 v[80:83], a[48:51], v[92:99], v88
  v_exp_f32 v105, v105
  v_exp_f32 v106, v106
  v_exp_f32 v107, v107
  s_waitcnt lgkmcnt(0)
  v_mfma_f32_32x32x16_bf16 v[124:139], a[24:27], a[0:3], v[16:31]
  v_exp_f32 v108, v108
  v_exp_f32 v109, v109
  v_exp_f32 v110, v110
  v_smfmac_f32_32x32x32_bf16 v[48:63], a[36:39], v[100:107], v88
  ds_read_b128 a[40:43], v2 offset:6144
  v_exp_f32 v111, v111
  v_exp_f32 v112, v112
  v_mfma_f32_32x32x16_bf16 v[124:139], a[28:31], a[4:7], v[124:139]
  ds_read_b128 a[44:47], v2 offset:7168
  v_exp_f32 v113, v113
  v_exp_f32 v114, v114
  v_exp_f32 v115, v115
  v_smfmac_f32_16x16x64_bf16 v[80:83], a[48:51], v[100:107], v88
  v_exp_f32 v116, v116
  v_exp_f32 v117, v117
  v_smfmac_f32_32x32x32_bf16 v[64:79], a[32:35], v[108:115], v88
  v_exp_f32 v118, v118
  v_exp_f32 v119, v119
  v_exp_f32 v120, v120
  v_smfmac_f32_16x16x64_bf16 v[84:87], a[48:51], v[108:115], v88
  v_exp_f32 v121, v121
  v_exp_f32 v122, v122
  v_exp_f32 v123, v123
  s_waitcnt lgkmcnt(0)
  v_mfma_f32_32x32x16_bf16 v[140:155], a[24:27], a[8:11], v[32:47]
  v_exp_f32 v124, v124
  v_exp_f32 v125, v125
  v_exp_f32 v126, v126
  v_smfmac_f32_32x32x32_bf16 v[64:79], a[36:39], v[116:123], v88
  ds_read_b128 a[16:19], v2 offset:8192
  v_exp_f32 v127, v127
  v_exp_f32 v128, v128
  v_mfma_f32_32x32x16_bf16 v[140:155], a[28:31], a[12:15], v[140:155]
  ds_read_b128 a[20:23], v2 offset:9216
  v_exp_f32 v129, v129
  v_exp_f32 v130, v130
  v_exp_f32 v131, v131
  v_smfmac_f32_16x16x64_bf16 v[84:87], a[48:51], v[116:123], v88
  v_exp_f32 v132, v132
  v_exp_f32 v133, v133
  v_smfmac_f32_32x32x32_bf16 v[48:63], a[40:43], v[124:131], v88
  v_exp_f32 v134, v134
  v_exp_f32 v135, v135
  v_exp_f32 v136, v136
  v_smfmac_f32_16x16x64_bf16 v[80:83], a[48:51], v[124:131], v88
  v_exp_f32 v137, v137
  v_exp_f32 v138, v138
  v_exp_f32 v139, v139
  s_waitcnt lgkmcnt(0)
  v_mfma_f32_32x32x16_bf16 v[92:107], a[16:19], a[0:3], v[16:31]
  v_exp_f32 v140, v140
  v_exp_f32 v141, v141
  v_exp_f32 v142, v142
  v_smfmac_f32_32x32x32_bf16 v[48:63], a[44:47], v[132:139], v88
  ds_read_b128 a[32:35], v2 offset:10240
  v_exp_f32 v143, v143
  v_exp_f32 v144, v144
  v_mfma_f32_32x32x16_bf16 v[92:107], a[20:23], a[4:7], v[92:107]
  ds_read_b128 a[36:39], v2 offset:11264
  v_exp_f32 v145, v145
  v_exp_f32 v146, v146
  v_exp_f32 v147, v147
  v_smfmac_f32_16x16x64_bf16 v[80:83], a[48:51], v[132:139], v88
  v_exp_f32 v148, v148
  v_exp_f32 v149, v149
  v_smfmac_f32_32x32x32_bf16 v[64:79], a[40:43], v[140:147], v88
  v_exp_f32 v150, v150
  v_exp_f32 v151, v151
  v_exp_f32 v152, v152
  v_smfmac_f32_16x16x64_bf16 v[84:87], a[48:51], v[140:147], v88
  v_exp_f32 v153, v153
  v_exp_f32 v154, v154
  v_exp_f32 v155, v155
  s_waitcnt lgkmcnt(0)
  v_mfma_f32_32x32x16_bf16 v[108:123], a[16:19], a[8:11], v[32:47]
  v_exp_f32 v92, v92
  v_exp_f32 v93, v93
  v_exp_f32 v94, v94
  v_smfmac_f32_32x32x32_bf16 v[64:79], a[44:47], v[148:155], v88
  ds_read_b128 a[24:27], v2 offset:12288
  v_exp_f32 v95, v95
  v_exp_f32 v96, v96
  v_mfma_f32_32x32x16_bf16 v[108:123], a[20:23], a[12:15], v[108:123]
  ds_read_b128 a[28:31], v2 offset:13312
  v_exp_f32 v97, v97
  v_exp_f32 v98, v98
  v_exp_f32 v99, v99
  v_smfmac_f32_16x16x64_bf16 v[84:87], a[48:51], v[148:155], v88
  v_exp_f32 v100, v100
  v_exp_f32 v101, v101
  v_smfmac_f32_32x32x32_bf16 v[48:63], a[32:35], v[92:99], v88
  v_exp_f32 v102, v102
  v_exp_f32 v103, v103
  v_exp_f32 v104, v104
  v_smfmac_f32_16x16x64_bf16 v[80:83], a[48:51], v[92:99], v88
  v_exp_f32 v105, v105
  v_exp_f32 v106, v106
  v_exp_f32 v107, v107
  s_waitcnt lgkmcnt(0)
  v_mfma_f32_32x32x16_bf16 v[124:139], a[24:27], a[0:3], v[16:31]
  v_exp_f32 v108, v108
  v_exp_f32 v109, v109
  v_exp_f32 v110, v110
  v_smfmac_f32_32x32x32_bf16 v[48:63], a[36:39], v[100:107], v88
  ds_read_b128 a[40:43], v2 offset:14336
  v_exp_f32 v111, v111
  v_exp_f32 v112, v112
  v_mfma_f32_32x32x16_bf16 v[124:139], a[28:31], a[4:7], v[124:139]
  ds_read_b128 a[44:47], v2 offset:15360
  v_exp_f32 v113, v113
  v_exp_f32 v114, v114
  v_exp_f32 v115, v115
  v_smfmac_f32_16x16x64_bf16 v[80:83], a[48:51], v[100:107], v88
  v_exp_f32 v116, v116
  v_exp_f32 v117, v117
  v_smfmac_f32_32x32x32_bf16 v[64:79], a[32:35], v[108:115], v88
  v_exp_f32 v118, v118
  v_exp_f32 v119, v119
  v_exp_f32 v120, v120
  v_smfmac_f32_16x16x64_bf16 v[84:87], a[48:51], v[108:115], v88
  v_exp_f32 v121, v121
  v_exp_f32 v122, v122
  v_exp_f32 v123, v123
  s_waitcnt vmcnt(12) lgkmcnt(0)
  v_mfma_f32_32x32x16_bf16 v[140:155], a[24:27], a[8:11], v[32:47]
  s_barrier
  v_exp_f32 v124, v124
  v_exp_f32 v125, v125
  v_exp_f32 v126, v126
  v_smfmac_f32_32x32x32_bf16 v[64:79], a[36:39], v[116:123], v88
  ds_read_b128 a[16:19], v2 offset:16384
  v_exp_f32 v127, v127
  v_exp_f32 v128, v128
  v_mfma_f32_32x32x16_bf16 v[140:155], a[28:31], a[12:15], v[140:155]
  ds_read_b128 a[20:23], v2 offset:17408
  v_exp_f32 v129, v129
  v_exp_f32 v130, v130
  v_exp_f32 v131, v131
  v_smfmac_f32_16x16x64_bf16 v[84:87], a[48:51], v[116:123], v88
  s_add_u32 m0, s18, 0
  v_exp_f32 v132, v132
  v_exp_f32 v133, v133
  v_smfmac_f32_32x32x32_bf16 v[48:63], a[40:43], v[124:131], v88
  v_exp_f32 v134, v134
  v_exp_f32 v135, v135
  v_exp_f32 v136, v136
  v_smfmac_f32_16x16x64_bf16 v[80:83], a[48:51], v[124:131], v88
  buffer_load_dwordx4 v2, s[8:11], s16 offen offset:0 lds
  v_exp_f32 v137, v137
  v_exp_f32 v138, v138
  v_exp_f32 v139, v139
  s_waitcnt lgkmcnt(0)
  v_mfma_f32_32x32x16_bf16 v[92:107], a[16:19], a[0:3], v[16:31]
  v_exp_f32 v140, v140
  v_exp_f32 v141, v141
  v_exp_f32 v142, v142
  v_smfmac_f32_32x32x32_bf16 v[48:63], a[44:47], v[132:139], v88
  ds_read_b128 a[32:35], v2 offset:18432
  v_exp_f32 v143, v143
  v_exp_f32 v144, v144
  v_mfma_f32_32x32x16_bf16 v[92:107], a[20:23], a[4:7], v[92:107]
  ds_read_b128 a[36:39], v2 offset:19456
  buffer_load_dwordx4 v2, s[8:11], s16 offen offset:1024 lds
  v_exp_f32 v145, v145
  v_exp_f32 v146, v146
  v_exp_f32 v147, v147
  v_smfmac_f32_16x16x64_bf16 v[80:83], a[48:51], v[132:139], v88
  v_exp_f32 v148, v148
  v_exp_f32 v149, v149
  v_smfmac_f32_32x32x32_bf16 v[64:79], a[40:43], v[140:147], v88
  v_exp_f32 v150, v150
  v_exp_f32 v151, v151
  v_exp_f32 v152, v152
  v_smfmac_f32_16x16x64_bf16 v[84:87], a[48:51], v[140:147], v88
  buffer_load_dwordx4 v2, s[8:11], s16 offen offset:2048 lds
  v_exp_f32 v153, v153
  v_exp_f32 v154, v154
  v_exp_f32 v155, v155
  s_waitcnt lgkmcnt(0)
  v_mfma_f32_32x32x16_bf16 v[108:123], a[16:19], a[8:11], v[32:47]
  v_exp_f32 v92, v92
  v_exp_f32 v93, v93
  v_exp_f32 v94, v94
  v_smfmac_f32_32x32x32_bf16 v[64:79], a[44:47], v[148:155], v88
  ds_read_b128 a[24:27], v2 offset:20480
  v_exp_f32 v95, v95
  v_exp_f32 v96, v96
  v_mfma_f32_32x32x16_bf16 v[108:123], a[20:23], a[12:15], v[108:123]
  ds_read_b128 a[28:31], v2 offset:21504
  buffer_load_dwordx4 v2, s[8:11], s16 offen offset:3072 lds
  v_exp_f32 v97, v97
  v_exp_f32 v98, v98
  v_exp_f32 v99, v99
  v_smfmac_f32_16x16x64_bf16 v[84:87], a[48:51], v[148:155], v88
  s_add_u32 s16, s16, 16384
  v_exp_f32 v100, v100
  v_exp_f32 v101, v101
  v_smfmac_f32_32x32x32_bf16 v[48:63], a[32:35], v[92:99], v88
  v_exp_f32 v102, v102
  v_exp_f32 v103, v103
  v_exp_f32 v104, v104
  v_smfmac_f32_16x16x64_bf16 v[80:83], a[48:51], v[92:99], v88
  v_exp_f32 v105, v105
  v_exp_f32 v106, v106
  v_exp_f32 v107, v107
  s_waitcnt lgkmcnt(0)
  v_mfma_f32_32x32x16_bf16 v[124:139], a[24:27], a[0:3], v[16:31]
  v_exp_f32 v108, v108
  v_exp_f32 v109, v109
  v_exp_f32 v110, v110
  v_smfmac_f32_32x32x32_bf16 v[48:63], a[36:39], v[100:107], v88
  ds_read_b128 a[40:43], v2 offset:22528
  v_exp_f32 v111, v111
  v_exp_f32 v112, v112
  v_mfma_f32_32x32x16_bf16 v[124:139], a[28:31], a[4:7], v[124:139]
  ds_read_b128 a[44:47], v2 offset:23552
  v_exp_f32 v113, v113
  v_exp_f32 v114, v114
  v_exp_f32 v115, v115
  v_smfmac_f32_16x16x64_bf16 v[80:83], a[48:51], v[100:107], v88
  v_exp_f32 v116, v116
  v_exp_f32 v117, v117
  v_smfmac_f32_32x32x32_bf16 v[64:79], a[32:35], v[108:115], v88
  v_exp_f32 v118, v118
  v_exp_f32 v119, v119
  v_exp_f32 v120, v120
  v_smfmac_f32_16x16x64_bf16 v[84:87], a[48:51], v[108:115], v88
  v_exp_f32 v121, v121
  v_exp_f32 v122, v122
  v_exp_f32 v123, v123
  s_waitcnt lgkmcnt(0)
  v_mfma_f32_32x32x16_bf16 v[140:155], a[24:27], a[8:11], v[32:47]
  v_exp_f32 v124, v124
  v_exp_f32 v125, v125
  v_exp_f32 v126, v126
  v_smfmac_f32_32x32x32_bf16 v[64:79], a[36:39], v[116:123], v88
  ds_read_b128 a[16:19], v2 offset:24576
  v_exp_f32 v127, v127
  v_exp_f32 v128, v128
  v_mfma_f32_32x32x16_bf16 v[140:155], a[28:31], a[12:15], v[140:155]
  ds_read_b128 a[20:23], v2 offset:25600
  v_exp_f32 v129, v129
  v_exp_f32 v130, v130
  v_exp_f32 v131, v131
  v_smfmac_f32_16x16x64_bf16 v[84:87], a[48:51], v[116:123], v88
  v_exp_f32 v132, v132
  v_exp_f32 v133, v133
  v_smfmac_f32_32x32x32_bf16 v[48:63], a[40:43], v[124:131], v88
  v_exp_f32 v134, v134
  v_exp_f32 v135, v135
  v_exp_f32 v136, v136
  v_smfmac_f32_16x16x64_bf16 v[80:83], a[48:51], v[124:131], v88
  v_exp_f32 v137, v137
  v_exp_f32 v138, v138
  v_exp_f32 v139, v139
  s_waitcnt lgkmcnt(0)
  v_mfma_f32_32x32x16_bf16 v[92:107], a[16:19], a[0:3], v[16:31]
  v_exp_f32 v140, v140
  v_exp_f32 v141, v141
  v_exp_f32 v142, v142
  v_smfmac_f32_32x32x32_bf16 v[48:63], a[44:47], v[132:139], v88
  ds_read_b128 a[32:35], v2 offset:26624
  v_exp_f32 v143, v143
  v_exp_f32 v144, v144
  v_mfma_f32_32x32x16_bf16 v[92:107], a[20:23], a[4:7], v[92:107]
  ds_read_b128 a[36:39], v2 offset:27648
  v_exp_f32 v145, v145
  v_exp_f32 v146, v146
  v_exp_f32 v147, v147
  v_smfmac_f32_16x16x64_bf16 v[80:83], a[48:51], v[132:139], v88
  v_exp_f32 v148, v148
  v_exp_f32 v149, v149
  v_smfmac_f32_32x32x32_bf16 v[64:79], a[40:43], v[140:147], v88
  v_exp_f32 v150, v150
  v_exp_f32 v151, v151
  v_exp_f32 v152, v152
  v_smfmac_f32_16x16x64_bf16 v[84:87], a[48:51], v[140:147], v88
  v_exp_f32 v153, v153
  v_exp_f32 v154, v154
  v_exp_f32 v155, v155
  s_waitcnt lgkmcnt(0)
  v_mfma_f32_32x32x16_bf16 v[108:123], a[16:19], a[8:11], v[32:47]
  v_exp_f32 v92, v92
  v_exp_f32 v93, v93
  v_exp_f32 v94, v94
  v_smfmac_f32_32x32x32_bf16 v[64:79], a[44:47], v[148:155], v88
  ds_read_b128 a[24:27], v2 offset:28672
  v_exp_f32 v95, v95
  v_exp_f32 v96, v96
  v_mfma_f32_32x32x16_bf16 v[108:123], a[20:23], a[12:15], v[108:123]
  ds_read_b128 a[28:31], v2 offset:29696
  v_exp_f32 v97, v97
  v_exp_f32 v98, v98
  v_exp_f32 v99, v99
  v_smfmac_f32_16x16x64_bf16 v[84:87], a[48:51], v[148:155], v88
  v_exp_f32 v100, v100
  v_exp_f32 v101, v101
  v_smfmac_f32_32x32x32_bf16 v[48:63], a[32:35], v[92:99], v88
  v_exp_f32 v102, v102
  v_exp_f32 v103, v103
  v_exp_f32 v104, v104
  v_smfmac_f32_16x16x64_bf16 v[80:83], a[48:51], v[92:99], v88
  v_exp_f32 v105, v105
  v_exp_f32 v106, v106
  v_exp_f32 v107, v107
  s_waitcnt lgkmcnt(0)
  v_mfma_f32_32x32x16_bf16 v[124:139], a[24:27], a[0:3], v[16:31]
  v_exp_f32 v108, v108
  v_exp_f32 v109, v109
  v_exp_f32 v110, v110
  v_smfmac_f32_32x32x32_bf16 v[48:63], a[36:39], v[100:107], v88
  ds_read_b128 a[40:43], v2 offset:30720
  v_exp_f32 v111, v111
  v_exp_f32 v112, v112
  v_mfma_f32_32x32x16_bf16 v[124:139], a[28:31], a[4:7], v[124:139]
  ds_read_b128 a[44:47], v2 offset:31744
  v_exp_f32 v113, v113
  v_exp_f32 v114, v114
  v_exp_f32 v115, v115
  v_smfmac_f32_16x16x64_bf16 v[80:83], a[48:51], v[100:107], v88
  v_exp_f32 v116, v116
  v_exp_f32 v117, v117
  v_smfmac_f32_32x32x32_bf16 v[64:79], a[32:35], v[108:115], v88
  v_exp_f32 v118, v118
  v_exp_f32 v119, v119
  v_exp_f32 v120, v120
  v_smfmac_f32_16x16x64_bf16 v[84:87], a[48:51], v[108:115], v88
  v_exp_f32 v121, v121
  v_exp_f32 v122, v122
  v_exp_f32 v123, v123
  s_waitcnt vmcnt(12) lgkmcnt(0)
  v_mfma_f32_32x32x16_bf16 v[140:155], a[24:27], a[8:11], v[32:47]
  s_barrier
  v_exp_f32 v124, v124
  v_exp_f32 v125, v125
  v_exp_f32 v126, v126
  v_smfmac_f32_32x32x32_bf16 v[64:79], a[36:39], v[116:123], v88
  ds_read_b128 a[16:19], v2 offset:32768
  v_exp_f32 v127, v127
  v_exp_f32 v128, v128
  v_mfma_f32_32x32x16_bf16 v[140:155], a[28:31], a[12:15], v[140:155]
  ds_read_b128 a[20:23], v2 offset:33792
  v_exp_f32 v129, v129
  v_exp_f32 v130, v130
  v_exp_f32 v131, v131
  v_smfmac_f32_16x16x64_bf16 v[84:87], a[48:51], v[116:123], v88
  s_add_u32 m0, s18, 16384
  v_exp_f32 v132, v132
  v_exp_f32 v133, v133
  v_smfmac_f32_32x32x32_bf16 v[48:63], a[40:43], v[124:131], v88
  v_exp_f32 v134, v134
  v_exp_f32 v135, v135
  v_exp_f32 v136, v136
  v_smfmac_f32_16x16x64_bf16 v[80:83], a[48:51], v[124:131], v88
  buffer_load_dwordx4 v2, s[8:11], s16 offen offset:0 lds
  v_exp_f32 v137, v137
  v_exp_f32 v138, v138
  v_exp_f32 v139, v139
  s_waitcnt lgkmcnt(0)
  v_mfma_f32_32x32x16_bf16 v[92:107], a[16:19], a[0:3], v[16:31]
  v_exp_f32 v140, v140
  v_exp_f32 v141, v141
  v_exp_f32 v142, v142
  v_smfmac_f32_32x32x32_bf16 v[48:63], a[44:47], v[132:139], v88
  ds_read_b128 a[32:35], v2 offset:34816
  v_exp_f32 v143, v143
  v_exp_f32 v144, v144
  v_mfma_f32_32x32x16_bf16 v[92:107], a[20:23], a[4:7], v[92:107]
  ds_read_b128 a[36:39], v2 offset:35840
  buffer_load_dwordx4 v2, s[8:11], s16 offen offset:1024 lds
  v_exp_f32 v145, v145
  v_exp_f32 v146, v146
  v_exp_f32 v147, v147
  v_smfmac_f32_16x16x64_bf16 v[80:83], a[48:51], v[132:139], v88
  v_exp_f32 v148, v148
  v_exp_f32 v149, v149
  v_smfmac_f32_32x32x32_bf16 v[64:79], a[40:43], v[140:147], v88
  v_exp_f32 v150, v150
  v_exp_f32 v151, v151
  v_exp_f32 v152, v152
  v_smfmac_f32_16x16x64_bf16 v[84:87], a[48:51], v[140:147], v88
  buffer_load_dwordx4 v2, s[8:11], s16 offen offset:2048 lds
  v_exp_f32 v153, v153
  v_exp_f32 v154, v154
  v_exp_f32 v155, v155
  s_waitcnt lgkmcnt(0)
  v_mfma_f32_32x32x16_bf16 v[108:123], a[16:19], a[8:11], v[32:47]
  v_exp_f32 v92, v92
  v_exp_f32 v93, v93
  v_exp_f32 v94, v94
  v_smfmac_f32_32x32x32_bf16 v[64:79], a[44:47], v[148:155], v88
  ds_read_b128 a[24:27], v2 offset:36864
  v_exp_f32 v95, v95
  v_exp_f32 v96, v96
  v_mfma_f32_32x32x16_bf16 v[108:123], a[20:23], a[12:15], v[108:123]
  ds_read_b128 a[28:31], v2 offset:37888
  buffer_load_dwordx4 v2, s[8:11], s16 offen offset:3072 lds
  v_exp_f32 v97, v97
  v_exp_f32 v98, v98
  v_exp_f32 v99, v99
  v_smfmac_f32_16x16x64_bf16 v[84:87], a[48:51], v[148:155], v88
  s_add_u32 s16, s16, 16384
  v_exp_f32 v100, v100
  v_exp_f32 v101, v101
  v_smfmac_f32_32x32x32_bf16 v[48:63], a[32:35], v[92:99], v88
  v_exp_f32 v102, v102
  v_exp_f32 v103, v103
  v_exp_f32 v104, v104
  v_smfmac_f32_16x16x64_bf16 v[80:83], a[48:51], v[92:99], v88
  v_exp_f32 v105, v105
  v_exp_f32 v106, v106
  v_exp_f32 v107, v107
  s_waitcnt lgkmcnt(0)
  v_mfma_f32_32x32x16_bf16 v[124:139], a[24:27], a[0:3], v[16:31]
  v_exp_f32 v108, v108
  v_exp_f32 v109, v109
  v_exp_f32 v110, v110
  v_smfmac_f32_32x32x32_bf16 v[48:63], a[36:39], v[100:107], v88
  ds_read_b128 a[40:43], v2 offset:38912
  v_exp_f32 v111, v111
  v_exp_f32 v112, v112
  v_mfma_f32_32x32x16_bf16 v[124:139], a[28:31], a[4:7], v[124:139]
  ds_read_b128 a[44:47], v2 offset:39936
  v_exp_f32 v113, v113
  v_exp_f32 v114, v114
  v_exp_f32 v115, v115
  v_smfmac_f32_16x16x64_bf16 v[80:83], a[48:51], v[100:107], v88
  v_exp_f32 v116, v116
  v_exp_f32 v117, v117
  v_smfmac_f32_32x32x32_bf16 v[64:79], a[32:35], v[108:115], v88
  v_exp_f32 v118, v118
  v_exp_f32 v119, v119
  v_exp_f32 v120, v120
  v_smfmac_f32_16x16x64_bf16 v[84:87], a[48:51], v[108:115], v88
  v_exp_f32 v121, v121
  v_exp_f32 v122, v122
  v_exp_f32 v123, v123
  s_waitcnt lgkmcnt(0)
  v_mfma_f32_32x32x16_bf16 v[140:155], a[24:27], a[8:11], v[32:47]
  v_exp_f32 v124, v124
  v_exp_f32 v125, v125
  v_exp_f32 v126, v126
  v_smfmac_f32_32x32x32_bf16 v[64:79], a[36:39], v[116:123], v88
  ds_read_b128 a[16:19], v2 offset:40960
  v_exp_f32 v127, v127
  v_exp_f32 v128, v128
  v_mfma_f32_32x32x16_bf16 v[140:155], a[28:31], a[12:15], v[140:155]
  ds_read_b128 a[20:23], v2 offset:41984
  v_exp_f32 v129, v129
  v_exp_f32 v130, v130
  v_exp_f32 v131, v131
  v_smfmac_f32_16x16x64_bf16 v[84:87], a[48:51], v[116:123], v88
  v_exp_f32 v132, v132
  v_exp_f32 v133, v133
  v_smfmac_f32_32x32x32_bf16 v[48:63], a[40:43], v[124:131], v88
  v_exp_f32 v134, v134
  v_exp_f32 v135, v135
  v_exp_f32 v136, v136
  v_smfmac_f32_16x16x64_bf16 v[80:83], a[48:51], v[124:131], v88
  v_exp_f32 v137, v137
  v_exp_f32 v138, v138
  v_exp_f32 v139, v139
  s_waitcnt lgkmcnt(0)
  v_mfma_f32_32x32x16_bf16 v[92:107], a[16:19], a[0:3], v[16:31]
  v_exp_f32 v140, v140
  v_exp_f32 v141, v141
  v_exp_f32 v142, v142
  v_smfmac_f32_32x32x32_bf16 v[48:63], a[44:47], v[132:139], v88
  ds_read_b128 a[32:35], v2 offset:43008
  v_exp_f32 v143, v143
  v_exp_f32 v144, v144
  v_mfma_f32_32x32x16_bf16 v[92:107], a[20:23], a[4:7], v[92:107]
  ds_read_b128 a[36:39], v2 offset:44032
  v_exp_f32 v145, v145
  v_exp_f32 v146, v146
  v_exp_f32 v147, v147
  v_smfmac_f32_16x16x64_bf16 v[80:83], a[48:51], v[132:139], v88
  v_exp_f32 v148, v148
  v_exp_f32 v149, v149
  v_smfmac_f32_32x32x32_bf16 v[64:79], a[40:43], v[140:147], v88
  v_exp_f32 v150, v150
  v_exp_f32 v151, v151
  v_exp_f32 v152, v152
  v_smfmac_f32_16x16x64_bf16 v[84:87], a[48:51], v[140:147], v88
  v_exp_f32 v153, v153
  v_exp_f32 v154, v154
  v_exp_f32 v155, v155
  s_waitcnt lgkmcnt(0)
  v_mfma_f32_32x32x16_bf16 v[108:123], a[16:19], a[8:11], v[32:47]
  v_exp_f32 v92, v92
  v_exp_f32 v93, v93
  v_exp_f32 v94, v94
  v_smfmac_f32_32x32x32_bf16 v[64:79], a[44:47], v[148:155], v88
  ds_read_b128 a[24:27], v2 offset:45056
  v_exp_f32 v95, v95
  v_exp_f32 v96, v96
  v_mfma_f32_32x32x16_bf16 v[108:123], a[20:23], a[12:15], v[108:123]
  ds_read_b128 a[28:31], v2 offset:46080
  v_exp_f32 v97, v97
  v_exp_f32 v98, v98
  v_exp_f32 v99, v99
  v_smfmac_f32_16x16x64_bf16 v[84:87], a[48:51], v[148:155], v88
  v_exp_f32 v100, v100
  v_exp_f32 v101, v101
  v_smfmac_f32_32x32x32_bf16 v[48:63], a[32:35], v[92:99], v88
  v_exp_f32 v102, v102
  v_exp_f32 v103, v103
  v_exp_f32 v104, v104
  v_smfmac_f32_16x16x64_bf16 v[80:83], a[48:51], v[92:99], v88
  v_exp_f32 v105, v105
  v_exp_f32 v106, v106
  v_exp_f32 v107, v107
  s_waitcnt lgkmcnt(0)
  v_mfma_f32_32x32x16_bf16 v[124:139], a[24:27], a[0:3], v[16:31]
  v_exp_f32 v108, v108
  v_exp_f32 v109, v109
  v_exp_f32 v110, v110
  v_smfmac_f32_32x32x32_bf16 v[48:63], a[36:39], v[100:107], v88
  ds_read_b128 a[40:43], v2 offset:47104
  v_exp_f32 v111, v111
  v_exp_f32 v112, v112
  v_mfma_f32_32x32x16_bf16 v[124:139], a[28:31], a[4:7], v[124:139]
  ds_read_b128 a[44:47], v2 offset:48128
  v_exp_f32 v113, v113
  v_exp_f32 v114, v114
  v_exp_f32 v115, v115
  v_smfmac_f32_16x16x64_bf16 v[80:83], a[48:51], v[100:107], v88
  v_exp_f32 v116, v116
  v_exp_f32 v117, v117
  v_smfmac_f32_32x32x32_bf16 v[64:79], a[32:35], v[108:115], v88
  v_exp_f32 v118, v118
  v_exp_f32 v119, v119
  v_exp_f32 v120, v120
  v_smfmac_f32_16x16x64_bf16 v[84:87], a[48:51], v[108:115], v88
  v_exp_f32 v121, v121
  v_exp_f32 v122, v122
  v_exp_f32 v123, v123
  s_waitcnt vmcnt(12) lgkmcnt(0)
  v_mfma_f32_32x32x16_bf16 v[140:155], a[24:27], a[8:11], v[32:47]
  s_barrier
  v_exp_f32 v124, v124
  v_exp_f32 v125, v125
  v_exp_f32 v126, v126
  v_smfmac_f32_32x32x32_bf16 v[64:79], a[36:39], v[116:123], v88
  ds_read_b128 a[16:19], v2 offset:49152
  v_exp_f32 v127, v127
  v_exp_f32 v128, v128
  v_mfma_f32_32x32x16_bf16 v[140:155], a[28:31], a[12:15], v[140:155]
  ds_read_b128 a[20:23], v2 offset:50176
  v_exp_f32 v129, v129
  v_exp_f32 v130, v130
  v_exp_f32 v131, v131
  v_smfmac_f32_16x16x64_bf16 v[84:87], a[48:51], v[116:123], v88
  s_add_u32 m0, s18, 32768
  v_exp_f32 v132, v132
  v_exp_f32 v133, v133
  v_smfmac_f32_32x32x32_bf16 v[48:63], a[40:43], v[124:131], v88
  v_exp_f32 v134, v134
  v_exp_f32 v135, v135
  v_exp_f32 v136, v136
  v_smfmac_f32_16x16x64_bf16 v[80:83], a[48:51], v[124:131], v88
  buffer_load_dwordx4 v2, s[8:11], s16 offen offset:0 lds
  v_exp_f32 v137, v137
  v_exp_f32 v138, v138
  v_exp_f32 v139, v139
  s_waitcnt lgkmcnt(0)
  v_mfma_f32_32x32x16_bf16 v[92:107], a[16:19], a[0:3], v[16:31]
  v_exp_f32 v140, v140
  v_exp_f32 v141, v141
  v_exp_f32 v142, v142
  v_smfmac_f32_32x32x32_bf16 v[48:63], a[44:47], v[132:139], v88
  ds_read_b128 a[32:35], v2 offset:51200
  v_exp_f32 v143, v143
  v_exp_f32 v144, v144
  v_mfma_f32_32x32x16_bf16 v[92:107], a[20:23], a[4:7], v[92:107]
  ds_read_b128 a[36:39], v2 offset:52224
  buffer_load_dwordx4 v2, s[8:11], s16 offen offset:1024 lds
  v_exp_f32 v145, v145
  v_exp_f32 v146, v146
  v_exp_f32 v147, v147
  v_smfmac_f32_16x16x64_bf16 v[80:83], a[48:51], v[132:139], v88
  v_exp_f32 v148, v148
  v_exp_f32 v149, v149
  v_smfmac_f32_32x32x32_bf16 v[64:79], a[40:43], v[140:147], v88
  v_exp_f32 v150, v150
  v_exp_f32 v151, v151
  v_exp_f32 v152, v152
  v_smfmac_f32_16x16x64_bf16 v[84:87], a[48:51], v[140:147], v88
  buffer_load_dwordx4 v2, s[8:11], s16 offen offset:2048 lds
  v_exp_f32 v153, v153
  v_exp_f32 v154, v154
  v_exp_f32 v155, v155
  s_waitcnt lgkmcnt(0)
  v_mfma_f32_32x32x16_bf16 v[108:123], a[16:19], a[8:11], v[32:47]
  v_exp_f32 v92, v92
  v_exp_f32 v93, v93
  v_exp_f32 v94, v94
  v_smfmac_f32_32x32x32_bf16 v[64:79], a[44:47], v[148:155], v88
  ds_read_b128 a[24:27], v2 offset:53248
  v_exp_f32 v95, v95
  v_exp_f32 v96, v96
  v_mfma_f32_32x32x16_bf16 v[108:123], a[20:23], a[12:15], v[108:123]
  ds_read_b128 a[28:31], v2 offset:54272
  buffer_load_dwordx4 v2, s[8:11], s16 offen offset:3072 lds
  v_exp_f32 v97, v97
  v_exp_f32 v98, v98
  v_exp_f32 v99, v99
  v_smfmac_f32_16x16x64_bf16 v[84:87], a[48:51], v[148:155], v88
  s_add_u32 s16, s16, 16384
  v_exp_f32 v100, v100
  v_exp_f32 v101, v101
  v_smfmac_f32_32x32x32_bf16 v[48:63], a[32:35], v[92:99], v88
  v_exp_f32 v102, v102
  v_exp_f32 v103, v103
  v_exp_f32 v104, v104
  v_smfmac_f32_16x16x64_bf16 v[80:83], a[48:51], v[92:99], v88
  v_exp_f32 v105, v105
  v_exp_f32 v106, v106
  v_exp_f32 v107, v107
  s_waitcnt lgkmcnt(0)
  v_mfma_f32_32x32x16_bf16 v[124:139], a[24:27], a[0:3], v[16:31]
  v_exp_f32 v108, v108
  v_exp_f32 v109, v109
  v_exp_f32 v110, v110
  v_smfmac_f32_32x32x32_bf16 v[48:63], a[36:39], v[100:107], v88
  ds_read_b128 a[40:43], v2 offset:55296
  v_exp_f32 v111, v111
  v_exp_f32 v112, v112
  v_mfma_f32_32x32x16_bf16 v[124:139], a[28:31], a[4:7], v[124:139]
  ds_read_b128 a[44:47], v2 offset:56320
  v_exp_f32 v113, v113
  v_exp_f32 v114, v114
  v_exp_f32 v115, v115
  v_smfmac_f32_16x16x64_bf16 v[80:83], a[48:51], v[100:107], v88
  v_exp_f32 v116, v116
  v_exp_f32 v117, v117
  v_smfmac_f32_32x32x32_bf16 v[64:79], a[32:35], v[108:115], v88
  v_exp_f32 v118, v118
  v_exp_f32 v119, v119
  v_exp_f32 v120, v120
  v_smfmac_f32_16x16x64_bf16 v[84:87], a[48:51], v[108:115], v88
  v_exp_f32 v121, v121
  v_exp_f32 v122, v122
  v_exp_f32 v123, v123
  s_waitcnt lgkmcnt(0)
  v_mfma_f32_32x32x16_bf16 v[140:155], a[24:27], a[8:11], v[32:47]
  v_exp_f32 v124, v124
  v_exp_f32 v125, v125
  v_exp_f32 v126, v126
  v_smfmac_f32_32x32x32_bf16 v[64:79], a[36:39], v[116:123], v88
  ds_read_b128 a[16:19], v2 offset:57344
  v_exp_f32 v127, v127
  v_exp_f32 v128, v128
  v_mfma_f32_32x32x16_bf16 v[140:155], a[28:31], a[12:15], v[140:155]
  ds_read_b128 a[20:23], v2 offset:58368
  v_exp_f32 v129, v129
  v_exp_f32 v130, v130
  v_exp_f32 v131, v131
  v_smfmac_f32_16x16x64_bf16 v[84:87], a[48:51], v[116:123], v88
  v_exp_f32 v132, v132
  v_exp_f32 v133, v133
  v_smfmac_f32_32x32x32_bf16 v[48:63], a[40:43], v[124:131], v88
  v_exp_f32 v134, v134
  v_exp_f32 v135, v135
  v_exp_f32 v136, v136
  v_smfmac_f32_16x16x64_bf16 v[80:83], a[48:51], v[124:131], v88
  v_exp_f32 v137, v137
  v_exp_f32 v138, v138
  v_exp_f32 v139, v139
  s_waitcnt lgkmcnt(0)
  v_mfma_f32_32x32x16_bf16 v[92:107], a[16:19], a[0:3], v[16:31]
  v_exp_f32 v140, v140
  v_exp_f32 v141, v141
  v_exp_f32 v142, v142
  v_smfmac_f32_32x32x32_bf16 v[48:63], a[44:47], v[132:139], v88
  ds_read_b128 a[32:35], v2 offset:59392
  v_exp_f32 v143, v143
  v_exp_f32 v144, v144
  v_mfma_f32_32x32x16_bf16 v[92:107], a[20:23], a[4:7], v[92:107]
  ds_read_b128 a[36:39], v2 offset:60416
  v_exp_f32 v145, v145
  v_exp_f32 v146, v146
  v_exp_f32 v147, v147
  v_smfmac_f32_16x16x64_bf16 v[80:83], a[48:51], v[132:139], v88
  v_exp_f32 v148, v148
  v_exp_f32 v149, v149
  v_smfmac_f32_32x32x32_bf16 v[64:79], a[40:43], v[140:147], v88
  v_exp_f32 v150, v150
  v_exp_f32 v151, v151
  v_exp_f32 v152, v152
  v_smfmac_f32_16x16x64_bf16 v[84:87], a[48:51], v[140:147], v88
  v_exp_f32 v153, v153
  v_exp_f32 v154, v154
  v_exp_f32 v155, v155
  s_waitcnt lgkmcnt(0)
  v_mfma_f32_32x32x16_bf16 v[108:123], a[16:19], a[8:11], v[32:47]
  v_exp_f32 v92, v92
  v_exp_f32 v93, v93
  v_exp_f32 v94, v94
  v_smfmac_f32_32x32x32_bf16 v[64:79], a[44:47], v[148:155], v88
  ds_read_b128 a[24:27], v2 offset:61440
  v_exp_f32 v95, v95
  v_exp_f32 v96, v96
  v_mfma_f32_32x32x16_bf16 v[108:123], a[20:23], a[12:15], v[108:123]
  ds_read_b128 a[28:31], v2 offset:62464
  v_exp_f32 v97, v97
  v_exp_f32 v98, v98
  v_exp_f32 v99, v99
  v_smfmac_f32_16x16x64_bf16 v[84:87], a[48:51], v[148:155], v88
  v_exp_f32 v100, v100
  v_exp_f32 v101, v101
  v_smfmac_f32_32x32x32_bf16 v[48:63], a[32:35], v[92:99], v88
  v_exp_f32 v102, v102
  v_exp_f32 v103, v103
  v_exp_f32 v104, v104
  v_smfmac_f32_16x16x64_bf16 v[80:83], a[48:51], v[92:99], v88
  v_exp_f32 v105, v105
  v_exp_f32 v106, v106
  v_exp_f32 v107, v107
  s_waitcnt lgkmcnt(0)
  v_mfma_f32_32x32x16_bf16 v[124:139], a[24:27], a[0:3], v[16:31]
  v_exp_f32 v108, v108
  v_exp_f32 v109, v109
  v_exp_f32 v110, v110
  v_smfmac_f32_32x32x32_bf16 v[48:63], a[36:39], v[100:107], v88
  ds_read_b128 a[40:43], v2 offset:63488
  v_exp_f32 v111, v111
  v_exp_f32 v112, v112
  v_mfma_f32_32x32x16_bf16 v[124:139], a[28:31], a[4:7], v[124:139]
  ds_read_b128 a[44:47], v2 offset:64512
  v_exp_f32 v113, v113
  v_exp_f32 v114, v114
  v_exp_f32 v115, v115
  v_smfmac_f32_16x16x64_bf16 v[80:83], a[48:51], v[100:107], v88
  v_exp_f32 v116, v116
  v_exp_f32 v117, v117
  v_smfmac_f32_32x32x32_bf16 v[64:79], a[32:35], v[108:115], v88
  v_exp_f32 v118, v118
  v_exp_f32 v119, v119
  v_exp_f32 v120, v120
  v_smfmac_f32_16x16x64_bf16 v[84:87], a[48:51], v[108:115], v88
  v_exp_f32 v121, v121
  v_exp_f32 v122, v122
  v_exp_f32 v123, v123
  s_waitcnt vmcnt(12) lgkmcnt(0)
  v_mfma_f32_32x32x16_bf16 v[140:155], a[24:27], a[8:11], v[32:47]
  s_barrier
  v_exp_f32 v124, v124
  v_exp_f32 v125, v125
  v_exp_f32 v126, v126
  v_smfmac_f32_32x32x32_bf16 v[64:79], a[36:39], v[116:123], v88
  ds_read_b128 a[16:19], v3 offset:0
  v_exp_f32 v127, v127
  v_exp_f32 v128, v128
  v_mfma_f32_32x32x16_bf16 v[140:155], a[28:31], a[12:15], v[140:155]
  ds_read_b128 a[20:23], v3 offset:1024
  v_exp_f32 v129, v129
  v_exp_f32 v130, v130
  v_exp_f32 v131, v131
  v_smfmac_f32_16x16x64_bf16 v[84:87], a[48:51], v[116:123], v88
  s_add_u32 m0, s18, 49152
  v_exp_f32 v132, v132
  v_exp_f32 v133, v133
  v_smfmac_f32_32x32x32_bf16 v[48:63], a[40:43], v[124:131], v88
  v_exp_f32 v134, v134
  v_exp_f32 v135, v135
  v_exp_f32 v136, v136
  v_smfmac_f32_16x16x64_bf16 v[80:83], a[48:51], v[124:131], v88
  buffer_load_dwordx4 v2, s[8:11], s16 offen offset:0 lds
  v_exp_f32 v137, v137
  v_exp_f32 v138, v138
  v_exp_f32 v139, v139
  s_waitcnt lgkmcnt(0)
  v_mfma_f32_32x32x16_bf16 v[92:107], a[16:19], a[0:3], v[16:31]
  v_exp_f32 v140, v140
  v_exp_f32 v141, v141
  v_exp_f32 v142, v142
  v_smfmac_f32_32x32x32_bf16 v[48:63], a[44:47], v[132:139], v88
  ds_read_b128 a[32:35], v3 offset:2048
  v_exp_f32 v143, v143
  v_exp_f32 v144, v144
  v_mfma_f32_32x32x16_bf16 v[92:107], a[20:23], a[4:7], v[92:107]
  ds_read_b128 a[36:39], v3 offset:3072
  buffer_load_dwordx4 v2, s[8:11], s16 offen offset:1024 lds
  v_exp_f32 v145, v145
  v_exp_f32 v146, v146
  v_exp_f32 v147, v147
  v_smfmac_f32_16x16x64_bf16 v[80:83], a[48:51], v[132:139], v88
  v_exp_f32 v148, v148
  v_exp_f32 v149, v149
  v_smfmac_f32_32x32x32_bf16 v[64:79], a[40:43], v[140:147], v88
  v_exp_f32 v150, v150
  v_exp_f32 v151, v151
  v_exp_f32 v152, v152
  v_smfmac_f32_16x16x64_bf16 v[84:87], a[48:51], v[140:147], v88
  buffer_load_dwordx4 v2, s[8:11], s16 offen offset:2048 lds
  v_exp_f32 v153, v153
  v_exp_f32 v154, v154
  v_exp_f32 v155, v155
  s_waitcnt lgkmcnt(0)
  v_mfma_f32_32x32x16_bf16 v[108:123], a[16:19], a[8:11], v[32:47]
  v_exp_f32 v92, v92
  v_exp_f32 v93, v93
  v_exp_f32 v94, v94
  v_smfmac_f32_32x32x32_bf16 v[64:79], a[44:47], v[148:155], v88
  ds_read_b128 a[24:27], v3 offset:4096
  v_exp_f32 v95, v95
  v_exp_f32 v96, v96
  v_mfma_f32_32x32x16_bf16 v[108:123], a[20:23], a[12:15], v[108:123]
  ds_read_b128 a[28:31], v3 offset:5120
  buffer_load_dwordx4 v2, s[8:11], s16 offen offset:3072 lds
  v_exp_f32 v97, v97
  v_exp_f32 v98, v98
  v_exp_f32 v99, v99
  v_smfmac_f32_16x16x64_bf16 v[84:87], a[48:51], v[148:155], v88
  s_add_u32 s16, s16, 16384
  v_exp_f32 v100, v100
  v_exp_f32 v101, v101
  v_smfmac_f32_32x32x32_bf16 v[48:63], a[32:35], v[92:99], v88
  v_exp_f32 v102, v102
  v_exp_f32 v103, v103
  v_exp_f32 v104, v104
  v_smfmac_f32_16x16x64_bf16 v[80:83], a[48:51], v[92:99], v88
  v_exp_f32 v105, v105
  v_exp_f32 v106, v106
  v_exp_f32 v107, v107
  s_waitcnt lgkmcnt(0)
  v_mfma_f32_32x32x16_bf16 v[124:139], a[24:27], a[0:3], v[16:31]
  v_exp_f32 v108, v108
  v_exp_f32 v109, v109
  v_exp_f32 v110, v110
  v_smfmac_f32_32x32x32_bf16 v[48:63], a[36:39], v[100:107], v88
  ds_read_b128 a[40:43], v3 offset:6144
  v_exp_f32 v111, v111
  v_exp_f32 v112, v112
  v_mfma_f32_32x32x16_bf16 v[124:139], a[28:31], a[4:7], v[124:139]
  ds_read_b128 a[44:47], v3 offset:7168
  v_exp_f32 v113, v113
  v_exp_f32 v114, v114
  v_exp_f32 v115, v115
  v_smfmac_f32_16x16x64_bf16 v[80:83], a[48:51], v[100:107], v88
  v_exp_f32 v116, v116
  v_exp_f32 v117, v117
  v_smfmac_f32_32x32x32_bf16 v[64:79], a[32:35], v[108:115], v88
  v_exp_f32 v118, v118
  v_exp_f32 v119, v119
  v_exp_f32 v120, v120
  v_smfmac_f32_16x16x64_bf16 v[84:87], a[48:51], v[108:115], v88
  v_exp_f32 v121, v121
  v_exp_f32 v122, v122
  v_exp_f32 v123, v123
  s_waitcnt lgkmcnt(0)
  v_mfma_f32_32x32x16_bf16 v[140:155], a[24:27], a[8:11], v[32:47]
  v_exp_f32 v124, v124
  v_exp_f32 v125, v125
  v_exp_f32 v126, v126
  v_smfmac_f32_32x32x32_bf16 v[64:79], a[36:39], v[116:123], v88
  ds_read_b128 a[16:19], v3 offset:8192
  v_exp_f32 v127, v127
  v_exp_f32 v128, v128
  v_mfma_f32_32x32x16_bf16 v[140:155], a[28:31], a[12:15], v[140:155]
  ds_read_b128 a[20:23], v3 offset:9216
  v_exp_f32 v129, v129
  v_exp_f32 v130, v130
  v_exp_f32 v131, v131
  v_smfmac_f32_16x16x64_bf16 v[84:87], a[48:51], v[116:123], v88
  v_exp_f32 v132, v132
  v_exp_f32 v133, v133
  v_smfmac_f32_32x32x32_bf16 v[48:63], a[40:43], v[124:131], v88
  v_exp_f32 v134, v134
  v_exp_f32 v135, v135
  v_exp_f32 v136, v136
  v_smfmac_f32_16x16x64_bf16 v[80:83], a[48:51], v[124:131], v88
  v_exp_f32 v137, v137
  v_exp_f32 v138, v138
  v_exp_f32 v139, v139
  s_waitcnt lgkmcnt(0)
  v_mfma_f32_32x32x16_bf16 v[92:107], a[16:19], a[0:3], v[16:31]
  v_exp_f32 v140, v140
  v_exp_f32 v141, v141
  v_exp_f32 v142, v142
  v_smfmac_f32_32x32x32_bf16 v[48:63], a[44:47], v[132:139], v88
  ds_read_b128 a[32:35], v3 offset:10240
  v_exp_f32 v143, v143
  v_exp_f32 v144, v144
  v_mfma_f32_32x32x16_bf16 v[92:107], a[20:23], a[4:7], v[92:107]
  ds_read_b128 a[36:39], v3 offset:11264
  v_exp_f32 v145, v145
  v_exp_f32 v146, v146
  v_exp_f32 v147, v147
  v_smfmac_f32_16x16x64_bf16 v[80:83], a[48:51], v[132:139], v88
  v_exp_f32 v148, v148
  v_exp_f32 v149, v149
  v_smfmac_f32_32x32x32_bf16 v[64:79], a[40:43], v[140:147], v88
  v_exp_f32 v150, v150
  v_exp_f32 v151, v151
  v_exp_f32 v152, v152
  v_smfmac_f32_16x16x64_bf16 v[84:87], a[48:51], v[140:147], v88
  v_exp_f32 v153, v153
  v_exp_f32 v154, v154
  v_exp_f32 v155, v155
  s_waitcnt lgkmcnt(0)
  v_mfma_f32_32x32x16_bf16 v[108:123], a[16:19], a[8:11], v[32:47]
  v_exp_f32 v92, v92
  v_exp_f32 v93, v93
  v_exp_f32 v94, v94
  v_smfmac_f32_32x32x32_bf16 v[64:79], a[44:47], v[148:155], v88
  ds_read_b128 a[24:27], v3 offset:12288
  v_exp_f32 v95, v95
  v_exp_f32 v96, v96
  v_mfma_f32_32x32x16_bf16 v[108:123], a[20:23], a[12:15], v[108:123]
  ds_read_b128 a[28:31], v3 offset:13312
  v_exp_f32 v97, v97
  v_exp_f32 v98, v98
  v_exp_f32 v99, v99
  v_smfmac_f32_16x16x64_bf16 v[84:87], a[48:51], v[148:155], v88
  v_exp_f32 v100, v100
  v_exp_f32 v101, v101
  v_smfmac_f32_32x32x32_bf16 v[48:63], a[32:35], v[92:99], v88
  v_exp_f32 v102, v102
  v_exp_f32 v103, v103
  v_exp_f32 v104, v104
  v_smfmac_f32_16x16x64_bf16 v[80:83], a[48:51], v[92:99], v88
  v_exp_f32 v105, v105
  v_exp_f32 v106, v106
  v_exp_f32 v107, v107
  s_waitcnt lgkmcnt(0)
  v_mfma_f32_32x32x16_bf16 v[124:139], a[24:27], a[0:3], v[16:31]
  v_exp_f32 v108, v108
  v_exp_f32 v109, v109
  v_exp_f32 v110, v110
  v_smfmac_f32_32x32x32_bf16 v[48:63], a[36:39], v[100:107], v88
  ds_read_b128 a[40:43], v3 offset:14336
  v_exp_f32 v111, v111
  v_exp_f32 v112, v112
  v_mfma_f32_32x32x16_bf16 v[124:139], a[28:31], a[4:7], v[124:139]
  ds_read_b128 a[44:47], v3 offset:15360
  v_exp_f32 v113, v113
  v_exp_f32 v114, v114
  v_exp_f32 v115, v115
  v_smfmac_f32_16x16x64_bf16 v[80:83], a[48:51], v[100:107], v88
  v_exp_f32 v116, v116
  v_exp_f32 v117, v117
  v_smfmac_f32_32x32x32_bf16 v[64:79], a[32:35], v[108:115], v88
  v_exp_f32 v118, v118
  v_exp_f32 v119, v119
  v_exp_f32 v120, v120
  v_smfmac_f32_16x16x64_bf16 v[84:87], a[48:51], v[108:115], v88
  v_exp_f32 v121, v121
  v_exp_f32 v122, v122
  v_exp_f32 v123, v123
  s_waitcnt vmcnt(12) lgkmcnt(0)
  v_mfma_f32_32x32x16_bf16 v[140:155], a[24:27], a[8:11], v[32:47]
  s_barrier
  v_exp_f32 v124, v124
  v_exp_f32 v125, v125
  v_exp_f32 v126, v126
  v_smfmac_f32_32x32x32_bf16 v[64:79], a[36:39], v[116:123], v88
  ds_read_b128 a[16:19], v2 offset:0
  v_exp_f32 v127, v127
  v_exp_f32 v128, v128
  v_mfma_f32_32x32x16_bf16 v[140:155], a[28:31], a[12:15], v[140:155]
  ds_read_b128 a[20:23], v2 offset:1024
  v_exp_f32 v129, v129
  v_exp_f32 v130, v130
  v_exp_f32 v131, v131
  v_smfmac_f32_16x16x64_bf16 v[84:87], a[48:51], v[116:123], v88
  s_add_u32 m0, s18, 65536
  v_exp_f32 v132, v132
  v_exp_f32 v133, v133
  v_smfmac_f32_32x32x32_bf16 v[48:63], a[40:43], v[124:131], v88
  v_exp_f32 v134, v134
  v_exp_f32 v135, v135
  v_exp_f32 v136, v136
  v_smfmac_f32_16x16x64_bf16 v[80:83], a[48:51], v[124:131], v88
  buffer_load_dwordx4 v2, s[8:11], s16 offen offset:0 lds
  v_exp_f32 v137, v137
  v_exp_f32 v138, v138
  v_exp_f32 v139, v139
  s_waitcnt lgkmcnt(0)
  v_mfma_f32_32x32x16_bf16 v[92:107], a[16:19], a[0:3], v[16:31]
  v_exp_f32 v140, v140
  v_exp_f32 v141, v141
  v_exp_f32 v142, v142
  v_smfmac_f32_32x32x32_bf16 v[48:63], a[44:47], v[132:139], v88
  ds_read_b128 a[32:35], v2 offset:2048
  v_exp_f32 v143, v143
  v_exp_f32 v144, v144
  v_mfma_f32_32x32x16_bf16 v[92:107], a[20:23], a[4:7], v[92:107]
  ds_read_b128 a[36:39], v2 offset:3072
  buffer_load_dwordx4 v2, s[8:11], s16 offen offset:1024 lds
  v_exp_f32 v145, v145
  v_exp_f32 v146, v146
  v_exp_f32 v147, v147
  v_smfmac_f32_16x16x64_bf16 v[80:83], a[48:51], v[132:139], v88
  v_exp_f32 v148, v148
  v_exp_f32 v149, v149
  v_smfmac_f32_32x32x32_bf16 v[64:79], a[40:43], v[140:147], v88
  v_exp_f32 v150, v150
  v_exp_f32 v151, v151
  v_exp_f32 v152, v152
  v_smfmac_f32_16x16x64_bf16 v[84:87], a[48:51], v[140:147], v88
  buffer_load_dwordx4 v2, s[8:11], s16 offen offset:2048 lds
  v_exp_f32 v153, v153
  v_exp_f32 v154, v154
  v_exp_f32 v155, v155
  s_waitcnt lgkmcnt(0)
  v_mfma_f32_32x32x16_bf16 v[108:123], a[16:19], a[8:11], v[32:47]
  v_exp_f32 v92, v92
  v_exp_f32 v93, v93
  v_exp_f32 v94, v94
  v_smfmac_f32_32x32x32_bf16 v[64:79], a[44:47], v[148:155], v88
  ds_read_b128 a[24:27], v2 offset:4096
  v_exp_f32 v95, v95
  v_exp_f32 v96, v96
  v_mfma_f32_32x32x16_bf16 v[108:123], a[20:23], a[12:15], v[108:123]
  ds_read_b128 a[28:31], v2 offset:5120
  buffer_load_dwordx4 v2, s[8:11], s16 offen offset:3072 lds
  v_exp_f32 v97, v97
  v_exp_f32 v98, v98
  v_exp_f32 v99, v99
  v_smfmac_f32_16x16x64_bf16 v[84:87], a[48:51], v[148:155], v88
  s_add_u32 s16, s16, 16384
  v_exp_f32 v100, v100
  v_exp_f32 v101, v101
  v_smfmac_f32_32x32x32_bf16 v[48:63], a[32:35], v[92:99], v88
  v_exp_f32 v102, v102
  v_exp_f32 v103, v103
  v_exp_f32 v104, v104
  v_smfmac_f32_16x16x64_bf16 v[80:83], a[48:51], v[92:99], v88
  v_exp_f32 v105, v105
  v_exp_f32 v106, v106
  v_exp_f32 v107, v107
  s_waitcnt lgkmcnt(0)
  v_mfma_f32_32x32x16_bf16 v[124:139], a[24:27], a[0:3], v[16:31]
  v_exp_f32 v108, v108
  v_exp_f32 v109, v109
  v_exp_f32 v110, v110
  v_smfmac_f32_32x32x32_bf16 v[48:63], a[36:39], v[100:107], v88
  ds_read_b128 a[40:43], v2 offset:6144
  v_exp_f32 v111, v111
  v_exp_f32 v112, v112
  v_mfma_f32_32x32x16_bf16 v[124:139], a[28:31], a[4:7], v[124:139]
  ds_read_b128 a[44:47], v2 offset:7168
  v_exp_f32 v113, v113
  v_exp_f32 v114, v114
  v_exp_f32 v115, v115
  v_smfmac_f32_16x16x64_bf16 v[80:83], a[48:51], v[100:107], v88
  v_exp_f32 v116, v116
  v_exp_f32 v117, v117
  v_smfmac_f32_32x32x32_bf16 v[64:79], a[32:35], v[108:115], v88
  v_exp_f32 v118, v118
  v_exp_f32 v119, v119
  v_exp_f32 v120, v120
  v_smfmac_f32_16x16x64_bf16 v[84:87], a[48:51], v[108:115], v88
  v_exp_f32 v121, v121
  v_exp_f32 v122, v122
  v_exp_f32 v123, v123
  s_waitcnt lgkmcnt(0)
  v_mfma_f32_32x32x16_bf16 v[140:155], a[24:27], a[8:11], v[32:47]
  v_exp_f32 v124, v124
  v_exp_f32 v125, v125
  v_exp_f32 v126, v126
  v_smfmac_f32_32x32x32_bf16 v[64:79], a[36:39], v[116:123], v88
  ds_read_b128 a[16:19], v2 offset:8192
  v_exp_f32 v127, v127
  v_exp_f32 v128, v128
  v_mfma_f32_32x32x16_bf16 v[140:155], a[28:31], a[12:15], v[140:155]
  ds_read_b128 a[20:23], v2 offset:9216
  v_exp_f32 v129, v129
  v_exp_f32 v130, v130
  v_exp_f32 v131, v131
  v_smfmac_f32_16x16x64_bf16 v[84:87], a[48:51], v[116:123], v88
  v_exp_f32 v132, v132
  v_exp_f32 v133, v133
  v_smfmac_f32_32x32x32_bf16 v[48:63], a[40:43], v[124:131], v88
  v_exp_f32 v134, v134
  v_exp_f32 v135, v135
  v_exp_f32 v136, v136
  v_smfmac_f32_16x16x64_bf16 v[80:83], a[48:51], v[124:131], v88
  v_exp_f32 v137, v137
  v_exp_f32 v138, v138
  v_exp_f32 v139, v139
  s_waitcnt lgkmcnt(0)
  v_mfma_f32_32x32x16_bf16 v[92:107], a[16:19], a[0:3], v[16:31]
  v_exp_f32 v140, v140
  v_exp_f32 v141, v141
  v_exp_f32 v142, v142
  v_smfmac_f32_32x32x32_bf16 v[48:63], a[44:47], v[132:139], v88
  ds_read_b128 a[32:35], v2 offset:10240
  v_exp_f32 v143, v143
  v_exp_f32 v144, v144
  v_mfma_f32_32x32x16_bf16 v[92:107], a[20:23], a[4:7], v[92:107]
  ds_read_b128 a[36:39], v2 offset:11264
  v_exp_f32 v145, v145
  v_exp_f32 v146, v146
  v_exp_f32 v147, v147
  v_smfmac_f32_16x16x64_bf16 v[80:83], a[48:51], v[132:139], v88
  v_exp_f32 v148, v148
  v_exp_f32 v149, v149
  v_smfmac_f32_32x32x32_bf16 v[64:79], a[40:43], v[140:147], v88
  v_exp_f32 v150, v150
  v_exp_f32 v151, v151
  v_exp_f32 v152, v152
  v_smfmac_f32_16x16x64_bf16 v[84:87], a[48:51], v[140:147], v88
  v_exp_f32 v153, v153
  v_exp_f32 v154, v154
  v_exp_f32 v155, v155
  s_waitcnt lgkmcnt(0)
  v_mfma_f32_32x32x16_bf16 v[108:123], a[16:19], a[8:11], v[32:47]
  v_exp_f32 v92, v92
  v_exp_f32 v93, v93
  v_exp_f32 v94, v94
  v_smfmac_f32_32x32x32_bf16 v[64:79], a[44:47], v[148:155], v88
  ds_read_b128 a[24:27], v2 offset:12288
  v_exp_f32 v95, v95
  v_exp_f32 v96, v96
  v_mfma_f32_32x32x16_bf16 v[108:123], a[20:23], a[12:15], v[108:123]
  ds_read_b128 a[28:31], v2 offset:13312
  v_exp_f32 v97, v97
  v_exp_f32 v98, v98
  v_exp_f32 v99, v99
  v_smfmac_f32_16x16x64_bf16 v[84:87], a[48:51], v[148:155], v88
  v_exp_f32 v100, v100
  v_exp_f32 v101, v101
  v_smfmac_f32_32x32x32_bf16 v[48:63], a[32:35], v[92:99], v88
  v_exp_f32 v102, v102
  v_exp_f32 v103, v103
  v_exp_f32 v104, v104
  v_smfmac_f32_16x16x64_bf16 v[80:83], a[48:51], v[92:99], v88
  v_exp_f32 v105, v105
  v_exp_f32 v106, v106
  v_exp_f32 v107, v107
  s_waitcnt lgkmcnt(0)
  v_mfma_f32_32x32x16_bf16 v[124:139], a[24:27], a[0:3], v[16:31]
  v_exp_f32 v108, v108
  v_exp_f32 v109, v109
  v_exp_f32 v110, v110
  v_smfmac_f32_32x32x32_bf16 v[48:63], a[36:39], v[100:107], v88
  ds_read_b128 a[40:43], v2 offset:14336
  v_exp_f32 v111, v111
  v_exp_f32 v112, v112
  v_mfma_f32_32x32x16_bf16 v[124:139], a[28:31], a[4:7], v[124:139]
  ds_read_b128 a[44:47], v2 offset:15360
  v_exp_f32 v113, v113
  v_exp_f32 v114, v114
  v_exp_f32 v115, v115
  v_smfmac_f32_16x16x64_bf16 v[80:83], a[48:51], v[100:107], v88
  v_exp_f32 v116, v116
  v_exp_f32 v117, v117
  v_smfmac_f32_32x32x32_bf16 v[64:79], a[32:35], v[108:115], v88
  v_exp_f32 v118, v118
  v_exp_f32 v119, v119
  v_exp_f32 v120, v120
  v_smfmac_f32_16x16x64_bf16 v[84:87], a[48:51], v[108:115], v88
  v_exp_f32 v121, v121
  v_exp_f32 v122, v122
  v_exp_f32 v123, v123
  s_waitcnt vmcnt(12) lgkmcnt(0)
  v_mfma_f32_32x32x16_bf16 v[140:155], a[24:27], a[8:11], v[32:47]
  s_barrier
  v_exp_f32 v124, v124
  v_exp_f32 v125, v125
  v_exp_f32 v126, v126
  v_smfmac_f32_32x32x32_bf16 v[64:79], a[36:39], v[116:123], v88
  ds_read_b128 a[16:19], v2 offset:16384
  v_exp_f32 v127, v127
  v_exp_f32 v128, v128
  v_mfma_f32_32x32x16_bf16 v[140:155], a[28:31], a[12:15], v[140:155]
  ds_read_b128 a[20:23], v2 offset:17408
  v_exp_f32 v129, v129
  v_exp_f32 v130, v130
  v_exp_f32 v131, v131
  v_smfmac_f32_16x16x64_bf16 v[84:87], a[48:51], v[116:123], v88
  s_add_u32 m0, s18, 0
  v_exp_f32 v132, v132
  v_exp_f32 v133, v133
  v_smfmac_f32_32x32x32_bf16 v[48:63], a[40:43], v[124:131], v88
  v_exp_f32 v134, v134
  v_exp_f32 v135, v135
  v_exp_f32 v136, v136
  v_smfmac_f32_16x16x64_bf16 v[80:83], a[48:51], v[124:131], v88
  buffer_load_dwordx4 v2, s[8:11], s16 offen offset:0 lds
  v_exp_f32 v137, v137
  v_exp_f32 v138, v138
  v_exp_f32 v139, v139
  s_waitcnt lgkmcnt(0)
  v_mfma_f32_32x32x16_bf16 v[92:107], a[16:19], a[0:3], v[16:31]
  v_exp_f32 v140, v140
  v_exp_f32 v141, v141
  v_exp_f32 v142, v142
  v_smfmac_f32_32x32x32_bf16 v[48:63], a[44:47], v[132:139], v88
  ds_read_b128 a[32:35], v2 offset:18432
  v_exp_f32 v143, v143
  v_exp_f32 v144, v144
  v_mfma_f32_32x32x16_bf16 v[92:107], a[20:23], a[4:7], v[92:107]
  ds_read_b128 a[36:39], v2 offset:19456
  buffer_load_dwordx4 v2, s[8:11], s16 offen offset:1024 lds
  v_exp_f32 v145, v145
  v_exp_f32 v146, v146
  v_exp_f32 v147, v147
  v_smfmac_f32_16x16x64_bf16 v[80:83], a[48:51], v[132:139], v88
  v_exp_f32 v148, v148
  v_exp_f32 v149, v149
  v_smfmac_f32_32x32x32_bf16 v[64:79], a[40:43], v[140:147], v88
  v_exp_f32 v150, v150
  v_exp_f32 v151, v151
  v_exp_f32 v152, v152
  v_smfmac_f32_16x16x64_bf16 v[84:87], a[48:51], v[140:147], v88
  buffer_load_dwordx4 v2, s[8:11], s16 offen offset:2048 lds
  v_exp_f32 v153, v153
  v_exp_f32 v154, v154
  v_exp_f32 v155, v155
  s_waitcnt lgkmcnt(0)
  v_mfma_f32_32x32x16_bf16 v[108:123], a[16:19], a[8:11], v[32:47]
  v_exp_f32 v92, v92
  v_exp_f32 v93, v93
  v_exp_f32 v94, v94
  v_smfmac_f32_32x32x32_bf16 v[64:79], a[44:47], v[148:155], v88
  ds_read_b128 a[24:27], v2 offset:20480
  v_exp_f32 v95, v95
  v_exp_f32 v96, v96
  v_mfma_f32_32x32x16_bf16 v[108:123], a[20:23], a[12:15], v[108:123]
  ds_read_b128 a[28:31], v2 offset:21504
  buffer_load_dwordx4 v2, s[8:11], s16 offen offset:3072 lds
  v_exp_f32 v97, v97
  v_exp_f32 v98, v98
  v_exp_f32 v99, v99
  v_smfmac_f32_16x16x64_bf16 v[84:87], a[48:51], v[148:155], v88
  s_add_u32 s16, s16, 16384
  v_exp_f32 v100, v100
  v_exp_f32 v101, v101
  v_smfmac_f32_32x32x32_bf16 v[48:63], a[32:35], v[92:99], v88
  v_exp_f32 v102, v102
  v_exp_f32 v103, v103
  v_exp_f32 v104, v104
  v_smfmac_f32_16x16x64_bf16 v[80:83], a[48:51], v[92:99], v88
  v_exp_f32 v105, v105
  v_exp_f32 v106, v106
  v_exp_f32 v107, v107
  s_waitcnt lgkmcnt(0)
  v_mfma_f32_32x32x16_bf16 v[124:139], a[24:27], a[0:3], v[16:31]
  v_exp_f32 v108, v108
  v_exp_f32 v109, v109
  v_exp_f32 v110, v110
  v_smfmac_f32_32x32x32_bf16 v[48:63], a[36:39], v[100:107], v88
  ds_read_b128 a[40:43], v2 offset:22528
  v_exp_f32 v111, v111
  v_exp_f32 v112, v112
  v_mfma_f32_32x32x16_bf16 v[124:139], a[28:31], a[4:7], v[124:139]
  ds_read_b128 a[44:47], v2 offset:23552
  v_exp_f32 v113, v113
  v_exp_f32 v114, v114
  v_exp_f32 v115, v115
  v_smfmac_f32_16x16x64_bf16 v[80:83], a[48:51], v[100:107], v88
  v_exp_f32 v116, v116
  v_exp_f32 v117, v117
  v_smfmac_f32_32x32x32_bf16 v[64:79], a[32:35], v[108:115], v88
  v_exp_f32 v118, v118
  v_exp_f32 v119, v119
  v_exp_f32 v120, v120
  v_smfmac_f32_16x16x64_bf16 v[84:87], a[48:51], v[108:115], v88
  v_exp_f32 v121, v121
  v_exp_f32 v122, v122
  v_exp_f32 v123, v123
  s_waitcnt lgkmcnt(0)
  v_mfma_f32_32x32x16_bf16 v[140:155], a[24:27], a[8:11], v[32:47]
  v_exp_f32 v124, v124
  v_exp_f32 v125, v125
  v_exp_f32 v126, v126
  v_smfmac_f32_32x32x32_bf16 v[64:79], a[36:39], v[116:123], v88
  ds_read_b128 a[16:19], v2 offset:24576
  v_exp_f32 v127, v127
  v_exp_f32 v128, v128
  v_mfma_f32_32x32x16_bf16 v[140:155], a[28:31], a[12:15], v[140:155]
  ds_read_b128 a[20:23], v2 offset:25600
  v_exp_f32 v129, v129
  v_exp_f32 v130, v130
  v_exp_f32 v131, v131
  v_smfmac_f32_16x16x64_bf16 v[84:87], a[48:51], v[116:123], v88
  v_exp_f32 v132, v132
  v_exp_f32 v133, v133
  v_smfmac_f32_32x32x32_bf16 v[48:63], a[40:43], v[124:131], v88
  v_exp_f32 v134, v134
  v_exp_f32 v135, v135
  v_exp_f32 v136, v136
  v_smfmac_f32_16x16x64_bf16 v[80:83], a[48:51], v[124:131], v88
  v_exp_f32 v137, v137
  v_exp_f32 v138, v138
  v_exp_f32 v139, v139
  s_waitcnt lgkmcnt(0)
  v_mfma_f32_32x32x16_bf16 v[92:107], a[16:19], a[0:3], v[16:31]
  v_exp_f32 v140, v140
  v_exp_f32 v141, v141
  v_exp_f32 v142, v142
  v_smfmac_f32_32x32x32_bf16 v[48:63], a[44:47], v[132:139], v88
  ds_read_b128 a[32:35], v2 offset:26624
  v_exp_f32 v143, v143
  v_exp_f32 v144, v144
  v_mfma_f32_32x32x16_bf16 v[92:107], a[20:23], a[4:7], v[92:107]
  ds_read_b128 a[36:39], v2 offset:27648
  v_exp_f32 v145, v145
  v_exp_f32 v146, v146
  v_exp_f32 v147, v147
  v_smfmac_f32_16x16x64_bf16 v[80:83], a[48:51], v[132:139], v88
  v_exp_f32 v148, v148
  v_exp_f32 v149, v149
  v_smfmac_f32_32x32x32_bf16 v[64:79], a[40:43], v[140:147], v88
  v_exp_f32 v150, v150
  v_exp_f32 v151, v151
  v_exp_f32 v152, v152
  v_smfmac_f32_16x16x64_bf16 v[84:87], a[48:51], v[140:147], v88
  v_exp_f32 v153, v153
  v_exp_f32 v154, v154
  v_exp_f32 v155, v155
  s_waitcnt lgkmcnt(0)
  v_mfma_f32_32x32x16_bf16 v[108:123], a[16:19], a[8:11], v[32:47]
  v_exp_f32 v92, v92
  v_exp_f32 v93, v93
  v_exp_f32 v94, v94
  v_smfmac_f32_32x32x32_bf16 v[64:79], a[44:47], v[148:155], v88
  ds_read_b128 a[24:27], v2 offset:28672
  v_exp_f32 v95, v95
  v_exp_f32 v96, v96
  v_mfma_f32_32x32x16_bf16 v[108:123], a[20:23], a[12:15], v[108:123]
  ds_read_b128 a[28:31], v2 offset:29696
  v_exp_f32 v97, v97
  v_exp_f32 v98, v98
  v_exp_f32 v99, v99
  v_smfmac_f32_16x16x64_bf16 v[84:87], a[48:51], v[148:155], v88
  v_exp_f32 v100, v100
  v_exp_f32 v101, v101
  v_smfmac_f32_32x32x32_bf16 v[48:63], a[32:35], v[92:99], v88
  v_exp_f32 v102, v102
  v_exp_f32 v103, v103
  v_exp_f32 v104, v104
  v_smfmac_f32_16x16x64_bf16 v[80:83], a[48:51], v[92:99], v88
  v_exp_f32 v105, v105
  v_exp_f32 v106, v106
  v_exp_f32 v107, v107
  s_waitcnt lgkmcnt(0)
  v_mfma_f32_32x32x16_bf16 v[124:139], a[24:27], a[0:3], v[16:31]
  v_exp_f32 v108, v108
  v_exp_f32 v109, v109
  v_exp_f32 v110, v110
  v_smfmac_f32_32x32x32_bf16 v[48:63], a[36:39], v[100:107], v88
  ds_read_b128 a[40:43], v2 offset:30720
  v_exp_f32 v111, v111
  v_exp_f32 v112, v112
  v_mfma_f32_32x32x16_bf16 v[124:139], a[28:31], a[4:7], v[124:139]
  ds_read_b128 a[44:47], v2 offset:31744
  v_exp_f32 v113, v113
  v_exp_f32 v114, v114
  v_exp_f32 v115, v115
  v_smfmac_f32_16x16x64_bf16 v[80:83], a[48:51], v[100:107], v88
  v_exp_f32 v116, v116
  v_exp_f32 v117, v117
  v_smfmac_f32_32x32x32_bf16 v[64:79], a[32:35], v[108:115], v88
  v_exp_f32 v118, v118
  v_exp_f32 v119, v119
  v_exp_f32 v120, v120
  v_smfmac_f32_16x16x64_bf16 v[84:87], a[48:51], v[108:115], v88
  v_exp_f32 v121, v121
  v_exp_f32 v122, v122
  v_exp_f32 v123, v123
  s_waitcnt vmcnt(12) lgkmcnt(0)
  v_mfma_f32_32x32x16_bf16 v[140:155], a[24:27], a[8:11], v[32:47]
  s_barrier
  v_exp_f32 v124, v124
  v_exp_f32 v125, v125
  v_exp_f32 v126, v126
  v_smfmac_f32_32x32x32_bf16 v[64:79], a[36:39], v[116:123], v88
  ds_read_b128 a[16:19], v2 offset:32768
  v_exp_f32 v127, v127
  v_exp_f32 v128, v128
  v_mfma_f32_32x32x16_bf16 v[140:155], a[28:31], a[12:15], v[140:155]
  ds_read_b128 a[20:23], v2 offset:33792
  v_exp_f32 v129, v129
  v_exp_f32 v130, v130
  v_exp_f32 v131, v131
  v_smfmac_f32_16x16x64_bf16 v[84:87], a[48:51], v[116:123], v88
  v_exp_f32 v132, v132
  v_exp_f32 v133, v133
  v_smfmac_f32_32x32x32_bf16 v[48:63], a[40:43], v[124:131], v88
  v_exp_f32 v134, v134
  v_exp_f32 v135, v135
  v_exp_f32 v136, v136
  v_smfmac_f32_16x16x64_bf16 v[80:83], a[48:51], v[124:131], v88
  v_exp_f32 v137, v137
  v_exp_f32 v138, v138
  v_exp_f32 v139, v139
  s_waitcnt lgkmcnt(0)
  v_mfma_f32_32x32x16_bf16 v[92:107], a[16:19], a[0:3], v[16:31]
  v_exp_f32 v140, v140
  v_exp_f32 v141, v141
  v_exp_f32 v142, v142
  v_smfmac_f32_32x32x32_bf16 v[48:63], a[44:47], v[132:139], v88
  ds_read_b128 a[32:35], v2 offset:34816
  v_exp_f32 v143, v143
  v_exp_f32 v144, v144
  v_mfma_f32_32x32x16_bf16 v[92:107], a[20:23], a[4:7], v[92:107]
  ds_read_b128 a[36:39], v2 offset:35840
  v_exp_f32 v145, v145
  v_exp_f32 v146, v146
  v_exp_f32 v147, v147
  v_smfmac_f32_16x16x64_bf16 v[80:83], a[48:51], v[132:139], v88
  v_exp_f32 v148, v148
  v_exp_f32 v149, v149
  v_smfmac_f32_32x32x32_bf16 v[64:79], a[40:43], v[140:147], v88
  v_exp_f32 v150, v150
  v_exp_f32 v151, v151
  v_exp_f32 v152, v152
  v_smfmac_f32_16x16x64_bf16 v[84:87], a[48:51], v[140:147], v88
  v_exp_f32 v153, v153
  v_exp_f32 v154, v154
  v_exp_f32 v155, v155
  s_waitcnt lgkmcnt(0)
  v_mfma_f32_32x32x16_bf16 v[108:123], a[16:19], a[8:11], v[32:47]
  v_exp_f32 v92, v92
  v_exp_f32 v93, v93
  v_exp_f32 v94, v94
  v_smfmac_f32_32x32x32_bf16 v[64:79], a[44:47], v[148:155], v88
  ds_read_b128 a[24:27], v2 offset:36864
  v_exp_f32 v95, v95
  v_exp_f32 v96, v96
  v_mfma_f32_32x32x16_bf16 v[108:123], a[20:23], a[12:15], v[108:123]
  ds_read_b128 a[28:31], v2 offset:37888
  v_exp_f32 v97, v97
  v_exp_f32 v98, v98
  v_exp_f32 v99, v99
  v_smfmac_f32_16x16x64_bf16 v[84:87], a[48:51], v[148:155], v88
  v_exp_f32 v100, v100
  v_exp_f32 v101, v101
  v_smfmac_f32_32x32x32_bf16 v[48:63], a[32:35], v[92:99], v88
  v_exp_f32 v102, v102
  v_exp_f32 v103, v103
  v_exp_f32 v104, v104
  v_smfmac_f32_16x16x64_bf16 v[80:83], a[48:51], v[92:99], v88
  v_exp_f32 v105, v105
  v_exp_f32 v106, v106
  v_exp_f32 v107, v107
  s_waitcnt lgkmcnt(0)
  v_mfma_f32_32x32x16_bf16 v[124:139], a[24:27], a[0:3], v[16:31]
  v_exp_f32 v108, v108
  v_exp_f32 v109, v109
  v_exp_f32 v110, v110
  v_smfmac_f32_32x32x32_bf16 v[48:63], a[36:39], v[100:107], v88
  ds_read_b128 a[40:43], v2 offset:38912
  v_exp_f32 v111, v111
  v_exp_f32 v112, v112
  v_mfma_f32_32x32x16_bf16 v[124:139], a[28:31], a[4:7], v[124:139]
  ds_read_b128 a[44:47], v2 offset:39936
  v_exp_f32 v113, v113
  v_exp_f32 v114, v114
  v_exp_f32 v115, v115
  v_smfmac_f32_16x16x64_bf16 v[80:83], a[48:51], v[100:107], v88
  v_exp_f32 v116, v116
  v_exp_f32 v117, v117
  v_smfmac_f32_32x32x32_bf16 v[64:79], a[32:35], v[108:115], v88
  v_exp_f32 v118, v118
  v_exp_f32 v119, v119
  v_exp_f32 v120, v120
  v_smfmac_f32_16x16x64_bf16 v[84:87], a[48:51], v[108:115], v88
  v_exp_f32 v121, v121
  v_exp_f32 v122, v122
  v_exp_f32 v123, v123
  s_waitcnt lgkmcnt(0)
  v_mfma_f32_32x32x16_bf16 v[140:155], a[24:27], a[8:11], v[32:47]
  v_exp_f32 v124, v124
  v_exp_f32 v125, v125
  v_exp_f32 v126, v126
  v_smfmac_f32_32x32x32_bf16 v[64:79], a[36:39], v[116:123], v88
  ds_read_b128 a[16:19], v2 offset:40960
  v_exp_f32 v127, v127
  v_exp_f32 v128, v128
  v_mfma_f32_32x32x16_bf16 v[140:155], a[28:31], a[12:15], v[140:155]
  ds_read_b128 a[20:23], v2 offset:41984
  v_exp_f32 v129, v129
  v_exp_f32 v130, v130
  v_exp_f32 v131, v131
  v_smfmac_f32_16x16x64_bf16 v[84:87], a[48:51], v[116:123], v88
  v_exp_f32 v132, v132
  v_exp_f32 v133, v133
  v_smfmac_f32_32x32x32_bf16 v[48:63], a[40:43], v[124:131], v88
  v_exp_f32 v134, v134
  v_exp_f32 v135, v135
  v_exp_f32 v136, v136
  v_smfmac_f32_16x16x64_bf16 v[80:83], a[48:51], v[124:131], v88
  v_exp_f32 v137, v137
  v_exp_f32 v138, v138
  v_exp_f32 v139, v139
  s_waitcnt lgkmcnt(0)
  v_mfma_f32_32x32x16_bf16 v[92:107], a[16:19], a[0:3], v[16:31]
  v_exp_f32 v140, v140
  v_exp_f32 v141, v141
  v_exp_f32 v142, v142
  v_smfmac_f32_32x32x32_bf16 v[48:63], a[44:47], v[132:139], v88
  ds_read_b128 a[32:35], v2 offset:43008
  v_exp_f32 v143, v143
  v_exp_f32 v144, v144
  v_mfma_f32_32x32x16_bf16 v[92:107], a[20:23], a[4:7], v[92:107]
  ds_read_b128 a[36:39], v2 offset:44032
  v_exp_f32 v145, v145
  v_exp_f32 v146, v146
  v_exp_f32 v147, v147
  v_smfmac_f32_16x16x64_bf16 v[80:83], a[48:51], v[132:139], v88
  v_exp_f32 v148, v148
  v_exp_f32 v149, v149
  v_smfmac_f32_32x32x32_bf16 v[64:79], a[40:43], v[140:147], v88
  v_exp_f32 v150, v150
  v_exp_f32 v151, v151
  v_exp_f32 v152, v152
  v_smfmac_f32_16x16x64_bf16 v[84:87], a[48:51], v[140:147], v88
  v_exp_f32 v153, v153
  v_exp_f32 v154, v154
  v_exp_f32 v155, v155
  s_waitcnt lgkmcnt(0)
  v_mfma_f32_32x32x16_bf16 v[108:123], a[16:19], a[8:11], v[32:47]
  v_exp_f32 v92, v92
  v_exp_f32 v93, v93
  v_exp_f32 v94, v94
  v_smfmac_f32_32x32x32_bf16 v[64:79], a[44:47], v[148:155], v88
  ds_read_b128 a[24:27], v2 offset:45056
  v_exp_f32 v95, v95
  v_exp_f32 v96, v96
  v_mfma_f32_32x32x16_bf16 v[108:123], a[20:23], a[12:15], v[108:123]
  ds_read_b128 a[28:31], v2 offset:46080
  buffer_load_dword v89, v9, s[36:39], s41 offen
  v_exp_f32 v97, v97
  v_exp_f32 v98, v98
  v_exp_f32 v99, v99
  v_smfmac_f32_16x16x64_bf16 v[84:87], a[48:51], v[148:155], v88
  v_exp_f32 v100, v100
  v_exp_f32 v101, v101
  v_smfmac_f32_32x32x32_bf16 v[48:63], a[32:35], v[92:99], v88
  v_exp_f32 v102, v102
  v_exp_f32 v103, v103
  v_exp_f32 v104, v104
  v_smfmac_f32_16x16x64_bf16 v[80:83], a[48:51], v[92:99], v88
  v_exp_f32 v105, v105
  v_exp_f32 v106, v106
  v_exp_f32 v107, v107
  s_waitcnt lgkmcnt(0)
  v_mfma_f32_32x32x16_bf16 v[124:139], a[24:27], a[0:3], v[16:31]
  v_exp_f32 v108, v108
  v_exp_f32 v109, v109
  v_exp_f32 v110, v110
  v_smfmac_f32_32x32x32_bf16 v[48:63], a[36:39], v[100:107], v88
  ds_read_b128 a[40:43], v2 offset:47104
  v_exp_f32 v111, v111
  v_exp_f32 v112, v112
  v_mfma_f32_32x32x16_bf16 v[124:139], a[28:31], a[4:7], v[124:139]
  ds_read_b128 a[44:47], v2 offset:48128
  v_exp_f32 v113, v113
  v_exp_f32 v114, v114
  v_exp_f32 v115, v115
  v_smfmac_f32_16x16x64_bf16 v[80:83], a[48:51], v[100:107], v88
  v_exp_f32 v116, v116
  v_exp_f32 v117, v117
  v_smfmac_f32_32x32x32_bf16 v[64:79], a[32:35], v[108:115], v88
  v_exp_f32 v118, v118
  v_exp_f32 v119, v119
  v_exp_f32 v120, v120
  v_smfmac_f32_16x16x64_bf16 v[84:87], a[48:51], v[108:115], v88
  v_exp_f32 v121, v121
  v_exp_f32 v122, v122
  v_exp_f32 v123, v123
  s_waitcnt vmcnt(9) lgkmcnt(0)
  v_mfma_f32_32x32x16_bf16 v[140:155], a[24:27], a[8:11], v[32:47]
  s_barrier
  v_exp_f32 v124, v124
  v_exp_f32 v125, v125
  v_exp_f32 v126, v126
  v_smfmac_f32_32x32x32_bf16 v[64:79], a[36:39], v[116:123], v88
  ds_read_b128 a[16:19], v2 offset:49152
  v_exp_f32 v127, v127
  v_exp_f32 v128, v128
  v_mfma_f32_32x32x16_bf16 v[140:155], a[28:31], a[12:15], v[140:155]
  ds_read_b128 a[20:23], v2 offset:50176
  v_exp_f32 v129, v129
  v_exp_f32 v130, v130
  v_exp_f32 v131, v131
  v_smfmac_f32_16x16x64_bf16 v[84:87], a[48:51], v[116:123], v88
  v_exp_f32 v132, v132
  v_exp_f32 v133, v133
  v_smfmac_f32_32x32x32_bf16 v[48:63], a[40:43], v[124:131], v88
  v_exp_f32 v134, v134
  v_exp_f32 v135, v135
  v_exp_f32 v136, v136
  v_smfmac_f32_16x16x64_bf16 v[80:83], a[48:51], v[124:131], v88
  v_exp_f32 v137, v137
  v_exp_f32 v138, v138
  v_exp_f32 v139, v139
  s_waitcnt lgkmcnt(0)
  v_mfma_f32_32x32x16_bf16 v[92:107], a[16:19], a[0:3], v[16:31]
  v_exp_f32 v140, v140
  v_exp_f32 v141, v141
  v_exp_f32 v142, v142
  v_smfmac_f32_32x32x32_bf16 v[48:63], a[44:47], v[132:139], v88
  ds_read_b128 a[32:35], v2 offset:51200
  v_exp_f32 v143, v143
  v_exp_f32 v144, v144
  v_mfma_f32_32x32x16_bf16 v[92:107], a[20:23], a[4:7], v[92:107]
  ds_read_b128 a[36:39], v2 offset:52224
  v_exp_f32 v145, v145
  v_exp_f32 v146, v146
  v_exp_f32 v147, v147
  v_smfmac_f32_16x16x64_bf16 v[80:83], a[48:51], v[132:139], v88
  v_exp_f32 v148, v148
  v_exp_f32 v149, v149
  v_smfmac_f32_32x32x32_bf16 v[64:79], a[40:43], v[140:147], v88
  v_exp_f32 v150, v150
  v_exp_f32 v151, v151
  v_exp_f32 v152, v152
  v_smfmac_f32_16x16x64_bf16 v[84:87], a[48:51], v[140:147], v88
  v_exp_f32 v153, v153
  v_exp_f32 v154, v154
  v_exp_f32 v155, v155
  s_waitcnt lgkmcnt(0)
  v_mfma_f32_32x32x16_bf16 v[108:123], a[16:19], a[8:11], v[32:47]
  v_exp_f32 v92, v92
  v_exp_f32 v93, v93
  v_exp_f32 v94, v94
  v_smfmac_f32_32x32x32_bf16 v[64:79], a[44:47], v[148:155], v88
  ds_read_b128 a[24:27], v2 offset:53248
  v_exp_f32 v95, v95
  v_exp_f32 v96, v96
  v_mfma_f32_32x32x16_bf16 v[108:123], a[20:23], a[12:15], v[108:123]
  ds_read_b128 a[28:31], v2 offset:54272
  v_exp_f32 v97, v97
  v_exp_f32 v98, v98
  v_exp_f32 v99, v99
  v_smfmac_f32_16x16x64_bf16 v[84:87], a[48:51], v[148:155], v88
  v_exp_f32 v100, v100
  v_exp_f32 v101, v101
  v_smfmac_f32_32x32x32_bf16 v[48:63], a[32:35], v[92:99], v88
  v_exp_f32 v102, v102
  v_exp_f32 v103, v103
  v_exp_f32 v104, v104
  v_smfmac_f32_16x16x64_bf16 v[80:83], a[48:51], v[92:99], v88
  v_exp_f32 v105, v105
  v_exp_f32 v106, v106
  v_exp_f32 v107, v107
  s_waitcnt lgkmcnt(0)
  v_mfma_f32_32x32x16_bf16 v[124:139], a[24:27], a[0:3], v[16:31]
  v_exp_f32 v108, v108
  v_exp_f32 v109, v109
  v_exp_f32 v110, v110
  v_smfmac_f32_32x32x32_bf16 v[48:63], a[36:39], v[100:107], v88
  ds_read_b128 a[40:43], v2 offset:55296
  v_exp_f32 v111, v111
  v_exp_f32 v112, v112
  v_mfma_f32_32x32x16_bf16 v[124:139], a[28:31], a[4:7], v[124:139]
  ds_read_b128 a[44:47], v2 offset:56320
  v_exp_f32 v113, v113
  v_exp_f32 v114, v114
  v_exp_f32 v115, v115
  v_smfmac_f32_16x16x64_bf16 v[80:83], a[48:51], v[100:107], v88
  v_exp_f32 v116, v116
  v_exp_f32 v117, v117
  v_smfmac_f32_32x32x32_bf16 v[64:79], a[32:35], v[108:115], v88
  v_exp_f32 v118, v118
  v_exp_f32 v119, v119
  v_exp_f32 v120, v120
  v_smfmac_f32_16x16x64_bf16 v[84:87], a[48:51], v[108:115], v88
  v_exp_f32 v121, v121
  v_exp_f32 v122, v122
  v_exp_f32 v123, v123
  s_waitcnt lgkmcnt(0)
  v_mfma_f32_32x32x16_bf16 v[140:155], a[24:27], a[8:11], v[32:47]
  v_exp_f32 v124, v124
  v_exp_f32 v125, v125
  v_exp_f32 v126, v126
  v_smfmac_f32_32x32x32_bf16 v[64:79], a[36:39], v[116:123], v88
  ds_read_b128 a[16:19], v2 offset:57344
  v_exp_f32 v127, v127
  v_exp_f32 v128, v128
  v_mfma_f32_32x32x16_bf16 v[140:155], a[28:31], a[12:15], v[140:155]
  ds_read_b128 a[20:23], v2 offset:58368
  v_exp_f32 v129, v129
  v_exp_f32 v130, v130
  v_exp_f32 v131, v131
  v_smfmac_f32_16x16x64_bf16 v[84:87], a[48:51], v[116:123], v88
  v_exp_f32 v132, v132
  v_exp_f32 v133, v133
  v_smfmac_f32_32x32x32_bf16 v[48:63], a[40:43], v[124:131], v88
  v_exp_f32 v134, v134
  v_exp_f32 v135, v135
  v_exp_f32 v136, v136
  v_smfmac_f32_16x16x64_bf16 v[80:83], a[48:51], v[124:131], v88
  v_exp_f32 v137, v137
  v_exp_f32 v138, v138
  v_exp_f32 v139, v139
  s_waitcnt lgkmcnt(0)
  v_mfma_f32_32x32x16_bf16 v[92:107], a[16:19], a[0:3], v[16:31]
  v_exp_f32 v140, v140
  v_exp_f32 v141, v141
  v_exp_f32 v142, v142
  v_smfmac_f32_32x32x32_bf16 v[48:63], a[44:47], v[132:139], v88
  ds_read_b128 a[32:35], v2 offset:59392
  v_exp_f32 v143, v143
  v_exp_f32 v144, v144
  v_mfma_f32_32x32x16_bf16 v[92:107], a[20:23], a[4:7], v[92:107]
  ds_read_b128 a[36:39], v2 offset:60416
  v_exp_f32 v145, v145
  v_exp_f32 v146, v146
  v_exp_f32 v147, v147
  v_smfmac_f32_16x16x64_bf16 v[80:83], a[48:51], v[132:139], v88
  v_exp_f32 v148, v148
  v_exp_f32 v149, v149
  v_smfmac_f32_32x32x32_bf16 v[64:79], a[40:43], v[140:147], v88
  v_exp_f32 v150, v150
  v_exp_f32 v151, v151
  v_exp_f32 v152, v152
  v_smfmac_f32_16x16x64_bf16 v[84:87], a[48:51], v[140:147], v88
  v_exp_f32 v153, v153
  v_exp_f32 v154, v154
  v_exp_f32 v155, v155
  s_waitcnt lgkmcnt(0)
  v_mfma_f32_32x32x16_bf16 v[108:123], a[16:19], a[8:11], v[32:47]
  v_exp_f32 v92, v92
  v_exp_f32 v93, v93
  v_exp_f32 v94, v94
  v_smfmac_f32_32x32x32_bf16 v[64:79], a[44:47], v[148:155], v88
  ds_read_b128 a[24:27], v2 offset:61440
  v_exp_f32 v95, v95
  v_exp_f32 v96, v96
  v_mfma_f32_32x32x16_bf16 v[108:123], a[20:23], a[12:15], v[108:123]
  ds_read_b128 a[28:31], v2 offset:62464
  v_exp_f32 v97, v97
  v_exp_f32 v98, v98
  v_exp_f32 v99, v99
  v_smfmac_f32_16x16x64_bf16 v[84:87], a[48:51], v[148:155], v88
  v_exp_f32 v100, v100
  v_exp_f32 v101, v101
  v_smfmac_f32_32x32x32_bf16 v[48:63], a[32:35], v[92:99], v88
  v_exp_f32 v102, v102
  v_exp_f32 v103, v103
  v_exp_f32 v104, v104
  v_smfmac_f32_16x16x64_bf16 v[80:83], a[48:51], v[92:99], v88
  v_exp_f32 v105, v105
  v_exp_f32 v106, v106
  v_exp_f32 v107, v107
  s_waitcnt lgkmcnt(0)
  v_mfma_f32_32x32x16_bf16 v[124:139], a[24:27], a[0:3], v[16:31]
  v_exp_f32 v108, v108
  v_exp_f32 v109, v109
  v_exp_f32 v110, v110
  v_smfmac_f32_32x32x32_bf16 v[48:63], a[36:39], v[100:107], v88
  ds_read_b128 a[40:43], v2 offset:63488
  v_exp_f32 v111, v111
  v_exp_f32 v112, v112
  v_mfma_f32_32x32x16_bf16 v[124:139], a[28:31], a[4:7], v[124:139]
  ds_read_b128 a[44:47], v2 offset:64512
  v_exp_f32 v113, v113
  v_exp_f32 v114, v114
  v_exp_f32 v115, v115
  v_smfmac_f32_16x16x64_bf16 v[80:83], a[48:51], v[100:107], v88
  v_exp_f32 v116, v116
  v_exp_f32 v117, v117
  v_smfmac_f32_32x32x32_bf16 v[64:79], a[32:35], v[108:115], v88
  v_exp_f32 v118, v118
  v_exp_f32 v119, v119
  v_exp_f32 v120, v120
  v_smfmac_f32_16x16x64_bf16 v[84:87], a[48:51], v[108:115], v88
  v_exp_f32 v121, v121
  v_exp_f32 v122, v122
  v_exp_f32 v123, v123
  s_waitcnt vmcnt(5) lgkmcnt(0)
  v_mfma_f32_32x32x16_bf16 v[140:155], a[24:27], a[8:11], v[32:47]
  s_barrier
  v_exp_f32 v124, v124
  v_exp_f32 v125, v125
  v_exp_f32 v126, v126
  v_smfmac_f32_32x32x32_bf16 v[64:79], a[36:39], v[116:123], v88
  ds_read_b128 a[16:19], v3 offset:0
  v_exp_f32 v127, v127
  v_exp_f32 v128, v128
  v_mfma_f32_32x32x16_bf16 v[140:155], a[28:31], a[12:15], v[140:155]
  ds_read_b128 a[20:23], v3 offset:1024
  v_exp_f32 v129, v129
  v_exp_f32 v130, v130
  v_exp_f32 v131, v131
  v_smfmac_f32_16x16x64_bf16 v[84:87], a[48:51], v[116:123], v88
  v_exp_f32 v132, v132
  v_exp_f32 v133, v133
  v_smfmac_f32_32x32x32_bf16 v[48:63], a[40:43], v[124:131], v88
  v_exp_f32 v134, v134
  v_exp_f32 v135, v135
  v_exp_f32 v136, v136
  v_smfmac_f32_16x16x64_bf16 v[80:83], a[48:51], v[124:131], v88
  v_exp_f32 v137, v137
  v_exp_f32 v138, v138
  v_exp_f32 v139, v139
  s_waitcnt lgkmcnt(0)
  v_mfma_f32_32x32x16_bf16 v[92:107], a[16:19], a[0:3], v[16:31]
  v_exp_f32 v140, v140
  v_exp_f32 v141, v141
  v_exp_f32 v142, v142
  v_smfmac_f32_32x32x32_bf16 v[48:63], a[44:47], v[132:139], v88
  ds_read_b128 a[32:35], v3 offset:2048
  v_exp_f32 v143, v143
  v_exp_f32 v144, v144
  v_mfma_f32_32x32x16_bf16 v[92:107], a[20:23], a[4:7], v[92:107]
  ds_read_b128 a[36:39], v3 offset:3072
  v_exp_f32 v145, v145
  v_exp_f32 v146, v146
  v_exp_f32 v147, v147
  v_smfmac_f32_16x16x64_bf16 v[80:83], a[48:51], v[132:139], v88
  v_exp_f32 v148, v148
  v_exp_f32 v149, v149
  v_smfmac_f32_32x32x32_bf16 v[64:79], a[40:43], v[140:147], v88
  v_exp_f32 v150, v150
  v_exp_f32 v151, v151
  v_exp_f32 v152, v152
  v_smfmac_f32_16x16x64_bf16 v[84:87], a[48:51], v[140:147], v88
  v_exp_f32 v153, v153
  v_exp_f32 v154, v154
  v_exp_f32 v155, v155
  s_waitcnt lgkmcnt(0)
  v_mfma_f32_32x32x16_bf16 v[108:123], a[16:19], a[8:11], v[32:47]
  v_exp_f32 v92, v92
  v_exp_f32 v93, v93
  v_exp_f32 v94, v94
  v_smfmac_f32_32x32x32_bf16 v[64:79], a[44:47], v[148:155], v88
  ds_read_b128 a[24:27], v3 offset:4096
  v_exp_f32 v95, v95
  v_exp_f32 v96, v96
  v_mfma_f32_32x32x16_bf16 v[108:123], a[20:23], a[12:15], v[108:123]
  ds_read_b128 a[28:31], v3 offset:5120
  v_exp_f32 v97, v97
  v_exp_f32 v98, v98
  v_exp_f32 v99, v99
  v_smfmac_f32_16x16x64_bf16 v[84:87], a[48:51], v[148:155], v88
  v_exp_f32 v100, v100
  v_exp_f32 v101, v101
  v_smfmac_f32_32x32x32_bf16 v[48:63], a[32:35], v[92:99], v88
  v_exp_f32 v102, v102
  v_exp_f32 v103, v103
  v_exp_f32 v104, v104
  v_smfmac_f32_16x16x64_bf16 v[80:83], a[48:51], v[92:99], v88
  v_exp_f32 v105, v105
  v_exp_f32 v106, v106
  v_exp_f32 v107, v107
  s_waitcnt lgkmcnt(0)
  v_mfma_f32_32x32x16_bf16 v[124:139], a[24:27], a[0:3], v[16:31]
  v_exp_f32 v108, v108
  v_exp_f32 v109, v109
  v_exp_f32 v110, v110
  v_smfmac_f32_32x32x32_bf16 v[48:63], a[36:39], v[100:107], v88
  ds_read_b128 a[40:43], v3 offset:6144
  v_exp_f32 v111, v111
  v_exp_f32 v112, v112
  v_mfma_f32_32x32x16_bf16 v[124:139], a[28:31], a[4:7], v[124:139]
  ds_read_b128 a[44:47], v3 offset:7168
  v_exp_f32 v113, v113
  v_exp_f32 v114, v114
  v_exp_f32 v115, v115
  v_smfmac_f32_16x16x64_bf16 v[80:83], a[48:51], v[100:107], v88
  v_exp_f32 v116, v116
  v_exp_f32 v117, v117
  v_smfmac_f32_32x32x32_bf16 v[64:79], a[32:35], v[108:115], v88
  v_exp_f32 v118, v118
  v_exp_f32 v119, v119
  v_exp_f32 v120, v120
  v_smfmac_f32_16x16x64_bf16 v[84:87], a[48:51], v[108:115], v88
  v_exp_f32 v121, v121
  v_exp_f32 v122, v122
  v_exp_f32 v123, v123
  s_waitcnt lgkmcnt(0)
  v_mfma_f32_32x32x16_bf16 v[140:155], a[24:27], a[8:11], v[32:47]
  v_exp_f32 v124, v124
  v_exp_f32 v125, v125
  v_exp_f32 v126, v126
  v_smfmac_f32_32x32x32_bf16 v[64:79], a[36:39], v[116:123], v88
  ds_read_b128 a[16:19], v3 offset:8192
  v_exp_f32 v127, v127
  v_exp_f32 v128, v128
  v_mfma_f32_32x32x16_bf16 v[140:155], a[28:31], a[12:15], v[140:155]
  ds_read_b128 a[20:23], v3 offset:9216
  v_exp_f32 v129, v129
  v_exp_f32 v130, v130
  v_exp_f32 v131, v131
  v_smfmac_f32_16x16x64_bf16 v[84:87], a[48:51], v[116:123], v88
  v_exp_f32 v132, v132
  v_exp_f32 v133, v133
  v_smfmac_f32_32x32x32_bf16 v[48:63], a[40:43], v[124:131], v88
  v_exp_f32 v134, v134
  v_exp_f32 v135, v135
  v_exp_f32 v136, v136
  v_smfmac_f32_16x16x64_bf16 v[80:83], a[48:51], v[124:131], v88
  v_exp_f32 v137, v137
  v_exp_f32 v138, v138
  v_exp_f32 v139, v139
  s_waitcnt lgkmcnt(0)
  v_mfma_f32_32x32x16_bf16 v[92:107], a[16:19], a[0:3], v[16:31]
  v_exp_f32 v140, v140
  v_exp_f32 v141, v141
  v_exp_f32 v142, v142
  v_smfmac_f32_32x32x32_bf16 v[48:63], a[44:47], v[132:139], v88
  ds_read_b128 a[32:35], v3 offset:10240
  v_exp_f32 v143, v143
  v_exp_f32 v144, v144
  v_mfma_f32_32x32x16_bf16 v[92:107], a[20:23], a[4:7], v[92:107]
  ds_read_b128 a[36:39], v3 offset:11264
  v_exp_f32 v145, v145
  v_exp_f32 v146, v146
  v_exp_f32 v147, v147
  v_smfmac_f32_16x16x64_bf16 v[80:83], a[48:51], v[132:139], v88
  v_exp_f32 v148, v148
  v_exp_f32 v149, v149
  v_smfmac_f32_32x32x32_bf16 v[64:79], a[40:43], v[140:147], v88
  v_exp_f32 v150, v150
  v_exp_f32 v151, v151
  v_exp_f32 v152, v152
  v_smfmac_f32_16x16x64_bf16 v[84:87], a[48:51], v[140:147], v88
  v_exp_f32 v153, v153
  v_exp_f32 v154, v154
  v_exp_f32 v155, v155
  s_waitcnt lgkmcnt(0)
  v_mfma_f32_32x32x16_bf16 v[108:123], a[16:19], a[8:11], v[32:47]
  v_exp_f32 v92, v92
  v_exp_f32 v93, v93
  v_exp_f32 v94, v94
  v_smfmac_f32_32x32x32_bf16 v[64:79], a[44:47], v[148:155], v88
  ds_read_b128 a[24:27], v3 offset:12288
  v_exp_f32 v95, v95
  v_exp_f32 v96, v96
  v_mfma_f32_32x32x16_bf16 v[108:123], a[20:23], a[12:15], v[108:123]
  ds_read_b128 a[28:31], v3 offset:13312
  v_exp_f32 v97, v97
  v_exp_f32 v98, v98
  v_exp_f32 v99, v99
  v_smfmac_f32_16x16x64_bf16 v[84:87], a[48:51], v[148:155], v88
  v_exp_f32 v100, v100
  v_exp_f32 v101, v101
  v_smfmac_f32_32x32x32_bf16 v[48:63], a[32:35], v[92:99], v88
  v_exp_f32 v102, v102
  v_exp_f32 v103, v103
  v_exp_f32 v104, v104
  v_smfmac_f32_16x16x64_bf16 v[80:83], a[48:51], v[92:99], v88
  v_exp_f32 v105, v105
  v_exp_f32 v106, v106
  v_exp_f32 v107, v107
  s_waitcnt lgkmcnt(0)
  v_mfma_f32_32x32x16_bf16 v[124:139], a[24:27], a[0:3], v[16:31]
  v_exp_f32 v108, v108
  v_exp_f32 v109, v109
  v_exp_f32 v110, v110
  v_smfmac_f32_32x32x32_bf16 v[48:63], a[36:39], v[100:107], v88
  ds_read_b128 a[40:43], v3 offset:14336
  v_exp_f32 v111, v111
  v_exp_f32 v112, v112
  v_mfma_f32_32x32x16_bf16 v[124:139], a[28:31], a[4:7], v[124:139]
  ds_read_b128 a[44:47], v3 offset:15360
  v_exp_f32 v113, v113
  v_exp_f32 v114, v114
  v_exp_f32 v115, v115
  v_smfmac_f32_16x16x64_bf16 v[80:83], a[48:51], v[100:107], v88
  v_exp_f32 v116, v116
  v_exp_f32 v117, v117
  v_smfmac_f32_32x32x32_bf16 v[64:79], a[32:35], v[108:115], v88
  v_exp_f32 v118, v118
  v_exp_f32 v119, v119
  v_exp_f32 v120, v120
  v_smfmac_f32_16x16x64_bf16 v[84:87], a[48:51], v[108:115], v88
  v_exp_f32 v121, v121
  v_exp_f32 v122, v122
  v_exp_f32 v123, v123
  s_waitcnt vmcnt(1) lgkmcnt(0)
  v_mfma_f32_32x32x16_bf16 v[140:155], a[24:27], a[8:11], v[32:47]
  s_barrier
  v_exp_f32 v124, v124
  v_exp_f32 v125, v125
  v_exp_f32 v126, v126
  v_smfmac_f32_32x32x32_bf16 v[64:79], a[36:39], v[116:123], v88
  ds_read_b128 a[16:19], v2 offset:0
  v_exp_f32 v127, v127
  v_exp_f32 v128, v128
  v_mfma_f32_32x32x16_bf16 v[140:155], a[28:31], a[12:15], v[140:155]
  ds_read_b128 a[20:23], v2 offset:1024
  v_exp_f32 v129, v129
  v_exp_f32 v130, v130
  v_exp_f32 v131, v131
  v_smfmac_f32_16x16x64_bf16 v[84:87], a[48:51], v[116:123], v88
  v_exp_f32 v132, v132
  v_exp_f32 v133, v133
  v_smfmac_f32_32x32x32_bf16 v[48:63], a[40:43], v[124:131], v88
  v_exp_f32 v134, v134
  v_exp_f32 v135, v135
  v_exp_f32 v136, v136
  v_smfmac_f32_16x16x64_bf16 v[80:83], a[48:51], v[124:131], v88
  v_exp_f32 v137, v137
  v_exp_f32 v138, v138
  v_exp_f32 v139, v139
  s_waitcnt lgkmcnt(0)
  v_mfma_f32_32x32x16_bf16 v[92:107], a[16:19], a[0:3], v[16:31]
  v_exp_f32 v140, v140
  v_exp_f32 v141, v141
  v_exp_f32 v142, v142
  v_smfmac_f32_32x32x32_bf16 v[48:63], a[44:47], v[132:139], v88
  ds_read_b128 a[32:35], v2 offset:2048
  v_exp_f32 v143, v143
  v_exp_f32 v144, v144
  v_mfma_f32_32x32x16_bf16 v[92:107], a[20:23], a[4:7], v[92:107]
  ds_read_b128 a[36:39], v2 offset:3072
  v_exp_f32 v145, v145
  v_exp_f32 v146, v146
  v_exp_f32 v147, v147
  v_smfmac_f32_16x16x64_bf16 v[80:83], a[48:51], v[132:139], v88
  v_exp_f32 v148, v148
  v_exp_f32 v149, v149
  v_smfmac_f32_32x32x32_bf16 v[64:79], a[40:43], v[140:147], v88
  v_exp_f32 v150, v150
  v_exp_f32 v151, v151
  v_exp_f32 v152, v152
  v_smfmac_f32_16x16x64_bf16 v[84:87], a[48:51], v[140:147], v88
  v_exp_f32 v153, v153
  v_exp_f32 v154, v154
  v_exp_f32 v155, v155
  s_waitcnt lgkmcnt(0)
  v_mfma_f32_32x32x16_bf16 v[108:123], a[16:19], a[8:11], v[32:47]
  v_exp_f32 v92, v92
  v_exp_f32 v93, v93
  v_exp_f32 v94, v94
  v_smfmac_f32_32x32x32_bf16 v[64:79], a[44:47], v[148:155], v88
  ds_read_b128 a[24:27], v2 offset:4096
  v_exp_f32 v95, v95
  v_exp_f32 v96, v96
  v_mfma_f32_32x32x16_bf16 v[108:123], a[20:23], a[12:15], v[108:123]
  ds_read_b128 a[28:31], v2 offset:5120
  v_exp_f32 v97, v97
  v_exp_f32 v98, v98
  v_exp_f32 v99, v99
  v_smfmac_f32_16x16x64_bf16 v[84:87], a[48:51], v[148:155], v88
  v_exp_f32 v100, v100
  v_exp_f32 v101, v101
  v_smfmac_f32_32x32x32_bf16 v[48:63], a[32:35], v[92:99], v88
  v_exp_f32 v102, v102
  v_exp_f32 v103, v103
  v_exp_f32 v104, v104
  v_smfmac_f32_16x16x64_bf16 v[80:83], a[48:51], v[92:99], v88
  v_exp_f32 v105, v105
  v_exp_f32 v106, v106
  v_exp_f32 v107, v107
  s_waitcnt lgkmcnt(0)
  v_mfma_f32_32x32x16_bf16 v[124:139], a[24:27], a[0:3], v[16:31]
  v_exp_f32 v108, v108
  v_exp_f32 v109, v109
  v_exp_f32 v110, v110
  v_smfmac_f32_32x32x32_bf16 v[48:63], a[36:39], v[100:107], v88
  ds_read_b128 a[40:43], v2 offset:6144
  v_exp_f32 v111, v111
  v_exp_f32 v112, v112
  v_mfma_f32_32x32x16_bf16 v[124:139], a[28:31], a[4:7], v[124:139]
  ds_read_b128 a[44:47], v2 offset:7168
  v_exp_f32 v113, v113
  v_exp_f32 v114, v114
  v_exp_f32 v115, v115
  v_smfmac_f32_16x16x64_bf16 v[80:83], a[48:51], v[100:107], v88
  v_exp_f32 v116, v116
  v_exp_f32 v117, v117
  v_smfmac_f32_32x32x32_bf16 v[64:79], a[32:35], v[108:115], v88
  v_exp_f32 v118, v118
  v_exp_f32 v119, v119
  v_exp_f32 v120, v120
  v_smfmac_f32_16x16x64_bf16 v[84:87], a[48:51], v[108:115], v88
  v_exp_f32 v121, v121
  v_exp_f32 v122, v122
  v_exp_f32 v123, v123
  s_waitcnt lgkmcnt(0)
  v_mfma_f32_32x32x16_bf16 v[140:155], a[24:27], a[8:11], v[32:47]
  v_exp_f32 v124, v124
  v_exp_f32 v125, v125
  v_exp_f32 v126, v126
  v_smfmac_f32_32x32x32_bf16 v[64:79], a[36:39], v[116:123], v88
  ds_read_b128 a[16:19], v2 offset:8192
  v_exp_f32 v127, v127
  v_exp_f32 v128, v128
  v_mfma_f32_32x32x16_bf16 v[140:155], a[28:31], a[12:15], v[140:155]
  ds_read_b128 a[20:23], v2 offset:9216
  v_exp_f32 v129, v129
  v_exp_f32 v130, v130
  v_exp_f32 v131, v131
  v_smfmac_f32_16x16x64_bf16 v[84:87], a[48:51], v[116:123], v88
  v_exp_f32 v132, v132
  v_exp_f32 v133, v133
  v_smfmac_f32_32x32x32_bf16 v[48:63], a[40:43], v[124:131], v88
  v_exp_f32 v134, v134
  v_exp_f32 v135, v135
  v_exp_f32 v136, v136
  v_smfmac_f32_16x16x64_bf16 v[80:83], a[48:51], v[124:131], v88
  v_exp_f32 v137, v137
  v_exp_f32 v138, v138
  v_exp_f32 v139, v139
  s_waitcnt lgkmcnt(0)
  v_mfma_f32_32x32x16_bf16 v[92:107], a[16:19], a[0:3], v[16:31]
  v_exp_f32 v140, v140
  v_exp_f32 v141, v141
  v_exp_f32 v142, v142
  v_smfmac_f32_32x32x32_bf16 v[48:63], a[44:47], v[132:139], v88
  ds_read_b128 a[32:35], v2 offset:10240
  v_exp_f32 v143, v143
  v_exp_f32 v144, v144
  v_mfma_f32_32x32x16_bf16 v[92:107], a[20:23], a[4:7], v[92:107]
  ds_read_b128 a[36:39], v2 offset:11264
  v_exp_f32 v145, v145
  v_exp_f32 v146, v146
  v_exp_f32 v147, v147
  v_smfmac_f32_16x16x64_bf16 v[80:83], a[48:51], v[132:139], v88
  v_exp_f32 v148, v148
  v_exp_f32 v149, v149
  v_smfmac_f32_32x32x32_bf16 v[64:79], a[40:43], v[140:147], v88
  v_exp_f32 v150, v150
  v_exp_f32 v151, v151
  v_exp_f32 v152, v152
  v_smfmac_f32_16x16x64_bf16 v[84:87], a[48:51], v[140:147], v88
  v_exp_f32 v153, v153
  v_exp_f32 v154, v154
  v_exp_f32 v155, v155
  s_waitcnt lgkmcnt(0)
  v_mfma_f32_32x32x16_bf16 v[108:123], a[16:19], a[8:11], v[32:47]
  v_exp_f32 v92, v92
  v_exp_f32 v93, v93
  v_exp_f32 v94, v94
  v_smfmac_f32_32x32x32_bf16 v[64:79], a[44:47], v[148:155], v88
  ds_read_b128 a[24:27], v2 offset:12288
  v_exp_f32 v95, v95
  v_exp_f32 v96, v96
  v_mfma_f32_32x32x16_bf16 v[108:123], a[20:23], a[12:15], v[108:123]
  ds_read_b128 a[28:31], v2 offset:13312
  v_exp_f32 v97, v97
  v_exp_f32 v98, v98
  v_exp_f32 v99, v99
  v_smfmac_f32_16x16x64_bf16 v[84:87], a[48:51], v[148:155], v88
  v_exp_f32 v100, v100
  v_exp_f32 v101, v101
  v_smfmac_f32_32x32x32_bf16 v[48:63], a[32:35], v[92:99], v88
  v_exp_f32 v102, v102
  v_exp_f32 v103, v103
  v_exp_f32 v104, v104
  v_smfmac_f32_16x16x64_bf16 v[80:83], a[48:51], v[92:99], v88
  v_exp_f32 v105, v105
  v_exp_f32 v106, v106
  v_exp_f32 v107, v107
  s_waitcnt lgkmcnt(0)
  v_mfma_f32_32x32x16_bf16 v[124:139], a[24:27], a[0:3], v[16:31]
  v_exp_f32 v108, v108
  v_exp_f32 v109, v109
  v_exp_f32 v110, v110
  v_smfmac_f32_32x32x32_bf16 v[48:63], a[36:39], v[100:107], v88
  ds_read_b128 a[40:43], v2 offset:14336
  v_exp_f32 v111, v111
  v_exp_f32 v112, v112
  v_mfma_f32_32x32x16_bf16 v[124:139], a[28:31], a[4:7], v[124:139]
  ds_read_b128 a[44:47], v2 offset:15360
  v_exp_f32 v113, v113
  v_exp_f32 v114, v114
  v_exp_f32 v115, v115
  v_smfmac_f32_16x16x64_bf16 v[80:83], a[48:51], v[100:107], v88
  v_exp_f32 v116, v116
  v_exp_f32 v117, v117
  v_smfmac_f32_32x32x32_bf16 v[64:79], a[32:35], v[108:115], v88
  v_exp_f32 v118, v118
  v_exp_f32 v119, v119
  v_exp_f32 v120, v120
  v_smfmac_f32_16x16x64_bf16 v[84:87], a[48:51], v[108:115], v88
  v_exp_f32 v121, v121
  v_exp_f32 v122, v122
  v_exp_f32 v123, v123
  s_waitcnt lgkmcnt(0)
  v_mfma_f32_32x32x16_bf16 v[140:155], a[24:27], a[8:11], v[32:47]
  v_exp_f32 v124, v124
  v_exp_f32 v125, v125
  v_exp_f32 v126, v126
  v_smfmac_f32_32x32x32_bf16 v[64:79], a[36:39], v[116:123], v88
  v_exp_f32 v127, v127
  v_exp_f32 v128, v128
  v_mfma_f32_32x32x16_bf16 v[140:155], a[28:31], a[12:15], v[140:155]
  v_exp_f32 v129, v129
  v_exp_f32 v130, v130
  v_exp_f32 v131, v131
  v_smfmac_f32_16x16x64_bf16 v[84:87], a[48:51], v[116:123], v88
  v_exp_f32 v132, v132
  v_exp_f32 v133, v133
  v_smfmac_f32_32x32x32_bf16 v[48:63], a[40:43], v[124:131], v88
  v_exp_f32 v134, v134
  v_exp_f32 v135, v135
  v_exp_f32 v136, v136
  v_smfmac_f32_16x16x64_bf16 v[80:83], a[48:51], v[124:131], v88
  v_exp_f32 v137, v137
  v_exp_f32 v138, v138
  v_exp_f32 v139, v139
  v_exp_f32 v140, v140
  v_exp_f32 v141, v141
  v_exp_f32 v142, v142
  v_smfmac_f32_32x32x32_bf16 v[48:63], a[44:47], v[132:139], v88
  v_exp_f32 v143, v143
  v_exp_f32 v144, v144
  v_exp_f32 v145, v145
  v_exp_f32 v146, v146
  v_exp_f32 v147, v147
  v_smfmac_f32_16x16x64_bf16 v[80:83], a[48:51], v[132:139], v88
  v_exp_f32 v148, v148
  v_exp_f32 v149, v149
  v_smfmac_f32_32x32x32_bf16 v[64:79], a[40:43], v[140:147], v88
  v_exp_f32 v150, v150
  v_exp_f32 v151, v151
  v_exp_f32 v152, v152
  v_smfmac_f32_16x16x64_bf16 v[84:87], a[48:51], v[140:147], v88
  v_exp_f32 v153, v153
  v_exp_f32 v154, v154
  v_exp_f32 v155, v155
  s_nop 1
  v_smfmac_f32_32x32x32_bf16 v[64:79], a[44:47], v[148:155], v88
  v_smfmac_f32_16x16x64_bf16 v[84:87], a[48:51], v[148:155], v88
  v_bfe_u32 v6, v0, 4, 1
  v_lshlrev_b32 v6, 15, v6
  v_and_b32 v7, 15, v0
  v_lshl_add_u32 v6, v7, 4, v6
  v_lshrrev_b32 v7, 5, v0
  v_lshl_add_u32 v6, v7, 8, v6
  s_lshl_b32 s34, s22, 16
  s_lshl_b32 s35, s21, 10
  s_add_u32 s34, s34, s35
  s_add_u32 s35, s34, 65536
  v_rcp_f32 v4, v80
  s_nop 2
  v_rcp_f32 v8, v84
  v_pk_mul_f32 v[108:109], v[48:49], v[4:5] op_sel_hi:[1,0]
  v_pk_mul_f32 v[110:111], v[50:51], v[4:5] op_sel_hi:[1,0]
  v_pk_mul_f32 v[112:113], v[52:53], v[4:5] op_sel_hi:[1,0]
  v_pk_mul_f32 v[114:115], v[54:55], v[4:5] op_sel_hi:[1,0]
  v_pk_mul_f32 v[116:117], v[56:57], v[4:5] op_sel_hi:[1,0]
  v_pk_mul_f32 v[118:119], v[58:59], v[4:5] op_sel_hi:[1,0]
  v_pk_mul_f32 v[120:121], v[60:61], v[4:5] op_sel_hi:[1,0]
  v_pk_mul_f32 v[122:123], v[62:63], v[4:5] op_sel_hi:[1,0]
  v_cvt_pk_bf16_f32 v92, v108, v109
  v_cvt_pk_bf16_f32 v93, v110, v111
  v_cvt_pk_bf16_f32 v94, v112, v113
  v_cvt_pk_bf16_f32 v95, v114, v115
  v_cvt_pk_bf16_f32 v96, v116, v117
  v_cvt_pk_bf16_f32 v97, v118, v119
  v_cvt_pk_bf16_f32 v98, v120, v121
  v_cvt_pk_bf16_f32 v99, v122, v123
  buffer_store_dwordx4 v[92:95], v6, s[28:31], s34 offen offset:0 sc1
  buffer_store_dwordx4 v[96:99], v6, s[28:31], s34 offen offset:512 sc1
  v_pk_mul_f32 v[108:109], v[64:65], v[8:9] op_sel_hi:[1,0]
  v_pk_mul_f32 v[110:111], v[66:67], v[8:9] op_sel_hi:[1,0]
  v_pk_mul_f32 v[112:113], v[68:69], v[8:9] op_sel_hi:[1,0]
  v_pk_mul_f32 v[114:115], v[70:71], v[8:9] op_sel_hi:[1,0]
  v_pk_mul_f32 v[116:117], v[72:73], v[8:9] op_sel_hi:[1,0]
  v_pk_mul_f32 v[118:119], v[74:75], v[8:9] op_sel_hi:[1,0]
  v_pk_mul_f32 v[120:121], v[76:77], v[8:9] op_sel_hi:[1,0]
  v_pk_mul_f32 v[122:123], v[78:79], v[8:9] op_sel_hi:[1,0]
  v_cvt_pk_bf16_f32 v100, v108, v109
  v_cvt_pk_bf16_f32 v101, v110, v111
  v_cvt_pk_bf16_f32 v102, v112, v113
  v_cvt_pk_bf16_f32 v103, v114, v115
  v_cvt_pk_bf16_f32 v104, v116, v117
  v_cvt_pk_bf16_f32 v105, v118, v119
  v_cvt_pk_bf16_f32 v106, v120, v121
  v_cvt_pk_bf16_f32 v107, v122, v123
  buffer_store_dwordx4 v[100:103], v6, s[28:31], s35 offen offset:0 sc1
  buffer_store_dwordx4 v[104:107], v6, s[28:31], s35 offen offset:512 sc1
  v_pk_mul_f32 v[10:11], v[48:49], 0 op_sel_hi:[1,0]
  v_pk_fma_f32 v[10:11], v[50:51], 0, v[10:11] op_sel_hi:[1,0,1]
  v_pk_fma_f32 v[10:11], v[52:53], 0, v[10:11] op_sel_hi:[1,0,1]
  v_pk_fma_f32 v[10:11], v[54:55], 0, v[10:11] op_sel_hi:[1,0,1]
  v_pk_fma_f32 v[10:11], v[56:57], 0, v[10:11] op_sel_hi:[1,0,1]
  v_pk_fma_f32 v[10:11], v[58:59], 0, v[10:11] op_sel_hi:[1,0,1]
  v_pk_fma_f32 v[10:11], v[60:61], 0, v[10:11] op_sel_hi:[1,0,1]
  v_pk_fma_f32 v[10:11], v[62:63], 0, v[10:11] op_sel_hi:[1,0,1]
  v_pk_fma_f32 v[10:11], v[64:65], 0, v[10:11] op_sel_hi:[1,0,1]
  v_pk_fma_f32 v[10:11], v[66:67], 0, v[10:11] op_sel_hi:[1,0,1]
  v_pk_fma_f32 v[10:11], v[68:69], 0, v[10:11] op_sel_hi:[1,0,1]
  v_pk_fma_f32 v[10:11], v[70:71], 0, v[10:11] op_sel_hi:[1,0,1]
  v_pk_fma_f32 v[10:11], v[72:73], 0, v[10:11] op_sel_hi:[1,0,1]
  v_pk_fma_f32 v[10:11], v[74:75], 0, v[10:11] op_sel_hi:[1,0,1]
  v_pk_fma_f32 v[10:11], v[76:77], 0, v[10:11] op_sel_hi:[1,0,1]
  v_pk_fma_f32 v[10:11], v[78:79], 0, v[10:11] op_sel_hi:[1,0,1]
  v_add_f32 v12, v80, v84
  v_add_f32 v10, v10, v11
  v_add_f32 v10, v10, v12
  v_mov_b32 v11, 0x71800000
  v_cmp_nlt_f32 vcc, v10, v11
  s_lshl_b32 s33, s20, 2
  s_add_u32 s33, s33, 16384
  s_cmp_lg_u64 vcc, 0
  s_cselect_b32 s32, 1, 0
  v_mov_b32 v10, s32
  v_mov_b32 v11, s33
  v_mov_b32 v12, 16384
  ds_write_b32 v11, v10
  s_waitcnt lgkmcnt(0)
  s_barrier
  ds_read_b128 v[12:15], v12
  s_waitcnt lgkmcnt(0)
  v_or_b32 v12, v12, v13
  v_or3_b32 v12, v12, v14, v15
  s_nop 0
  v_readfirstlane_b32 s32, v12
  s_nop 3
  s_andn2_b32 s32, s32, s27
  s_cmp_eq_u32 s32, 0
  s_cbranch_scc1 L_fin_25
  s_waitcnt vmcnt(0)
  s_barrier
  v_mov_b32 v4, 0xff800000
  v_mov_b32 v5, 0xff800000
  s_mov_b32 s16, 0
L_maxl_28:
  buffer_load_dwordx4 a[16:19], v2, s[8:11], s16 offen
  buffer_load_dwordx4 a[20:23], v2, s[8:11], s16 offen offset:1024
  s_waitcnt vmcnt(0)
  v_mfma_f32_32x32x16_bf16 v[108:123], a[16:19], a[0:3], 0
  v_mfma_f32_32x32x16_bf16 v[108:123], a[20:23], a[4:7], v[108:123]
  v_mfma_f32_32x32x16_bf16 v[124:139], a[16:19], a[8:11], 0
  v_mfma_f32_32x32x16_bf16 v[124:139], a[20:23], a[12:15], v[124:139]
  s_nop 9
  s_nop 7
  v_max3_f32 v4, v108, v109, v4
  v_max3_f32 v4, v110, v111, v4
  v_max3_f32 v4, v112, v113, v4
  v_max3_f32 v4, v114, v115, v4
  v_max3_f32 v4, v116, v117, v4
  v_max3_f32 v4, v118, v119, v4
  v_max3_f32 v4, v120, v121, v4
  v_max3_f32 v4, v122, v123, v4
  v_max3_f32 v5, v124, v125, v5
  v_max3_f32 v5, v126, v127, v5
  v_max3_f32 v5, v128, v129, v5
  v_max3_f32 v5, v130, v131, v5
  v_max3_f32 v5, v132, v133, v5
  v_max3_f32 v5, v134, v135, v5
  v_max3_f32 v5, v136, v137, v5
  v_max3_f32 v5, v138, v139, v5
  s_add_u32 s16, s16, 4096
  s_cmp_lt_u32 s16, 262144
  s_cbranch_scc1 L_maxl_28
  v_mov_b32 v6, v4
  v_mov_b32 v7, v5
  s_nop 1
  v_permlane32_swap_b32 v4, v6
  v_permlane32_swap_b32 v5, v7
  s_nop 1
  v_max_f32 v4, v4, v6
  v_max_f32 v5, v5, v7
  v_sub_f32 v16, 0, v4
  v_sub_f32 v17, 0, v4
  v_sub_f32 v18, 0, v4
  v_sub_f32 v19, 0, v4
  v_sub_f32 v20, 0, v4
  v_sub_f32 v21, 0, v4
  v_sub_f32 v22, 0, v4
  v_sub_f32 v23, 0, v4
  v_sub_f32 v24, 0, v4
  v_sub_f32 v25, 0, v4
  v_sub_f32 v26, 0, v4
  v_sub_f32 v27, 0, v4
  v_sub_f32 v28, 0, v4
  v_sub_f32 v29, 0, v4
  v_sub_f32 v30, 0, v4
  v_sub_f32 v31, 0, v4
  v_sub_f32 v32, 0, v5
  v_sub_f32 v33, 0, v5
  v_sub_f32 v34, 0, v5
  v_sub_f32 v35, 0, v5
  v_sub_f32 v36, 0, v5
  v_sub_f32 v37, 0, v5
  v_sub_f32 v38, 0, v5
  v_sub_f32 v39, 0, v5
  v_sub_f32 v40, 0, v5
  v_sub_f32 v41, 0, v5
  v_sub_f32 v42, 0, v5
  v_sub_f32 v43, 0, v5
  v_sub_f32 v44, 0, v5
  v_sub_f32 v45, 0, v5
  v_sub_f32 v46, 0, v5
  v_sub_f32 v47, 0, v5
  s_mov_b32 s27, 1
  s_branch L_start_24
L_fin_25:
  s_endpgm
L_side_23:
  s_sub_u32 s34, s2, 256
  s_cmp_ge_u32 s34, 256
  s_cbranch_scc1 L_end_22
  s_load_dwordx2 s[4:5], s[0:1], 88
  s_load_dwordx4 s[36:39], s[0:1], 32
  s_load_dwordx2 s[40:41], s[0:1], 48
  s_load_dwordx2 s[44:45], s[0:1], 16
  s_load_dwordx4 s[64:67], s[0:1], 56
  s_load_dwordx2 s[68:69], s[0:1], 0
  v_lshrrev_b32 v1, 6, v0
  v_and_b32 v46, 63, v0
  v_lshlrev_b32 v44, 4, v46
  v_readfirstlane_b32 s21, v1
  v_bfe_u32 v4, v0, 4, 2
  v_lshlrev_b32 v3, 2, v46
  v_lshlrev_b32 v5, 1, v46
  v_lshrrev_b32 v6, 3, v46
  v_mul_u32_u24 v40, 12288, v6
  v_and_b32 v7, 7, v0
  v_lshl_add_u32 v40, v7, 4, v40
  v_mov_b32 v41, v40
  v_mov_b32 v2, 0
  s_lshl_b32 s22, s21, 13
  s_and_b32 s25, s34, 3
  s_lshl_b32 s29, s25, 14
  s_lshl_b32 s25, s25, 8
  s_lshl_b32 s26, s21, 6
  s_add_u32 s25, s25, s26
  s_lshl_b32 s27, s25, 1
  s_mul_i32 s56, s25, 12288
  s_lshr_b32 s25, s34, 2
  s_bfe_u32 s26, s25, 0x10003
  s_xor_b32 s25, s25, s26
  s_lshl_b32 s26, s25, 8
  s_add_u32 s29, s29, s26
  s_add_u32 s29, s29, 163840
  s_add_u32 s25, s25, 32
  s_lshl_b32 s25, s25, 7
  s_add_u32 s56, s56, s25
  s_lshl_b32 s30, s34, 7
  s_add_u32 s30, s30, 229376
  s_lshl_b32 s28, s21, 8
  s_add_u32 s31, s28, 32768
  s_add_u32 s28, s28, 36864
  s_waitcnt lgkmcnt(0)
  s_mov_b32 s8, s66
  s_mov_b32 s9, s67
  s_mov_b32 s12, s4
  s_mov_b32 s13, s5
  s_mov_b32 s10, 0xc00000
  s_mov_b32 s11, 0x20000
  s_mov_b32 s66, 0x800
  s_mov_b32 s67, 0x20000
  s_mov_b32 s14, 0x100000
  s_mov_b32 s15, 0x20000
  buffer_load_ushort v8, v5, s[64:67], s27 offen
  v_lshrrev_b32 v42, 2, v46
  v_and_b32 v45, 7, v42
  v_lshlrev_b32 v42, 8, v42
  v_lshl_add_u32 v42, v45, 5, v42
  v_and_b32 v45, 3, v46
  v_lshl_add_u32 v42, v45, 3, v42
  v_add_u32 v42, s22, v42
  v_lshrrev_b32 v43, 2, v46
  v_add_u32 v43, 16, v43
  v_and_b32 v45, 7, v43
  v_lshlrev_b32 v43, 8, v43
  v_lshl_add_u32 v43, v45, 5, v43
  v_and_b32 v45, 3, v46
  v_lshl_add_u32 v43, v45, 3, v43
  v_add_u32 v43, s22, v43
  v_xor_b32 v176, 0, v42
  v_xor_b32 v177, 0, v43
  v_xor_b32 v178, 32, v42
  v_xor_b32 v179, 32, v43
  v_xor_b32 v180, 64, v42
  v_xor_b32 v181, 64, v43
  v_xor_b32 v182, 96, v42
  v_xor_b32 v183, 96, v43
  v_xor_b32 v184, 128, v42
  v_xor_b32 v185, 128, v43
  v_xor_b32 v186, 160, v42
  v_xor_b32 v187, 160, v43
  v_xor_b32 v188, 192, v42
  v_xor_b32 v189, 192, v43
  v_xor_b32 v190, 224, v42
  v_xor_b32 v191, 224, v43
  s_waitcnt vmcnt(0)
  v_lshlrev_b32 v8, 16, v8
  v_mul_f32 v9, 0xbfb8aa3b, v8
  v_exp_f32 v9, v9
  v_add_u32 v20, s28, v5
  v_add_f32 v9, 1.0, v9
  v_rcp_f32 v9, v9
  v_lshl_add_u32 v10, v4, 4, s28
  v_mul_f32 v9, v8, v9
  v_cvt_pk_bf16_f32 v9, v9, v9
  ds_write_b16 v20, v9
  ds_read_b128 v[24:27], v10
  ds_read_b128 v[28:31], v10 offset:64
  v_bfe_u32 v11, v0, 2, 2
  v_lshl_add_u32 v11, v4, 3, v11
  v_lshlrev_b32 v11, 7, v11
  v_and_b32 v12, 3, v0
  v_lshl_add_u32 v11, v12, 3, v11
  v_add_u32 v11, s22, v11
  v_lshl_add_u32 v12, v4, 4, s31
  s_waitcnt vmcnt(4)
  s_add_u32 m0, s22, 0
  s_nop 0
  buffer_load_dwordx4 v40, s[8:11], s56 offen offset:0 nt lds
  s_add_u32 s56, s56, 97280
  s_waitcnt vmcnt(4)
  buffer_load_dwordx4 v41, s[8:11], s56 offen offset:1024 nt lds
  s_add_u32 s56, s56, 97280
  s_waitcnt vmcnt(4)
  buffer_load_dwordx4 v40, s[8:11], s56 offen offset:2048 nt lds
  s_add_u32 s56, s56, 97280
  s_waitcnt vmcnt(4)
  buffer_load_dwordx4 v41, s[8:11], s56 offen offset:3072 nt lds
  s_add_u32 s56, s56, 101376
  s_waitcnt vmcnt(4)
  s_add_u32 m0, s22, 4096
  s_nop 0
  buffer_load_dwordx4 v40, s[8:11], s56 offen offset:0 nt lds
  s_add_u32 s56, s56, 97280
  s_waitcnt vmcnt(4)
  buffer_load_dwordx4 v41, s[8:11], s56 offen offset:1024 nt lds
  s_add_u32 s56, s56, 97280
  s_waitcnt vmcnt(4)
  buffer_load_dwordx4 v40, s[8:11], s56 offen offset:2048 nt lds
  s_add_u32 s56, s56, 97280
  s_waitcnt vmcnt(4)
  buffer_load_dwordx4 v41, s[8:11], s56 offen offset:3072 nt lds
  s_waitcnt vmcnt(0)
  ds_read_b64_tr_b16 v[48:49], v11 offset:0
  ds_read_b64_tr_b16 v[50:51], v11 offset:512
  ds_read_b64_tr_b16 v[52:53], v11 offset:32
  ds_read_b64_tr_b16 v[54:55], v11 offset:544
  ds_read_b64_tr_b16 v[56:57], v11 offset:64
  ds_read_b64_tr_b16 v[58:59], v11 offset:576
  ds_read_b64_tr_b16 v[60:61], v11 offset:96
  ds_read_b64_tr_b16 v[62:63], v11 offset:608
  s_waitcnt lgkmcnt(0)
  ds_read_b64_tr_b16 v[64:65], v11 offset:4096
  ds_read_b64_tr_b16 v[66:67], v11 offset:4608
  ds_read_b64_tr_b16 v[68:69], v11 offset:4128
  ds_read_b64_tr_b16 v[70:71], v11 offset:4640
  ds_read_b64_tr_b16 v[72:73], v11 offset:4160
  ds_read_b64_tr_b16 v[74:75], v11 offset:4672
  ds_read_b64_tr_b16 v[76:77], v11 offset:4192
  ds_read_b64_tr_b16 v[78:79], v11 offset:4704
  s_waitcnt lgkmcnt(0)
  v_mfma_f32_16x16x32_bf16 v[80:83], v[48:51], v[24:27], 0
  v_mfma_f32_16x16x32_bf16 v[84:87], v[52:55], v[24:27], 0
  v_mfma_f32_16x16x32_bf16 v[88:91], v[56:59], v[24:27], 0
  v_mfma_f32_16x16x32_bf16 v[92:95], v[60:63], v[24:27], 0
  v_mfma_f32_16x16x32_bf16 v[80:83], v[64:67], v[28:31], v[80:83]
  v_mfma_f32_16x16x32_bf16 v[84:87], v[68:71], v[28:31], v[84:87]
  v_mfma_f32_16x16x32_bf16 v[88:91], v[72:75], v[28:31], v[88:91]
  v_mfma_f32_16x16x32_bf16 v[92:95], v[76:79], v[28:31], v[92:95]
  v_lshrrev_b32 v45, 4, v46
  v_mul_u32_u24 v40, 2048, v45
  v_lshlrev_b32 v45, 1, v45
  v_and_b32 v41, 15, v46
  v_xor_b32 v45, v45, v41
  v_xor_b32 v41, 8, v45
  v_lshl_add_u32 v41, v41, 4, v40
  v_lshl_add_u32 v40, v45, 4, v40
  v_and_b32 v13, 15, v0
  v_cmp_eq_u32 vcc, 0, v13
  s_and_saveexec_b64 s[60:61], vcc
  ds_write_b128 v12, v[80:83] offset:0
  ds_write_b128 v12, v[84:87] offset:64
  ds_write_b128 v12, v[88:91] offset:128
  ds_write_b128 v12, v[92:95] offset:192
  s_mov_b64 exec, s[60:61]
  s_waitcnt lgkmcnt(0)
  s_barrier
  s_cmp_lg_u32 s21, 0
  s_cbranch_scc1 L_nb0_30
  ds_read_b32 v8, v3 offset:32768
  ds_read_b32 v9, v3 offset:33024
  ds_read_b32 v10, v3 offset:33280
  ds_read_b32 v11, v3 offset:33536
  v_mov_b32 v12, 1
  s_waitcnt lgkmcnt(0)
  v_add_f32 v8, v8, v9
  v_add_f32 v10, v10, v11
  v_add_f32 v8, v8, v10
  buffer_store_dword v8, v3, s[12:15], s29 offen sc1
  s_waitcnt vmcnt(0)
  buffer_store_dword v12, v2, s[12:15], s30 offen sc1
L_nb0_30:
  s_cmp_ge_u32 s34, 224
  s_cbranch_scc1 L_wo_pack_29
  s_lshl_b32 s56, s34, 2
  s_add_u32 s56, s56, s21
  s_lshr_b32 s57, s56, 3
  s_and_b32 s58, s56, 7
  s_lshl_b32 s56, s57, 16
  s_lshl_b32 s59, s58, 8
  s_add_u32 s56, s56, s59
  s_mul_i32 s59, s58, 112
  s_add_u32 s59, s59, s57
  s_lshl_b32 s48, s59, 13
  s_add_u32 s49, s48, 4096
  s_mov_b32 s42, 0x700000
  s_mov_b32 s43, 0x20000
  s_add_u32 s16, s4, 0x4100000
  s_addc_u32 s17, s5, 0
  s_mov_b32 s18, 0x700000
  s_mov_b32 s19, 0x20000
  s_waitcnt vmcnt(4)
  s_add_u32 m0, s22, 0
  s_nop 0
  buffer_load_dwordx4 v40, s[40:43], s56 offen offset:0 nt lds
  s_add_u32 s56, s56, 7168
  s_waitcnt vmcnt(4)
  buffer_load_dwordx4 v41, s[40:43], s56 offen offset:1024 nt lds
  s_add_u32 s56, s56, 7168
  s_waitcnt vmcnt(4)
  buffer_load_dwordx4 v40, s[40:43], s56 offen offset:2048 nt lds
  s_add_u32 s56, s56, 7168
  s_waitcnt vmcnt(4)
  buffer_load_dwordx4 v41, s[40:43], s56 offen offset:3072 nt lds
  s_add_u32 s56, s56, 11264
  s_waitcnt vmcnt(4)
  s_add_u32 m0, s22, 4096
  s_nop 0
  buffer_load_dwordx4 v40, s[40:43], s56 offen offset:0 nt lds
  s_add_u32 s56, s56, 7168
  s_waitcnt vmcnt(4)
  buffer_load_dwordx4 v41, s[40:43], s56 offen offset:1024 nt lds
  s_add_u32 s56, s56, 7168
  s_waitcnt vmcnt(4)
  buffer_load_dwordx4 v40, s[40:43], s56 offen offset:2048 nt lds
  s_add_u32 s56, s56, 7168
  s_waitcnt vmcnt(4)
  buffer_load_dwordx4 v41, s[40:43], s56 offen offset:3072 nt lds
  s_mul_i32 s59, s57, 9363
  s_lshr_b32 s59, s59, 16
  s_mul_i32 s59, s59, 7
  s_sub_u32 s59, s57, s59
  s_cmp_lg_u32 s59, 3
  s_cbranch_scc1 L_notnat_31
  v_lshrrev_b32 v42, 4, v46
  v_bfe_u32 v45, v46, 2, 2
  v_lshl_add_u32 v42, v42, 3, v45
  v_and_b32 v45, 7, v42
  v_lshlrev_b32 v42, 8, v42
  v_lshl_add_u32 v42, v45, 5, v42
  v_and_b32 v45, 3, v46
  v_lshl_add_u32 v42, v45, 3, v42
  v_add_u32 v42, s22, v42
  v_lshrrev_b32 v43, 4, v46
  v_bfe_u32 v45, v46, 2, 2
  v_lshl_add_u32 v43, v43, 3, v45
  v_add_u32 v43, 4, v43
  v_and_b32 v45, 7, v43
  v_lshlrev_b32 v43, 8, v43
  v_lshl_add_u32 v43, v45, 5, v43
  v_and_b32 v45, 3, v46
  v_lshl_add_u32 v43, v45, 3, v43
  v_add_u32 v43, s22, v43
  s_waitcnt vmcnt(0)
  ds_read_b64_tr_b16 v[48:49], v42
  ds_read_b64_tr_b16 v[50:51], v43
  v_xor_b32 v45, 32, v42
  ds_read_b64_tr_b16 v[52:53], v45
  v_xor_b32 v45, 32, v43
  ds_read_b64_tr_b16 v[54:55], v45
  v_xor_b32 v45, 64, v42
  ds_read_b64_tr_b16 v[56:57], v45
  v_xor_b32 v45, 64, v43
  ds_read_b64_tr_b16 v[58:59], v45
  v_xor_b32 v45, 96, v42
  ds_read_b64_tr_b16 v[60:61], v45
  v_xor_b32 v45, 96, v43
  ds_read_b64_tr_b16 v[62:63], v45
  s_waitcnt lgkmcnt(4)
  v_xor_b32 v45, 128, v42
  ds_read_b64_tr_b16 v[64:65], v45
  v_xor_b32 v45, 128, v43
  ds_read_b64_tr_b16 v[66:67], v45
  v_xor_b32 v45, 160, v42
  ds_read_b64_tr_b16 v[68:69], v45
  v_xor_b32 v45, 160, v43
  ds_read_b64_tr_b16 v[70:71], v45
  v_xor_b32 v45, 192, v42
  ds_read_b64_tr_b16 v[72:73], v45
  v_xor_b32 v45, 192, v43
  ds_read_b64_tr_b16 v[74:75], v45
  v_xor_b32 v45, 224, v42
  ds_read_b64_tr_b16 v[76:77], v45
  v_xor_b32 v45, 224, v43
  ds_read_b64_tr_b16 v[78:79], v45
  s_waitcnt lgkmcnt(0)
  s_branch L_natjoin_32
L_notnat_31:
  s_waitcnt vmcnt(0)
  ds_read_b64_tr_b16 v[48:49], v176
  ds_read_b64_tr_b16 v[50:51], v177
  ds_read_b64_tr_b16 v[52:53], v178
  ds_read_b64_tr_b16 v[54:55], v179
  ds_read_b64_tr_b16 v[56:57], v180
  ds_read_b64_tr_b16 v[58:59], v181
  ds_read_b64_tr_b16 v[60:61], v182
  ds_read_b64_tr_b16 v[62:63], v183
  s_waitcnt lgkmcnt(4)
  ds_read_b64_tr_b16 v[64:65], v184
  ds_read_b64_tr_b16 v[66:67], v185
  ds_read_b64_tr_b16 v[68:69], v186
  ds_read_b64_tr_b16 v[70:71], v187
  ds_read_b64_tr_b16 v[72:73], v188
  ds_read_b64_tr_b16 v[74:75], v189
  ds_read_b64_tr_b16 v[76:77], v190
  ds_read_b64_tr_b16 v[78:79], v191
  s_waitcnt lgkmcnt(0)
L_natjoin_32:
  s_waitcnt vmcnt(4)
  buffer_store_dwordx4 v[48:51], v44, s[16:19], s48 offen offset:0 sc1
  s_waitcnt vmcnt(4)
  buffer_store_dwordx4 v[52:55], v44, s[16:19], s48 offen offset:1024 sc1
  s_waitcnt vmcnt(4)
  buffer_store_dwordx4 v[56:59], v44, s[16:19], s48 offen offset:2048 sc1
  s_waitcnt vmcnt(4)
  buffer_store_dwordx4 v[60:63], v44, s[16:19], s48 offen offset:3072 sc1
  s_waitcnt vmcnt(4)
  buffer_store_dwordx4 v[64:67], v44, s[16:19], s49 offen offset:0 sc1
  s_waitcnt vmcnt(4)
  buffer_store_dwordx4 v[68:71], v44, s[16:19], s49 offen offset:1024 sc1
  s_waitcnt vmcnt(4)
  buffer_store_dwordx4 v[72:75], v44, s[16:19], s49 offen offset:2048 sc1
  s_waitcnt vmcnt(4)
  buffer_store_dwordx4 v[76:79], v44, s[16:19], s49 offen offset:3072 sc1
  s_lshr_b32 s23, s34, 2
  s_and_b32 s24, s34, 3
  s_cmp_ge_u32 s23, 28
  s_cselect_b32 s8, s38, s36
  s_cselect_b32 s9, s39, s37
  s_cselect_b32 s25, 1, 0
  s_cselect_b32 s26, 28, 0
  s_sub_u32 s23, s23, s26
  s_lshl_b32 s26, s24, 3
  s_lshl_b32 s27, s21, 1
  s_add_u32 s26, s26, s27
  s_lshl_b32 s48, s26, 1
  s_add_u32 s48, s48, s25
  s_mul_i32 s48, s48, 28
  s_add_u32 s48, s48, s23
  s_lshl_b32 s48, s48, 13
  s_add_u32 s49, s48, 4096
  s_add_u32 s50, s48, 458752
  s_add_u32 s51, s50, 4096
  s_lshr_b32 s57, s26, 1
  s_bfe_u32 s58, s57, 0x10003
  s_xor_b32 s57, s57, s58
  s_lshl_b32 s57, s57, 9
  s_add_u32 s57, s57, 237568
  s_lshl_b32 s27, s26, 7
  s_add_u32 s27, s27, 167936
  v_bfe_u32 v8, v0, 2, 1
  v_lshlrev_b32 v8, 13, v8
  v_and_b32 v9, 3, v0
  v_lshl_add_u32 v8, v9, 7, v8
  s_mov_b32 s10, 0x700000
  s_mov_b32 s11, 0x20000
  s_add_u32 s16, s4, 0x3300000
  s_addc_u32 s17, s5, 0
  s_mov_b32 s18, 0xe00000
  s_mov_b32 s19, 0x20000
  v_lshrrev_b32 v45, 4, v46
  v_mul_u32_u24 v40, 7168, v45
  v_lshlrev_b32 v45, 1, v45
  v_and_b32 v41, 15, v46
  v_xor_b32 v45, v45, v41
  v_xor_b32 v41, 8, v45
  v_lshl_add_u32 v41, v41, 4, v40
  v_lshl_add_u32 v40, v45, 4, v40
  s_add_u32 s56, s26, 0
  s_mul_i32 s56, s56, 229376
  s_lshl_b32 s58, s23, 8
  s_add_u32 s56, s56, s58
  s_waitcnt vmcnt(4)
  s_add_u32 m0, s22, 0
  s_nop 0
  buffer_load_dwordx4 v40, s[8:11], s56 offen offset:0 nt lds
  s_add_u32 s56, s56, 27648
  s_waitcnt vmcnt(4)
  buffer_load_dwordx4 v41, s[8:11], s56 offen offset:1024 nt lds
  s_add_u32 s56, s56, 27648
  s_waitcnt vmcnt(4)
  buffer_load_dwordx4 v40, s[8:11], s56 offen offset:2048 nt lds
  s_add_u32 s56, s56, 27648
  s_waitcnt vmcnt(4)
  buffer_load_dwordx4 v41, s[8:11], s56 offen offset:3072 nt lds
  s_add_u32 s56, s56, 31744
  s_waitcnt vmcnt(4)
  s_add_u32 m0, s22, 4096
  s_nop 0
  buffer_load_dwordx4 v40, s[8:11], s56 offen offset:0 nt lds
  s_add_u32 s56, s56, 27648
  s_waitcnt vmcnt(4)
  buffer_load_dwordx4 v41, s[8:11], s56 offen offset:1024 nt lds
  s_add_u32 s56, s56, 27648
  s_waitcnt vmcnt(4)
  buffer_load_dwordx4 v40, s[8:11], s56 offen offset:2048 nt lds
  s_add_u32 s56, s56, 27648
  s_waitcnt vmcnt(4)
  buffer_load_dwordx4 v41, s[8:11], s56 offen offset:3072 nt lds
  s_mov_b32 s59, 0x100000
L_pollB_33:
  buffer_load_dword v9, v8, s[12:15], s57 offen sc1
  s_waitcnt vmcnt(0)
  v_cmp_ne_u32 vcc, 1, v9
  s_nop 1
  s_sub_u32 s59, s59, 1
  s_cselect_b64 s[60:61], 0, vcc
  s_cmp_lg_u64 s[60:61], 0
  s_cbranch_scc1 L_pollB_33
  buffer_load_dword v8, v3, s[12:15], s27 offen sc1
  s_add_u32 s58, s27, 0x1000
  buffer_load_dword v12, v3, s[12:15], s58 offen sc1
  s_add_u32 s27, s27, 16384
  buffer_load_dword v9, v3, s[12:15], s27 offen sc1
  s_add_u32 s58, s27, 0x1000
  buffer_load_dword v13, v3, s[12:15], s58 offen sc1
  s_add_u32 s27, s27, 16384
  buffer_load_dword v10, v3, s[12:15], s27 offen sc1
  s_add_u32 s58, s27, 0x1000
  buffer_load_dword v14, v3, s[12:15], s58 offen sc1
  s_add_u32 s27, s27, 16384
  buffer_load_dword v11, v3, s[12:15], s27 offen sc1
  s_add_u32 s58, s27, 0x1000
  buffer_load_dword v15, v3, s[12:15], s58 offen sc1
  ds_read_b64_tr_b16 v[48:49], v176
  ds_read_b64_tr_b16 v[50:51], v177
  ds_read_b64_tr_b16 v[52:53], v178
  ds_read_b64_tr_b16 v[54:55], v179
  ds_read_b64_tr_b16 v[56:57], v180
  ds_read_b64_tr_b16 v[58:59], v181
  ds_read_b64_tr_b16 v[60:61], v182
  ds_read_b64_tr_b16 v[62:63], v183
  s_waitcnt lgkmcnt(4)
  ds_read_b64_tr_b16 v[64:65], v184
  ds_read_b64_tr_b16 v[66:67], v185
  ds_read_b64_tr_b16 v[68:69], v186
  ds_read_b64_tr_b16 v[70:71], v187
  ds_read_b64_tr_b16 v[72:73], v188
  ds_read_b64_tr_b16 v[74:75], v189
  ds_read_b64_tr_b16 v[76:77], v190
  ds_read_b64_tr_b16 v[78:79], v191
  s_waitcnt lgkmcnt(0)
  s_waitcnt vmcnt(0)
  v_add_f32 v8, v8, v9
  v_add_f32 v10, v10, v11
  v_add_f32 v12, v12, v13
  v_add_f32 v14, v14, v15
  v_add_f32 v8, v8, v10
  v_add_f32 v12, v12, v14
  v_cvt_pk_bf16_f32 v12, v12, v12
  v_lshlrev_b32 v12, 16, v12
  v_add_f32 v12, 1.0, v12
  v_cvt_pk_bf16_f32 v12, v12, v8
  ds_write_b16 v20, v12
  ds_write_b16_d16_hi v20, v12 offset:128
  v_and_b32 v10, 1, v0
  v_lshlrev_b32 v10, 7, v10
  v_lshl_add_u32 v10, v4, 3, v10
  v_add_u32 v10, s28, v10
  ds_read_b64 v[24:25], v10 offset:0
  ds_read_b64 v[26:27], v10 offset:32
  ds_read_b64 v[28:29], v10 offset:64
  ds_read_b64 v[30:31], v10 offset:96
  s_waitcnt lgkmcnt(0)
  s_waitcnt vmcnt(4)
  v_mfma_f32_16x16x32_bf16 v[80:83], v[48:51], v[24:27], 0
  buffer_store_dwordx4 v[48:51], v44, s[16:19], s48 offen offset:0 sc1
  s_waitcnt vmcnt(4)
  v_mfma_f32_16x16x32_bf16 v[84:87], v[52:55], v[24:27], 0
  buffer_store_dwordx4 v[52:55], v44, s[16:19], s48 offen offset:1024 sc1
  s_waitcnt vmcnt(4)
  v_mfma_f32_16x16x32_bf16 v[88:91], v[56:59], v[24:27], 0
  buffer_store_dwordx4 v[56:59], v44, s[16:19], s48 offen offset:2048 sc1
  s_waitcnt vmcnt(4)
  v_mfma_f32_16x16x32_bf16 v[92:95], v[60:63], v[24:27], 0
  buffer_store_dwordx4 v[60:63], v44, s[16:19], s48 offen offset:3072 sc1
  s_waitcnt vmcnt(4)
  v_mfma_f32_16x16x32_bf16 v[96:99], v[64:67], v[24:27], 0
  buffer_store_dwordx4 v[64:67], v44, s[16:19], s49 offen offset:0 sc1
  s_waitcnt vmcnt(4)
  v_mfma_f32_16x16x32_bf16 v[100:103], v[68:71], v[24:27], 0
  buffer_store_dwordx4 v[68:71], v44, s[16:19], s49 offen offset:1024 sc1
  s_waitcnt vmcnt(4)
  v_mfma_f32_16x16x32_bf16 v[104:107], v[72:75], v[24:27], 0
  buffer_store_dwordx4 v[72:75], v44, s[16:19], s49 offen offset:2048 sc1
  s_waitcnt vmcnt(4)
  v_mfma_f32_16x16x32_bf16 v[108:111], v[76:79], v[24:27], 0
  buffer_store_dwordx4 v[76:79], v44, s[16:19], s49 offen offset:3072 sc1
  s_add_u32 s56, s26, 1
  s_mul_i32 s56, s56, 229376
  s_lshl_b32 s58, s23, 8
  s_add_u32 s56, s56, s58
  s_waitcnt vmcnt(4)
  s_add_u32 m0, s22, 0
  s_nop 0
  buffer_load_dwordx4 v40, s[8:11], s56 offen offset:0 nt lds
  s_add_u32 s56, s56, 27648
  s_waitcnt vmcnt(4)
  buffer_load_dwordx4 v41, s[8:11], s56 offen offset:1024 nt lds
  s_add_u32 s56, s56, 27648
  s_waitcnt vmcnt(4)
  buffer_load_dwordx4 v40, s[8:11], s56 offen offset:2048 nt lds
  s_add_u32 s56, s56, 27648
  s_waitcnt vmcnt(4)
  buffer_load_dwordx4 v41, s[8:11], s56 offen offset:3072 nt lds
  s_add_u32 s56, s56, 31744
  s_waitcnt vmcnt(4)
  s_add_u32 m0, s22, 4096
  s_nop 0
  buffer_load_dwordx4 v40, s[8:11], s56 offen offset:0 nt lds
  s_add_u32 s56, s56, 27648
  s_waitcnt vmcnt(4)
  buffer_load_dwordx4 v41, s[8:11], s56 offen offset:1024 nt lds
  s_add_u32 s56, s56, 27648
  s_waitcnt vmcnt(4)
  buffer_load_dwordx4 v40, s[8:11], s56 offen offset:2048 nt lds
  s_add_u32 s56, s56, 27648
  s_waitcnt vmcnt(4)
  buffer_load_dwordx4 v41, s[8:11], s56 offen offset:3072 nt lds
  s_waitcnt vmcnt(0)
  ds_read_b64_tr_b16 v[48:49], v176
  ds_read_b64_tr_b16 v[50:51], v177
  ds_read_b64_tr_b16 v[52:53], v178
  ds_read_b64_tr_b16 v[54:55], v179
  ds_read_b64_tr_b16 v[56:57], v180
  ds_read_b64_tr_b16 v[58:59], v181
  ds_read_b64_tr_b16 v[60:61], v182
  ds_read_b64_tr_b16 v[62:63], v183
  s_waitcnt lgkmcnt(4)
  ds_read_b64_tr_b16 v[64:65], v184
  ds_read_b64_tr_b16 v[66:67], v185
  ds_read_b64_tr_b16 v[68:69], v186
  ds_read_b64_tr_b16 v[70:71], v187
  ds_read_b64_tr_b16 v[72:73], v188
  ds_read_b64_tr_b16 v[74:75], v189
  ds_read_b64_tr_b16 v[76:77], v190
  ds_read_b64_tr_b16 v[78:79], v191
  s_waitcnt lgkmcnt(0)
  s_waitcnt vmcnt(4)
  v_mfma_f32_16x16x32_bf16 v[80:83], v[48:51], v[28:31], v[80:83]
  buffer_store_dwordx4 v[48:51], v44, s[16:19], s50 offen offset:0 sc1
  s_waitcnt vmcnt(4)
  v_mfma_f32_16x16x32_bf16 v[84:87], v[52:55], v[28:31], v[84:87]
  buffer_store_dwordx4 v[52:55], v44, s[16:19], s50 offen offset:1024 sc1
  s_waitcnt vmcnt(4)
  v_mfma_f32_16x16x32_bf16 v[88:91], v[56:59], v[28:31], v[88:91]
  buffer_store_dwordx4 v[56:59], v44, s[16:19], s50 offen offset:2048 sc1
  s_waitcnt vmcnt(4)
  v_mfma_f32_16x16x32_bf16 v[92:95], v[60:63], v[28:31], v[92:95]
  buffer_store_dwordx4 v[60:63], v44, s[16:19], s50 offen offset:3072 sc1
  s_waitcnt vmcnt(4)
  v_mfma_f32_16x16x32_bf16 v[96:99], v[64:67], v[28:31], v[96:99]
  buffer_store_dwordx4 v[64:67], v44, s[16:19], s51 offen offset:0 sc1
  s_waitcnt vmcnt(4)
  v_mfma_f32_16x16x32_bf16 v[100:103], v[68:71], v[28:31], v[100:103]
  buffer_store_dwordx4 v[68:71], v44, s[16:19], s51 offen offset:1024 sc1
  s_waitcnt vmcnt(4)
  v_mfma_f32_16x16x32_bf16 v[104:107], v[72:75], v[28:31], v[104:107]
  buffer_store_dwordx4 v[72:75], v44, s[16:19], s51 offen offset:2048 sc1
  s_waitcnt vmcnt(4)
  v_mfma_f32_16x16x32_bf16 v[108:111], v[76:79], v[28:31], v[108:111]
  buffer_store_dwordx4 v[76:79], v44, s[16:19], s51 offen offset:3072 sc1
  s_nop 3
  v_and_b32 v8, 15, v46
  v_lshlrev_b32 v9, 9, v8
  v_lshl_add_u32 v9, v4, 4, v9
  s_lshl_b32 s59, s21, 10
  s_add_u32 s59, s59, 40960
  v_add_u32 v9, s59, v9
  v_cmp_gt_u32 vcc, 2, v8
  s_and_saveexec_b64 s[60:61], vcc
  ds_write_b128 v9, v[80:83] offset:0
  ds_write_b128 v9, v[84:87] offset:64
  ds_write_b128 v9, v[88:91] offset:128
  ds_write_b128 v9, v[92:95] offset:192
  ds_write_b128 v9, v[96:99] offset:256
  ds_write_b128 v9, v[100:103] offset:320
  ds_write_b128 v9, v[104:107] offset:384
  ds_write_b128 v9, v[108:111] offset:448
  s_mov_b64 exec, s[60:61]
  v_lshlrev_b32 v9, 2, v0
  s_waitcnt lgkmcnt(0)
  s_barrier
  ds_read_b32 v10, v9 offset:40960
  ds_read_b32 v11, v9 offset:41984
  ds_read_b32 v12, v9 offset:43008
  ds_read_b32 v13, v9 offset:44032
  v_lshrrev_b32 v14, 7, v0
  v_mul_u32_u24 v14, 14336, v14
  v_and_b32 v15, 127, v0
  v_lshl_add_u32 v14, v15, 2, v14
  s_lshl_b32 s59, s24, 1
  s_add_u32 s59, s59, s25
  s_mul_i32 s59, s59, 28672
  s_lshl_b32 s60, s23, 9
  s_add_u32 s59, s59, s60
  s_add_u32 s59, s59, 524288
  s_waitcnt lgkmcnt(0)
  v_add_f32 v10, v10, v11
  v_add_f32 v12, v12, v13
  v_add_f32 v10, v10, v12
  buffer_store_dword v10, v14, s[12:15], s59 offen sc1
  s_mov_b32 s70, 0x400000
  s_mov_b32 s71, 0x20000
  v_and_b32 v6, 3, v6
  v_lshlrev_b32 v6, 11, v6
  v_lshl_add_u32 v6, v7, 8, v6
  s_lshr_b32 s59, s34, 3
  s_lshl_b32 s59, s59, 2
  s_add_u32 s59, s59, s21
  s_lshl_b32 s59, s59, 13
  s_bfe_u32 s60, s34, 0x20001
  s_lshl_b32 s60, s60, 20
  s_add_u32 s59, s59, s60
  s_and_b32 s60, s34, 1
  s_lshl_b32 s60, s60, 7
  s_add_u32 s59, s59, s60
  buffer_load_dword v5, v6, s[68:71], s59 offen nt
  s_endpgm
L_wo_pack_29:
  s_sub_u32 s23, s34, 224
  s_mov_b32 s46, 0x200000
  s_mov_b32 s47, 0x20000
  s_add_u32 s16, s4, 0x3100000
  s_addc_u32 s17, s5, 0
  s_mov_b32 s18, 0x200000
  s_mov_b32 s19, 0x20000
  v_lshrrev_b32 v42, 5, v46
  v_bfe_u32 v45, v46, 2, 3
  v_lshl_add_u32 v42, v42, 4, v45
  v_and_b32 v45, 7, v42
  v_lshlrev_b32 v42, 8, v42
  v_lshl_add_u32 v42, v45, 5, v42
  v_and_b32 v45, 3, v46
  v_lshl_add_u32 v42, v45, 3, v42
  v_add_u32 v42, s22, v42
  v_lshrrev_b32 v43, 5, v46
  v_bfe_u32 v45, v46, 2, 3
  v_lshl_add_u32 v43, v43, 4, v45
  v_add_u32 v43, 8, v43
  v_and_b32 v45, 7, v43
  v_lshlrev_b32 v43, 8, v43
  v_lshl_add_u32 v43, v45, 5, v43
  v_and_b32 v45, 3, v46
  v_lshl_add_u32 v43, v45, 3, v43
  v_add_u32 v43, s22, v43
  s_lshl_b32 s57, s21, 1
  s_add_u32 s57, s57, 0
  s_lshl_b32 s56, s23, 16
  s_lshl_b32 s58, s57, 8
  s_add_u32 s56, s56, s58
  s_lshl_b32 s58, s57, 6
  s_add_u32 s58, s58, s23
  s_lshl_b32 s48, s58, 12
  s_add_u32 s49, s48, 131072
  s_waitcnt vmcnt(4)
  s_add_u32 m0, s22, 0
  s_nop 0
  buffer_load_dwordx4 v40, s[44:47], s56 offen offset:0 nt lds
  s_add_u32 s56, s56, 7168
  s_waitcnt vmcnt(4)
  buffer_load_dwordx4 v41, s[44:47], s56 offen offset:1024 nt lds
  s_add_u32 s56, s56, 7168
  s_waitcnt vmcnt(4)
  buffer_load_dwordx4 v40, s[44:47], s56 offen offset:2048 nt lds
  s_add_u32 s56, s56, 7168
  s_waitcnt vmcnt(4)
  buffer_load_dwordx4 v41, s[44:47], s56 offen offset:3072 nt lds
  s_add_u32 s56, s56, 11264
  s_waitcnt vmcnt(4)
  s_add_u32 m0, s22, 4096
  s_nop 0
  buffer_load_dwordx4 v40, s[44:47], s56 offen offset:0 nt lds
  s_add_u32 s56, s56, 7168
  s_waitcnt vmcnt(4)
  buffer_load_dwordx4 v41, s[44:47], s56 offen offset:1024 nt lds
  s_add_u32 s56, s56, 7168
  s_waitcnt vmcnt(4)
  buffer_load_dwordx4 v40, s[44:47], s56 offen offset:2048 nt lds
  s_add_u32 s56, s56, 7168
  s_waitcnt vmcnt(4)
  buffer_load_dwordx4 v41, s[44:47], s56 offen offset:3072 nt lds
  s_waitcnt vmcnt(0)
  ds_read_b64_tr_b16 v[48:49], v42
  ds_read_b64_tr_b16 v[50:51], v43
  v_xor_b32 v45, 32, v42
  ds_read_b64_tr_b16 v[52:53], v45
  v_xor_b32 v45, 32, v43
  ds_read_b64_tr_b16 v[54:55], v45
  v_xor_b32 v45, 64, v42
  ds_read_b64_tr_b16 v[56:57], v45
  v_xor_b32 v45, 64, v43
  ds_read_b64_tr_b16 v[58:59], v45
  v_xor_b32 v45, 96, v42
  ds_read_b64_tr_b16 v[60:61], v45
  v_xor_b32 v45, 96, v43
  ds_read_b64_tr_b16 v[62:63], v45
  s_waitcnt lgkmcnt(4)
  v_xor_b32 v45, 128, v42
  ds_read_b64_tr_b16 v[64:65], v45
  v_xor_b32 v45, 128, v43
  ds_read_b64_tr_b16 v[66:67], v45
  v_xor_b32 v45, 160, v42
  ds_read_b64_tr_b16 v[68:69], v45
  v_xor_b32 v45, 160, v43
  ds_read_b64_tr_b16 v[70:71], v45
  v_xor_b32 v45, 192, v42
  ds_read_b64_tr_b16 v[72:73], v45
  v_xor_b32 v45, 192, v43
  ds_read_b64_tr_b16 v[74:75], v45
  v_xor_b32 v45, 224, v42
  ds_read_b64_tr_b16 v[76:77], v45
  v_xor_b32 v45, 224, v43
  ds_read_b64_tr_b16 v[78:79], v45
  s_waitcnt lgkmcnt(0)
  s_waitcnt vmcnt(4)
  buffer_store_dwordx4 v[48:51], v44, s[16:19], s48 offen offset:0 sc1
  s_waitcnt vmcnt(4)
  buffer_store_dwordx4 v[52:55], v44, s[16:19], s48 offen offset:1024 sc1
  s_waitcnt vmcnt(4)
  buffer_store_dwordx4 v[56:59], v44, s[16:19], s48 offen offset:2048 sc1
  s_waitcnt vmcnt(4)
  buffer_store_dwordx4 v[60:63], v44, s[16:19], s48 offen offset:3072 sc1
  s_waitcnt vmcnt(4)
  buffer_store_dwordx4 v[64:67], v44, s[16:19], s49 offen offset:0 sc1
  s_waitcnt vmcnt(4)
  buffer_store_dwordx4 v[68:71], v44, s[16:19], s49 offen offset:1024 sc1
  s_waitcnt vmcnt(4)
  buffer_store_dwordx4 v[72:75], v44, s[16:19], s49 offen offset:2048 sc1
  s_waitcnt vmcnt(4)
  buffer_store_dwordx4 v[76:79], v44, s[16:19], s49 offen offset:3072 sc1
  s_lshl_b32 s57, s21, 1
  s_add_u32 s57, s57, 1
  s_lshl_b32 s56, s23, 16
  s_lshl_b32 s58, s57, 8
  s_add_u32 s56, s56, s58
  s_lshl_b32 s58, s57, 6
  s_add_u32 s58, s58, s23
  s_lshl_b32 s48, s58, 12
  s_add_u32 s49, s48, 131072
  s_waitcnt vmcnt(4)
  s_add_u32 m0, s22, 0
  s_nop 0
  buffer_load_dwordx4 v40, s[44:47], s56 offen offset:0 nt lds
  s_add_u32 s56, s56, 7168
  s_waitcnt vmcnt(4)
  buffer_load_dwordx4 v41, s[44:47], s56 offen offset:1024 nt lds
  s_add_u32 s56, s56, 7168
  s_waitcnt vmcnt(4)
  buffer_load_dwordx4 v40, s[44:47], s56 offen offset:2048 nt lds
  s_add_u32 s56, s56, 7168
  s_waitcnt vmcnt(4)
  buffer_load_dwordx4 v41, s[44:47], s56 offen offset:3072 nt lds
  s_add_u32 s56, s56, 11264
  s_waitcnt vmcnt(4)
  s_add_u32 m0, s22, 4096
  s_nop 0
  buffer_load_dwordx4 v40, s[44:47], s56 offen offset:0 nt lds
  s_add_u32 s56, s56, 7168
  s_waitcnt vmcnt(4)
  buffer_load_dwordx4 v41, s[44:47], s56 offen offset:1024 nt lds
  s_add_u32 s56, s56, 7168
  s_waitcnt vmcnt(4)
  buffer_load_dwordx4 v40, s[44:47], s56 offen offset:2048 nt lds
  s_add_u32 s56, s56, 7168
  s_waitcnt vmcnt(4)
  buffer_load_dwordx4 v41, s[44:47], s56 offen offset:3072 nt lds
  s_waitcnt vmcnt(0)
  ds_read_b64_tr_b16 v[48:49], v42
  ds_read_b64_tr_b16 v[50:51], v43
  v_xor_b32 v45, 32, v42
  ds_read_b64_tr_b16 v[52:53], v45
  v_xor_b32 v45, 32, v43
  ds_read_b64_tr_b16 v[54:55], v45
  v_xor_b32 v45, 64, v42
  ds_read_b64_tr_b16 v[56:57], v45
  v_xor_b32 v45, 64, v43
  ds_read_b64_tr_b16 v[58:59], v45
  v_xor_b32 v45, 96, v42
  ds_read_b64_tr_b16 v[60:61], v45
  v_xor_b32 v45, 96, v43
  ds_read_b64_tr_b16 v[62:63], v45
  s_waitcnt lgkmcnt(4)
  v_xor_b32 v45, 128, v42
  ds_read_b64_tr_b16 v[64:65], v45
  v_xor_b32 v45, 128, v43
  ds_read_b64_tr_b16 v[66:67], v45
  v_xor_b32 v45, 160, v42
  ds_read_b64_tr_b16 v[68:69], v45
  v_xor_b32 v45, 160, v43
  ds_read_b64_tr_b16 v[70:71], v45
  v_xor_b32 v45, 192, v42
  ds_read_b64_tr_b16 v[72:73], v45
  v_xor_b32 v45, 192, v43
  ds_read_b64_tr_b16 v[74:75], v45
  v_xor_b32 v45, 224, v42
  ds_read_b64_tr_b16 v[76:77], v45
  v_xor_b32 v45, 224, v43
  ds_read_b64_tr_b16 v[78:79], v45
  s_waitcnt lgkmcnt(0)
  s_waitcnt vmcnt(4)
  buffer_store_dwordx4 v[48:51], v44, s[16:19], s48 offen offset:0 sc1
  s_waitcnt vmcnt(4)
  buffer_store_dwordx4 v[52:55], v44, s[16:19], s48 offen offset:1024 sc1
  s_waitcnt vmcnt(4)
  buffer_store_dwordx4 v[56:59], v44, s[16:19], s48 offen offset:2048 sc1
  s_waitcnt vmcnt(4)
  buffer_store_dwordx4 v[60:63], v44, s[16:19], s48 offen offset:3072 sc1
  s_waitcnt vmcnt(4)
  buffer_store_dwordx4 v[64:67], v44, s[16:19], s49 offen offset:0 sc1
  s_waitcnt vmcnt(4)
  buffer_store_dwordx4 v[68:71], v44, s[16:19], s49 offen offset:1024 sc1
  s_waitcnt vmcnt(4)
  buffer_store_dwordx4 v[72:75], v44, s[16:19], s49 offen offset:2048 sc1
  s_waitcnt vmcnt(4)
  buffer_store_dwordx4 v[76:79], v44, s[16:19], s49 offen offset:3072 sc1
  s_mov_b32 s70, 0x400000
  s_mov_b32 s71, 0x20000
  v_and_b32 v6, 3, v6
  v_lshlrev_b32 v6, 11, v6
  v_lshl_add_u32 v6, v7, 8, v6
  s_lshr_b32 s59, s34, 3
  s_lshl_b32 s59, s59, 2
  s_add_u32 s59, s59, s21
  s_lshl_b32 s59, s59, 13
  s_bfe_u32 s60, s34, 0x20001
  s_lshl_b32 s60, s60, 20
  s_add_u32 s59, s59, s60
  s_and_b32 s60, s34, 1
  s_lshl_b32 s60, s60, 7
  s_add_u32 s59, s59, s60
  buffer_load_dword v5, v6, s[68:71], s59 offen nt
L_end_22:
  s_endpgm
L_tail_code:
.text
.globl wo_kernel
.p2align 8
.type wo_kernel,@function
wo_kernel:
  s_cmp_ge_u32 s2, 256
  s_cbranch_scc1 L_end_34
  s_load_dwordx2 s[4:5], s[0:1], 88
  v_lshrrev_b32 v1, 6, v0
  v_and_b32 v0, 63, v0
  v_readfirstlane_b32 s20, v1
  s_and_b32 s23, s2, 7
  s_lshr_b32 s24, s2, 3
  v_lshlrev_b32 v2, 4, v0
  v_add_u32 v3, 65536, v2
  v_mov_b32 v4, v2
  v_add_u32 v5, 4096, v2
  s_load_dwordx2 s[28:29], s[0:1], 0
  s_load_dwordx2 s[68:69], s[0:1], 72
  s_lshr_b32 s21, s23, 1
  s_lshl_b32 s21, s21, 2
  s_and_b32 s25, s24, 3
  s_add_u32 s21, s21, s25
  s_and_b32 s22, s23, 1
  s_lshr_b32 s25, s24, 2
  s_lshl_b32 s25, s25, 1
  s_add_u32 s22, s22, s25
  s_lshl_b32 s25, s21, 2
  s_add_u32 s27, s25, s20
  s_lshl_b32 s26, s27, 1
  v_add_u32 v8, 0, v2
  v_add_u32 v9, 32768, v2
  s_mul_i32 s18, s20, 4096
  s_mul_i32 s16, s22, 131072
  s_add_u32 s16, s16, s18
  s_mul_i32 s25, s26, 32768
  s_add_u32 s25, s25, 17825792
  s_mov_b32 s17, 0
  s_waitcnt lgkmcnt(0)
  s_add_u32 s8, s4, 0x3100000
  s_addc_u32 s9, s5, 0
  s_mov_b32 s10, 0x200000
  s_mov_b32 s11, 0x20000
  s_add_u32 s12, s4, s25
  s_addc_u32 s13, s5, 0
  s_mov_b32 s14, 0x10000
  s_mov_b32 s15, 0x20000
  s_add_u32 m0, s18, 0
  s_nop 0
  buffer_load_dwordx4 v4, s[8:11], s16 offen offset:0  lds
  buffer_load_dwordx4 v4, s[8:11], s16 offen offset:1024  lds
  buffer_load_dwordx4 v4, s[8:11], s16 offen offset:2048  lds
  buffer_load_dwordx4 v4, s[8:11], s16 offen offset:3072  lds
  s_add_u32 s16, s16, 16384
  buffer_load_dwordx4 a[0:3], v8, s[12:15], s17 offen offset:0
  buffer_load_dwordx4 a[4:7], v9, s[12:15], s17 offen offset:0
  buffer_load_dwordx4 a[8:11], v8, s[12:15], s17 offen offset:1024
  buffer_load_dwordx4 a[12:15], v9, s[12:15], s17 offen offset:1024
  buffer_load_dwordx4 a[16:19], v8, s[12:15], s17 offen offset:2048
  buffer_load_dwordx4 a[20:23], v9, s[12:15], s17 offen offset:2048
  buffer_load_dwordx4 a[24:27], v8, s[12:15], s17 offen offset:3072
  buffer_load_dwordx4 a[28:31], v9, s[12:15], s17 offen offset:3072
  s_add_u32 s17, s17, 4096
  s_add_u32 m0, s18, 16384
  s_nop 0
  buffer_load_dwordx4 v4, s[8:11], s16 offen offset:0  lds
  buffer_load_dwordx4 v4, s[8:11], s16 offen offset:1024  lds
  buffer_load_dwordx4 v4, s[8:11], s16 offen offset:2048  lds
  buffer_load_dwordx4 v4, s[8:11], s16 offen offset:3072  lds
  s_add_u32 s16, s16, 16384
  buffer_load_dwordx4 a[32:35], v8, s[12:15], s17 offen offset:0
  buffer_load_dwordx4 a[36:39], v9, s[12:15], s17 offen offset:0
  buffer_load_dwordx4 a[40:43], v8, s[12:15], s17 offen offset:1024
  buffer_load_dwordx4 a[44:47], v9, s[12:15], s17 offen offset:1024
  buffer_load_dwordx4 a[48:51], v8, s[12:15], s17 offen offset:2048
  buffer_load_dwordx4 a[52:55], v9, s[12:15], s17 offen offset:2048
  buffer_load_dwordx4 a[56:59], v8, s[12:15], s17 offen offset:3072
  buffer_load_dwordx4 a[60:63], v9, s[12:15], s17 offen offset:3072
  s_add_u32 s17, s17, 4096
  s_mov_b32 s30, 0x400000
  s_mov_b32 s31, 0x20000
  s_add_u32 s32, s4, 0x28000
  s_addc_u32 s33, s5, 0
  s_mov_b32 s34, 0x10000
  s_mov_b32 s35, 0x20000
  s_add_u32 s40, s4, 0x1900000
  s_addc_u32 s41, s5, 0
  s_mov_b32 s42, 0x400000
  s_mov_b32 s43, 0x20000
  s_add_u32 s48, s4, 0x40000
  s_addc_u32 s49, s5, 0
  s_mov_b32 s50, 0x40000
  s_mov_b32 s51, 0x20000
  v_lshrrev_b32 v20, 3, v0
  v_and_b32 v21, 7, v0
  v_xor_b32 v21, v21, v20
  v_lshlrev_b32 v22, 11, v20
  v_lshl_add_u32 v22, v21, 4, v22
  v_lshlrev_b32 v23, 2, v0
  s_mul_i32 s57, s20, 4608
  s_add_u32 s57, s57, 65536
  v_and_b32 v20, 15, v0
  v_lshrrev_b32 v21, 5, v0
  v_and_b32 v24, 7, v0
  v_xor_b32 v21, v21, v24
  v_lshlrev_b32 v21, 4, v21
  v_lshl_add_u32 v21, v20, 7, v21
  v_bfe_u32 v24, v0, 4, 1
  v_lshl_add_u32 v21, v24, 3, v21
  v_xor_b32 v25, 32, v21
  v_xor_b32 v26, 64, v21
  v_xor_b32 v27, 0x60, v21
  v_add_u32 v24, s57, v21
  v_add_u32 v25, s57, v25
  v_add_u32 v26, s57, v26
  v_add_u32 v27, s57, v27
  v_lshrrev_b32 v28, 4, v0
  v_lshlrev_b32 v28, 4, v28
  v_add_u32 v28, s57, v28
  s_lshl_b32 s36, s27, 16
  s_lshl_b32 s25, s22, 7
  s_add_u32 s36, s36, s25
  s_lshl_b32 s38, s22, 8
  v_add_u32 v29, s57, v23
  s_lshl_b32 s54, s27, 16
  s_lshl_b32 s25, s22, 11
  s_add_u32 s54, s54, s25
  s_add_u32 s55, s54, 32768
  s_lshl_b32 s56, s22, 14
  s_lshl_b32 s25, s27, 8
  s_add_u32 s56, s56, s25
  s_getpc_b64 s[44:45]
L_pc_35:
  s_add_u32 s44, s44, L_wo_epi-L_pc_35
  s_addc_u32 s45, s45, 0
  s_mov_b32 s46, L_gu_tail-L_wo_epi
  s_mov_b32 s47, 0x20000
  s_lshl_b32 s58, s24, 2
  s_add_u32 s58, s58, s20
  s_lshl_b32 s58, s58, 8
  v_and_b32 v30, 1, v0
  v_lshlrev_b32 v30, 7, v30
  s_waitcnt vmcnt(12) lgkmcnt(0)
  s_barrier
  ds_read_b128 a[128:131], v2 offset:0
  s_add_u32 m0, s18, 32768
  ds_read_b128 a[132:135], v2 offset:1024
  buffer_load_dwordx4 v4, s[8:11], s16 offen offset:0  lds
  ds_read_b128 a[136:139], v2 offset:2048
  buffer_load_dwordx4 v4, s[8:11], s16 offen offset:1024  lds
  ds_read_b128 a[140:143], v2 offset:3072
  ds_read_b128 a[144:147], v2 offset:4096
  buffer_load_dwordx4 v4, s[8:11], s16 offen offset:2048  lds
  s_waitcnt lgkmcnt(3)
  v_mfma_f32_16x16x32_bf16 v[32:35], a[128:131], a[0:3], 0
  v_mfma_f32_16x16x32_bf16 v[36:39], a[128:131], a[4:7], 0
  ds_read_b128 a[148:151], v2 offset:5120
  buffer_load_dwordx4 v4, s[8:11], s16 offen offset:3072  lds
  s_add_u32 s16, s16, 16384
  v_mfma_f32_16x16x32_bf16 v[40:43], a[132:135], a[0:3], 0
  ds_read_b128 a[152:155], v2 offset:6144
  v_mfma_f32_16x16x32_bf16 v[44:47], a[132:135], a[4:7], 0
  s_waitcnt lgkmcnt(2)
  v_mfma_f32_16x16x32_bf16 v[48:51], a[136:139], a[0:3], 0
  ds_read_b128 a[156:159], v2 offset:7168
  buffer_load_dwordx4 a[64:67], v8, s[12:15], s17 offen offset:0
  v_mfma_f32_16x16x32_bf16 v[52:55], a[136:139], a[4:7], 0
  v_mfma_f32_16x16x32_bf16 v[56:59], a[140:143], a[0:3], 0
  ds_read_b128 a[128:131], v2 offset:8192
  buffer_load_dwordx4 a[68:71], v9, s[12:15], s17 offen offset:0
  v_mfma_f32_16x16x32_bf16 v[60:63], a[140:143], a[4:7], 0
  ds_read_b128 a[132:135], v2 offset:9216
  v_mfma_f32_16x16x32_bf16 v[32:35], a[144:147], a[8:11], v[32:35]
  v_mfma_f32_16x16x32_bf16 v[36:39], a[144:147], a[12:15], v[36:39]
  ds_read_b128 a[136:139], v2 offset:10240
  buffer_load_dwordx4 a[72:75], v8, s[12:15], s17 offen offset:1024
  s_waitcnt lgkmcnt(3)
  v_mfma_f32_16x16x32_bf16 v[40:43], a[148:151], a[8:11], v[40:43]
  ds_read_b128 a[140:143], v2 offset:11264
  v_mfma_f32_16x16x32_bf16 v[44:47], a[148:151], a[12:15], v[44:47]
  buffer_load_dwordx4 a[76:79], v9, s[12:15], s17 offen offset:1024
  v_mfma_f32_16x16x32_bf16 v[48:51], a[152:155], a[8:11], v[48:51]
  ds_read_b128 a[144:147], v2 offset:12288
  v_mfma_f32_16x16x32_bf16 v[52:55], a[152:155], a[12:15], v[52:55]
  v_mfma_f32_16x16x32_bf16 v[56:59], a[156:159], a[8:11], v[56:59]
  ds_read_b128 a[148:151], v2 offset:13312
  buffer_load_dwordx4 a[80:83], v8, s[12:15], s17 offen offset:2048
  v_mfma_f32_16x16x32_bf16 v[60:63], a[156:159], a[12:15], v[60:63]
  ds_read_b128 a[152:155], v2 offset:14336
  s_waitcnt lgkmcnt(3)
  v_mfma_f32_16x16x32_bf16 v[32:35], a[128:131], a[16:19], v[32:35]
  buffer_load_dwordx4 a[84:87], v9, s[12:15], s17 offen offset:2048
  v_mfma_f32_16x16x32_bf16 v[36:39], a[128:131], a[20:23], v[36:39]
  ds_read_b128 a[156:159], v2 offset:15360
  v_mfma_f32_16x16x32_bf16 v[40:43], a[132:135], a[16:19], v[40:43]
  v_mfma_f32_16x16x32_bf16 v[44:47], a[132:135], a[20:23], v[44:47]
  buffer_load_dwordx4 a[88:91], v8, s[12:15], s17 offen offset:3072
  v_mfma_f32_16x16x32_bf16 v[48:51], a[136:139], a[16:19], v[48:51]
  v_mfma_f32_16x16x32_bf16 v[52:55], a[136:139], a[20:23], v[52:55]
  buffer_load_dwordx4 a[92:95], v9, s[12:15], s17 offen offset:3072
  s_add_u32 s17, s17, 4096
  v_mfma_f32_16x16x32_bf16 v[56:59], a[140:143], a[16:19], v[56:59]
  v_mfma_f32_16x16x32_bf16 v[60:63], a[140:143], a[20:23], v[60:63]
  s_waitcnt lgkmcnt(0)
  v_mfma_f32_16x16x32_bf16 v[32:35], a[144:147], a[24:27], v[32:35]
  s_waitcnt vmcnt(12) lgkmcnt(0)
  s_barrier
  v_mfma_f32_16x16x32_bf16 v[36:39], a[144:147], a[28:31], v[36:39]
  ds_read_b128 a[128:131], v2 offset:16384
  s_add_u32 m0, s18, 49152
  v_mfma_f32_16x16x32_bf16 v[40:43], a[148:151], a[24:27], v[40:43]
  ds_read_b128 a[132:135], v2 offset:17408
  buffer_load_dwordx4 v4, s[8:11], s16 offen offset:0  lds
  v_mfma_f32_16x16x32_bf16 v[44:47], a[148:151], a[28:31], v[44:47]
  v_mfma_f32_16x16x32_bf16 v[48:51], a[152:155], a[24:27], v[48:51]
  ds_read_b128 a[136:139], v2 offset:18432
  buffer_load_dwordx4 v4, s[8:11], s16 offen offset:1024  lds
  v_mfma_f32_16x16x32_bf16 v[52:55], a[152:155], a[28:31], v[52:55]
  ds_read_b128 a[140:143], v2 offset:19456
  v_mfma_f32_16x16x32_bf16 v[56:59], a[156:159], a[24:27], v[56:59]
  v_mfma_f32_16x16x32_bf16 v[60:63], a[156:159], a[28:31], v[60:63]
  ds_read_b128 a[144:147], v2 offset:20480
  buffer_load_dwordx4 v4, s[8:11], s16 offen offset:2048  lds
  s_waitcnt lgkmcnt(3)
  v_mfma_f32_16x16x32_bf16 v[32:35], a[128:131], a[32:35], v[32:35]
  v_mfma_f32_16x16x32_bf16 v[36:39], a[128:131], a[36:39], v[36:39]
  ds_read_b128 a[148:151], v2 offset:21504
  buffer_load_dwordx4 v4, s[8:11], s16 offen offset:3072  lds
  s_add_u32 s16, s16, 16384
  v_mfma_f32_16x16x32_bf16 v[40:43], a[132:135], a[32:35], v[40:43]
  ds_read_b128 a[152:155], v2 offset:22528
  v_mfma_f32_16x16x32_bf16 v[44:47], a[132:135], a[36:39], v[44:47]
  s_waitcnt lgkmcnt(2)
  v_mfma_f32_16x16x32_bf16 v[48:51], a[136:139], a[32:35], v[48:51]
  ds_read_b128 a[156:159], v2 offset:23552
  buffer_load_dwordx4 a[96:99], v8, s[12:15], s17 offen offset:0
  v_mfma_f32_16x16x32_bf16 v[52:55], a[136:139], a[36:39], v[52:55]
  v_mfma_f32_16x16x32_bf16 v[56:59], a[140:143], a[32:35], v[56:59]
  ds_read_b128 a[128:131], v2 offset:24576
  buffer_load_dwordx4 a[100:103], v9, s[12:15], s17 offen offset:0
  v_mfma_f32_16x16x32_bf16 v[60:63], a[140:143], a[36:39], v[60:63]
  ds_read_b128 a[132:135], v2 offset:25600
  v_mfma_f32_16x16x32_bf16 v[32:35], a[144:147], a[40:43], v[32:35]
  v_mfma_f32_16x16x32_bf16 v[36:39], a[144:147], a[44:47], v[36:39]
  ds_read_b128 a[136:139], v2 offset:26624
  buffer_load_dwordx4 a[104:107], v8, s[12:15], s17 offen offset:1024
  s_waitcnt lgkmcnt(3)
  v_mfma_f32_16x16x32_bf16 v[40:43], a[148:151], a[40:43], v[40:43]
  ds_read_b128 a[140:143], v2 offset:27648
  v_mfma_f32_16x16x32_bf16 v[44:47], a[148:151], a[44:47], v[44:47]
  buffer_load_dwordx4 a[108:111], v9, s[12:15], s17 offen offset:1024
  v_mfma_f32_16x16x32_bf16 v[48:51], a[152:155], a[40:43], v[48:51]
  ds_read_b128 a[144:147], v2 offset:28672
  v_mfma_f32_16x16x32_bf16 v[52:55], a[152:155], a[44:47], v[52:55]
  v_mfma_f32_16x16x32_bf16 v[56:59], a[156:159], a[40:43], v[56:59]
  ds_read_b128 a[148:151], v2 offset:29696
  buffer_load_dwordx4 a[112:115], v8, s[12:15], s17 offen offset:2048
  v_mfma_f32_16x16x32_bf16 v[60:63], a[156:159], a[44:47], v[60:63]
  ds_read_b128 a[152:155], v2 offset:30720
  s_waitcnt lgkmcnt(3)
  v_mfma_f32_16x16x32_bf16 v[32:35], a[128:131], a[48:51], v[32:35]
  buffer_load_dwordx4 a[116:119], v9, s[12:15], s17 offen offset:2048
  v_mfma_f32_16x16x32_bf16 v[36:39], a[128:131], a[52:55], v[36:39]
  ds_read_b128 a[156:159], v2 offset:31744
  v_mfma_f32_16x16x32_bf16 v[40:43], a[132:135], a[48:51], v[40:43]
  v_mfma_f32_16x16x32_bf16 v[44:47], a[132:135], a[52:55], v[44:47]
  buffer_load_dwordx4 a[120:123], v8, s[12:15], s17 offen offset:3072
  v_mfma_f32_16x16x32_bf16 v[48:51], a[136:139], a[48:51], v[48:51]
  v_mfma_f32_16x16x32_bf16 v[52:55], a[136:139], a[52:55], v[52:55]
  buffer_load_dwordx4 a[124:127], v9, s[12:15], s17 offen offset:3072
  s_add_u32 s17, s17, 4096
  v_mfma_f32_16x16x32_bf16 v[56:59], a[140:143], a[48:51], v[56:59]
  v_mfma_f32_16x16x32_bf16 v[60:63], a[140:143], a[52:55], v[60:63]
  s_waitcnt lgkmcnt(0)
  v_mfma_f32_16x16x32_bf16 v[32:35], a[144:147], a[56:59], v[32:35]
  s_waitcnt vmcnt(12) lgkmcnt(0)
  s_barrier
  v_mfma_f32_16x16x32_bf16 v[36:39], a[144:147], a[60:63], v[36:39]
  ds_read_b128 a[128:131], v2 offset:32768
  s_add_u32 m0, s18, 0
  v_mfma_f32_16x16x32_bf16 v[40:43], a[148:151], a[56:59], v[40:43]
  ds_read_b128 a[132:135], v2 offset:33792
  buffer_load_dwordx4 v4, s[8:11], s16 offen offset:0  lds
  v_mfma_f32_16x16x32_bf16 v[44:47], a[148:151], a[60:63], v[44:47]
  v_mfma_f32_16x16x32_bf16 v[48:51], a[152:155], a[56:59], v[48:51]
  ds_read_b128 a[136:139], v2 offset:34816
  buffer_load_dwordx4 v4, s[8:11], s16 offen offset:1024  lds
  v_mfma_f32_16x16x32_bf16 v[52:55], a[152:155], a[60:63], v[52:55]
  ds_read_b128 a[140:143], v2 offset:35840
  v_mfma_f32_16x16x32_bf16 v[56:59], a[156:159], a[56:59], v[56:59]
  v_mfma_f32_16x16x32_bf16 v[60:63], a[156:159], a[60:63], v[60:63]
  ds_read_b128 a[144:147], v2 offset:36864
  buffer_load_dwordx4 v4, s[8:11], s16 offen offset:2048  lds
  s_waitcnt lgkmcnt(3)
  v_mfma_f32_16x16x32_bf16 v[32:35], a[128:131], a[64:67], v[32:35]
  v_mfma_f32_16x16x32_bf16 v[36:39], a[128:131], a[68:71], v[36:39]
  ds_read_b128 a[148:151], v2 offset:37888
  buffer_load_dwordx4 v4, s[8:11], s16 offen offset:3072  lds
  s_add_u32 s16, s16, 16384
  v_mfma_f32_16x16x32_bf16 v[40:43], a[132:135], a[64:67], v[40:43]
  ds_read_b128 a[152:155], v2 offset:38912
  v_mfma_f32_16x16x32_bf16 v[44:47], a[132:135], a[68:71], v[44:47]
  s_waitcnt lgkmcnt(2)
  v_mfma_f32_16x16x32_bf16 v[48:51], a[136:139], a[64:67], v[48:51]
  ds_read_b128 a[156:159], v2 offset:39936
  buffer_load_dwordx4 a[0:3], v8, s[12:15], s17 offen offset:0
  v_mfma_f32_16x16x32_bf16 v[52:55], a[136:139], a[68:71], v[52:55]
  v_mfma_f32_16x16x32_bf16 v[56:59], a[140:143], a[64:67], v[56:59]
  ds_read_b128 a[128:131], v2 offset:40960
  buffer_load_dwordx4 a[4:7], v9, s[12:15], s17 offen offset:0
  v_mfma_f32_16x16x32_bf16 v[60:63], a[140:143], a[68:71], v[60:63]
  ds_read_b128 a[132:135], v2 offset:41984
  v_mfma_f32_16x16x32_bf16 v[32:35], a[144:147], a[72:75], v[32:35]
  v_mfma_f32_16x16x32_bf16 v[36:39], a[144:147], a[76:79], v[36:39]
  ds_read_b128 a[136:139], v2 offset:43008
  buffer_load_dwordx4 a[8:11], v8, s[12:15], s17 offen offset:1024
  s_waitcnt lgkmcnt(3)
  v_mfma_f32_16x16x32_bf16 v[40:43], a[148:151], a[72:75], v[40:43]
  ds_read_b128 a[140:143], v2 offset:44032
  v_mfma_f32_16x16x32_bf16 v[44:47], a[148:151], a[76:79], v[44:47]
  buffer_load_dwordx4 a[12:15], v9, s[12:15], s17 offen offset:1024
  v_mfma_f32_16x16x32_bf16 v[48:51], a[152:155], a[72:75], v[48:51]
  ds_read_b128 a[144:147], v2 offset:45056
  v_mfma_f32_16x16x32_bf16 v[52:55], a[152:155], a[76:79], v[52:55]
  v_mfma_f32_16x16x32_bf16 v[56:59], a[156:159], a[72:75], v[56:59]
  ds_read_b128 a[148:151], v2 offset:46080
  buffer_load_dwordx4 a[16:19], v8, s[12:15], s17 offen offset:2048
  v_mfma_f32_16x16x32_bf16 v[60:63], a[156:159], a[76:79], v[60:63]
  ds_read_b128 a[152:155], v2 offset:47104
  s_waitcnt lgkmcnt(3)
  v_mfma_f32_16x16x32_bf16 v[32:35], a[128:131], a[80:83], v[32:35]
  buffer_load_dwordx4 a[20:23], v9, s[12:15], s17 offen offset:2048
  v_mfma_f32_16x16x32_bf16 v[36:39], a[128:131], a[84:87], v[36:39]
  ds_read_b128 a[156:159], v2 offset:48128
  v_mfma_f32_16x16x32_bf16 v[40:43], a[132:135], a[80:83], v[40:43]
  v_mfma_f32_16x16x32_bf16 v[44:47], a[132:135], a[84:87], v[44:47]
  buffer_load_dwordx4 a[24:27], v8, s[12:15], s17 offen offset:3072
  v_mfma_f32_16x16x32_bf16 v[48:51], a[136:139], a[80:83], v[48:51]
  v_mfma_f32_16x16x32_bf16 v[52:55], a[136:139], a[84:87], v[52:55]
  buffer_load_dwordx4 a[28:31], v9, s[12:15], s17 offen offset:3072
  s_add_u32 s17, s17, 4096
  v_mfma_f32_16x16x32_bf16 v[56:59], a[140:143], a[80:83], v[56:59]
  v_mfma_f32_16x16x32_bf16 v[60:63], a[140:143], a[84:87], v[60:63]
  s_waitcnt lgkmcnt(0)
  v_mfma_f32_16x16x32_bf16 v[32:35], a[144:147], a[88:91], v[32:35]
  s_waitcnt vmcnt(12) lgkmcnt(0)
  s_barrier
  v_mfma_f32_16x16x32_bf16 v[36:39], a[144:147], a[92:95], v[36:39]
  ds_read_b128 a[128:131], v2 offset:49152
  s_add_u32 m0, s18, 16384
  v_mfma_f32_16x16x32_bf16 v[40:43], a[148:151], a[88:91], v[40:43]
  ds_read_b128 a[132:135], v2 offset:50176
  buffer_load_dwordx4 v4, s[8:11], s16 offen offset:0  lds
  v_mfma_f32_16x16x32_bf16 v[44:47], a[148:151], a[92:95], v[44:47]
  v_mfma_f32_16x16x32_bf16 v[48:51], a[152:155], a[88:91], v[48:51]
  ds_read_b128 a[136:139], v2 offset:51200
  buffer_load_dwordx4 v4, s[8:11], s16 offen offset:1024  lds
  v_mfma_f32_16x16x32_bf16 v[52:55], a[152:155], a[92:95], v[52:55]
  ds_read_b128 a[140:143], v2 offset:52224
  v_mfma_f32_16x16x32_bf16 v[56:59], a[156:159], a[88:91], v[56:59]
  v_mfma_f32_16x16x32_bf16 v[60:63], a[156:159], a[92:95], v[60:63]
  ds_read_b128 a[144:147], v2 offset:53248
  buffer_load_dwordx4 v4, s[8:11], s16 offen offset:2048  lds
  s_waitcnt lgkmcnt(3)
  v_mfma_f32_16x16x32_bf16 v[32:35], a[128:131], a[96:99], v[32:35]
  v_mfma_f32_16x16x32_bf16 v[36:39], a[128:131], a[100:103], v[36:39]
  ds_read_b128 a[148:151], v2 offset:54272
  buffer_load_dwordx4 v4, s[8:11], s16 offen offset:3072  lds
  s_add_u32 s16, s16, 16384
  v_mfma_f32_16x16x32_bf16 v[40:43], a[132:135], a[96:99], v[40:43]
  ds_read_b128 a[152:155], v2 offset:55296
  v_mfma_f32_16x16x32_bf16 v[44:47], a[132:135], a[100:103], v[44:47]
  s_waitcnt lgkmcnt(2)
  v_mfma_f32_16x16x32_bf16 v[48:51], a[136:139], a[96:99], v[48:51]
  ds_read_b128 a[156:159], v2 offset:56320
  buffer_load_dwordx4 a[32:35], v8, s[12:15], s17 offen offset:0
  v_mfma_f32_16x16x32_bf16 v[52:55], a[136:139], a[100:103], v[52:55]
  v_mfma_f32_16x16x32_bf16 v[56:59], a[140:143], a[96:99], v[56:59]
  ds_read_b128 a[128:131], v2 offset:57344
  buffer_load_dwordx4 a[36:39], v9, s[12:15], s17 offen offset:0
  v_mfma_f32_16x16x32_bf16 v[60:63], a[140:143], a[100:103], v[60:63]
  ds_read_b128 a[132:135], v2 offset:58368
  v_mfma_f32_16x16x32_bf16 v[32:35], a[144:147], a[104:107], v[32:35]
  v_mfma_f32_16x16x32_bf16 v[36:39], a[144:147], a[108:111], v[36:39]
  ds_read_b128 a[136:139], v2 offset:59392
  buffer_load_dwordx4 a[40:43], v8, s[12:15], s17 offen offset:1024
  s_waitcnt lgkmcnt(3)
  v_mfma_f32_16x16x32_bf16 v[40:43], a[148:151], a[104:107], v[40:43]
  ds_read_b128 a[140:143], v2 offset:60416
  v_mfma_f32_16x16x32_bf16 v[44:47], a[148:151], a[108:111], v[44:47]
  buffer_load_dwordx4 a[44:47], v9, s[12:15], s17 offen offset:1024
  v_mfma_f32_16x16x32_bf16 v[48:51], a[152:155], a[104:107], v[48:51]
  ds_read_b128 a[144:147], v2 offset:61440
  v_mfma_f32_16x16x32_bf16 v[52:55], a[152:155], a[108:111], v[52:55]
  v_mfma_f32_16x16x32_bf16 v[56:59], a[156:159], a[104:107], v[56:59]
  ds_read_b128 a[148:151], v2 offset:62464
  buffer_load_dwordx4 a[48:51], v8, s[12:15], s17 offen offset:2048
  v_mfma_f32_16x16x32_bf16 v[60:63], a[156:159], a[108:111], v[60:63]
  ds_read_b128 a[152:155], v2 offset:63488
  s_waitcnt lgkmcnt(3)
  v_mfma_f32_16x16x32_bf16 v[32:35], a[128:131], a[112:115], v[32:35]
  buffer_load_dwordx4 a[52:55], v9, s[12:15], s17 offen offset:2048
  v_mfma_f32_16x16x32_bf16 v[36:39], a[128:131], a[116:119], v[36:39]
  ds_read_b128 a[156:159], v2 offset:64512
  v_mfma_f32_16x16x32_bf16 v[40:43], a[132:135], a[112:115], v[40:43]
  v_mfma_f32_16x16x32_bf16 v[44:47], a[132:135], a[116:119], v[44:47]
  buffer_load_dwordx4 a[56:59], v8, s[12:15], s17 offen offset:3072
  v_mfma_f32_16x16x32_bf16 v[48:51], a[136:139], a[112:115], v[48:51]
  v_mfma_f32_16x16x32_bf16 v[52:55], a[136:139], a[116:119], v[52:55]
  buffer_load_dwordx4 a[60:63], v9, s[12:15], s17 offen offset:3072
  s_add_u32 s17, s17, 4096
  v_mfma_f32_16x16x32_bf16 v[56:59], a[140:143], a[112:115], v[56:59]
  v_mfma_f32_16x16x32_bf16 v[60:63], a[140:143], a[116:119], v[60:63]
  s_waitcnt lgkmcnt(0)
  v_mfma_f32_16x16x32_bf16 v[32:35], a[144:147], a[120:123], v[32:35]
  s_waitcnt vmcnt(12) lgkmcnt(0)
  s_barrier
  v_mfma_f32_16x16x32_bf16 v[36:39], a[144:147], a[124:127], v[36:39]
  ds_read_b128 a[128:131], v2 offset:0
  s_add_u32 m0, s18, 32768
  s_nop 0
  buffer_load_dwordx4 v4, s[8:11], s16 offen offset:0  lds
  v_mfma_f32_16x16x32_bf16 v[40:43], a[148:151], a[120:123], v[40:43]
  ds_read_b128 a[132:135], v2 offset:1024
  buffer_load_dwordx4 v4, s[8:11], s16 offen offset:1024  lds
  v_mfma_f32_16x16x32_bf16 v[44:47], a[148:151], a[124:127], v[44:47]
  v_mfma_f32_16x16x32_bf16 v[48:51], a[152:155], a[120:123], v[48:51]
  ds_read_b128 a[136:139], v2 offset:2048
  buffer_load_dwordx4 v4, s[8:11], s16 offen offset:2048  lds
  v_mfma_f32_16x16x32_bf16 v[52:55], a[152:155], a[124:127], v[52:55]
  ds_read_b128 a[140:143], v2 offset:3072
  buffer_load_dwordx4 v4, s[8:11], s16 offen offset:3072  lds
  s_add_u32 s16, s16, 16384
  v_mfma_f32_16x16x32_bf16 v[56:59], a[156:159], a[120:123], v[56:59]
  buffer_load_dwordx4 a[64:67], v8, s[12:15], s17 offen offset:0
  v_mfma_f32_16x16x32_bf16 v[60:63], a[156:159], a[124:127], v[60:63]
  ds_read_b128 a[144:147], v2 offset:4096
  buffer_load_dwordx4 a[68:71], v9, s[12:15], s17 offen offset:0
  s_waitcnt lgkmcnt(3)
  v_mfma_f32_16x16x32_bf16 v[32:35], a[128:131], a[0:3], v[32:35]
  buffer_load_dwordx4 a[72:75], v8, s[12:15], s17 offen offset:1024
  v_mfma_f32_16x16x32_bf16 v[36:39], a[128:131], a[4:7], v[36:39]
  ds_read_b128 a[148:151], v2 offset:5120
  v_mfma_f32_16x16x32_bf16 v[40:43], a[132:135], a[0:3], v[40:43]
  ds_read_b128 a[152:155], v2 offset:6144
  buffer_load_dwordx4 a[76:79], v9, s[12:15], s17 offen offset:1024
  v_mfma_f32_16x16x32_bf16 v[44:47], a[132:135], a[4:7], v[44:47]
  buffer_load_dwordx4 a[80:83], v8, s[12:15], s17 offen offset:2048
  s_waitcnt lgkmcnt(2)
  v_mfma_f32_16x16x32_bf16 v[48:51], a[136:139], a[0:3], v[48:51]
  ds_read_b128 a[156:159], v2 offset:7168
  buffer_load_dwordx4 a[84:87], v9, s[12:15], s17 offen offset:2048
  v_mfma_f32_16x16x32_bf16 v[52:55], a[136:139], a[4:7], v[52:55]
  buffer_load_dwordx4 a[88:91], v8, s[12:15], s17 offen offset:3072
  v_mfma_f32_16x16x32_bf16 v[56:59], a[140:143], a[0:3], v[56:59]
  ds_read_b128 a[128:131], v2 offset:8192
  buffer_load_dwordx4 a[92:95], v9, s[12:15], s17 offen offset:3072
  s_add_u32 s17, s17, 4096
  v_mfma_f32_16x16x32_bf16 v[60:63], a[140:143], a[4:7], v[60:63]
  ds_read_b128 a[132:135], v2 offset:9216
  v_mfma_f32_16x16x32_bf16 v[32:35], a[144:147], a[8:11], v[32:35]
  buffer_load_dword v31, v30, s[44:47], s58 offen
  s_mov_b32 m0, s57
  v_mfma_f32_16x16x32_bf16 v[36:39], a[144:147], a[12:15], v[36:39]
  ds_read_b128 a[136:139], v2 offset:10240
  buffer_load_dwordx4 v22, s[28:31], s36 offen offset:0 lds
  s_add_u32 s36, s36, 15360
  s_waitcnt lgkmcnt(3)
  v_mfma_f32_16x16x32_bf16 v[40:43], a[148:151], a[8:11], v[40:43]
  ds_read_b128 a[140:143], v2 offset:11264
  buffer_load_dwordx4 v22, s[28:31], s36 offen offset:1024 lds
  s_add_u32 s36, s36, 15360
  v_mfma_f32_16x16x32_bf16 v[44:47], a[148:151], a[12:15], v[44:47]
  buffer_load_dwordx4 v22, s[28:31], s36 offen offset:2048 lds
  s_add_u32 s36, s36, 15360
  v_mfma_f32_16x16x32_bf16 v[48:51], a[152:155], a[8:11], v[48:51]
  ds_read_b128 a[144:147], v2 offset:12288
  buffer_load_dwordx4 v22, s[28:31], s36 offen offset:3072 lds
  v_mfma_f32_16x16x32_bf16 v[52:55], a[152:155], a[12:15], v[52:55]
  v_mfma_f32_16x16x32_bf16 v[56:59], a[156:159], a[8:11], v[56:59]
  ds_read_b128 a[148:151], v2 offset:13312
  buffer_load_dword v96, v23, s[32:35], s38 offen sc1
  s_add_u32 s38, s38, 8192
  v_mfma_f32_16x16x32_bf16 v[60:63], a[156:159], a[12:15], v[60:63]
  ds_read_b128 a[152:155], v2 offset:14336
  buffer_load_dword v100, v23, s[32:35], s38 offen sc1
  s_add_u32 s38, s38, 8192
  s_waitcnt lgkmcnt(3)
  v_mfma_f32_16x16x32_bf16 v[32:35], a[128:131], a[16:19], v[32:35]
  buffer_load_dword v97, v23, s[32:35], s38 offen sc1
  s_add_u32 s38, s38, 8192
  v_mfma_f32_16x16x32_bf16 v[36:39], a[128:131], a[20:23], v[36:39]
  ds_read_b128 a[156:159], v2 offset:15360
  buffer_load_dword v101, v23, s[32:35], s38 offen sc1
  s_add_u32 s38, s38, 8192
  v_mfma_f32_16x16x32_bf16 v[40:43], a[132:135], a[16:19], v[40:43]
  buffer_load_dword v98, v23, s[32:35], s38 offen sc1
  v_mfma_f32_16x16x32_bf16 v[44:47], a[132:135], a[20:23], v[44:47]
  s_add_u32 s38, s38, 8192
  v_mfma_f32_16x16x32_bf16 v[48:51], a[136:139], a[16:19], v[48:51]
  buffer_load_dword v102, v23, s[32:35], s38 offen sc1
  s_add_u32 s38, s38, 8192
  v_mfma_f32_16x16x32_bf16 v[52:55], a[136:139], a[20:23], v[52:55]
  buffer_load_dword v99, v23, s[32:35], s38 offen sc1
  s_add_u32 s38, s38, 8192
  v_mfma_f32_16x16x32_bf16 v[56:59], a[140:143], a[16:19], v[56:59]
  buffer_load_dword v103, v23, s[32:35], s38 offen sc1
  v_mfma_f32_16x16x32_bf16 v[60:63], a[140:143], a[20:23], v[60:63]
  s_waitcnt lgkmcnt(0)
  v_mfma_f32_16x16x32_bf16 v[32:35], a[144:147], a[24:27], v[32:35]
  s_waitcnt vmcnt(25) lgkmcnt(0)
  s_barrier
  v_mfma_f32_16x16x32_bf16 v[36:39], a[144:147], a[28:31], v[36:39]
  ds_read_b128 a[128:131], v2 offset:16384
  s_add_u32 m0, s18, 49152
  v_mfma_f32_16x16x32_bf16 v[40:43], a[148:151], a[24:27], v[40:43]
  ds_read_b128 a[132:135], v2 offset:17408
  buffer_load_dwordx4 v4, s[8:11], s16 offen offset:0  lds
  v_mfma_f32_16x16x32_bf16 v[44:47], a[148:151], a[28:31], v[44:47]
  v_mfma_f32_16x16x32_bf16 v[48:51], a[152:155], a[24:27], v[48:51]
  ds_read_b128 a[136:139], v2 offset:18432
  buffer_load_dwordx4 v4, s[8:11], s16 offen offset:1024  lds
  v_mfma_f32_16x16x32_bf16 v[52:55], a[152:155], a[28:31], v[52:55]
  ds_read_b128 a[140:143], v2 offset:19456
  v_mfma_f32_16x16x32_bf16 v[56:59], a[156:159], a[24:27], v[56:59]
  v_mfma_f32_16x16x32_bf16 v[60:63], a[156:159], a[28:31], v[60:63]
  ds_read_b128 a[144:147], v2 offset:20480
  buffer_load_dwordx4 v4, s[8:11], s16 offen offset:2048  lds
  s_waitcnt lgkmcnt(3)
  v_mfma_f32_16x16x32_bf16 v[32:35], a[128:131], a[32:35], v[32:35]
  v_mfma_f32_16x16x32_bf16 v[36:39], a[128:131], a[36:39], v[36:39]
  ds_read_b128 a[148:151], v2 offset:21504
  buffer_load_dwordx4 v4, s[8:11], s16 offen offset:3072  lds
  s_add_u32 s16, s16, 16384
  v_mfma_f32_16x16x32_bf16 v[40:43], a[132:135], a[32:35], v[40:43]
  ds_read_b128 a[152:155], v2 offset:22528
  v_mfma_f32_16x16x32_bf16 v[44:47], a[132:135], a[36:39], v[44:47]
  s_waitcnt lgkmcnt(2)
  v_mfma_f32_16x16x32_bf16 v[48:51], a[136:139], a[32:35], v[48:51]
  ds_read_b128 a[156:159], v2 offset:23552
  buffer_load_dwordx4 a[96:99], v8, s[12:15], s17 offen offset:0
  v_mfma_f32_16x16x32_bf16 v[52:55], a[136:139], a[36:39], v[52:55]
  v_mfma_f32_16x16x32_bf16 v[56:59], a[140:143], a[32:35], v[56:59]
  ds_read_b128 a[128:131], v2 offset:24576
  buffer_load_dwordx4 a[100:103], v9, s[12:15], s17 offen offset:0
  v_mfma_f32_16x16x32_bf16 v[60:63], a[140:143], a[36:39], v[60:63]
  ds_read_b128 a[132:135], v2 offset:25600
  v_mfma_f32_16x16x32_bf16 v[32:35], a[144:147], a[40:43], v[32:35]
  v_mfma_f32_16x16x32_bf16 v[36:39], a[144:147], a[44:47], v[36:39]
  ds_read_b128 a[136:139], v2 offset:26624
  buffer_load_dwordx4 a[104:107], v8, s[12:15], s17 offen offset:1024
  s_waitcnt lgkmcnt(3)
  v_mfma_f32_16x16x32_bf16 v[40:43], a[148:151], a[40:43], v[40:43]
  ds_read_b128 a[140:143], v2 offset:27648
  v_mfma_f32_16x16x32_bf16 v[44:47], a[148:151], a[44:47], v[44:47]
  buffer_load_dwordx4 a[108:111], v9, s[12:15], s17 offen offset:1024
  v_mfma_f32_16x16x32_bf16 v[48:51], a[152:155], a[40:43], v[48:51]
  ds_read_b128 a[144:147], v2 offset:28672
  v_mfma_f32_16x16x32_bf16 v[52:55], a[152:155], a[44:47], v[52:55]
  v_mfma_f32_16x16x32_bf16 v[56:59], a[156:159], a[40:43], v[56:59]
  ds_read_b128 a[148:151], v2 offset:29696
  buffer_load_dwordx4 a[112:115], v8, s[12:15], s17 offen offset:2048
  v_mfma_f32_16x16x32_bf16 v[60:63], a[156:159], a[44:47], v[60:63]
  ds_read_b128 a[152:155], v2 offset:30720
  s_waitcnt lgkmcnt(3)
  v_mfma_f32_16x16x32_bf16 v[32:35], a[128:131], a[48:51], v[32:35]
  buffer_load_dwordx4 a[116:119], v9, s[12:15], s17 offen offset:2048
  v_mfma_f32_16x16x32_bf16 v[36:39], a[128:131], a[52:55], v[36:39]
  ds_read_b128 a[156:159], v2 offset:31744
  v_mfma_f32_16x16x32_bf16 v[40:43], a[132:135], a[48:51], v[40:43]
  v_mfma_f32_16x16x32_bf16 v[44:47], a[132:135], a[52:55], v[44:47]
  buffer_load_dwordx4 a[120:123], v8, s[12:15], s17 offen offset:3072
  v_mfma_f32_16x16x32_bf16 v[48:51], a[136:139], a[48:51], v[48:51]
  v_mfma_f32_16x16x32_bf16 v[52:55], a[136:139], a[52:55], v[52:55]
  buffer_load_dwordx4 a[124:127], v9, s[12:15], s17 offen offset:3072
  s_add_u32 s17, s17, 4096
  v_mfma_f32_16x16x32_bf16 v[56:59], a[140:143], a[48:51], v[56:59]
  v_mfma_f32_16x16x32_bf16 v[60:63], a[140:143], a[52:55], v[60:63]
  s_waitcnt lgkmcnt(0)
  v_mfma_f32_16x16x32_bf16 v[32:35], a[144:147], a[56:59], v[32:35]
  s_waitcnt vmcnt(25) lgkmcnt(0)
  s_barrier
  v_mfma_f32_16x16x32_bf16 v[36:39], a[144:147], a[60:63], v[36:39]
  ds_read_b128 a[128:131], v2 offset:32768
  v_mfma_f32_16x16x32_bf16 v[40:43], a[148:151], a[56:59], v[40:43]
  ds_read_b128 a[132:135], v2 offset:33792
  v_mfma_f32_16x16x32_bf16 v[44:47], a[148:151], a[60:63], v[44:47]
  v_mfma_f32_16x16x32_bf16 v[48:51], a[152:155], a[56:59], v[48:51]
  ds_read_b128 a[136:139], v2 offset:34816
  v_mfma_f32_16x16x32_bf16 v[52:55], a[152:155], a[60:63], v[52:55]
  ds_read_b128 a[140:143], v2 offset:35840
  v_mfma_f32_16x16x32_bf16 v[56:59], a[156:159], a[56:59], v[56:59]
  v_mfma_f32_16x16x32_bf16 v[60:63], a[156:159], a[60:63], v[60:63]
  ds_read_b128 a[144:147], v2 offset:36864
  s_waitcnt lgkmcnt(3)
  v_mfma_f32_16x16x32_bf16 v[32:35], a[128:131], a[64:67], v[32:35]
  v_mfma_f32_16x16x32_bf16 v[36:39], a[128:131], a[68:71], v[36:39]
  ds_read_b128 a[148:151], v2 offset:37888
  v_mfma_f32_16x16x32_bf16 v[40:43], a[132:135], a[64:67], v[40:43]
  ds_read_b128 a[152:155], v2 offset:38912
  v_mfma_f32_16x16x32_bf16 v[44:47], a[132:135], a[68:71], v[44:47]
  s_waitcnt lgkmcnt(2)
  v_mfma_f32_16x16x32_bf16 v[48:51], a[136:139], a[64:67], v[48:51]
  ds_read_b128 a[156:159], v2 offset:39936
  v_mfma_f32_16x16x32_bf16 v[52:55], a[136:139], a[68:71], v[52:55]
  v_mfma_f32_16x16x32_bf16 v[56:59], a[140:143], a[64:67], v[56:59]
  ds_read_b128 a[128:131], v2 offset:40960
  v_mfma_f32_16x16x32_bf16 v[60:63], a[140:143], a[68:71], v[60:63]
  ds_read_b128 a[132:135], v2 offset:41984
  v_mfma_f32_16x16x32_bf16 v[32:35], a[144:147], a[72:75], v[32:35]
  v_mfma_f32_16x16x32_bf16 v[36:39], a[144:147], a[76:79], v[36:39]
  ds_read_b128 a[136:139], v2 offset:43008
  s_waitcnt lgkmcnt(3)
  v_mfma_f32_16x16x32_bf16 v[40:43], a[148:151], a[72:75], v[40:43]
  ds_read_b128 a[140:143], v2 offset:44032
  v_mfma_f32_16x16x32_bf16 v[44:47], a[148:151], a[76:79], v[44:47]
  v_mfma_f32_16x16x32_bf16 v[48:51], a[152:155], a[72:75], v[48:51]
  ds_read_b128 a[144:147], v2 offset:45056
  v_mfma_f32_16x16x32_bf16 v[52:55], a[152:155], a[76:79], v[52:55]
  v_mfma_f32_16x16x32_bf16 v[56:59], a[156:159], a[72:75], v[56:59]
  ds_read_b128 a[148:151], v2 offset:46080
  v_mfma_f32_16x16x32_bf16 v[60:63], a[156:159], a[76:79], v[60:63]
  ds_read_b128 a[152:155], v2 offset:47104
  s_waitcnt lgkmcnt(3)
  v_mfma_f32_16x16x32_bf16 v[32:35], a[128:131], a[80:83], v[32:35]
  v_mfma_f32_16x16x32_bf16 v[36:39], a[128:131], a[84:87], v[36:39]
  ds_read_b128 a[156:159], v2 offset:48128
  v_mfma_f32_16x16x32_bf16 v[40:43], a[132:135], a[80:83], v[40:43]
  v_mfma_f32_16x16x32_bf16 v[44:47], a[132:135], a[84:87], v[44:47]
  v_mfma_f32_16x16x32_bf16 v[48:51], a[136:139], a[80:83], v[48:51]
  v_mfma_f32_16x16x32_bf16 v[52:55], a[136:139], a[84:87], v[52:55]
  v_mfma_f32_16x16x32_bf16 v[56:59], a[140:143], a[80:83], v[56:59]
  v_mfma_f32_16x16x32_bf16 v[60:63], a[140:143], a[84:87], v[60:63]
  s_waitcnt lgkmcnt(0)
  v_mfma_f32_16x16x32_bf16 v[32:35], a[144:147], a[88:91], v[32:35]
  s_waitcnt vmcnt(0) lgkmcnt(0)
  s_barrier
  v_mfma_f32_16x16x32_bf16 v[36:39], a[144:147], a[92:95], v[36:39]
  ds_read_b128 a[128:131], v2 offset:49152
  v_mfma_f32_16x16x32_bf16 v[40:43], a[148:151], a[88:91], v[40:43]
  v_mfma_f32_16x16x32_bf16 v[44:47], a[148:151], a[92:95], v[44:47]
  ds_read_b128 a[132:135], v2 offset:50176
  v_mfma_f32_16x16x32_bf16 v[48:51], a[152:155], a[88:91], v[48:51]
  v_mfma_f32_16x16x32_bf16 v[52:55], a[152:155], a[92:95], v[52:55]
  ds_read_b128 a[136:139], v2 offset:51200
  v_mfma_f32_16x16x32_bf16 v[56:59], a[156:159], a[88:91], v[56:59]
  v_mfma_f32_16x16x32_bf16 v[60:63], a[156:159], a[92:95], v[60:63]
  ds_read_b128 a[140:143], v2 offset:52224
  s_waitcnt lgkmcnt(2)
  v_mfma_f32_16x16x32_bf16 v[32:35], a[128:131], a[96:99], v[32:35]
  v_add_f32 v96, v96, v97
  v_add_f32 v98, v98, v99
  v_add_f32 v96, v96, v98
  v_mfma_f32_16x16x32_bf16 v[36:39], a[128:131], a[100:103], v[36:39]
  ds_read_b128 a[144:147], v2 offset:53248
  v_cvt_pk_bf16_f32 v96, v96, v96
  v_lshlrev_b32 v96, 16, v96
  v_mfma_f32_16x16x32_bf16 v[40:43], a[132:135], a[96:99], v[40:43]
  ds_write_b32 v29, v96 offset:4096
  v_add_f32 v100, v100, v101
  v_mfma_f32_16x16x32_bf16 v[44:47], a[132:135], a[100:103], v[44:47]
  ds_read_b128 a[148:151], v2 offset:54272
  v_add_f32 v102, v102, v103
  v_add_f32 v100, v100, v102
  s_waitcnt lgkmcnt(3)
  v_mfma_f32_16x16x32_bf16 v[48:51], a[136:139], a[96:99], v[48:51]
  v_cvt_pk_bf16_f32 v100, v100, v100
  v_lshlrev_b32 v100, 16, v100
  v_mfma_f32_16x16x32_bf16 v[52:55], a[136:139], a[100:103], v[52:55]
  ds_read_b128 a[152:155], v2 offset:55296
  v_add_f32 v100, 1.0, v100
  v_cvt_pk_bf16_f32 v100, v100, v100
  v_mfma_f32_16x16x32_bf16 v[56:59], a[140:143], a[96:99], v[56:59]
  v_lshlrev_b32 v100, 16, v100
  ds_write_b32 v29, v100 offset:4352
  v_mfma_f32_16x16x32_bf16 v[60:63], a[140:143], a[100:103], v[60:63]
  ds_read_b128 a[156:159], v2 offset:56320
  ds_read_b64 v[64:65], v24 offset:0
  ds_read_b64 v[66:67], v25 offset:0
  s_waitcnt lgkmcnt(5)
  v_mfma_f32_16x16x32_bf16 v[32:35], a[144:147], a[104:107], v[32:35]
  ds_read_b64 v[68:69], v26 offset:0
  ds_read_b64 v[70:71], v27 offset:0
  v_mfma_f32_16x16x32_bf16 v[36:39], a[144:147], a[108:111], v[36:39]
  ds_read_b128 a[128:131], v2 offset:57344
  ds_read_b64 v[72:73], v24 offset:2048
  ds_read_b64 v[74:75], v25 offset:2048
  v_mfma_f32_16x16x32_bf16 v[40:43], a[148:151], a[104:107], v[40:43]
  ds_read_b64 v[76:77], v26 offset:2048
  ds_read_b64 v[78:79], v27 offset:2048
  v_mfma_f32_16x16x32_bf16 v[44:47], a[148:151], a[108:111], v[44:47]
  ds_read_b128 a[132:135], v2 offset:58368
  ds_read_b128 v[80:83], v28 offset:4096
  ds_read_b128 v[84:87], v28 offset:4160
  s_waitcnt lgkmcnt(10)
  v_mfma_f32_16x16x32_bf16 v[48:51], a[152:155], a[104:107], v[48:51]
  ds_read_b128 v[88:91], v28 offset:4224
  ds_read_b128 v[92:95], v28 offset:4288
  v_mfma_f32_16x16x32_bf16 v[52:55], a[152:155], a[108:111], v[52:55]
  ds_read_b128 a[136:139], v2 offset:59392
  s_waitcnt lgkmcnt(4)
  ds_read_b128 v[96:99], v28 offset:4352
  v_mfma_f32_16x16x32_bf16 v[56:59], a[156:159], a[104:107], v[56:59]
  ds_read_b128 v[100:103], v28 offset:4416
  ds_read_b128 v[104:107], v28 offset:4480
  v_mfma_f32_16x16x32_bf16 v[60:63], a[156:159], a[108:111], v[60:63]
  ds_read_b128 a[140:143], v2 offset:60416
  ds_read_b128 v[108:111], v28 offset:4544
  s_waitcnt lgkmcnt(0)
  v_mfma_f32_16x16x32_bf16 v[32:35], a[128:131], a[112:115], v[32:35]
  v_lshlrev_b32 v128, 16, v64
  v_and_b32 v129, 0xffff0000, v64
  v_mfma_f32_16x16x32_bf16 v[36:39], a[128:131], a[116:119], v[36:39]
  ds_read_b128 a[144:147], v2 offset:61440
  v_lshlrev_b32 v130, 16, v65
  v_and_b32 v131, 0xffff0000, v65
  v_mfma_f32_16x16x32_bf16 v[40:43], a[132:135], a[112:115], v[40:43]
  v_lshlrev_b32 v132, 16, v66
  v_and_b32 v133, 0xffff0000, v66
  v_mfma_f32_16x16x32_bf16 v[44:47], a[132:135], a[116:119], v[44:47]
  ds_read_b128 a[148:151], v2 offset:62464
  v_lshlrev_b32 v134, 16, v67
  v_and_b32 v135, 0xffff0000, v67
  v_mfma_f32_16x16x32_bf16 v[48:51], a[136:139], a[112:115], v[48:51]
  v_lshlrev_b32 v136, 16, v68
  v_and_b32 v137, 0xffff0000, v68
  v_mfma_f32_16x16x32_bf16 v[52:55], a[136:139], a[116:119], v[52:55]
  ds_read_b128 a[152:155], v2 offset:63488
  v_lshlrev_b32 v138, 16, v69
  v_and_b32 v139, 0xffff0000, v69
  v_mfma_f32_16x16x32_bf16 v[56:59], a[140:143], a[112:115], v[56:59]
  v_lshlrev_b32 v140, 16, v70
  v_and_b32 v141, 0xffff0000, v70
  v_mfma_f32_16x16x32_bf16 v[60:63], a[140:143], a[116:119], v[60:63]
  ds_read_b128 a[156:159], v2 offset:64512
  v_lshlrev_b32 v142, 16, v71
  v_and_b32 v143, 0xffff0000, v71
  s_waitcnt lgkmcnt(2)
  v_mfma_f32_16x16x32_bf16 v[32:35], a[144:147], a[120:123], v[32:35]
  v_lshlrev_b32 v144, 16, v72
  v_and_b32 v145, 0xffff0000, v72
  v_mfma_f32_16x16x32_bf16 v[36:39], a[144:147], a[124:127], v[36:39]
  v_lshlrev_b32 v146, 16, v73
  v_and_b32 v147, 0xffff0000, v73
  v_mfma_f32_16x16x32_bf16 v[40:43], a[148:151], a[120:123], v[40:43]
  v_lshlrev_b32 v148, 16, v74
  v_and_b32 v149, 0xffff0000, v74
  v_mfma_f32_16x16x32_bf16 v[44:47], a[148:151], a[124:127], v[44:47]
  v_lshlrev_b32 v150, 16, v75
  v_and_b32 v151, 0xffff0000, v75
  s_waitcnt lgkmcnt(0)
  v_mfma_f32_16x16x32_bf16 v[48:51], a[152:155], a[120:123], v[48:51]
  v_lshlrev_b32 v152, 16, v76
  v_and_b32 v153, 0xffff0000, v76
  v_mfma_f32_16x16x32_bf16 v[52:55], a[152:155], a[124:127], v[52:55]
  v_lshlrev_b32 v154, 16, v77
  v_and_b32 v155, 0xffff0000, v77
  v_mfma_f32_16x16x32_bf16 v[56:59], a[156:159], a[120:123], v[56:59]
  v_lshlrev_b32 v156, 16, v78
  v_and_b32 v157, 0xffff0000, v78
  v_mfma_f32_16x16x32_bf16 v[60:63], a[156:159], a[124:127], v[60:63]
  v_lshlrev_b32 v158, 16, v79
  v_and_b32 v159, 0xffff0000, v79
L_wo_epi:
  s_barrier
  s_and_b32 s21, s23, 1
  s_lshl_b32 s21, s21, 2
  s_and_b32 s25, s24, 3
  s_add_u32 s21, s21, s25
  s_lshr_b32 s22, s23, 1
  s_lshl_b32 s22, s22, 3
  s_lshr_b32 s25, s24, 2
  s_add_u32 s22, s22, s25
  s_lshl_b32 s25, s21, 4
  s_lshl_b32 s26, s20, 2
  s_add_u32 s26, s26, s25
  s_and_b32 s27, s22, 1
  s_mul_i32 s33, s20, 222208
  s_mul_i32 s18, s20, 7168
  s_mul_i32 s16, s22, 7168
  s_add_u32 s16, s16, s18
  s_mul_i32 s25, s26, 32768
  s_add_u32 s25, s25, 26214400
  s_mov_b32 s17, 0
  s_add_u32 s16, s16, s33
  s_waitcnt lgkmcnt(0)
  s_add_u32 s8, s4, 0x3300000
  s_addc_u32 s9, s5, 0
  s_mov_b32 s10, 0xe00000
  s_mov_b32 s11, 0x20000
  s_add_u32 s12, s4, s25
  s_addc_u32 s13, s5, 0
  s_mov_b32 s14, 0x20000
  s_mov_b32 s15, 0x20000
  s_nop 7
  v_pk_fma_f32 v[128:129], v[32:33], v[80:81], v[128:129]
  v_pk_fma_f32 v[130:131], v[34:35], v[82:83], v[130:131]
  v_pk_fma_f32 v[132:133], v[40:41], v[84:85], v[132:133]
  v_pk_fma_f32 v[134:135], v[42:43], v[86:87], v[134:135]
  v_pk_fma_f32 v[136:137], v[48:49], v[88:89], v[136:137]
  v_pk_fma_f32 v[138:139], v[50:51], v[90:91], v[138:139]
  v_pk_fma_f32 v[140:141], v[56:57], v[92:93], v[140:141]
  v_pk_fma_f32 v[142:143], v[58:59], v[94:95], v[142:143]
  v_cvt_pk_bf16_f32 v112, v128, v129
  v_cvt_pk_bf16_f32 v113, v130, v131
  v_cvt_pk_bf16_f32 v114, v132, v133
  v_cvt_pk_bf16_f32 v115, v134, v135
  v_cvt_pk_bf16_f32 v116, v136, v137
  v_cvt_pk_bf16_f32 v117, v138, v139
  v_cvt_pk_bf16_f32 v118, v140, v141
  v_cvt_pk_bf16_f32 v119, v142, v143
  v_lshlrev_b32 v128, 16, v112
  v_and_b32 v129, 0xffff0000, v112
  v_lshlrev_b32 v130, 16, v113
  v_and_b32 v131, 0xffff0000, v113
  v_lshlrev_b32 v132, 16, v114
  v_and_b32 v133, 0xffff0000, v114
  v_lshlrev_b32 v134, 16, v115
  v_and_b32 v135, 0xffff0000, v115
  v_lshlrev_b32 v136, 16, v116
  v_and_b32 v137, 0xffff0000, v116
  v_lshlrev_b32 v138, 16, v117
  v_and_b32 v139, 0xffff0000, v117
  v_lshlrev_b32 v140, 16, v118
  v_and_b32 v141, 0xffff0000, v118
  v_lshlrev_b32 v142, 16, v119
  v_and_b32 v143, 0xffff0000, v119
  v_pk_mul_f32 v[160:161], v[128:129], v[96:97]
  v_pk_mul_f32 v[162:163], v[130:131], v[98:99]
  v_pk_mul_f32 v[164:165], v[132:133], v[100:101]
  v_pk_mul_f32 v[166:167], v[134:135], v[102:103]
  v_pk_mul_f32 v[168:169], v[136:137], v[104:105]
  v_pk_mul_f32 v[170:171], v[138:139], v[106:107]
  v_pk_mul_f32 v[172:173], v[140:141], v[108:109]
  v_pk_mul_f32 v[174:175], v[142:143], v[110:111]
  v_cvt_pk_bf16_f32 v64, v160, v161
  v_cvt_pk_bf16_f32 v65, v162, v163
  v_cvt_pk_bf16_f32 v66, v164, v165
  v_cvt_pk_bf16_f32 v67, v166, v167
  v_cvt_pk_bf16_f32 v68, v168, v169
  v_cvt_pk_bf16_f32 v69, v170, v171
  v_cvt_pk_bf16_f32 v70, v172, v173
  v_cvt_pk_bf16_f32 v71, v174, v175
  buffer_store_dwordx4 v[64:67], v2, s[40:43], s54 offen offset:0 sc1
  buffer_store_dwordx4 v[68:71], v2, s[40:43], s54 offen offset:1024 sc1
  v_pk_fma_f32 v[144:145], v[36:37], v[80:81], v[144:145]
  v_pk_fma_f32 v[146:147], v[38:39], v[82:83], v[146:147]
  v_pk_fma_f32 v[148:149], v[44:45], v[84:85], v[148:149]
  v_pk_fma_f32 v[150:151], v[46:47], v[86:87], v[150:151]
  v_pk_fma_f32 v[152:153], v[52:53], v[88:89], v[152:153]
  v_pk_fma_f32 v[154:155], v[54:55], v[90:91], v[154:155]
  v_pk_fma_f32 v[156:157], v[60:61], v[92:93], v[156:157]
  v_pk_fma_f32 v[158:159], v[62:63], v[94:95], v[158:159]
  v_cvt_pk_bf16_f32 v120, v144, v145
  v_cvt_pk_bf16_f32 v121, v146, v147
  v_cvt_pk_bf16_f32 v122, v148, v149
  v_cvt_pk_bf16_f32 v123, v150, v151
  v_cvt_pk_bf16_f32 v124, v152, v153
  v_cvt_pk_bf16_f32 v125, v154, v155
  v_cvt_pk_bf16_f32 v126, v156, v157
  v_cvt_pk_bf16_f32 v127, v158, v159
  v_lshlrev_b32 v144, 16, v120
  v_and_b32 v145, 0xffff0000, v120
  v_lshlrev_b32 v146, 16, v121
  v_and_b32 v147, 0xffff0000, v121
  v_lshlrev_b32 v148, 16, v122
  v_and_b32 v149, 0xffff0000, v122
  v_lshlrev_b32 v150, 16, v123
  v_and_b32 v151, 0xffff0000, v123
  v_lshlrev_b32 v152, 16, v124
  v_and_b32 v153, 0xffff0000, v124
  v_lshlrev_b32 v154, 16, v125
  v_and_b32 v155, 0xffff0000, v125
  v_lshlrev_b32 v156, 16, v126
  v_and_b32 v157, 0xffff0000, v126
  v_lshlrev_b32 v158, 16, v127
  v_and_b32 v159, 0xffff0000, v127
  v_pk_mul_f32 v[176:177], v[144:145], v[96:97]
  v_pk_mul_f32 v[178:179], v[146:147], v[98:99]
  v_pk_mul_f32 v[180:181], v[148:149], v[100:101]
  v_pk_mul_f32 v[182:183], v[150:151], v[102:103]
  v_pk_mul_f32 v[184:185], v[152:153], v[104:105]
  v_pk_mul_f32 v[186:187], v[154:155], v[106:107]
  v_pk_mul_f32 v[188:189], v[156:157], v[108:109]
  v_pk_mul_f32 v[190:191], v[158:159], v[110:111]
  v_cvt_pk_bf16_f32 v72, v176, v177
  v_cvt_pk_bf16_f32 v73, v178, v179
  v_cvt_pk_bf16_f32 v74, v180, v181
  v_cvt_pk_bf16_f32 v75, v182, v183
  v_cvt_pk_bf16_f32 v76, v184, v185
  v_cvt_pk_bf16_f32 v77, v186, v187
  v_cvt_pk_bf16_f32 v78, v188, v189
  v_cvt_pk_bf16_f32 v79, v190, v191
  buffer_store_dwordx4 v[72:75], v2, s[40:43], s55 offen offset:0 sc1
  buffer_store_dwordx4 v[76:79], v2, s[40:43], s55 offen offset:1024 sc1
  v_pk_add_f32 v[32:33], v[128:129], v[136:137]
  v_pk_add_f32 v[34:35], v[130:131], v[138:139]
  v_pk_add_f32 v[36:37], v[132:133], v[140:141]
  v_pk_add_f32 v[38:39], v[134:135], v[142:143]
  v_pk_add_f32 v[40:41], v[144:145], v[152:153]
  v_pk_add_f32 v[42:43], v[146:147], v[154:155]
  v_pk_add_f32 v[44:45], v[148:149], v[156:157]
  v_pk_add_f32 v[46:47], v[150:151], v[158:159]
  v_pk_add_f32 v[32:33], v[32:33], v[36:37]
  v_pk_add_f32 v[34:35], v[34:35], v[38:39]
  v_pk_add_f32 v[40:41], v[40:41], v[44:45]
  v_pk_add_f32 v[42:43], v[42:43], v[46:47]
  v_pk_add_f32 v[32:33], v[32:33], v[34:35]
  v_pk_add_f32 v[40:41], v[40:41], v[42:43]
  v_add_f32 v8, v32, v33
  v_add_f32 v10, v40, v41
  v_mov_b32 v12, v8
  v_mov_b32 v13, v10
  s_nop 1
  v_permlane16_swap_b32 v8, v12
  v_permlane16_swap_b32 v10, v13
  s_nop 1
  v_add_f32 v8, v8, v12
  v_add_f32 v10, v10, v13
  v_mov_b32 v12, v8
  v_mov_b32 v13, v10
  s_nop 1
  v_permlane32_swap_b32 v8, v12
  v_permlane32_swap_b32 v10, v13
  s_nop 1
  v_add_f32 v8, v8, v12
  v_add_f32 v10, v10, v13
  v_mul_f32 v8, 0x3c800000, v8
  v_mul_f32 v10, 0x3c800000, v10
  v_pk_add_f32 v[128:129], v[128:129], v[8:9] op_sel_hi:[1,0] neg_lo:[0,1] neg_hi:[0,1]
  v_pk_add_f32 v[130:131], v[130:131], v[8:9] op_sel_hi:[1,0] neg_lo:[0,1] neg_hi:[0,1]
  v_pk_add_f32 v[132:133], v[132:133], v[8:9] op_sel_hi:[1,0] neg_lo:[0,1] neg_hi:[0,1]
  v_pk_add_f32 v[134:135], v[134:135], v[8:9] op_sel_hi:[1,0] neg_lo:[0,1] neg_hi:[0,1]
  v_pk_add_f32 v[136:137], v[136:137], v[8:9] op_sel_hi:[1,0] neg_lo:[0,1] neg_hi:[0,1]
  v_pk_add_f32 v[138:139], v[138:139], v[8:9] op_sel_hi:[1,0] neg_lo:[0,1] neg_hi:[0,1]
  v_pk_add_f32 v[140:141], v[140:141], v[8:9] op_sel_hi:[1,0] neg_lo:[0,1] neg_hi:[0,1]
  v_pk_add_f32 v[142:143], v[142:143], v[8:9] op_sel_hi:[1,0] neg_lo:[0,1] neg_hi:[0,1]
  v_pk_add_f32 v[144:145], v[144:145], v[10:11] op_sel_hi:[1,0] neg_lo:[0,1] neg_hi:[0,1]
  v_pk_add_f32 v[146:147], v[146:147], v[10:11] op_sel_hi:[1,0] neg_lo:[0,1] neg_hi:[0,1]
  v_pk_add_f32 v[148:149], v[148:149], v[10:11] op_sel_hi:[1,0] neg_lo:[0,1] neg_hi:[0,1]
  v_pk_add_f32 v[150:151], v[150:151], v[10:11] op_sel_hi:[1,0] neg_lo:[0,1] neg_hi:[0,1]
  v_pk_add_f32 v[152:153], v[152:153], v[10:11] op_sel_hi:[1,0] neg_lo:[0,1] neg_hi:[0,1]
  v_pk_add_f32 v[154:155], v[154:155], v[10:11] op_sel_hi:[1,0] neg_lo:[0,1] neg_hi:[0,1]
  v_pk_add_f32 v[156:157], v[156:157], v[10:11] op_sel_hi:[1,0] neg_lo:[0,1] neg_hi:[0,1]
  v_pk_add_f32 v[158:159], v[158:159], v[10:11] op_sel_hi:[1,0] neg_lo:[0,1] neg_hi:[0,1]
  v_pk_mul_f32 v[32:33], v[128:129], v[128:129]
  v_pk_mul_f32 v[34:35], v[130:131], v[130:131]
  v_pk_mul_f32 v[40:41], v[144:145], v[144:145]
  v_pk_mul_f32 v[42:43], v[146:147], v[146:147]
  v_pk_fma_f32 v[32:33], v[132:133], v[132:133], v[32:33]
  v_pk_fma_f32 v[34:35], v[134:135], v[134:135], v[34:35]
  v_pk_fma_f32 v[40:41], v[148:149], v[148:149], v[40:41]
  v_pk_fma_f32 v[42:43], v[150:151], v[150:151], v[42:43]
  v_pk_fma_f32 v[32:33], v[136:137], v[136:137], v[32:33]
  v_pk_fma_f32 v[34:35], v[138:139], v[138:139], v[34:35]
  v_pk_fma_f32 v[40:41], v[152:153], v[152:153], v[40:41]
  v_pk_fma_f32 v[42:43], v[154:155], v[154:155], v[42:43]
  v_pk_fma_f32 v[32:33], v[140:141], v[140:141], v[32:33]
  v_pk_fma_f32 v[34:35], v[142:143], v[142:143], v[34:35]
  v_pk_fma_f32 v[40:41], v[156:157], v[156:157], v[40:41]
  v_pk_fma_f32 v[42:43], v[158:159], v[158:159], v[42:43]
  v_pk_add_f32 v[32:33], v[32:33], v[34:35]
  v_pk_add_f32 v[40:41], v[40:41], v[42:43]
  v_add_f32 v9, v32, v33
  v_add_f32 v11, v40, v41
  v_mov_b32 v12, v9
  v_mov_b32 v13, v11
  s_nop 1
  v_permlane16_swap_b32 v9, v12
  v_permlane16_swap_b32 v11, v13
  s_nop 1
  v_add_f32 v9, v9, v12
  v_add_f32 v11, v11, v13
  v_mov_b32 v12, v9
  v_mov_b32 v13, v11
  s_nop 1
  v_permlane32_swap_b32 v9, v12
  v_permlane32_swap_b32 v11, v13
  s_nop 1
  v_add_f32 v9, v9, v12
  v_add_f32 v11, v11, v13
  v_cmp_gt_u32 vcc, 16, v0
  s_nop 1
  v_cndmask_b32 v8, v10, v8, vcc
  v_cndmask_b32 v9, v11, v9, vcc
  v_lshlrev_b32 v12, 3, v0
  v_cmp_gt_u32 vcc, 32, v0
  s_and_saveexec_b64 s[52:53], vcc
  buffer_store_dwordx2 v[8:9], v12, s[48:51], s56 offen sc1
  s_mov_b64 exec, -1
  v_accvgpr_write_b32 a212, v112
  v_accvgpr_write_b32 a213, v113
  v_accvgpr_write_b32 a214, v114
  v_accvgpr_write_b32 a215, v115
  v_accvgpr_write_b32 a216, v116
  v_accvgpr_write_b32 a217, v117
  v_accvgpr_write_b32 a218, v118
  v_accvgpr_write_b32 a219, v119
  v_accvgpr_write_b32 a220, v120
  v_accvgpr_write_b32 a221, v121
  v_accvgpr_write_b32 a222, v122
  v_accvgpr_write_b32 a223, v123
  v_accvgpr_write_b32 a224, v124
  v_accvgpr_write_b32 a225, v125
  v_accvgpr_write_b32 a226, v126
  v_accvgpr_write_b32 a227, v127
  v_add_u32 v8, 0, v2
  v_add_u32 v9, 32768, v2
  v_add_u32 v10, 65536, v2
  v_add_u32 v11, 98304, v2
  s_add_u32 s36, s4, 0x40000
  s_addc_u32 s37, s5, 0
  s_mov_b32 s38, 0x40000
  s_mov_b32 s39, 0x20000
  s_add_u32 s40, s4, 0x80000
  s_addc_u32 s41, s5, 0
  s_mov_b32 s42, 0x38000
  s_mov_b32 s43, 0x20000
  s_add_u32 s44, s4, 0x1d00000
  s_addc_u32 s45, s5, 0
  s_mov_b32 s46, 0xe00000
  s_mov_b32 s47, 0x20000
  v_lshrrev_b32 v30, 4, v0
  v_lshlrev_b32 v30, 16, v30
  v_and_b32 v25, 15, v0
  v_lshl_add_u32 v30, v25, 3, v30
  s_lshl_b32 s58, s26, 7
  s_add_u32 s59, s58, 16384
  s_add_u32 s60, s59, 16384
  s_add_u32 s61, s60, 16384
  s_lshl_b32 s33, s27, 2
  v_add_u32 v25, s33, v0
  v_subrev_u32 v26, 28, v25
  v_min_u32 v25, v25, v26
  v_lshlrev_b32 v31, 4, v25
  s_mul_i32 s62, s20, 14336
  s_mul_i32 s33, s22, 448
  s_add_u32 s62, s62, s33
  s_add_u32 s63, s62, 57344
  s_add_u32 s64, s63, 57344
  s_add_u32 s65, s64, 57344
  s_lshl_b32 s33, s20, 10
  s_add_u32 s33, s33, 114688
  v_add_u32 v12, s33, v2
  s_mul_i32 s32, s22, 7
  s_add_u32 s32, s32, 1
  s_lshr_b32 s32, s32, 1
  s_lshl_b32 s32, s32, 10
  s_mul_i32 s33, s26, 114688
  s_add_u32 s48, s32, s33
  s_add_u32 s49, s48, 114688
  s_add_u32 s50, s49, 114688
  s_add_u32 s51, s50, 114688
  s_movk_i32 s33, 3072
  s_cmp_eq_u32 s27, 1
  s_cselect_b32 s32, 0xfffffe00, s33
  s_add_u32 s52, s48, s32
  s_add_u32 s53, s50, s32
  s_mov_b32 s56, 0xc0135761
  s_mov_b32 s57, 0xbdd2d3e8
  s_add_u32 s72, s4, 0xc0000
  s_addc_u32 s73, s5, 0
  s_mov_b32 s74, 0x20000
  s_mov_b32 s75, 0x20000
  v_bfe_u32 v14, v0, 1, 3
  v_lshlrev_b32 v14, 5, v14
  v_bfe_u32 v15, v0, 4, 1
  v_add_u32 v14, v14, v15
  v_and_b32 v15, 1, v0
  v_lshl_add_u32 v14, v14, 2, v15
  s_lshl_b32 s76, s21, 1
  s_lshr_b32 s77, s20, 1
  s_add_u32 s76, s76, s77
  s_lshr_b32 s77, s76, 2
  s_lshl_b32 s77, s77, 1
  s_and_b32 s76, s76, 3
  s_lshl_b32 s76, s76, 3
  s_add_u32 s76, s76, s77
  s_lshl_b32 s76, s76, 2
  s_and_b32 s77, s20, 1
  s_lshl_b32 s77, s77, 1
  s_add_u32 s76, s76, s77
  v_add_u32 v14, s76, v14
  v_lshlrev_b32 v14, 7, v14
  s_lshl_b32 s76, s2, 2
  s_add_u32 s76, s76, s20
  s_lshl_b32 s76, s76, 7
  v_mov_b32 v13, 0
  v_mov_b32 v15, 1
  s_mov_b32 s77, 0x100000
  s_waitcnt vmcnt(0)
  buffer_store_dword v15, v13, s[72:75], s76 offen sc1
  s_add_u32 m0, s18, 0
  s_nop 0
  buffer_load_dwordx4 v4, s[8:11], s16 offen offset:0  lds
  buffer_load_dwordx4 v4, s[8:11], s16 offen offset:1024  lds
  buffer_load_dwordx4 v4, s[8:11], s16 offen offset:2048  lds
  buffer_load_dwordx4 v4, s[8:11], s16 offen offset:3072  lds
  s_add_u32 m0, s18, 4096
  s_nop 0
  buffer_load_dwordx4 v5, s[8:11], s16 offen offset:0  lds
  buffer_load_dwordx4 v5, s[8:11], s16 offen offset:1024  lds
  buffer_load_dwordx4 v5, s[8:11], s16 offen offset:2048  lds
  s_add_u32 s16, s16, 917504
  s_add_u32 m0, s18, 28672
  s_nop 0
  buffer_load_dwordx4 v4, s[8:11], s16 offen offset:0  lds
  buffer_load_dwordx4 v4, s[8:11], s16 offen offset:1024  lds
  buffer_load_dwordx4 v4, s[8:11], s16 offen offset:2048  lds
  buffer_load_dwordx4 v4, s[8:11], s16 offen offset:3072  lds
  s_add_u32 m0, s18, 32768
  s_nop 0
  buffer_load_dwordx4 v5, s[8:11], s16 offen offset:0  lds
  buffer_load_dwordx4 v5, s[8:11], s16 offen offset:1024  lds
  buffer_load_dwordx4 v5, s[8:11], s16 offen offset:2048  lds
  s_add_u32 s16, s16, 917504
L_poll_36:
  buffer_load_dword v13, v14, s[72:75], 0 offen sc1
  s_waitcnt vmcnt(0)
  v_cmp_ne_u32 vcc, 1, v13
  s_nop 1
  s_sub_u32 s77, s77, 1
  s_cselect_b64 s[78:79], 0, vcc
  s_cmp_lg_u64 s[78:79], 0
  s_cbranch_scc1 L_poll_36
  buffer_load_dwordx4 a[0:3], v8, s[12:15], s17 offen offset:0 sc1
  buffer_load_dwordx4 a[4:7], v9, s[12:15], s17 offen offset:0 sc1
  buffer_load_dwordx4 a[8:11], v10, s[12:15], s17 offen offset:0 sc1
  buffer_load_dwordx4 a[12:15], v11, s[12:15], s17 offen offset:0 sc1
  buffer_load_dwordx4 a[16:19], v8, s[12:15], s17 offen offset:1024 sc1
  buffer_load_dwordx4 a[20:23], v9, s[12:15], s17 offen offset:1024 sc1
  buffer_load_dwordx4 a[24:27], v10, s[12:15], s17 offen offset:1024 sc1
  buffer_load_dwordx4 a[28:31], v11, s[12:15], s17 offen offset:1024 sc1
  s_add_u32 s17, s17, 2048
  s_lshl_b32 s33, s27, 10
  v_add_u32 v7, s33, v2
  v_add_u32 v3, 57344, v7
  s_xor_b32 s33, s27, 1
  s_mul_i32 s33, s33, 6144
  v_add_u32 v1, s33, v2
  v_add_u32 v13, 57344, v1
  s_getpc_b64 s[28:29]
L_pc_37:
  s_add_u32 s28, s28, L_gu_tail-L_pc_37
  s_addc_u32 s29, s29, 0
  s_mov_b32 s30, L_code_end-L_gu_tail
  s_mov_b32 s31, 0x20000
  s_lshl_b32 s66, s24, 2
  s_add_u32 s66, s66, s20
  s_lshl_b32 s66, s66, 8
  v_and_b32 v15, 1, v0
  v_lshlrev_b32 v15, 7, v15
  s_waitcnt vmcnt(0) lgkmcnt(0)
  s_barrier
  ds_read_b128 a[128:131], v7 offset:0
  buffer_load_dwordx4 a[32:35], v8, s[12:15], s17 offen offset:0 sc1
  ds_read_b128 a[132:135], v7 offset:7168
  buffer_load_dwordx4 a[36:39], v9, s[12:15], s17 offen offset:0 sc1
  buffer_load_dwordx4 a[40:43], v10, s[12:15], s17 offen offset:0 sc1
  ds_read_b128 a[136:139], v7 offset:1024
  buffer_load_dwordx4 a[44:47], v11, s[12:15], s17 offen offset:0 sc1
  buffer_load_dwordx4 a[48:51], v8, s[12:15], s17 offen offset:1024 sc1
  ds_read_b128 a[140:143], v7 offset:8192
  buffer_load_dwordx4 a[52:55], v9, s[12:15], s17 offen offset:1024 sc1
  s_waitcnt lgkmcnt(2)
  v_mfma_f32_16x16x32_bf16 v[32:35], a[128:131], a[0:3], 0
  v_mfma_f32_16x16x32_bf16 v[36:39], a[128:131], a[4:7], 0
  buffer_load_dwordx4 a[56:59], v10, s[12:15], s17 offen offset:1024 sc1
  v_mfma_f32_16x16x32_bf16 v[40:43], a[128:131], a[8:11], 0
  ds_read_b128 a[144:147], v7 offset:2048
  v_mfma_f32_16x16x32_bf16 v[44:47], a[128:131], a[12:15], 0
  buffer_load_dwordx4 a[60:63], v11, s[12:15], s17 offen offset:1024 sc1
  s_add_u32 s17, s17, 2048
  v_mfma_f32_16x16x32_bf16 v[48:51], a[132:135], a[0:3], 0
  v_mfma_f32_16x16x32_bf16 v[52:55], a[132:135], a[4:7], 0
  v_mfma_f32_16x16x32_bf16 v[56:59], a[132:135], a[8:11], 0
  ds_read_b128 a[148:151], v7 offset:9216
  s_add_u32 m0, s18, 57344
  v_mfma_f32_16x16x32_bf16 v[60:63], a[132:135], a[12:15], 0
  buffer_load_dwordx4 v4, s[8:11], s16 offen offset:0  lds
  s_waitcnt lgkmcnt(2)
  v_mfma_f32_16x16x32_bf16 v[64:67], a[136:139], a[0:3], 0
  v_mfma_f32_16x16x32_bf16 v[68:71], a[136:139], a[4:7], 0
  ds_read_b128 a[152:155], v7 offset:3072
  v_mfma_f32_16x16x32_bf16 v[72:75], a[136:139], a[8:11], 0
  v_mfma_f32_16x16x32_bf16 v[76:79], a[136:139], a[12:15], 0
  buffer_load_dwordx4 v4, s[8:11], s16 offen offset:1024  lds
  v_mfma_f32_16x16x32_bf16 v[80:83], a[140:143], a[0:3], 0
  v_mfma_f32_16x16x32_bf16 v[84:87], a[140:143], a[4:7], 0
  ds_read_b128 a[128:131], v7 offset:10240
  v_mfma_f32_16x16x32_bf16 v[88:91], a[140:143], a[8:11], 0
  v_mfma_f32_16x16x32_bf16 v[92:95], a[140:143], a[12:15], 0
  buffer_load_dwordx4 v4, s[8:11], s16 offen offset:2048  lds
  s_waitcnt lgkmcnt(2)
  v_mfma_f32_16x16x32_bf16 v[96:99], a[144:147], a[0:3], 0
  v_mfma_f32_16x16x32_bf16 v[100:103], a[144:147], a[4:7], 0
  ds_read_b128 a[132:135], v7 offset:4096
  v_mfma_f32_16x16x32_bf16 v[104:107], a[144:147], a[8:11], 0
  buffer_load_dwordx4 v4, s[8:11], s16 offen offset:3072  lds
  v_mfma_f32_16x16x32_bf16 v[108:111], a[144:147], a[12:15], 0
  v_mfma_f32_16x16x32_bf16 v[112:115], a[148:151], a[0:3], 0
  ds_read_b128 a[136:139], v7 offset:11264
  v_mfma_f32_16x16x32_bf16 v[116:119], a[148:151], a[4:7], 0
  s_add_u32 m0, s18, 61440
  v_mfma_f32_16x16x32_bf16 v[120:123], a[148:151], a[8:11], 0
  buffer_load_dwordx4 v5, s[8:11], s16 offen offset:0  lds
  v_mfma_f32_16x16x32_bf16 v[124:127], a[148:151], a[12:15], 0
  s_waitcnt lgkmcnt(2)
  v_mfma_f32_16x16x32_bf16 v[128:131], a[152:155], a[0:3], 0
  ds_read_b128 a[140:143], v7 offset:5120
  v_mfma_f32_16x16x32_bf16 v[132:135], a[152:155], a[4:7], 0
  v_mfma_f32_16x16x32_bf16 v[136:139], a[152:155], a[8:11], 0
  buffer_load_dwordx4 v5, s[8:11], s16 offen offset:1024  lds
  v_mfma_f32_16x16x32_bf16 v[140:143], a[152:155], a[12:15], 0
  v_mfma_f32_16x16x32_bf16 v[144:147], a[128:131], a[0:3], 0
  ds_read_b128 a[144:147], v7 offset:12288
  v_mfma_f32_16x16x32_bf16 v[148:151], a[128:131], a[4:7], 0
  buffer_load_dwordx4 v5, s[8:11], s16 offen offset:2048  lds
  s_add_u32 s16, s16, 917504
  v_mfma_f32_16x16x32_bf16 v[152:155], a[128:131], a[8:11], 0
  v_mfma_f32_16x16x32_bf16 v[156:159], a[128:131], a[12:15], 0
  ds_read_b128 a[148:151], v1 offset:0
  s_waitcnt lgkmcnt(2)
  v_mfma_f32_16x16x32_bf16 v[160:163], a[132:135], a[0:3], 0
  v_mfma_f32_16x16x32_bf16 v[164:167], a[132:135], a[4:7], 0
  buffer_load_dwordx4 a[64:67], v8, s[12:15], s17 offen offset:0 sc1
  v_mfma_f32_16x16x32_bf16 v[168:171], a[132:135], a[8:11], 0
  v_mfma_f32_16x16x32_bf16 v[172:175], a[132:135], a[12:15], 0
  ds_read_b128 a[152:155], v1 offset:7168
  v_mfma_f32_16x16x32_bf16 v[176:179], a[136:139], a[0:3], 0
  v_mfma_f32_16x16x32_bf16 v[180:183], a[136:139], a[4:7], 0
  buffer_load_dwordx4 a[68:71], v9, s[12:15], s17 offen offset:0 sc1
  v_mfma_f32_16x16x32_bf16 v[184:187], a[136:139], a[8:11], 0
  v_mfma_f32_16x16x32_bf16 v[188:191], a[136:139], a[12:15], 0
  ds_read_b128 a[128:131], v7 offset:14336
  v_mfma_f32_16x16x32_bf16 v[192:195], a[140:143], a[0:3], 0
  buffer_load_dwordx4 a[72:75], v10, s[12:15], s17 offen offset:0 sc1
  v_mfma_f32_16x16x32_bf16 v[196:199], a[140:143], a[4:7], 0
  v_mfma_f32_16x16x32_bf16 v[200:203], a[140:143], a[8:11], 0
  ds_read_b128 a[132:135], v7 offset:21504
  v_mfma_f32_16x16x32_bf16 v[204:207], a[140:143], a[12:15], 0
  s_waitcnt lgkmcnt(2)
  v_mfma_f32_16x16x32_bf16 v[208:211], a[144:147], a[0:3], 0
  buffer_load_dwordx4 a[76:79], v11, s[12:15], s17 offen offset:0 sc1
  v_mfma_f32_16x16x32_bf16 v[212:215], a[144:147], a[4:7], 0
  v_mfma_f32_16x16x32_bf16 v[216:219], a[144:147], a[8:11], 0
  ds_read_b128 a[136:139], v7 offset:15360
  v_mfma_f32_16x16x32_bf16 v[220:223], a[144:147], a[12:15], 0
  v_mfma_f32_16x16x32_bf16 v[224:227], a[148:151], a[0:3], 0
  buffer_load_dwordx4 a[80:83], v8, s[12:15], s17 offen offset:1024 sc1
  v_mfma_f32_16x16x32_bf16 v[228:231], a[148:151], a[4:7], 0
  ds_read_b128 a[140:143], v7 offset:22528
  v_mfma_f32_16x16x32_bf16 v[232:235], a[148:151], a[8:11], 0
  v_mfma_f32_16x16x32_bf16 v[236:239], a[148:151], a[12:15], 0
  v_mfma_f32_16x16x32_bf16 v[240:243], a[152:155], a[0:3], 0
  buffer_load_dwordx4 a[84:87], v9, s[12:15], s17 offen offset:1024 sc1
  v_mfma_f32_16x16x32_bf16 v[244:247], a[152:155], a[4:7], 0
  ds_read_b128 a[144:147], v7 offset:16384
  v_mfma_f32_16x16x32_bf16 v[248:251], a[152:155], a[8:11], 0
  v_mfma_f32_16x16x32_bf16 v[252:255], a[152:155], a[12:15], 0
  buffer_load_dwordx4 a[88:91], v10, s[12:15], s17 offen offset:1024 sc1
  s_waitcnt lgkmcnt(2)
  v_mfma_f32_16x16x32_bf16 v[32:35], a[128:131], a[16:19], v[32:35]
  v_mfma_f32_16x16x32_bf16 v[36:39], a[128:131], a[20:23], v[36:39]
  ds_read_b128 a[148:151], v7 offset:23552
  v_mfma_f32_16x16x32_bf16 v[40:43], a[128:131], a[24:27], v[40:43]
  v_mfma_f32_16x16x32_bf16 v[44:47], a[128:131], a[28:31], v[44:47]
  buffer_load_dwordx4 a[92:95], v11, s[12:15], s17 offen offset:1024 sc1
  s_add_u32 s17, s17, 2048
  v_mfma_f32_16x16x32_bf16 v[48:51], a[132:135], a[16:19], v[48:51]
  ds_read_b128 a[152:155], v7 offset:17408
  v_mfma_f32_16x16x32_bf16 v[52:55], a[132:135], a[20:23], v[52:55]
  v_mfma_f32_16x16x32_bf16 v[56:59], a[132:135], a[24:27], v[56:59]
  v_mfma_f32_16x16x32_bf16 v[60:63], a[132:135], a[28:31], v[60:63]
  buffer_load_dwordx2 a[160:161], v30, s[36:39], s58 offen offset:0 sc1
  v_mfma_f32_16x16x32_bf16 v[64:67], a[136:139], a[16:19], v[64:67]
  ds_read_b128 a[128:131], v7 offset:24576
  v_mfma_f32_16x16x32_bf16 v[68:71], a[136:139], a[20:23], v[68:71]
  v_mfma_f32_16x16x32_bf16 v[72:75], a[136:139], a[24:27], v[72:75]
  buffer_load_dwordx2 a[168:169], v30, s[36:39], s58 offen offset:128 sc1
  v_mfma_f32_16x16x32_bf16 v[76:79], a[136:139], a[28:31], v[76:79]
  s_waitcnt lgkmcnt(1)
  v_mfma_f32_16x16x32_bf16 v[80:83], a[140:143], a[16:19], v[80:83]
  ds_read_b128 a[132:135], v7 offset:18432
  v_mfma_f32_16x16x32_bf16 v[84:87], a[140:143], a[20:23], v[84:87]
  v_mfma_f32_16x16x32_bf16 v[88:91], a[140:143], a[24:27], v[88:91]
  buffer_load_dwordx2 a[176:177], v30, s[36:39], s58 offen offset:256 sc1
  v_mfma_f32_16x16x32_bf16 v[92:95], a[140:143], a[28:31], v[92:95]
  ds_read_b128 a[136:139], v7 offset:25600
  v_mfma_f32_16x16x32_bf16 v[96:99], a[144:147], a[16:19], v[96:99]
  v_mfma_f32_16x16x32_bf16 v[100:103], a[144:147], a[20:23], v[100:103]
  v_mfma_f32_16x16x32_bf16 v[104:107], a[144:147], a[24:27], v[104:107]
  buffer_load_dwordx2 a[184:185], v30, s[36:39], s58 offen offset:384 sc1
  v_mfma_f32_16x16x32_bf16 v[108:111], a[144:147], a[28:31], v[108:111]
  ds_read_b128 a[140:143], v7 offset:19456
  v_mfma_f32_16x16x32_bf16 v[112:115], a[148:151], a[16:19], v[112:115]
  v_mfma_f32_16x16x32_bf16 v[116:119], a[148:151], a[20:23], v[116:119]
  buffer_load_dwordx2 a[162:163], v30, s[36:39], s59 offen offset:0 sc1
  v_mfma_f32_16x16x32_bf16 v[120:123], a[148:151], a[24:27], v[120:123]
  v_mfma_f32_16x16x32_bf16 v[124:127], a[148:151], a[28:31], v[124:127]
  ds_read_b128 a[144:147], v7 offset:26624
  v_mfma_f32_16x16x32_bf16 v[128:131], a[152:155], a[16:19], v[128:131]
  v_mfma_f32_16x16x32_bf16 v[132:135], a[152:155], a[20:23], v[132:135]
  buffer_load_dwordx2 a[170:171], v30, s[36:39], s59 offen offset:128 sc1
  v_mfma_f32_16x16x32_bf16 v[136:139], a[152:155], a[24:27], v[136:139]
  ds_read_b128 a[148:151], v1 offset:14336
  v_mfma_f32_16x16x32_bf16 v[140:143], a[152:155], a[28:31], v[140:143]
  s_waitcnt lgkmcnt(2)
  v_mfma_f32_16x16x32_bf16 v[144:147], a[128:131], a[16:19], v[144:147]
  v_mfma_f32_16x16x32_bf16 v[148:151], a[128:131], a[20:23], v[148:151]
  buffer_load_dwordx2 a[178:179], v30, s[36:39], s59 offen offset:256 sc1
  v_mfma_f32_16x16x32_bf16 v[152:155], a[128:131], a[24:27], v[152:155]
  ds_read_b128 a[152:155], v1 offset:21504
  v_mfma_f32_16x16x32_bf16 v[156:159], a[128:131], a[28:31], v[156:159]
  v_mfma_f32_16x16x32_bf16 v[160:163], a[132:135], a[16:19], v[160:163]
  buffer_load_dwordx2 a[186:187], v30, s[36:39], s59 offen offset:384 sc1
  v_mfma_f32_16x16x32_bf16 v[164:167], a[132:135], a[20:23], v[164:167]
  v_mfma_f32_16x16x32_bf16 v[168:171], a[132:135], a[24:27], v[168:171]
  v_mfma_f32_16x16x32_bf16 v[172:175], a[132:135], a[28:31], v[172:175]
  v_mfma_f32_16x16x32_bf16 v[176:179], a[136:139], a[16:19], v[176:179]
  buffer_load_dwordx2 a[164:165], v30, s[36:39], s60 offen offset:0 sc1
  v_mfma_f32_16x16x32_bf16 v[180:183], a[136:139], a[20:23], v[180:183]
  v_mfma_f32_16x16x32_bf16 v[184:187], a[136:139], a[24:27], v[184:187]
  v_mfma_f32_16x16x32_bf16 v[188:191], a[136:139], a[28:31], v[188:191]
  v_mfma_f32_16x16x32_bf16 v[192:195], a[140:143], a[16:19], v[192:195]
  buffer_load_dwordx2 a[172:173], v30, s[36:39], s60 offen offset:128 sc1
  v_mfma_f32_16x16x32_bf16 v[196:199], a[140:143], a[20:23], v[196:199]
  v_mfma_f32_16x16x32_bf16 v[200:203], a[140:143], a[24:27], v[200:203]
  v_mfma_f32_16x16x32_bf16 v[204:207], a[140:143], a[28:31], v[204:207]
  s_waitcnt vmcnt(25) lgkmcnt(0)
  s_barrier
  v_mfma_f32_16x16x32_bf16 v[208:211], a[144:147], a[16:19], v[208:211]
  ds_read_b128 a[128:131], v7 offset:28672
  v_mfma_f32_16x16x32_bf16 v[212:215], a[144:147], a[20:23], v[212:215]
  s_add_u32 m0, s18, 86016
  v_mfma_f32_16x16x32_bf16 v[216:219], a[144:147], a[24:27], v[216:219]
  buffer_load_dwordx4 v4, s[8:11], s16 offen offset:0  lds
  v_mfma_f32_16x16x32_bf16 v[220:223], a[144:147], a[28:31], v[220:223]
  ds_read_b128 a[132:135], v7 offset:35840
  v_mfma_f32_16x16x32_bf16 v[224:227], a[148:151], a[16:19], v[224:227]
  v_mfma_f32_16x16x32_bf16 v[228:231], a[148:151], a[20:23], v[228:231]
  v_mfma_f32_16x16x32_bf16 v[232:235], a[148:151], a[24:27], v[232:235]
  buffer_load_dwordx4 v4, s[8:11], s16 offen offset:1024  lds
  v_mfma_f32_16x16x32_bf16 v[236:239], a[148:151], a[28:31], v[236:239]
  ds_read_b128 a[136:139], v7 offset:29696
  v_mfma_f32_16x16x32_bf16 v[240:243], a[152:155], a[16:19], v[240:243]
  v_mfma_f32_16x16x32_bf16 v[244:247], a[152:155], a[20:23], v[244:247]
  v_mfma_f32_16x16x32_bf16 v[248:251], a[152:155], a[24:27], v[248:251]
  ds_read_b128 a[140:143], v7 offset:36864
  v_mfma_f32_16x16x32_bf16 v[252:255], a[152:155], a[28:31], v[252:255]
  buffer_load_dwordx4 v4, s[8:11], s16 offen offset:2048  lds
  s_waitcnt lgkmcnt(2)
  v_mfma_f32_16x16x32_bf16 v[32:35], a[128:131], a[32:35], v[32:35]
  v_mfma_f32_16x16x32_bf16 v[36:39], a[128:131], a[36:39], v[36:39]
  v_mfma_f32_16x16x32_bf16 v[40:43], a[128:131], a[40:43], v[40:43]
  ds_read_b128 a[144:147], v7 offset:30720
  v_mfma_f32_16x16x32_bf16 v[44:47], a[128:131], a[44:47], v[44:47]
  buffer_load_dwordx4 v4, s[8:11], s16 offen offset:3072  lds
  v_mfma_f32_16x16x32_bf16 v[48:51], a[132:135], a[32:35], v[48:51]
  v_mfma_f32_16x16x32_bf16 v[52:55], a[132:135], a[36:39], v[52:55]
  v_mfma_f32_16x16x32_bf16 v[56:59], a[132:135], a[40:43], v[56:59]
  ds_read_b128 a[148:151], v7 offset:37888
  s_add_u32 m0, s18, 90112
  v_mfma_f32_16x16x32_bf16 v[60:63], a[132:135], a[44:47], v[60:63]
  buffer_load_dwordx4 v5, s[8:11], s16 offen offset:0  lds
  s_waitcnt lgkmcnt(2)
  v_mfma_f32_16x16x32_bf16 v[64:67], a[136:139], a[32:35], v[64:67]
  v_mfma_f32_16x16x32_bf16 v[68:71], a[136:139], a[36:39], v[68:71]
  ds_read_b128 a[152:155], v7 offset:31744
  v_mfma_f32_16x16x32_bf16 v[72:75], a[136:139], a[40:43], v[72:75]
  v_mfma_f32_16x16x32_bf16 v[76:79], a[136:139], a[44:47], v[76:79]
  v_mfma_f32_16x16x32_bf16 v[80:83], a[140:143], a[32:35], v[80:83]
  buffer_load_dwordx4 v5, s[8:11], s16 offen offset:1024  lds
  v_mfma_f32_16x16x32_bf16 v[84:87], a[140:143], a[36:39], v[84:87]
  ds_read_b128 a[128:131], v7 offset:38912
  v_mfma_f32_16x16x32_bf16 v[88:91], a[140:143], a[40:43], v[88:91]
  v_mfma_f32_16x16x32_bf16 v[92:95], a[140:143], a[44:47], v[92:95]
  s_waitcnt lgkmcnt(2)
  v_mfma_f32_16x16x32_bf16 v[96:99], a[144:147], a[32:35], v[96:99]
  buffer_load_dwordx4 v5, s[8:11], s16 offen offset:2048  lds
  s_add_u32 s16, s16, 917504
  v_mfma_f32_16x16x32_bf16 v[100:103], a[144:147], a[36:39], v[100:103]
  ds_read_b128 a[132:135], v7 offset:32768
  v_mfma_f32_16x16x32_bf16 v[104:107], a[144:147], a[40:43], v[104:107]
  v_mfma_f32_16x16x32_bf16 v[108:111], a[144:147], a[44:47], v[108:111]
  v_mfma_f32_16x16x32_bf16 v[112:115], a[148:151], a[32:35], v[112:115]
  ds_read_b128 a[136:139], v7 offset:39936
  v_mfma_f32_16x16x32_bf16 v[116:119], a[148:151], a[36:39], v[116:119]
  buffer_load_dwordx4 a[96:99], v8, s[12:15], s17 offen offset:0 sc1
  v_mfma_f32_16x16x32_bf16 v[120:123], a[148:151], a[40:43], v[120:123]
  v_mfma_f32_16x16x32_bf16 v[124:127], a[148:151], a[44:47], v[124:127]
  s_waitcnt lgkmcnt(2)
  v_mfma_f32_16x16x32_bf16 v[128:131], a[152:155], a[32:35], v[128:131]
  ds_read_b128 a[140:143], v7 offset:33792
  v_mfma_f32_16x16x32_bf16 v[132:135], a[152:155], a[36:39], v[132:135]
  buffer_load_dwordx4 a[100:103], v9, s[12:15], s17 offen offset:0 sc1
  v_mfma_f32_16x16x32_bf16 v[136:139], a[152:155], a[40:43], v[136:139]
  v_mfma_f32_16x16x32_bf16 v[140:143], a[152:155], a[44:47], v[140:143]
  v_mfma_f32_16x16x32_bf16 v[144:147], a[128:131], a[32:35], v[144:147]
  ds_read_b128 a[144:147], v7 offset:40960
  v_mfma_f32_16x16x32_bf16 v[148:151], a[128:131], a[36:39], v[148:151]
  buffer_load_dwordx4 a[104:107], v10, s[12:15], s17 offen offset:0 sc1
  v_mfma_f32_16x16x32_bf16 v[152:155], a[128:131], a[40:43], v[152:155]
  v_mfma_f32_16x16x32_bf16 v[156:159], a[128:131], a[44:47], v[156:159]
  ds_read_b128 a[148:151], v1 offset:28672
  s_waitcnt lgkmcnt(2)
  v_mfma_f32_16x16x32_bf16 v[160:163], a[132:135], a[32:35], v[160:163]
  v_mfma_f32_16x16x32_bf16 v[164:167], a[132:135], a[36:39], v[164:167]
  v_mfma_f32_16x16x32_bf16 v[168:171], a[132:135], a[40:43], v[168:171]
  buffer_load_dwordx4 a[108:111], v11, s[12:15], s17 offen offset:0 sc1
  v_mfma_f32_16x16x32_bf16 v[172:175], a[132:135], a[44:47], v[172:175]
  ds_read_b128 a[152:155], v1 offset:35840
  v_mfma_f32_16x16x32_bf16 v[176:179], a[136:139], a[32:35], v[176:179]
  v_mfma_f32_16x16x32_bf16 v[180:183], a[136:139], a[36:39], v[180:183]
  v_mfma_f32_16x16x32_bf16 v[184:187], a[136:139], a[40:43], v[184:187]
  buffer_load_dwordx4 a[112:115], v8, s[12:15], s17 offen offset:1024 sc1
  v_mfma_f32_16x16x32_bf16 v[188:191], a[136:139], a[44:47], v[188:191]
  ds_read_b128 a[128:131], v7 offset:43008
  v_mfma_f32_16x16x32_bf16 v[192:195], a[140:143], a[32:35], v[192:195]
  v_mfma_f32_16x16x32_bf16 v[196:199], a[140:143], a[36:39], v[196:199]
  v_mfma_f32_16x16x32_bf16 v[200:203], a[140:143], a[40:43], v[200:203]
  ds_read_b128 a[132:135], v7 offset:50176
  v_mfma_f32_16x16x32_bf16 v[204:207], a[140:143], a[44:47], v[204:207]
  buffer_load_dwordx4 a[116:119], v9, s[12:15], s17 offen offset:1024 sc1
  s_waitcnt lgkmcnt(2)
  v_mfma_f32_16x16x32_bf16 v[208:211], a[144:147], a[32:35], v[208:211]
  v_mfma_f32_16x16x32_bf16 v[212:215], a[144:147], a[36:39], v[212:215]
  v_mfma_f32_16x16x32_bf16 v[216:219], a[144:147], a[40:43], v[216:219]
  ds_read_b128 a[136:139], v7 offset:44032
  v_mfma_f32_16x16x32_bf16 v[220:223], a[144:147], a[44:47], v[220:223]
  buffer_load_dwordx4 a[120:123], v10, s[12:15], s17 offen offset:1024 sc1
  v_mfma_f32_16x16x32_bf16 v[224:227], a[148:151], a[32:35], v[224:227]
  v_mfma_f32_16x16x32_bf16 v[228:231], a[148:151], a[36:39], v[228:231]
  ds_read_b128 a[140:143], v7 offset:51200
  v_mfma_f32_16x16x32_bf16 v[232:235], a[148:151], a[40:43], v[232:235]
  v_mfma_f32_16x16x32_bf16 v[236:239], a[148:151], a[44:47], v[236:239]
  buffer_load_dwordx4 a[124:127], v11, s[12:15], s17 offen offset:1024 sc1
  s_add_u32 s17, s17, 2048
  v_mfma_f32_16x16x32_bf16 v[240:243], a[152:155], a[32:35], v[240:243]
  v_mfma_f32_16x16x32_bf16 v[244:247], a[152:155], a[36:39], v[244:247]
  ds_read_b128 a[144:147], v7 offset:45056
  v_mfma_f32_16x16x32_bf16 v[248:251], a[152:155], a[40:43], v[248:251]
  v_mfma_f32_16x16x32_bf16 v[252:255], a[152:155], a[44:47], v[252:255]
  s_waitcnt lgkmcnt(2)
  v_mfma_f32_16x16x32_bf16 v[32:35], a[128:131], a[48:51], v[32:35]
  buffer_load_dwordx2 a[180:181], v30, s[36:39], s60 offen offset:256 sc1
  v_mfma_f32_16x16x32_bf16 v[36:39], a[128:131], a[52:55], v[36:39]
  ds_read_b128 a[148:151], v7 offset:52224
  v_mfma_f32_16x16x32_bf16 v[40:43], a[128:131], a[56:59], v[40:43]
  v_mfma_f32_16x16x32_bf16 v[44:47], a[128:131], a[60:63], v[44:47]
  v_mfma_f32_16x16x32_bf16 v[48:51], a[132:135], a[48:51], v[48:51]
  ds_read_b128 a[152:155], v7 offset:46080
  buffer_load_dwordx2 a[188:189], v30, s[36:39], s60 offen offset:384 sc1
  v_mfma_f32_16x16x32_bf16 v[52:55], a[132:135], a[52:55], v[52:55]
  v_mfma_f32_16x16x32_bf16 v[56:59], a[132:135], a[56:59], v[56:59]
  v_mfma_f32_16x16x32_bf16 v[60:63], a[132:135], a[60:63], v[60:63]
  v_mfma_f32_16x16x32_bf16 v[64:67], a[136:139], a[48:51], v[64:67]
  ds_read_b128 a[128:131], v7 offset:53248
  v_mfma_f32_16x16x32_bf16 v[68:71], a[136:139], a[52:55], v[68:71]
  buffer_load_dwordx2 a[166:167], v30, s[36:39], s61 offen offset:0 sc1
  v_mfma_f32_16x16x32_bf16 v[72:75], a[136:139], a[56:59], v[72:75]
  v_mfma_f32_16x16x32_bf16 v[76:79], a[136:139], a[60:63], v[76:79]
  s_waitcnt lgkmcnt(1)
  v_mfma_f32_16x16x32_bf16 v[80:83], a[140:143], a[48:51], v[80:83]
  ds_read_b128 a[132:135], v7 offset:47104
  v_mfma_f32_16x16x32_bf16 v[84:87], a[140:143], a[52:55], v[84:87]
  buffer_load_dwordx2 a[174:175], v30, s[36:39], s61 offen offset:128 sc1
  v_mfma_f32_16x16x32_bf16 v[88:91], a[140:143], a[56:59], v[88:91]
  v_mfma_f32_16x16x32_bf16 v[92:95], a[140:143], a[60:63], v[92:95]
  ds_read_b128 a[136:139], v7 offset:54272
  v_mfma_f32_16x16x32_bf16 v[96:99], a[144:147], a[48:51], v[96:99]
  v_mfma_f32_16x16x32_bf16 v[100:103], a[144:147], a[52:55], v[100:103]
  buffer_load_dwordx2 a[182:183], v30, s[36:39], s61 offen offset:256 sc1
  v_mfma_f32_16x16x32_bf16 v[104:107], a[144:147], a[56:59], v[104:107]
  v_mfma_f32_16x16x32_bf16 v[108:111], a[144:147], a[60:63], v[108:111]
  ds_read_b128 a[140:143], v7 offset:48128
  v_mfma_f32_16x16x32_bf16 v[112:115], a[148:151], a[48:51], v[112:115]
  v_mfma_f32_16x16x32_bf16 v[116:119], a[148:151], a[52:55], v[116:119]
  v_mfma_f32_16x16x32_bf16 v[120:123], a[148:151], a[56:59], v[120:123]
  buffer_load_dwordx2 a[190:191], v30, s[36:39], s61 offen offset:384 sc1
  v_mfma_f32_16x16x32_bf16 v[124:127], a[148:151], a[60:63], v[124:127]
  ds_read_b128 a[144:147], v7 offset:55296
  v_mfma_f32_16x16x32_bf16 v[128:131], a[152:155], a[48:51], v[128:131]
  v_mfma_f32_16x16x32_bf16 v[132:135], a[152:155], a[52:55], v[132:135]
  v_mfma_f32_16x16x32_bf16 v[136:139], a[152:155], a[56:59], v[136:139]
  ds_read_b128 a[148:151], v1 offset:43008
  buffer_load_dwordx4 a[192:195], v31, s[40:43], s62 offen
  v_mfma_f32_16x16x32_bf16 v[140:143], a[152:155], a[60:63], v[140:143]
  s_waitcnt lgkmcnt(2)
  v_mfma_f32_16x16x32_bf16 v[144:147], a[128:131], a[48:51], v[144:147]
  v_mfma_f32_16x16x32_bf16 v[148:151], a[128:131], a[52:55], v[148:151]
  v_mfma_f32_16x16x32_bf16 v[152:155], a[128:131], a[56:59], v[152:155]
  ds_read_b128 a[152:155], v1 offset:50176
  v_mfma_f32_16x16x32_bf16 v[156:159], a[128:131], a[60:63], v[156:159]
  buffer_load_dwordx4 a[196:199], v31, s[40:43], s63 offen
  v_mfma_f32_16x16x32_bf16 v[160:163], a[132:135], a[48:51], v[160:163]
  v_mfma_f32_16x16x32_bf16 v[164:167], a[132:135], a[52:55], v[164:167]
  v_mfma_f32_16x16x32_bf16 v[168:171], a[132:135], a[56:59], v[168:171]
  v_mfma_f32_16x16x32_bf16 v[172:175], a[132:135], a[60:63], v[172:175]
  buffer_load_dwordx4 a[200:203], v31, s[40:43], s64 offen
  v_mfma_f32_16x16x32_bf16 v[176:179], a[136:139], a[48:51], v[176:179]
  v_mfma_f32_16x16x32_bf16 v[180:183], a[136:139], a[52:55], v[180:183]
  v_mfma_f32_16x16x32_bf16 v[184:187], a[136:139], a[56:59], v[184:187]
  v_mfma_f32_16x16x32_bf16 v[188:191], a[136:139], a[60:63], v[188:191]
  buffer_load_dwordx4 a[204:207], v31, s[40:43], s65 offen
  v_mfma_f32_16x16x32_bf16 v[192:195], a[140:143], a[48:51], v[192:195]
  v_mfma_f32_16x16x32_bf16 v[196:199], a[140:143], a[52:55], v[196:199]
  v_mfma_f32_16x16x32_bf16 v[200:203], a[140:143], a[56:59], v[200:203]
  v_mfma_f32_16x16x32_bf16 v[204:207], a[140:143], a[60:63], v[204:207]
  s_waitcnt vmcnt(35) lgkmcnt(0)
  s_barrier
  v_mfma_f32_16x16x32_bf16 v[208:211], a[144:147], a[48:51], v[208:211]
  ds_read_b128 a[128:131], v3 offset:0
  v_mfma_f32_16x16x32_bf16 v[212:215], a[144:147], a[52:55], v[212:215]
  v_mfma_f32_16x16x32_bf16 v[216:219], a[144:147], a[56:59], v[216:219]
  s_add_u32 m0, s18, 0
  v_mfma_f32_16x16x32_bf16 v[220:223], a[144:147], a[60:63], v[220:223]
  ds_read_b128 a[132:135], v3 offset:7168
  buffer_load_dwordx4 v4, s[8:11], s16 offen offset:0  lds
  v_mfma_f32_16x16x32_bf16 v[224:227], a[148:151], a[48:51], v[224:227]
  v_mfma_f32_16x16x32_bf16 v[228:231], a[148:151], a[52:55], v[228:231]
  v_mfma_f32_16x16x32_bf16 v[232:235], a[148:151], a[56:59], v[232:235]
  v_mfma_f32_16x16x32_bf16 v[236:239], a[148:151], a[60:63], v[236:239]
  ds_read_b128 a[136:139], v3 offset:1024
  v_mfma_f32_16x16x32_bf16 v[240:243], a[152:155], a[48:51], v[240:243]
  v_mfma_f32_16x16x32_bf16 v[244:247], a[152:155], a[52:55], v[244:247]
  v_mfma_f32_16x16x32_bf16 v[248:251], a[152:155], a[56:59], v[248:251]
  ds_read_b128 a[140:143], v3 offset:8192
  v_mfma_f32_16x16x32_bf16 v[252:255], a[152:155], a[60:63], v[252:255]
  buffer_load_dwordx4 v4, s[8:11], s16 offen offset:1024  lds
  s_waitcnt lgkmcnt(2)
  v_mfma_f32_16x16x32_bf16 v[32:35], a[128:131], a[64:67], v[32:35]
  v_mfma_f32_16x16x32_bf16 v[36:39], a[128:131], a[68:71], v[36:39]
  v_mfma_f32_16x16x32_bf16 v[40:43], a[128:131], a[72:75], v[40:43]
  ds_read_b128 a[144:147], v3 offset:2048
  v_mfma_f32_16x16x32_bf16 v[44:47], a[128:131], a[76:79], v[44:47]
  v_mfma_f32_16x16x32_bf16 v[48:51], a[132:135], a[64:67], v[48:51]
  v_mfma_f32_16x16x32_bf16 v[52:55], a[132:135], a[68:71], v[52:55]
  v_mfma_f32_16x16x32_bf16 v[56:59], a[132:135], a[72:75], v[56:59]
  ds_read_b128 a[148:151], v3 offset:9216
  buffer_load_dwordx4 v4, s[8:11], s16 offen offset:2048  lds
  v_mfma_f32_16x16x32_bf16 v[60:63], a[132:135], a[76:79], v[60:63]
  s_waitcnt lgkmcnt(2)
  v_mfma_f32_16x16x32_bf16 v[64:67], a[136:139], a[64:67], v[64:67]
  v_mfma_f32_16x16x32_bf16 v[68:71], a[136:139], a[68:71], v[68:71]
  ds_read_b128 a[152:155], v3 offset:3072
  v_mfma_f32_16x16x32_bf16 v[72:75], a[136:139], a[72:75], v[72:75]
  v_mfma_f32_16x16x32_bf16 v[76:79], a[136:139], a[76:79], v[76:79]
  v_mfma_f32_16x16x32_bf16 v[80:83], a[140:143], a[64:67], v[80:83]
  v_mfma_f32_16x16x32_bf16 v[84:87], a[140:143], a[68:71], v[84:87]
  ds_read_b128 a[128:131], v3 offset:10240
  buffer_load_dwordx4 v4, s[8:11], s16 offen offset:3072  lds
  v_mfma_f32_16x16x32_bf16 v[88:91], a[140:143], a[72:75], v[88:91]
  v_mfma_f32_16x16x32_bf16 v[92:95], a[140:143], a[76:79], v[92:95]
  s_waitcnt lgkmcnt(2)
  v_mfma_f32_16x16x32_bf16 v[96:99], a[144:147], a[64:67], v[96:99]
  v_mfma_f32_16x16x32_bf16 v[100:103], a[144:147], a[68:71], v[100:103]
  ds_read_b128 a[132:135], v3 offset:4096
  v_mfma_f32_16x16x32_bf16 v[104:107], a[144:147], a[72:75], v[104:107]
  v_mfma_f32_16x16x32_bf16 v[108:111], a[144:147], a[76:79], v[108:111]
  v_mfma_f32_16x16x32_bf16 v[112:115], a[148:151], a[64:67], v[112:115]
  ds_read_b128 a[136:139], v3 offset:11264
  s_add_u32 m0, s18, 4096
  v_mfma_f32_16x16x32_bf16 v[116:119], a[148:151], a[68:71], v[116:119]
  buffer_load_dwordx4 v5, s[8:11], s16 offen offset:0  lds
  v_mfma_f32_16x16x32_bf16 v[120:123], a[148:151], a[72:75], v[120:123]
  s_waitcnt vmcnt(5)
  v_accvgpr_read_b32 v24, a192
  v_mfma_f32_16x16x32_bf16 v[124:127], a[148:151], a[76:79], v[124:127]
  v_accvgpr_read_b32 v25, a193
  s_waitcnt lgkmcnt(2)
  v_mfma_f32_16x16x32_bf16 v[128:131], a[152:155], a[64:67], v[128:131]
  ds_read_b128 a[140:143], v3 offset:5120
  v_accvgpr_read_b32 v26, a194
  v_mfma_f32_16x16x32_bf16 v[132:135], a[152:155], a[68:71], v[132:135]
  v_accvgpr_read_b32 v27, a195
  v_mfma_f32_16x16x32_bf16 v[136:139], a[152:155], a[72:75], v[136:139]
  v_accvgpr_read_b32 v28, a196
  v_mfma_f32_16x16x32_bf16 v[140:143], a[152:155], a[76:79], v[140:143]
  v_accvgpr_read_b32 v29, a197
  v_mfma_f32_16x16x32_bf16 v[144:147], a[128:131], a[64:67], v[144:147]
  ds_read_b128 a[144:147], v3 offset:12288
  buffer_load_dwordx4 v5, s[8:11], s16 offen offset:1024  lds
  v_accvgpr_read_b32 v30, a198
  v_mfma_f32_16x16x32_bf16 v[148:151], a[128:131], a[68:71], v[148:151]
  v_accvgpr_read_b32 v31, a199
  v_add_f32 v24, v24, v28
  v_mfma_f32_16x16x32_bf16 v[152:155], a[128:131], a[72:75], v[152:155]
  v_add_f32 v25, v25, v29
  v_mfma_f32_16x16x32_bf16 v[156:159], a[128:131], a[76:79], v[156:159]
  ds_read_b128 a[148:151], v13 offset:0
  v_add_f32 v26, v26, v30
  s_waitcnt lgkmcnt(2)
  v_mfma_f32_16x16x32_bf16 v[160:163], a[132:135], a[64:67], v[160:163]
  v_add_f32 v27, v27, v31
  v_mfma_f32_16x16x32_bf16 v[164:167], a[132:135], a[68:71], v[164:167]
  v_accvgpr_read_b32 v28, a200
  v_mfma_f32_16x16x32_bf16 v[168:171], a[132:135], a[72:75], v[168:171]
  v_accvgpr_read_b32 v29, a201
  v_mfma_f32_16x16x32_bf16 v[172:175], a[132:135], a[76:79], v[172:175]
  ds_read_b128 a[152:155], v13 offset:7168
  buffer_load_dwordx4 v5, s[8:11], s16 offen offset:2048  lds
  s_add_u32 s16, s16, 917504
  v_accvgpr_read_b32 v30, a202
  v_mfma_f32_16x16x32_bf16 v[176:179], a[136:139], a[64:67], v[176:179]
  v_accvgpr_read_b32 v31, a203
  v_mfma_f32_16x16x32_bf16 v[180:183], a[136:139], a[68:71], v[180:183]
  v_add_f32 v24, v24, v28
  v_add_f32 v25, v25, v29
  v_mfma_f32_16x16x32_bf16 v[184:187], a[136:139], a[72:75], v[184:187]
  v_add_f32 v26, v26, v30
  v_mfma_f32_16x16x32_bf16 v[188:191], a[136:139], a[76:79], v[188:191]
  ds_read_b128 a[128:131], v3 offset:14336
  v_add_f32 v27, v27, v31
  v_mfma_f32_16x16x32_bf16 v[192:195], a[140:143], a[64:67], v[192:195]
  v_accvgpr_read_b32 v28, a204
  v_mfma_f32_16x16x32_bf16 v[196:199], a[140:143], a[68:71], v[196:199]
  v_accvgpr_read_b32 v29, a205
  v_mfma_f32_16x16x32_bf16 v[200:203], a[140:143], a[72:75], v[200:203]
  ds_read_b128 a[132:135], v3 offset:21504
  v_accvgpr_read_b32 v30, a206
  v_mfma_f32_16x16x32_bf16 v[204:207], a[140:143], a[76:79], v[204:207]
  buffer_load_dwordx4 a[0:3], v8, s[12:15], s17 offen offset:0 sc1
  v_accvgpr_read_b32 v31, a207
  s_waitcnt lgkmcnt(2)
  v_mfma_f32_16x16x32_bf16 v[208:211], a[144:147], a[64:67], v[208:211]
  v_add_f32 v24, v24, v28
  v_mfma_f32_16x16x32_bf16 v[212:215], a[144:147], a[68:71], v[212:215]
  v_add_f32 v25, v25, v29
  v_add_f32 v26, v26, v30
  v_mfma_f32_16x16x32_bf16 v[216:219], a[144:147], a[72:75], v[216:219]
  ds_read_b128 a[136:139], v3 offset:15360
  v_add_f32 v27, v27, v31
  v_mfma_f32_16x16x32_bf16 v[220:223], a[144:147], a[76:79], v[220:223]
  ds_write_b128 v12, v[24:27]
  v_mfma_f32_16x16x32_bf16 v[224:227], a[148:151], a[64:67], v[224:227]
  s_nop 0
  v_mfma_f32_16x16x32_bf16 v[228:231], a[148:151], a[68:71], v[228:231]
  ds_read_b128 a[140:143], v3 offset:22528
  v_accvgpr_read_b32 v28, a160
  v_mfma_f32_16x16x32_bf16 v[232:235], a[148:151], a[72:75], v[232:235]
  buffer_load_dwordx4 a[4:7], v9, s[12:15], s17 offen offset:0 sc1
  v_accvgpr_read_b32 v29, a162
  v_mfma_f32_16x16x32_bf16 v[236:239], a[148:151], a[76:79], v[236:239]
  v_accvgpr_read_b32 v30, a164
  v_mfma_f32_16x16x32_bf16 v[240:243], a[152:155], a[64:67], v[240:243]
  v_accvgpr_read_b32 v31, a166
  v_mfma_f32_16x16x32_bf16 v[244:247], a[152:155], a[68:71], v[244:247]
  ds_read_b128 a[144:147], v3 offset:16384
  v_add_f32 v28, v28, v29
  v_add_f32 v30, v30, v31
  v_mfma_f32_16x16x32_bf16 v[248:251], a[152:155], a[72:75], v[248:251]
  v_add_f32 v17, v28, v30
  v_mfma_f32_16x16x32_bf16 v[252:255], a[152:155], a[76:79], v[252:255]
  v_accvgpr_read_b32 v28, a168
  s_waitcnt lgkmcnt(2)
  v_mfma_f32_16x16x32_bf16 v[32:35], a[128:131], a[80:83], v[32:35]
  v_accvgpr_read_b32 v29, a170
  v_mfma_f32_16x16x32_bf16 v[36:39], a[128:131], a[84:87], v[36:39]
  ds_read_b128 a[148:151], v3 offset:23552
  buffer_load_dwordx4 a[8:11], v10, s[12:15], s17 offen offset:0 sc1
  v_accvgpr_read_b32 v30, a172
  v_mfma_f32_16x16x32_bf16 v[40:43], a[128:131], a[88:91], v[40:43]
  v_accvgpr_read_b32 v31, a174
  v_mfma_f32_16x16x32_bf16 v[44:47], a[128:131], a[92:95], v[44:47]
  v_add_f32 v28, v28, v29
  v_mfma_f32_16x16x32_bf16 v[48:51], a[132:135], a[80:83], v[48:51]
  ds_read_b128 a[152:155], v3 offset:17408
  v_add_f32 v30, v30, v31
  v_add_f32 v19, v28, v30
  v_mfma_f32_16x16x32_bf16 v[52:55], a[132:135], a[84:87], v[52:55]
  v_accvgpr_read_b32 v28, a176
  v_mfma_f32_16x16x32_bf16 v[56:59], a[132:135], a[88:91], v[56:59]
  v_accvgpr_read_b32 v29, a178
  v_mfma_f32_16x16x32_bf16 v[60:63], a[132:135], a[92:95], v[60:63]
  v_accvgpr_read_b32 v30, a180
  v_mfma_f32_16x16x32_bf16 v[64:67], a[136:139], a[80:83], v[64:67]
  ds_read_b128 a[128:131], v3 offset:24576
  v_accvgpr_read_b32 v31, a182
  v_mfma_f32_16x16x32_bf16 v[68:71], a[136:139], a[84:87], v[68:71]
  buffer_load_dwordx4 a[12:15], v11, s[12:15], s17 offen offset:0 sc1
  v_add_f32 v28, v28, v29
  v_mfma_f32_16x16x32_bf16 v[72:75], a[136:139], a[88:91], v[72:75]
  v_add_f32 v30, v30, v31
  v_mfma_f32_16x16x32_bf16 v[76:79], a[136:139], a[92:95], v[76:79]
  v_add_f32 v21, v28, v30
  s_waitcnt lgkmcnt(1)
  v_mfma_f32_16x16x32_bf16 v[80:83], a[140:143], a[80:83], v[80:83]
  ds_read_b128 a[132:135], v3 offset:18432
  v_accvgpr_read_b32 v28, a184
  v_accvgpr_read_b32 v29, a186
  v_mfma_f32_16x16x32_bf16 v[84:87], a[140:143], a[84:87], v[84:87]
  v_accvgpr_read_b32 v30, a188
  v_mfma_f32_16x16x32_bf16 v[88:91], a[140:143], a[88:91], v[88:91]
  v_accvgpr_read_b32 v31, a190
  v_mfma_f32_16x16x32_bf16 v[92:95], a[140:143], a[92:95], v[92:95]
  ds_read_b128 a[136:139], v3 offset:25600
  v_add_f32 v28, v28, v29
  v_mfma_f32_16x16x32_bf16 v[96:99], a[144:147], a[80:83], v[96:99]
  buffer_load_dwordx4 a[16:19], v8, s[12:15], s17 offen offset:1024 sc1
  v_add_f32 v30, v30, v31
  v_mfma_f32_16x16x32_bf16 v[100:103], a[144:147], a[84:87], v[100:103]
  v_add_f32 v23, v28, v30
  v_mfma_f32_16x16x32_bf16 v[104:107], a[144:147], a[88:91], v[104:107]
  v_mov_b32 v24, v17
  v_mfma_f32_16x16x32_bf16 v[108:111], a[144:147], a[92:95], v[108:111]
  ds_read_b128 a[140:143], v3 offset:19456
  v_mov_b32 v25, v19
  v_mfma_f32_16x16x32_bf16 v[112:115], a[148:151], a[80:83], v[112:115]
  v_mov_b32 v26, v21
  v_mov_b32 v27, v23
  v_mfma_f32_16x16x32_bf16 v[116:119], a[148:151], a[84:87], v[116:119]
  s_nop 1
  v_mfma_f32_16x16x32_bf16 v[120:123], a[148:151], a[88:91], v[120:123]
  v_permlane16_swap_b32 v17, v24
  v_mfma_f32_16x16x32_bf16 v[124:127], a[148:151], a[92:95], v[124:127]
  ds_read_b128 a[144:147], v3 offset:26624
  buffer_load_dwordx4 a[20:23], v9, s[12:15], s17 offen offset:1024 sc1
  v_permlane16_swap_b32 v19, v25
  v_mfma_f32_16x16x32_bf16 v[128:131], a[152:155], a[80:83], v[128:131]
  v_permlane16_swap_b32 v21, v26
  v_mfma_f32_16x16x32_bf16 v[132:135], a[152:155], a[84:87], v[132:135]
  v_permlane16_swap_b32 v23, v27
  v_mfma_f32_16x16x32_bf16 v[136:139], a[152:155], a[88:91], v[136:139]
  ds_read_b128 a[148:151], v13 offset:14336
  s_nop 1
  v_mfma_f32_16x16x32_bf16 v[140:143], a[152:155], a[92:95], v[140:143]
  v_add_f32 v17, v17, v24
  s_waitcnt lgkmcnt(2)
  v_mfma_f32_16x16x32_bf16 v[144:147], a[128:131], a[80:83], v[144:147]
  v_add_f32 v19, v19, v25
  v_add_f32 v21, v21, v26
  v_mfma_f32_16x16x32_bf16 v[148:151], a[128:131], a[84:87], v[148:151]
  v_add_f32 v23, v23, v27
  v_mfma_f32_16x16x32_bf16 v[152:155], a[128:131], a[88:91], v[152:155]
  ds_read_b128 a[152:155], v13 offset:21504
  v_mov_b32 v24, v17
  v_mfma_f32_16x16x32_bf16 v[156:159], a[128:131], a[92:95], v[156:159]
  buffer_load_dwordx4 a[24:27], v10, s[12:15], s17 offen offset:1024 sc1
  v_mov_b32 v25, v19
  v_mfma_f32_16x16x32_bf16 v[160:163], a[132:135], a[80:83], v[160:163]
  v_mov_b32 v26, v21
  v_mfma_f32_16x16x32_bf16 v[164:167], a[132:135], a[84:87], v[164:167]
  v_mov_b32 v27, v23
  v_mfma_f32_16x16x32_bf16 v[168:171], a[132:135], a[88:91], v[168:171]
  s_nop 1
  v_mfma_f32_16x16x32_bf16 v[172:175], a[132:135], a[92:95], v[172:175]
  v_permlane32_swap_b32 v17, v24
  v_permlane32_swap_b32 v19, v25
  v_mfma_f32_16x16x32_bf16 v[176:179], a[136:139], a[80:83], v[176:179]
  v_permlane32_swap_b32 v21, v26
  v_mfma_f32_16x16x32_bf16 v[180:183], a[136:139], a[84:87], v[180:183]
  v_permlane32_swap_b32 v23, v27
  v_mfma_f32_16x16x32_bf16 v[184:187], a[136:139], a[88:91], v[184:187]
  buffer_load_dwordx4 a[28:31], v11, s[12:15], s17 offen offset:1024 sc1
  s_add_u32 s17, s17, 2048
  s_nop 1
  v_mfma_f32_16x16x32_bf16 v[188:191], a[136:139], a[92:95], v[188:191]
  v_add_f32 v17, v17, v24
  v_mfma_f32_16x16x32_bf16 v[192:195], a[140:143], a[80:83], v[192:195]
  v_add_f32 v19, v19, v25
  v_mfma_f32_16x16x32_bf16 v[196:199], a[140:143], a[84:87], v[196:199]
  v_add_f32 v21, v21, v26
  v_mfma_f32_16x16x32_bf16 v[200:203], a[140:143], a[88:91], v[200:203]
  v_add_f32 v23, v23, v27
  v_mfma_f32_16x16x32_bf16 v[204:207], a[140:143], a[92:95], v[204:207]
  v_mul_f32 v17, 0x3d800000, v17
  v_mul_f32 v19, 0x3d800000, v19
  s_waitcnt vmcnt(25) lgkmcnt(0)
  s_barrier
  v_mfma_f32_16x16x32_bf16 v[208:211], a[144:147], a[80:83], v[208:211]
  ds_read_b128 a[128:131], v3 offset:28672
  v_mul_f32 v21, 0x3d800000, v21
  v_mfma_f32_16x16x32_bf16 v[212:215], a[144:147], a[84:87], v[212:215]
  v_mul_f32 v23, 0x3d800000, v23
  v_mfma_f32_16x16x32_bf16 v[216:219], a[144:147], a[88:91], v[216:219]
  s_add_u32 m0, s18, 28672
  v_accvgpr_read_b32 v24, a160
  v_mfma_f32_16x16x32_bf16 v[220:223], a[144:147], a[92:95], v[220:223]
  ds_read_b128 a[132:135], v3 offset:35840
  buffer_load_dwordx4 v4, s[8:11], s16 offen offset:0  lds
  v_accvgpr_read_b32 v25, a161
  v_mfma_f32_16x16x32_bf16 v[224:227], a[148:151], a[80:83], v[224:227]
  v_accvgpr_read_b32 v26, a162
  v_mfma_f32_16x16x32_bf16 v[228:231], a[148:151], a[84:87], v[228:231]
  v_accvgpr_read_b32 v27, a163
  v_mfma_f32_16x16x32_bf16 v[232:235], a[148:151], a[88:91], v[232:235]
  v_accvgpr_read_b32 v28, a164
  v_mfma_f32_16x16x32_bf16 v[236:239], a[148:151], a[92:95], v[236:239]
  ds_read_b128 a[136:139], v3 offset:29696
  v_accvgpr_read_b32 v29, a165
  v_accvgpr_read_b32 v30, a166
  v_mfma_f32_16x16x32_bf16 v[240:243], a[152:155], a[80:83], v[240:243]
  v_accvgpr_read_b32 v31, a167
  v_mfma_f32_16x16x32_bf16 v[244:247], a[152:155], a[84:87], v[244:247]
  v_sub_f32 v24, v24, v17
  v_mfma_f32_16x16x32_bf16 v[248:251], a[152:155], a[88:91], v[248:251]
  ds_read_b128 a[140:143], v3 offset:36864
  v_sub_f32 v26, v26, v17
  v_mfma_f32_16x16x32_bf16 v[252:255], a[152:155], a[92:95], v[252:255]
  buffer_load_dwordx4 v4, s[8:11], s16 offen offset:1024  lds
  v_sub_f32 v28, v28, v17
  s_waitcnt lgkmcnt(2)
  v_mfma_f32_16x16x32_bf16 v[32:35], a[128:131], a[96:99], v[32:35]
  v_sub_f32 v30, v30, v17
  v_mfma_f32_16x16x32_bf16 v[36:39], a[128:131], a[100:103], v[36:39]
  v_mul_f32 v16, v24, v24
  v_mfma_f32_16x16x32_bf16 v[40:43], a[128:131], a[104:107], v[40:43]
  ds_read_b128 a[144:147], v3 offset:30720
  v_fmac_f32 v16, v26, v26
  v_mfma_f32_16x16x32_bf16 v[44:47], a[128:131], a[108:111], v[44:47]
  v_fmac_f32 v16, v28, v28
  v_fmac_f32 v16, v30, v30
  v_mfma_f32_16x16x32_bf16 v[48:51], a[132:135], a[96:99], v[48:51]
  v_mul_f32 v16, 0x42800000, v16
  v_mfma_f32_16x16x32_bf16 v[52:55], a[132:135], a[100:103], v[52:55]
  v_add_f32 v16, v16, v25
  v_mfma_f32_16x16x32_bf16 v[56:59], a[132:135], a[104:107], v[56:59]
  ds_read_b128 a[148:151], v3 offset:37888
  buffer_load_dwordx4 v4, s[8:11], s16 offen offset:2048  lds
  v_add_f32 v16, v16, v27
  v_mfma_f32_16x16x32_bf16 v[60:63], a[132:135], a[108:111], v[60:63]
  v_add_f32 v16, v16, v29
  s_waitcnt lgkmcnt(2)
  v_mfma_f32_16x16x32_bf16 v[64:67], a[136:139], a[96:99], v[64:67]
  v_add_f32 v16, v16, v31
  v_mfma_f32_16x16x32_bf16 v[68:71], a[136:139], a[100:103], v[68:71]
  ds_read_b128 a[152:155], v3 offset:31744
  v_accvgpr_read_b32 v24, a168
  v_mfma_f32_16x16x32_bf16 v[72:75], a[136:139], a[104:107], v[72:75]
  v_accvgpr_read_b32 v25, a169
  v_mfma_f32_16x16x32_bf16 v[76:79], a[136:139], a[108:111], v[76:79]
  v_accvgpr_read_b32 v26, a170
  v_accvgpr_read_b32 v27, a171
  v_mfma_f32_16x16x32_bf16 v[80:83], a[140:143], a[96:99], v[80:83]
  v_accvgpr_read_b32 v28, a172
  v_mfma_f32_16x16x32_bf16 v[84:87], a[140:143], a[100:103], v[84:87]
  ds_read_b128 a[128:131], v3 offset:38912
  buffer_load_dwordx4 v4, s[8:11], s16 offen offset:3072  lds
  v_accvgpr_read_b32 v29, a173
  v_mfma_f32_16x16x32_bf16 v[88:91], a[140:143], a[104:107], v[88:91]
  v_accvgpr_read_b32 v30, a174
  v_mfma_f32_16x16x32_bf16 v[92:95], a[140:143], a[108:111], v[92:95]
  v_accvgpr_read_b32 v31, a175
  s_waitcnt lgkmcnt(2)
  v_mfma_f32_16x16x32_bf16 v[96:99], a[144:147], a[96:99], v[96:99]
  v_sub_f32 v24, v24, v19
  v_mfma_f32_16x16x32_bf16 v[100:103], a[144:147], a[100:103], v[100:103]
  ds_read_b128 a[132:135], v3 offset:32768
  v_sub_f32 v26, v26, v19
  v_mfma_f32_16x16x32_bf16 v[104:107], a[144:147], a[104:107], v[104:107]
  v_sub_f32 v28, v28, v19
  v_sub_f32 v30, v30, v19
  v_mfma_f32_16x16x32_bf16 v[108:111], a[144:147], a[108:111], v[108:111]
  v_mul_f32 v18, v24, v24
  v_mfma_f32_16x16x32_bf16 v[112:115], a[148:151], a[96:99], v[112:115]
  ds_read_b128 a[136:139], v3 offset:39936
  s_add_u32 m0, s18, 32768
  v_fmac_f32 v18, v26, v26
  v_mfma_f32_16x16x32_bf16 v[116:119], a[148:151], a[100:103], v[116:119]
  buffer_load_dwordx4 v5, s[8:11], s16 offen offset:0  lds
  v_fmac_f32 v18, v28, v28
  v_mfma_f32_16x16x32_bf16 v[120:123], a[148:151], a[104:107], v[120:123]
  v_fmac_f32 v18, v30, v30
  v_mfma_f32_16x16x32_bf16 v[124:127], a[148:151], a[108:111], v[124:127]
  v_mul_f32 v18, 0x42800000, v18
  s_waitcnt lgkmcnt(2)
  v_mfma_f32_16x16x32_bf16 v[128:131], a[152:155], a[96:99], v[128:131]
  ds_read_b128 a[140:143], v3 offset:33792
  v_add_f32 v18, v18, v25
  v_mfma_f32_16x16x32_bf16 v[132:135], a[152:155], a[100:103], v[132:135]
  v_add_f32 v18, v18, v27
  v_mfma_f32_16x16x32_bf16 v[136:139], a[152:155], a[104:107], v[136:139]
  v_add_f32 v18, v18, v29
  v_add_f32 v18, v18, v31
  v_mfma_f32_16x16x32_bf16 v[140:143], a[152:155], a[108:111], v[140:143]
  v_accvgpr_read_b32 v24, a176
  v_mfma_f32_16x16x32_bf16 v[144:147], a[128:131], a[96:99], v[144:147]
  ds_read_b128 a[144:147], v3 offset:40960
  buffer_load_dwordx4 v5, s[8:11], s16 offen offset:1024  lds
  v_accvgpr_read_b32 v25, a177
  v_mfma_f32_16x16x32_bf16 v[148:151], a[128:131], a[100:103], v[148:151]
  v_accvgpr_read_b32 v26, a178
  v_mfma_f32_16x16x32_bf16 v[152:155], a[128:131], a[104:107], v[152:155]
  v_accvgpr_read_b32 v27, a179
  v_mfma_f32_16x16x32_bf16 v[156:159], a[128:131], a[108:111], v[156:159]
  ds_read_b128 a[148:151], v13 offset:28672
  v_accvgpr_read_b32 v28, a180
  s_waitcnt lgkmcnt(2)
  v_mfma_f32_16x16x32_bf16 v[160:163], a[132:135], a[96:99], v[160:163]
  v_accvgpr_read_b32 v29, a181
  v_mfma_f32_16x16x32_bf16 v[164:167], a[132:135], a[100:103], v[164:167]
  v_accvgpr_read_b32 v30, a182
  v_mfma_f32_16x16x32_bf16 v[168:171], a[132:135], a[104:107], v[168:171]
  v_accvgpr_read_b32 v31, a183
  v_sub_f32 v24, v24, v21
  v_mfma_f32_16x16x32_bf16 v[172:175], a[132:135], a[108:111], v[172:175]
  ds_read_b128 a[152:155], v13 offset:35840
  buffer_load_dwordx4 v5, s[8:11], s16 offen offset:2048  lds
  s_add_u32 s16, s16, 917504
  v_sub_f32 v26, v26, v21
  v_mfma_f32_16x16x32_bf16 v[176:179], a[136:139], a[96:99], v[176:179]
  v_sub_f32 v28, v28, v21
  v_mfma_f32_16x16x32_bf16 v[180:183], a[136:139], a[100:103], v[180:183]
  v_sub_f32 v30, v30, v21
  v_mfma_f32_16x16x32_bf16 v[184:187], a[136:139], a[104:107], v[184:187]
  v_mul_f32 v20, v24, v24
  v_mfma_f32_16x16x32_bf16 v[188:191], a[136:139], a[108:111], v[188:191]
  ds_read_b128 a[128:131], v3 offset:43008
  v_fmac_f32 v20, v26, v26
  v_mfma_f32_16x16x32_bf16 v[192:195], a[140:143], a[96:99], v[192:195]
  v_fmac_f32 v20, v28, v28
  v_mfma_f32_16x16x32_bf16 v[196:199], a[140:143], a[100:103], v[196:199]
  v_fmac_f32 v20, v30, v30
  v_mfma_f32_16x16x32_bf16 v[200:203], a[140:143], a[104:107], v[200:203]
  ds_read_b128 a[132:135], v3 offset:50176
  v_mul_f32 v20, 0x42800000, v20
  v_add_f32 v20, v20, v25
  v_mfma_f32_16x16x32_bf16 v[204:207], a[140:143], a[108:111], v[204:207]
  buffer_load_dwordx4 a[32:35], v8, s[12:15], s17 offen offset:0 sc1
  v_add_f32 v20, v20, v27
  s_waitcnt lgkmcnt(2)
  v_mfma_f32_16x16x32_bf16 v[208:211], a[144:147], a[96:99], v[208:211]
  v_add_f32 v20, v20, v29
  v_mfma_f32_16x16x32_bf16 v[212:215], a[144:147], a[100:103], v[212:215]
  v_add_f32 v20, v20, v31
  v_mfma_f32_16x16x32_bf16 v[216:219], a[144:147], a[104:107], v[216:219]
  ds_read_b128 a[136:139], v3 offset:44032
  v_accvgpr_read_b32 v24, a184
  v_mfma_f32_16x16x32_bf16 v[220:223], a[144:147], a[108:111], v[220:223]
  v_accvgpr_read_b32 v25, a185
  v_mfma_f32_16x16x32_bf16 v[224:227], a[148:151], a[96:99], v[224:227]
  v_accvgpr_read_b32 v26, a186
  v_mfma_f32_16x16x32_bf16 v[228:231], a[148:151], a[100:103], v[228:231]
  ds_read_b128 a[140:143], v3 offset:51200
  v_accvgpr_read_b32 v27, a187
  v_accvgpr_read_b32 v28, a188
  v_mfma_f32_16x16x32_bf16 v[232:235], a[148:151], a[104:107], v[232:235]
  buffer_load_dwordx4 a[36:39], v9, s[12:15], s17 offen offset:0 sc1
  v_accvgpr_read_b32 v29, a189
  v_mfma_f32_16x16x32_bf16 v[236:239], a[148:151], a[108:111], v[236:239]
  v_accvgpr_read_b32 v30, a190
  v_mfma_f32_16x16x32_bf16 v[240:243], a[152:155], a[96:99], v[240:243]
  v_accvgpr_read_b32 v31, a191
  v_mfma_f32_16x16x32_bf16 v[244:247], a[152:155], a[100:103], v[244:247]
  ds_read_b128 a[144:147], v3 offset:45056
  v_sub_f32 v24, v24, v23
  v_mfma_f32_16x16x32_bf16 v[248:251], a[152:155], a[104:107], v[248:251]
  v_sub_f32 v26, v26, v23
  v_mfma_f32_16x16x32_bf16 v[252:255], a[152:155], a[108:111], v[252:255]
  v_sub_f32 v28, v28, v23
  s_waitcnt lgkmcnt(2)
  v_mfma_f32_16x16x32_bf16 v[32:35], a[128:131], a[112:115], v[32:35]
  v_sub_f32 v30, v30, v23
  v_mfma_f32_16x16x32_bf16 v[36:39], a[128:131], a[116:119], v[36:39]
  ds_read_b128 a[148:151], v3 offset:52224
  buffer_load_dwordx4 a[40:43], v10, s[12:15], s17 offen offset:0 sc1
  v_mul_f32 v22, v24, v24
  v_fmac_f32 v22, v26, v26
  v_mfma_f32_16x16x32_bf16 v[40:43], a[128:131], a[120:123], v[40:43]
  v_fmac_f32 v22, v28, v28
  v_mfma_f32_16x16x32_bf16 v[44:47], a[128:131], a[124:127], v[44:47]
  v_fmac_f32 v22, v30, v30
  v_mfma_f32_16x16x32_bf16 v[48:51], a[132:135], a[112:115], v[48:51]
  ds_read_b128 a[152:155], v3 offset:46080
  v_mul_f32 v22, 0x42800000, v22
  v_mfma_f32_16x16x32_bf16 v[52:55], a[132:135], a[116:119], v[52:55]
  v_add_f32 v22, v22, v25
  v_mfma_f32_16x16x32_bf16 v[56:59], a[132:135], a[120:123], v[56:59]
  v_add_f32 v22, v22, v27
  v_mfma_f32_16x16x32_bf16 v[60:63], a[132:135], a[124:127], v[60:63]
  v_add_f32 v22, v22, v29
  v_mfma_f32_16x16x32_bf16 v[64:67], a[136:139], a[112:115], v[64:67]
  ds_read_b128 a[128:131], v3 offset:53248
  v_add_f32 v22, v22, v31
  v_mfma_f32_16x16x32_bf16 v[68:71], a[136:139], a[116:119], v[68:71]
  buffer_load_dwordx4 a[44:47], v11, s[12:15], s17 offen offset:0 sc1
  v_mov_b32 v24, v16
  v_mov_b32 v25, v18
  v_mfma_f32_16x16x32_bf16 v[72:75], a[136:139], a[120:123], v[72:75]
  v_mov_b32 v26, v20
  v_mfma_f32_16x16x32_bf16 v[76:79], a[136:139], a[124:127], v[76:79]
  v_mov_b32 v27, v22
  s_waitcnt lgkmcnt(1)
  v_mfma_f32_16x16x32_bf16 v[80:83], a[140:143], a[112:115], v[80:83]
  ds_read_b128 a[132:135], v3 offset:47104
  s_nop 1
  v_mfma_f32_16x16x32_bf16 v[84:87], a[140:143], a[116:119], v[84:87]
  v_permlane16_swap_b32 v16, v24
  v_mfma_f32_16x16x32_bf16 v[88:91], a[140:143], a[120:123], v[88:91]
  v_permlane16_swap_b32 v18, v25
  v_mfma_f32_16x16x32_bf16 v[92:95], a[140:143], a[124:127], v[92:95]
  ds_read_b128 a[136:139], v3 offset:54272
  v_permlane16_swap_b32 v20, v26
  v_mfma_f32_16x16x32_bf16 v[96:99], a[144:147], a[112:115], v[96:99]
  buffer_load_dwordx4 a[48:51], v8, s[12:15], s17 offen offset:1024 sc1
  v_permlane16_swap_b32 v22, v27
  v_mfma_f32_16x16x32_bf16 v[100:103], a[144:147], a[116:119], v[100:103]
  s_nop 1
  v_add_f32 v16, v16, v24
  v_mfma_f32_16x16x32_bf16 v[104:107], a[144:147], a[120:123], v[104:107]
  v_add_f32 v18, v18, v25
  v_mfma_f32_16x16x32_bf16 v[108:111], a[144:147], a[124:127], v[108:111]
  ds_read_b128 a[140:143], v3 offset:48128
  v_add_f32 v20, v20, v26
  v_mfma_f32_16x16x32_bf16 v[112:115], a[148:151], a[112:115], v[112:115]
  v_add_f32 v22, v22, v27
  v_mfma_f32_16x16x32_bf16 v[116:119], a[148:151], a[116:119], v[116:119]
  v_mov_b32 v24, v16
  v_mfma_f32_16x16x32_bf16 v[120:123], a[148:151], a[120:123], v[120:123]
  v_mov_b32 v25, v18
  v_mfma_f32_16x16x32_bf16 v[124:127], a[148:151], a[124:127], v[124:127]
  ds_read_b128 a[144:147], v3 offset:55296
  buffer_load_dwordx4 a[52:55], v9, s[12:15], s17 offen offset:1024 sc1
  v_mov_b32 v26, v20
  v_mfma_f32_16x16x32_bf16 v[128:131], a[152:155], a[112:115], v[128:131]
  v_mov_b32 v27, v22
  s_nop 1
  v_mfma_f32_16x16x32_bf16 v[132:135], a[152:155], a[116:119], v[132:135]
  v_permlane32_swap_b32 v16, v24
  v_mfma_f32_16x16x32_bf16 v[136:139], a[152:155], a[120:123], v[136:139]
  ds_read_b128 a[148:151], v13 offset:43008
  v_permlane32_swap_b32 v18, v25
  v_mfma_f32_16x16x32_bf16 v[140:143], a[152:155], a[124:127], v[140:143]
  v_permlane32_swap_b32 v20, v26
  s_waitcnt lgkmcnt(2)
  v_mfma_f32_16x16x32_bf16 v[144:147], a[128:131], a[112:115], v[144:147]
  v_permlane32_swap_b32 v22, v27
  v_mfma_f32_16x16x32_bf16 v[148:151], a[128:131], a[116:119], v[148:151]
  s_nop 1
  v_mfma_f32_16x16x32_bf16 v[152:155], a[128:131], a[120:123], v[152:155]
  ds_read_b128 a[152:155], v13 offset:50176
  v_add_f32 v16, v16, v24
  v_mfma_f32_16x16x32_bf16 v[156:159], a[128:131], a[124:127], v[156:159]
  buffer_load_dwordx4 a[56:59], v10, s[12:15], s17 offen offset:1024 sc1
  v_add_f32 v18, v18, v25
  v_mfma_f32_16x16x32_bf16 v[160:163], a[132:135], a[112:115], v[160:163]
  v_add_f32 v20, v20, v26
  v_add_f32 v22, v22, v27
  v_mfma_f32_16x16x32_bf16 v[164:167], a[132:135], a[116:119], v[164:167]
  v_mov_b32 v24, 0x3727c5ac
  v_mfma_f32_16x16x32_bf16 v[168:171], a[132:135], a[120:123], v[168:171]
  v_fmac_f32 v24, 0x3a800000, v16
  v_mfma_f32_16x16x32_bf16 v[172:175], a[132:135], a[124:127], v[172:175]
  v_mov_b32 v25, 0x3727c5ac
  v_mfma_f32_16x16x32_bf16 v[176:179], a[136:139], a[112:115], v[176:179]
  v_fmac_f32 v25, 0x3a800000, v18
  v_mfma_f32_16x16x32_bf16 v[180:183], a[136:139], a[116:119], v[180:183]
  v_mov_b32 v26, 0x3727c5ac
  v_mfma_f32_16x16x32_bf16 v[184:187], a[136:139], a[120:123], v[184:187]
  buffer_load_dwordx4 a[60:63], v11, s[12:15], s17 offen offset:1024 sc1
  s_add_u32 s17, s17, 2048
  v_fmac_f32 v26, 0x3a800000, v20
  v_mfma_f32_16x16x32_bf16 v[188:191], a[136:139], a[124:127], v[188:191]
  v_mov_b32 v27, 0x3727c5ac
  v_mfma_f32_16x16x32_bf16 v[192:195], a[140:143], a[112:115], v[192:195]
  v_fmac_f32 v27, 0x3a800000, v22
  v_sqrt_f32 v16, v24
  v_mfma_f32_16x16x32_bf16 v[196:199], a[140:143], a[116:119], v[196:199]
  v_sqrt_f32 v18, v25
  v_mfma_f32_16x16x32_bf16 v[200:203], a[140:143], a[120:123], v[200:203]
  v_sqrt_f32 v20, v26
  v_mfma_f32_16x16x32_bf16 v[204:207], a[140:143], a[124:127], v[204:207]
  v_sqrt_f32 v22, v27
  s_waitcnt vmcnt(15) lgkmcnt(0)
  s_barrier
  v_mfma_f32_16x16x32_bf16 v[208:211], a[144:147], a[112:115], v[208:211]
  ds_read_b128 a[128:131], v7 offset:0
  v_sub_f32 v17, 0, v17
  v_mfma_f32_16x16x32_bf16 v[212:215], a[144:147], a[116:119], v[212:215]
  v_sub_f32 v19, 0, v19
  v_mfma_f32_16x16x32_bf16 v[216:219], a[144:147], a[120:123], v[216:219]
  s_add_u32 m0, s18, 57344
  v_sub_f32 v21, 0, v21
  v_mfma_f32_16x16x32_bf16 v[220:223], a[144:147], a[124:127], v[220:223]
  ds_read_b128 a[132:135], v7 offset:7168
  buffer_load_dwordx4 v4, s[8:11], s16 offen offset:0  lds
  v_sub_f32 v23, 0, v23
  v_mfma_f32_16x16x32_bf16 v[224:227], a[148:151], a[112:115], v[224:227]
  v_lshrrev_b32 v12, 4, v0
  v_and_b32 v6, 1, v12
  v_mfma_f32_16x16x32_bf16 v[228:231], a[148:151], a[116:119], v[228:231]
  v_mul_u32_u24 v6, 114688, v6
  v_mfma_f32_16x16x32_bf16 v[232:235], a[148:151], a[120:123], v[232:235]
  v_lshrrev_b32 v14, 5, v0
  v_mfma_f32_16x16x32_bf16 v[236:239], a[148:151], a[124:127], v[236:239]
  ds_read_b128 a[136:139], v7 offset:1024
  v_lshl_add_u32 v6, v14, 8, v6
  v_mfma_f32_16x16x32_bf16 v[240:243], a[152:155], a[112:115], v[240:243]
  v_and_b32 v14, 15, v0
  v_mfma_f32_16x16x32_bf16 v[244:247], a[152:155], a[116:119], v[244:247]
  v_lshl_add_u32 v6, v14, 4, v6
  v_mfma_f32_16x16x32_bf16 v[248:251], a[152:155], a[120:123], v[248:251]
  ds_read_b128 a[140:143], v7 offset:8192
  v_lshlrev_b32 v12, 4, v12
  v_mfma_f32_16x16x32_bf16 v[252:255], a[152:155], a[124:127], v[252:255]
  buffer_load_dwordx4 v4, s[8:11], s16 offen offset:1024  lds
  v_add_u32 v12, 114688, v12
  s_mov_b32 s19, 2
.p2align 4
L_gemm_38:
  s_waitcnt lgkmcnt(2)
  v_mfma_f32_16x16x32_bf16 v[32:35], a[128:131], a[0:3], v[32:35]
  v_mfma_f32_16x16x32_bf16 v[36:39], a[128:131], a[4:7], v[36:39]
  v_mfma_f32_16x16x32_bf16 v[40:43], a[128:131], a[8:11], v[40:43]
  ds_read_b128 a[144:147], v7 offset:2048
  v_mfma_f32_16x16x32_bf16 v[44:47], a[128:131], a[12:15], v[44:47]
  v_mfma_f32_16x16x32_bf16 v[48:51], a[132:135], a[0:3], v[48:51]
  v_mfma_f32_16x16x32_bf16 v[52:55], a[132:135], a[4:7], v[52:55]
  v_mfma_f32_16x16x32_bf16 v[56:59], a[132:135], a[8:11], v[56:59]
  ds_read_b128 a[148:151], v7 offset:9216
  buffer_load_dwordx4 v4, s[8:11], s16 offen offset:2048  lds
  v_mfma_f32_16x16x32_bf16 v[60:63], a[132:135], a[12:15], v[60:63]
  s_waitcnt lgkmcnt(2)
  v_mfma_f32_16x16x32_bf16 v[64:67], a[136:139], a[0:3], v[64:67]
  v_mfma_f32_16x16x32_bf16 v[68:71], a[136:139], a[4:7], v[68:71]
  ds_read_b128 a[152:155], v7 offset:3072
  v_mfma_f32_16x16x32_bf16 v[72:75], a[136:139], a[8:11], v[72:75]
  v_mfma_f32_16x16x32_bf16 v[76:79], a[136:139], a[12:15], v[76:79]
  v_mfma_f32_16x16x32_bf16 v[80:83], a[140:143], a[0:3], v[80:83]
  v_mfma_f32_16x16x32_bf16 v[84:87], a[140:143], a[4:7], v[84:87]
  ds_read_b128 a[128:131], v7 offset:10240
  buffer_load_dwordx4 v4, s[8:11], s16 offen offset:3072  lds
  v_mfma_f32_16x16x32_bf16 v[88:91], a[140:143], a[8:11], v[88:91]
  v_mfma_f32_16x16x32_bf16 v[92:95], a[140:143], a[12:15], v[92:95]
  s_waitcnt lgkmcnt(2)
  v_mfma_f32_16x16x32_bf16 v[96:99], a[144:147], a[0:3], v[96:99]
  v_mfma_f32_16x16x32_bf16 v[100:103], a[144:147], a[4:7], v[100:103]
  ds_read_b128 a[132:135], v7 offset:4096
  v_mfma_f32_16x16x32_bf16 v[104:107], a[144:147], a[8:11], v[104:107]
  v_mfma_f32_16x16x32_bf16 v[108:111], a[144:147], a[12:15], v[108:111]
  v_mfma_f32_16x16x32_bf16 v[112:115], a[148:151], a[0:3], v[112:115]
  ds_read_b128 a[136:139], v7 offset:11264
  s_add_u32 m0, s18, 61440
  v_mfma_f32_16x16x32_bf16 v[116:119], a[148:151], a[4:7], v[116:119]
  buffer_load_dwordx4 v5, s[8:11], s16 offen offset:0  lds
  v_mfma_f32_16x16x32_bf16 v[120:123], a[148:151], a[8:11], v[120:123]
  v_mfma_f32_16x16x32_bf16 v[124:127], a[148:151], a[12:15], v[124:127]
  s_waitcnt lgkmcnt(2)
  v_mfma_f32_16x16x32_bf16 v[128:131], a[152:155], a[0:3], v[128:131]
  ds_read_b128 a[140:143], v7 offset:5120
  v_mfma_f32_16x16x32_bf16 v[132:135], a[152:155], a[4:7], v[132:135]
  v_mfma_f32_16x16x32_bf16 v[136:139], a[152:155], a[8:11], v[136:139]
  v_mfma_f32_16x16x32_bf16 v[140:143], a[152:155], a[12:15], v[140:143]
  v_mfma_f32_16x16x32_bf16 v[144:147], a[128:131], a[0:3], v[144:147]
  ds_read_b128 a[144:147], v7 offset:12288
  buffer_load_dwordx4 v5, s[8:11], s16 offen offset:1024  lds
  v_mfma_f32_16x16x32_bf16 v[148:151], a[128:131], a[4:7], v[148:151]
  v_mfma_f32_16x16x32_bf16 v[152:155], a[128:131], a[8:11], v[152:155]
  v_mfma_f32_16x16x32_bf16 v[156:159], a[128:131], a[12:15], v[156:159]
  ds_read_b128 a[148:151], v1 offset:0
  s_waitcnt lgkmcnt(2)
  v_mfma_f32_16x16x32_bf16 v[160:163], a[132:135], a[0:3], v[160:163]
  v_mfma_f32_16x16x32_bf16 v[164:167], a[132:135], a[4:7], v[164:167]
  v_mfma_f32_16x16x32_bf16 v[168:171], a[132:135], a[8:11], v[168:171]
  v_mfma_f32_16x16x32_bf16 v[172:175], a[132:135], a[12:15], v[172:175]
  ds_read_b128 a[152:155], v1 offset:7168
  buffer_load_dwordx4 v5, s[8:11], s16 offen offset:2048  lds
  s_add_u32 s16, s16, 917504
  v_mfma_f32_16x16x32_bf16 v[176:179], a[136:139], a[0:3], v[176:179]
  v_mfma_f32_16x16x32_bf16 v[180:183], a[136:139], a[4:7], v[180:183]
  v_mfma_f32_16x16x32_bf16 v[184:187], a[136:139], a[8:11], v[184:187]
  v_mfma_f32_16x16x32_bf16 v[188:191], a[136:139], a[12:15], v[188:191]
  ds_read_b128 a[128:131], v7 offset:14336
  v_mfma_f32_16x16x32_bf16 v[192:195], a[140:143], a[0:3], v[192:195]
  v_mfma_f32_16x16x32_bf16 v[196:199], a[140:143], a[4:7], v[196:199]
  v_mfma_f32_16x16x32_bf16 v[200:203], a[140:143], a[8:11], v[200:203]
  ds_read_b128 a[132:135], v7 offset:21504
  v_mfma_f32_16x16x32_bf16 v[204:207], a[140:143], a[12:15], v[204:207]
  buffer_load_dwordx4 a[64:67], v8, s[12:15], s17 offen offset:0 sc1
  s_waitcnt lgkmcnt(2)
  v_mfma_f32_16x16x32_bf16 v[208:211], a[144:147], a[0:3], v[208:211]
  v_mfma_f32_16x16x32_bf16 v[212:215], a[144:147], a[4:7], v[212:215]
  v_mfma_f32_16x16x32_bf16 v[216:219], a[144:147], a[8:11], v[216:219]
  ds_read_b128 a[136:139], v7 offset:15360
  v_mfma_f32_16x16x32_bf16 v[220:223], a[144:147], a[12:15], v[220:223]
  v_mfma_f32_16x16x32_bf16 v[224:227], a[148:151], a[0:3], v[224:227]
  v_mfma_f32_16x16x32_bf16 v[228:231], a[148:151], a[4:7], v[228:231]
  ds_read_b128 a[140:143], v7 offset:22528
  v_mfma_f32_16x16x32_bf16 v[232:235], a[148:151], a[8:11], v[232:235]
  buffer_load_dwordx4 a[68:71], v9, s[12:15], s17 offen offset:0 sc1
  v_mfma_f32_16x16x32_bf16 v[236:239], a[148:151], a[12:15], v[236:239]
  v_mfma_f32_16x16x32_bf16 v[240:243], a[152:155], a[0:3], v[240:243]
  v_mfma_f32_16x16x32_bf16 v[244:247], a[152:155], a[4:7], v[244:247]
  ds_read_b128 a[144:147], v7 offset:16384
  v_mfma_f32_16x16x32_bf16 v[248:251], a[152:155], a[8:11], v[248:251]
  v_mfma_f32_16x16x32_bf16 v[252:255], a[152:155], a[12:15], v[252:255]
  s_waitcnt lgkmcnt(2)
  v_mfma_f32_16x16x32_bf16 v[32:35], a[128:131], a[16:19], v[32:35]
  v_mfma_f32_16x16x32_bf16 v[36:39], a[128:131], a[20:23], v[36:39]
  ds_read_b128 a[148:151], v7 offset:23552
  buffer_load_dwordx4 a[72:75], v10, s[12:15], s17 offen offset:0 sc1
  v_mfma_f32_16x16x32_bf16 v[40:43], a[128:131], a[24:27], v[40:43]
  v_mfma_f32_16x16x32_bf16 v[44:47], a[128:131], a[28:31], v[44:47]
  v_mfma_f32_16x16x32_bf16 v[48:51], a[132:135], a[16:19], v[48:51]
  ds_read_b128 a[152:155], v7 offset:17408
  v_mfma_f32_16x16x32_bf16 v[52:55], a[132:135], a[20:23], v[52:55]
  v_mfma_f32_16x16x32_bf16 v[56:59], a[132:135], a[24:27], v[56:59]
  v_mfma_f32_16x16x32_bf16 v[60:63], a[132:135], a[28:31], v[60:63]
  v_mfma_f32_16x16x32_bf16 v[64:67], a[136:139], a[16:19], v[64:67]
  ds_read_b128 a[128:131], v7 offset:24576
  v_mfma_f32_16x16x32_bf16 v[68:71], a[136:139], a[20:23], v[68:71]
  buffer_load_dwordx4 a[76:79], v11, s[12:15], s17 offen offset:0 sc1
  v_mfma_f32_16x16x32_bf16 v[72:75], a[136:139], a[24:27], v[72:75]
  v_mfma_f32_16x16x32_bf16 v[76:79], a[136:139], a[28:31], v[76:79]
  s_waitcnt lgkmcnt(1)
  v_mfma_f32_16x16x32_bf16 v[80:83], a[140:143], a[16:19], v[80:83]
  ds_read_b128 a[132:135], v7 offset:18432
  v_mfma_f32_16x16x32_bf16 v[84:87], a[140:143], a[20:23], v[84:87]
  v_mfma_f32_16x16x32_bf16 v[88:91], a[140:143], a[24:27], v[88:91]
  v_mfma_f32_16x16x32_bf16 v[92:95], a[140:143], a[28:31], v[92:95]
  ds_read_b128 a[136:139], v7 offset:25600
  v_mfma_f32_16x16x32_bf16 v[96:99], a[144:147], a[16:19], v[96:99]
  buffer_load_dwordx4 a[80:83], v8, s[12:15], s17 offen offset:1024 sc1
  v_mfma_f32_16x16x32_bf16 v[100:103], a[144:147], a[20:23], v[100:103]
  v_mfma_f32_16x16x32_bf16 v[104:107], a[144:147], a[24:27], v[104:107]
  v_mfma_f32_16x16x32_bf16 v[108:111], a[144:147], a[28:31], v[108:111]
  ds_read_b128 a[140:143], v7 offset:19456
  v_mfma_f32_16x16x32_bf16 v[112:115], a[148:151], a[16:19], v[112:115]
  v_mfma_f32_16x16x32_bf16 v[116:119], a[148:151], a[20:23], v[116:119]
  v_mfma_f32_16x16x32_bf16 v[120:123], a[148:151], a[24:27], v[120:123]
  v_mfma_f32_16x16x32_bf16 v[124:127], a[148:151], a[28:31], v[124:127]
  ds_read_b128 a[144:147], v7 offset:26624
  buffer_load_dwordx4 a[84:87], v9, s[12:15], s17 offen offset:1024 sc1
  v_mfma_f32_16x16x32_bf16 v[128:131], a[152:155], a[16:19], v[128:131]
  v_mfma_f32_16x16x32_bf16 v[132:135], a[152:155], a[20:23], v[132:135]
  v_mfma_f32_16x16x32_bf16 v[136:139], a[152:155], a[24:27], v[136:139]
  ds_read_b128 a[148:151], v1 offset:14336
  v_mfma_f32_16x16x32_bf16 v[140:143], a[152:155], a[28:31], v[140:143]
  s_waitcnt lgkmcnt(2)
  v_mfma_f32_16x16x32_bf16 v[144:147], a[128:131], a[16:19], v[144:147]
  v_mfma_f32_16x16x32_bf16 v[148:151], a[128:131], a[20:23], v[148:151]
  v_mfma_f32_16x16x32_bf16 v[152:155], a[128:131], a[24:27], v[152:155]
  ds_read_b128 a[152:155], v1 offset:21504
  v_mfma_f32_16x16x32_bf16 v[156:159], a[128:131], a[28:31], v[156:159]
  buffer_load_dwordx4 a[88:91], v10, s[12:15], s17 offen offset:1024 sc1
  v_mfma_f32_16x16x32_bf16 v[160:163], a[132:135], a[16:19], v[160:163]
  v_mfma_f32_16x16x32_bf16 v[164:167], a[132:135], a[20:23], v[164:167]
  v_mfma_f32_16x16x32_bf16 v[168:171], a[132:135], a[24:27], v[168:171]
  v_mfma_f32_16x16x32_bf16 v[172:175], a[132:135], a[28:31], v[172:175]
  v_mfma_f32_16x16x32_bf16 v[176:179], a[136:139], a[16:19], v[176:179]
  v_mfma_f32_16x16x32_bf16 v[180:183], a[136:139], a[20:23], v[180:183]
  v_mfma_f32_16x16x32_bf16 v[184:187], a[136:139], a[24:27], v[184:187]
  buffer_load_dwordx4 a[92:95], v11, s[12:15], s17 offen offset:1024 sc1
  s_add_u32 s17, s17, 2048
  v_mfma_f32_16x16x32_bf16 v[188:191], a[136:139], a[28:31], v[188:191]
  v_mfma_f32_16x16x32_bf16 v[192:195], a[140:143], a[16:19], v[192:195]
  v_mfma_f32_16x16x32_bf16 v[196:199], a[140:143], a[20:23], v[196:199]
  v_mfma_f32_16x16x32_bf16 v[200:203], a[140:143], a[24:27], v[200:203]
  v_mfma_f32_16x16x32_bf16 v[204:207], a[140:143], a[28:31], v[204:207]
  s_waitcnt vmcnt(15) lgkmcnt(0)
  s_barrier
  v_mfma_f32_16x16x32_bf16 v[208:211], a[144:147], a[16:19], v[208:211]
  ds_read_b128 a[128:131], v7 offset:28672
  v_mfma_f32_16x16x32_bf16 v[212:215], a[144:147], a[20:23], v[212:215]
  v_mfma_f32_16x16x32_bf16 v[216:219], a[144:147], a[24:27], v[216:219]
  s_add_u32 m0, s18, 86016
  v_mfma_f32_16x16x32_bf16 v[220:223], a[144:147], a[28:31], v[220:223]
  ds_read_b128 a[132:135], v7 offset:35840
  buffer_load_dwordx4 v4, s[8:11], s16 offen offset:0  lds
  v_mfma_f32_16x16x32_bf16 v[224:227], a[148:151], a[16:19], v[224:227]
  v_mfma_f32_16x16x32_bf16 v[228:231], a[148:151], a[20:23], v[228:231]
  v_mfma_f32_16x16x32_bf16 v[232:235], a[148:151], a[24:27], v[232:235]
  v_mfma_f32_16x16x32_bf16 v[236:239], a[148:151], a[28:31], v[236:239]
  ds_read_b128 a[136:139], v7 offset:29696
  v_mfma_f32_16x16x32_bf16 v[240:243], a[152:155], a[16:19], v[240:243]
  v_mfma_f32_16x16x32_bf16 v[244:247], a[152:155], a[20:23], v[244:247]
  v_mfma_f32_16x16x32_bf16 v[248:251], a[152:155], a[24:27], v[248:251]
  ds_read_b128 a[140:143], v7 offset:36864
  buffer_load_dwordx4 v4, s[8:11], s16 offen offset:1024  lds
  v_mfma_f32_16x16x32_bf16 v[252:255], a[152:155], a[28:31], v[252:255]
  s_waitcnt lgkmcnt(2)
  v_mfma_f32_16x16x32_bf16 v[32:35], a[128:131], a[32:35], v[32:35]
  v_mfma_f32_16x16x32_bf16 v[36:39], a[128:131], a[36:39], v[36:39]
  v_mfma_f32_16x16x32_bf16 v[40:43], a[128:131], a[40:43], v[40:43]
  ds_read_b128 a[144:147], v7 offset:30720
  v_mfma_f32_16x16x32_bf16 v[44:47], a[128:131], a[44:47], v[44:47]
  v_mfma_f32_16x16x32_bf16 v[48:51], a[132:135], a[32:35], v[48:51]
  v_mfma_f32_16x16x32_bf16 v[52:55], a[132:135], a[36:39], v[52:55]
  buffer_load_dwordx4 v4, s[8:11], s16 offen offset:2048  lds
  v_mfma_f32_16x16x32_bf16 v[56:59], a[132:135], a[40:43], v[56:59]
  ds_read_b128 a[148:151], v7 offset:37888
  v_mfma_f32_16x16x32_bf16 v[60:63], a[132:135], a[44:47], v[60:63]
  s_waitcnt lgkmcnt(2)
  v_mfma_f32_16x16x32_bf16 v[64:67], a[136:139], a[32:35], v[64:67]
  v_mfma_f32_16x16x32_bf16 v[68:71], a[136:139], a[36:39], v[68:71]
  ds_read_b128 a[152:155], v7 offset:31744
  v_mfma_f32_16x16x32_bf16 v[72:75], a[136:139], a[40:43], v[72:75]
  v_mfma_f32_16x16x32_bf16 v[76:79], a[136:139], a[44:47], v[76:79]
  v_mfma_f32_16x16x32_bf16 v[80:83], a[140:143], a[32:35], v[80:83]
  buffer_load_dwordx4 v4, s[8:11], s16 offen offset:3072  lds
  v_mfma_f32_16x16x32_bf16 v[84:87], a[140:143], a[36:39], v[84:87]
  ds_read_b128 a[128:131], v7 offset:38912
  v_mfma_f32_16x16x32_bf16 v[88:91], a[140:143], a[40:43], v[88:91]
  v_mfma_f32_16x16x32_bf16 v[92:95], a[140:143], a[44:47], v[92:95]
  s_waitcnt lgkmcnt(2)
  v_mfma_f32_16x16x32_bf16 v[96:99], a[144:147], a[32:35], v[96:99]
  v_mfma_f32_16x16x32_bf16 v[100:103], a[144:147], a[36:39], v[100:103]
  ds_read_b128 a[132:135], v7 offset:32768
  s_add_u32 m0, s18, 90112
  v_mfma_f32_16x16x32_bf16 v[104:107], a[144:147], a[40:43], v[104:107]
  buffer_load_dwordx4 v5, s[8:11], s16 offen offset:0  lds
  v_mfma_f32_16x16x32_bf16 v[108:111], a[144:147], a[44:47], v[108:111]
  v_mfma_f32_16x16x32_bf16 v[112:115], a[148:151], a[32:35], v[112:115]
  ds_read_b128 a[136:139], v7 offset:39936
  v_mfma_f32_16x16x32_bf16 v[116:119], a[148:151], a[36:39], v[116:119]
  v_mfma_f32_16x16x32_bf16 v[120:123], a[148:151], a[40:43], v[120:123]
  v_mfma_f32_16x16x32_bf16 v[124:127], a[148:151], a[44:47], v[124:127]
  s_waitcnt lgkmcnt(2)
  v_mfma_f32_16x16x32_bf16 v[128:131], a[152:155], a[32:35], v[128:131]
  ds_read_b128 a[140:143], v7 offset:33792
  v_mfma_f32_16x16x32_bf16 v[132:135], a[152:155], a[36:39], v[132:135]
  buffer_load_dwordx4 v5, s[8:11], s16 offen offset:1024  lds
  v_mfma_f32_16x16x32_bf16 v[136:139], a[152:155], a[40:43], v[136:139]
  v_mfma_f32_16x16x32_bf16 v[140:143], a[152:155], a[44:47], v[140:143]
  v_mfma_f32_16x16x32_bf16 v[144:147], a[128:131], a[32:35], v[144:147]
  ds_read_b128 a[144:147], v7 offset:40960
  v_mfma_f32_16x16x32_bf16 v[148:151], a[128:131], a[36:39], v[148:151]
  v_mfma_f32_16x16x32_bf16 v[152:155], a[128:131], a[40:43], v[152:155]
  v_mfma_f32_16x16x32_bf16 v[156:159], a[128:131], a[44:47], v[156:159]
  ds_read_b128 a[148:151], v1 offset:28672
  s_waitcnt lgkmcnt(2)
  v_mfma_f32_16x16x32_bf16 v[160:163], a[132:135], a[32:35], v[160:163]
  buffer_load_dwordx4 v5, s[8:11], s16 offen offset:2048  lds
  s_add_u32 s16, s16, 917504
  v_mfma_f32_16x16x32_bf16 v[164:167], a[132:135], a[36:39], v[164:167]
  v_mfma_f32_16x16x32_bf16 v[168:171], a[132:135], a[40:43], v[168:171]
  v_mfma_f32_16x16x32_bf16 v[172:175], a[132:135], a[44:47], v[172:175]
  ds_read_b128 a[152:155], v1 offset:35840
  v_mfma_f32_16x16x32_bf16 v[176:179], a[136:139], a[32:35], v[176:179]
  v_mfma_f32_16x16x32_bf16 v[180:183], a[136:139], a[36:39], v[180:183]
  v_mfma_f32_16x16x32_bf16 v[184:187], a[136:139], a[40:43], v[184:187]
  v_mfma_f32_16x16x32_bf16 v[188:191], a[136:139], a[44:47], v[188:191]
  ds_read_b128 a[128:131], v7 offset:43008
  buffer_load_dwordx4 a[96:99], v8, s[12:15], s17 offen offset:0 sc1
  v_mfma_f32_16x16x32_bf16 v[192:195], a[140:143], a[32:35], v[192:195]
  v_mfma_f32_16x16x32_bf16 v[196:199], a[140:143], a[36:39], v[196:199]
  v_mfma_f32_16x16x32_bf16 v[200:203], a[140:143], a[40:43], v[200:203]
  ds_read_b128 a[132:135], v7 offset:50176
  v_mfma_f32_16x16x32_bf16 v[204:207], a[140:143], a[44:47], v[204:207]
  s_waitcnt lgkmcnt(2)
  v_mfma_f32_16x16x32_bf16 v[208:211], a[144:147], a[32:35], v[208:211]
  v_mfma_f32_16x16x32_bf16 v[212:215], a[144:147], a[36:39], v[212:215]
  v_mfma_f32_16x16x32_bf16 v[216:219], a[144:147], a[40:43], v[216:219]
  ds_read_b128 a[136:139], v7 offset:44032
  buffer_load_dwordx4 a[100:103], v9, s[12:15], s17 offen offset:0 sc1
  v_mfma_f32_16x16x32_bf16 v[220:223], a[144:147], a[44:47], v[220:223]
  v_mfma_f32_16x16x32_bf16 v[224:227], a[148:151], a[32:35], v[224:227]
  v_mfma_f32_16x16x32_bf16 v[228:231], a[148:151], a[36:39], v[228:231]
  ds_read_b128 a[140:143], v7 offset:51200
  v_mfma_f32_16x16x32_bf16 v[232:235], a[148:151], a[40:43], v[232:235]
  v_mfma_f32_16x16x32_bf16 v[236:239], a[148:151], a[44:47], v[236:239]
  v_mfma_f32_16x16x32_bf16 v[240:243], a[152:155], a[32:35], v[240:243]
  v_mfma_f32_16x16x32_bf16 v[244:247], a[152:155], a[36:39], v[244:247]
  ds_read_b128 a[144:147], v7 offset:45056
  buffer_load_dwordx4 a[104:107], v10, s[12:15], s17 offen offset:0 sc1
  v_mfma_f32_16x16x32_bf16 v[248:251], a[152:155], a[40:43], v[248:251]
  v_mfma_f32_16x16x32_bf16 v[252:255], a[152:155], a[44:47], v[252:255]
  s_waitcnt lgkmcnt(2)
  v_mfma_f32_16x16x32_bf16 v[32:35], a[128:131], a[48:51], v[32:35]
  v_mfma_f32_16x16x32_bf16 v[36:39], a[128:131], a[52:55], v[36:39]
  ds_read_b128 a[148:151], v7 offset:52224
  v_mfma_f32_16x16x32_bf16 v[40:43], a[128:131], a[56:59], v[40:43]
  v_mfma_f32_16x16x32_bf16 v[44:47], a[128:131], a[60:63], v[44:47]
  v_mfma_f32_16x16x32_bf16 v[48:51], a[132:135], a[48:51], v[48:51]
  ds_read_b128 a[152:155], v7 offset:46080
  buffer_load_dwordx4 a[108:111], v11, s[12:15], s17 offen offset:0 sc1
  v_mfma_f32_16x16x32_bf16 v[52:55], a[132:135], a[52:55], v[52:55]
  v_mfma_f32_16x16x32_bf16 v[56:59], a[132:135], a[56:59], v[56:59]
  v_mfma_f32_16x16x32_bf16 v[60:63], a[132:135], a[60:63], v[60:63]
  v_mfma_f32_16x16x32_bf16 v[64:67], a[136:139], a[48:51], v[64:67]
  ds_read_b128 a[128:131], v7 offset:53248
  v_mfma_f32_16x16x32_bf16 v[68:71], a[136:139], a[52:55], v[68:71]
  v_mfma_f32_16x16x32_bf16 v[72:75], a[136:139], a[56:59], v[72:75]
  v_mfma_f32_16x16x32_bf16 v[76:79], a[136:139], a[60:63], v[76:79]
  buffer_load_dwordx4 a[112:115], v8, s[12:15], s17 offen offset:1024 sc1
  s_waitcnt lgkmcnt(1)
  v_mfma_f32_16x16x32_bf16 v[80:83], a[140:143], a[48:51], v[80:83]
  ds_read_b128 a[132:135], v7 offset:47104
  v_mfma_f32_16x16x32_bf16 v[84:87], a[140:143], a[52:55], v[84:87]
  v_mfma_f32_16x16x32_bf16 v[88:91], a[140:143], a[56:59], v[88:91]
  v_mfma_f32_16x16x32_bf16 v[92:95], a[140:143], a[60:63], v[92:95]
  ds_read_b128 a[136:139], v7 offset:54272
  v_mfma_f32_16x16x32_bf16 v[96:99], a[144:147], a[48:51], v[96:99]
  v_mfma_f32_16x16x32_bf16 v[100:103], a[144:147], a[52:55], v[100:103]
  buffer_load_dwordx4 a[116:119], v9, s[12:15], s17 offen offset:1024 sc1
  v_mfma_f32_16x16x32_bf16 v[104:107], a[144:147], a[56:59], v[104:107]
  v_mfma_f32_16x16x32_bf16 v[108:111], a[144:147], a[60:63], v[108:111]
  ds_read_b128 a[140:143], v7 offset:48128
  v_mfma_f32_16x16x32_bf16 v[112:115], a[148:151], a[48:51], v[112:115]
  v_mfma_f32_16x16x32_bf16 v[116:119], a[148:151], a[52:55], v[116:119]
  v_mfma_f32_16x16x32_bf16 v[120:123], a[148:151], a[56:59], v[120:123]
  v_mfma_f32_16x16x32_bf16 v[124:127], a[148:151], a[60:63], v[124:127]
  ds_read_b128 a[144:147], v7 offset:55296
  v_mfma_f32_16x16x32_bf16 v[128:131], a[152:155], a[48:51], v[128:131]
  buffer_load_dwordx4 a[120:123], v10, s[12:15], s17 offen offset:1024 sc1
  v_mfma_f32_16x16x32_bf16 v[132:135], a[152:155], a[52:55], v[132:135]
  v_mfma_f32_16x16x32_bf16 v[136:139], a[152:155], a[56:59], v[136:139]
  ds_read_b128 a[148:151], v1 offset:43008
  v_mfma_f32_16x16x32_bf16 v[140:143], a[152:155], a[60:63], v[140:143]
  s_waitcnt lgkmcnt(2)
  v_mfma_f32_16x16x32_bf16 v[144:147], a[128:131], a[48:51], v[144:147]
  v_mfma_f32_16x16x32_bf16 v[148:151], a[128:131], a[52:55], v[148:151]
  v_mfma_f32_16x16x32_bf16 v[152:155], a[128:131], a[56:59], v[152:155]
  ds_read_b128 a[152:155], v1 offset:50176
  v_mfma_f32_16x16x32_bf16 v[156:159], a[128:131], a[60:63], v[156:159]
  buffer_load_dwordx4 a[124:127], v11, s[12:15], s17 offen offset:1024 sc1
  s_add_u32 s17, s17, 2048
  v_mfma_f32_16x16x32_bf16 v[160:163], a[132:135], a[48:51], v[160:163]
  v_mfma_f32_16x16x32_bf16 v[164:167], a[132:135], a[52:55], v[164:167]
  v_mfma_f32_16x16x32_bf16 v[168:171], a[132:135], a[56:59], v[168:171]
  v_mfma_f32_16x16x32_bf16 v[172:175], a[132:135], a[60:63], v[172:175]
  v_mfma_f32_16x16x32_bf16 v[176:179], a[136:139], a[48:51], v[176:179]
  v_mfma_f32_16x16x32_bf16 v[180:183], a[136:139], a[52:55], v[180:183]
  v_mfma_f32_16x16x32_bf16 v[184:187], a[136:139], a[56:59], v[184:187]
  buffer_load_dword a208, v15, s[28:31], s66 offen
  v_mfma_f32_16x16x32_bf16 v[188:191], a[136:139], a[60:63], v[188:191]
  v_mfma_f32_16x16x32_bf16 v[192:195], a[140:143], a[48:51], v[192:195]
  v_mfma_f32_16x16x32_bf16 v[196:199], a[140:143], a[52:55], v[196:199]
  v_mfma_f32_16x16x32_bf16 v[200:203], a[140:143], a[56:59], v[200:203]
  v_mfma_f32_16x16x32_bf16 v[204:207], a[140:143], a[60:63], v[204:207]
  s_waitcnt vmcnt(16) lgkmcnt(0)
  s_barrier
  v_mfma_f32_16x16x32_bf16 v[208:211], a[144:147], a[48:51], v[208:211]
  ds_read_b128 a[128:131], v3 offset:0
  v_mfma_f32_16x16x32_bf16 v[212:215], a[144:147], a[52:55], v[212:215]
  v_mfma_f32_16x16x32_bf16 v[216:219], a[144:147], a[56:59], v[216:219]
  s_add_u32 m0, s18, 0
  v_mfma_f32_16x16x32_bf16 v[220:223], a[144:147], a[60:63], v[220:223]
  ds_read_b128 a[132:135], v3 offset:7168
  buffer_load_dwordx4 v4, s[8:11], s16 offen offset:0  lds
  v_mfma_f32_16x16x32_bf16 v[224:227], a[148:151], a[48:51], v[224:227]
  v_mfma_f32_16x16x32_bf16 v[228:231], a[148:151], a[52:55], v[228:231]
  v_mfma_f32_16x16x32_bf16 v[232:235], a[148:151], a[56:59], v[232:235]
  v_mfma_f32_16x16x32_bf16 v[236:239], a[148:151], a[60:63], v[236:239]
  ds_read_b128 a[136:139], v3 offset:1024
  v_mfma_f32_16x16x32_bf16 v[240:243], a[152:155], a[48:51], v[240:243]
  v_mfma_f32_16x16x32_bf16 v[244:247], a[152:155], a[52:55], v[244:247]
  v_mfma_f32_16x16x32_bf16 v[248:251], a[152:155], a[56:59], v[248:251]
  ds_read_b128 a[140:143], v3 offset:8192
  v_mfma_f32_16x16x32_bf16 v[252:255], a[152:155], a[60:63], v[252:255]
  buffer_load_dwordx4 v4, s[8:11], s16 offen offset:1024  lds
  s_waitcnt lgkmcnt(2)
  v_mfma_f32_16x16x32_bf16 v[32:35], a[128:131], a[64:67], v[32:35]
  v_mfma_f32_16x16x32_bf16 v[36:39], a[128:131], a[68:71], v[36:39]
  v_mfma_f32_16x16x32_bf16 v[40:43], a[128:131], a[72:75], v[40:43]
  ds_read_b128 a[144:147], v3 offset:2048
  v_mfma_f32_16x16x32_bf16 v[44:47], a[128:131], a[76:79], v[44:47]
  v_mfma_f32_16x16x32_bf16 v[48:51], a[132:135], a[64:67], v[48:51]
  v_mfma_f32_16x16x32_bf16 v[52:55], a[132:135], a[68:71], v[52:55]
  v_mfma_f32_16x16x32_bf16 v[56:59], a[132:135], a[72:75], v[56:59]
  ds_read_b128 a[148:151], v3 offset:9216
  buffer_load_dwordx4 v4, s[8:11], s16 offen offset:2048  lds
  v_mfma_f32_16x16x32_bf16 v[60:63], a[132:135], a[76:79], v[60:63]
  s_waitcnt lgkmcnt(2)
  v_mfma_f32_16x16x32_bf16 v[64:67], a[136:139], a[64:67], v[64:67]
  v_mfma_f32_16x16x32_bf16 v[68:71], a[136:139], a[68:71], v[68:71]
  ds_read_b128 a[152:155], v3 offset:3072
  v_mfma_f32_16x16x32_bf16 v[72:75], a[136:139], a[72:75], v[72:75]
  v_mfma_f32_16x16x32_bf16 v[76:79], a[136:139], a[76:79], v[76:79]
  v_mfma_f32_16x16x32_bf16 v[80:83], a[140:143], a[64:67], v[80:83]
  v_mfma_f32_16x16x32_bf16 v[84:87], a[140:143], a[68:71], v[84:87]
  ds_read_b128 a[128:131], v3 offset:10240
  buffer_load_dwordx4 v4, s[8:11], s16 offen offset:3072  lds
  v_mfma_f32_16x16x32_bf16 v[88:91], a[140:143], a[72:75], v[88:91]
  v_mfma_f32_16x16x32_bf16 v[92:95], a[140:143], a[76:79], v[92:95]
  s_waitcnt lgkmcnt(2)
  v_mfma_f32_16x16x32_bf16 v[96:99], a[144:147], a[64:67], v[96:99]
  v_mfma_f32_16x16x32_bf16 v[100:103], a[144:147], a[68:71], v[100:103]
  ds_read_b128 a[132:135], v3 offset:4096
  v_mfma_f32_16x16x32_bf16 v[104:107], a[144:147], a[72:75], v[104:107]
  v_mfma_f32_16x16x32_bf16 v[108:111], a[144:147], a[76:79], v[108:111]
  v_mfma_f32_16x16x32_bf16 v[112:115], a[148:151], a[64:67], v[112:115]
  ds_read_b128 a[136:139], v3 offset:11264
  s_add_u32 m0, s18, 4096
  v_mfma_f32_16x16x32_bf16 v[116:119], a[148:151], a[68:71], v[116:119]
  buffer_load_dwordx4 v5, s[8:11], s16 offen offset:0  lds
  v_mfma_f32_16x16x32_bf16 v[120:123], a[148:151], a[72:75], v[120:123]
  v_mfma_f32_16x16x32_bf16 v[124:127], a[148:151], a[76:79], v[124:127]
  s_waitcnt lgkmcnt(2)
  v_mfma_f32_16x16x32_bf16 v[128:131], a[152:155], a[64:67], v[128:131]
  ds_read_b128 a[140:143], v3 offset:5120
  v_mfma_f32_16x16x32_bf16 v[132:135], a[152:155], a[68:71], v[132:135]
  v_mfma_f32_16x16x32_bf16 v[136:139], a[152:155], a[72:75], v[136:139]
  v_mfma_f32_16x16x32_bf16 v[140:143], a[152:155], a[76:79], v[140:143]
  v_mfma_f32_16x16x32_bf16 v[144:147], a[128:131], a[64:67], v[144:147]
  ds_read_b128 a[144:147], v3 offset:12288
  buffer_load_dwordx4 v5, s[8:11], s16 offen offset:1024  lds
  v_mfma_f32_16x16x32_bf16 v[148:151], a[128:131], a[68:71], v[148:151]
  v_mfma_f32_16x16x32_bf16 v[152:155], a[128:131], a[72:75], v[152:155]
  v_mfma_f32_16x16x32_bf16 v[156:159], a[128:131], a[76:79], v[156:159]
  ds_read_b128 a[148:151], v13 offset:0
  s_waitcnt lgkmcnt(2)
  v_mfma_f32_16x16x32_bf16 v[160:163], a[132:135], a[64:67], v[160:163]
  v_mfma_f32_16x16x32_bf16 v[164:167], a[132:135], a[68:71], v[164:167]
  v_mfma_f32_16x16x32_bf16 v[168:171], a[132:135], a[72:75], v[168:171]
  v_mfma_f32_16x16x32_bf16 v[172:175], a[132:135], a[76:79], v[172:175]
  ds_read_b128 a[152:155], v13 offset:7168
  buffer_load_dwordx4 v5, s[8:11], s16 offen offset:2048  lds
  s_add_u32 s16, s16, 917504
  v_mfma_f32_16x16x32_bf16 v[176:179], a[136:139], a[64:67], v[176:179]
  v_mfma_f32_16x16x32_bf16 v[180:183], a[136:139], a[68:71], v[180:183]
  v_mfma_f32_16x16x32_bf16 v[184:187], a[136:139], a[72:75], v[184:187]
  v_mfma_f32_16x16x32_bf16 v[188:191], a[136:139], a[76:79], v[188:191]
  ds_read_b128 a[128:131], v3 offset:14336
  v_mfma_f32_16x16x32_bf16 v[192:195], a[140:143], a[64:67], v[192:195]
  v_mfma_f32_16x16x32_bf16 v[196:199], a[140:143], a[68:71], v[196:199]
  v_mfma_f32_16x16x32_bf16 v[200:203], a[140:143], a[72:75], v[200:203]
  ds_read_b128 a[132:135], v3 offset:21504
  v_mfma_f32_16x16x32_bf16 v[204:207], a[140:143], a[76:79], v[204:207]
  buffer_load_dwordx4 a[0:3], v8, s[12:15], s17 offen offset:0 sc1
  s_waitcnt lgkmcnt(2)
  v_mfma_f32_16x16x32_bf16 v[208:211], a[144:147], a[64:67], v[208:211]
  v_mfma_f32_16x16x32_bf16 v[212:215], a[144:147], a[68:71], v[212:215]
  v_mfma_f32_16x16x32_bf16 v[216:219], a[144:147], a[72:75], v[216:219]
  ds_read_b128 a[136:139], v3 offset:15360
  v_mfma_f32_16x16x32_bf16 v[220:223], a[144:147], a[76:79], v[220:223]
  v_mfma_f32_16x16x32_bf16 v[224:227], a[148:151], a[64:67], v[224:227]
  v_mfma_f32_16x16x32_bf16 v[228:231], a[148:151], a[68:71], v[228:231]
  ds_read_b128 a[140:143], v3 offset:22528
  v_mfma_f32_16x16x32_bf16 v[232:235], a[148:151], a[72:75], v[232:235]
  buffer_load_dwordx4 a[4:7], v9, s[12:15], s17 offen offset:0 sc1
  v_mfma_f32_16x16x32_bf16 v[236:239], a[148:151], a[76:79], v[236:239]
  v_mfma_f32_16x16x32_bf16 v[240:243], a[152:155], a[64:67], v[240:243]
  v_mfma_f32_16x16x32_bf16 v[244:247], a[152:155], a[68:71], v[244:247]
  ds_read_b128 a[144:147], v3 offset:16384
  v_mfma_f32_16x16x32_bf16 v[248:251], a[152:155], a[72:75], v[248:251]
  v_mfma_f32_16x16x32_bf16 v[252:255], a[152:155], a[76:79], v[252:255]
  s_waitcnt lgkmcnt(2)
  v_mfma_f32_16x16x32_bf16 v[32:35], a[128:131], a[80:83], v[32:35]
  v_mfma_f32_16x16x32_bf16 v[36:39], a[128:131], a[84:87], v[36:39]
  ds_read_b128 a[148:151], v3 offset:23552
  buffer_load_dwordx4 a[8:11], v10, s[12:15], s17 offen offset:0 sc1
  v_mfma_f32_16x16x32_bf16 v[40:43], a[128:131], a[88:91], v[40:43]
  v_mfma_f32_16x16x32_bf16 v[44:47], a[128:131], a[92:95], v[44:47]
  v_mfma_f32_16x16x32_bf16 v[48:51], a[132:135], a[80:83], v[48:51]
  ds_read_b128 a[152:155], v3 offset:17408
  v_mfma_f32_16x16x32_bf16 v[52:55], a[132:135], a[84:87], v[52:55]
  v_mfma_f32_16x16x32_bf16 v[56:59], a[132:135], a[88:91], v[56:59]
  v_mfma_f32_16x16x32_bf16 v[60:63], a[132:135], a[92:95], v[60:63]
  v_mfma_f32_16x16x32_bf16 v[64:67], a[136:139], a[80:83], v[64:67]
  ds_read_b128 a[128:131], v3 offset:24576
  v_mfma_f32_16x16x32_bf16 v[68:71], a[136:139], a[84:87], v[68:71]
  buffer_load_dwordx4 a[12:15], v11, s[12:15], s17 offen offset:0 sc1
  v_mfma_f32_16x16x32_bf16 v[72:75], a[136:139], a[88:91], v[72:75]
  v_mfma_f32_16x16x32_bf16 v[76:79], a[136:139], a[92:95], v[76:79]
  s_waitcnt lgkmcnt(1)
  v_mfma_f32_16x16x32_bf16 v[80:83], a[140:143], a[80:83], v[80:83]
  ds_read_b128 a[132:135], v3 offset:18432
  v_mfma_f32_16x16x32_bf16 v[84:87], a[140:143], a[84:87], v[84:87]
  v_mfma_f32_16x16x32_bf16 v[88:91], a[140:143], a[88:91], v[88:91]
  v_mfma_f32_16x16x32_bf16 v[92:95], a[140:143], a[92:95], v[92:95]
  ds_read_b128 a[136:139], v3 offset:25600
  v_mfma_f32_16x16x32_bf16 v[96:99], a[144:147], a[80:83], v[96:99]
  buffer_load_dwordx4 a[16:19], v8, s[12:15], s17 offen offset:1024 sc1
  v_mfma_f32_16x16x32_bf16 v[100:103], a[144:147], a[84:87], v[100:103]
  v_mfma_f32_16x16x32_bf16 v[104:107], a[144:147], a[88:91], v[104:107]
  v_mfma_f32_16x16x32_bf16 v[108:111], a[144:147], a[92:95], v[108:111]
  ds_read_b128 a[140:143], v3 offset:19456
  v_mfma_f32_16x16x32_bf16 v[112:115], a[148:151], a[80:83], v[112:115]
  v_mfma_f32_16x16x32_bf16 v[116:119], a[148:151], a[84:87], v[116:119]
  v_mfma_f32_16x16x32_bf16 v[120:123], a[148:151], a[88:91], v[120:123]
  v_mfma_f32_16x16x32_bf16 v[124:127], a[148:151], a[92:95], v[124:127]
  ds_read_b128 a[144:147], v3 offset:26624
  buffer_load_dwordx4 a[20:23], v9, s[12:15], s17 offen offset:1024 sc1
  v_mfma_f32_16x16x32_bf16 v[128:131], a[152:155], a[80:83], v[128:131]
  v_mfma_f32_16x16x32_bf16 v[132:135], a[152:155], a[84:87], v[132:135]
  v_mfma_f32_16x16x32_bf16 v[136:139], a[152:155], a[88:91], v[136:139]
  ds_read_b128 a[148:151], v13 offset:14336
  v_mfma_f32_16x16x32_bf16 v[140:143], a[152:155], a[92:95], v[140:143]
  s_waitcnt lgkmcnt(2)
  v_mfma_f32_16x16x32_bf16 v[144:147], a[128:131], a[80:83], v[144:147]
  v_mfma_f32_16x16x32_bf16 v[148:151], a[128:131], a[84:87], v[148:151]
  v_mfma_f32_16x16x32_bf16 v[152:155], a[128:131], a[88:91], v[152:155]
  ds_read_b128 a[152:155], v13 offset:21504
  v_mfma_f32_16x16x32_bf16 v[156:159], a[128:131], a[92:95], v[156:159]
  buffer_load_dwordx4 a[24:27], v10, s[12:15], s17 offen offset:1024 sc1
  v_mfma_f32_16x16x32_bf16 v[160:163], a[132:135], a[80:83], v[160:163]
  v_mfma_f32_16x16x32_bf16 v[164:167], a[132:135], a[84:87], v[164:167]
  v_mfma_f32_16x16x32_bf16 v[168:171], a[132:135], a[88:91], v[168:171]
  v_mfma_f32_16x16x32_bf16 v[172:175], a[132:135], a[92:95], v[172:175]
  v_mfma_f32_16x16x32_bf16 v[176:179], a[136:139], a[80:83], v[176:179]
  v_mfma_f32_16x16x32_bf16 v[180:183], a[136:139], a[84:87], v[180:183]
  v_mfma_f32_16x16x32_bf16 v[184:187], a[136:139], a[88:91], v[184:187]
  buffer_load_dwordx4 a[28:31], v11, s[12:15], s17 offen offset:1024 sc1
  s_add_u32 s17, s17, 2048
  v_mfma_f32_16x16x32_bf16 v[188:191], a[136:139], a[92:95], v[188:191]
  v_mfma_f32_16x16x32_bf16 v[192:195], a[140:143], a[80:83], v[192:195]
  v_mfma_f32_16x16x32_bf16 v[196:199], a[140:143], a[84:87], v[196:199]
  v_mfma_f32_16x16x32_bf16 v[200:203], a[140:143], a[88:91], v[200:203]
  v_mfma_f32_16x16x32_bf16 v[204:207], a[140:143], a[92:95], v[204:207]
  s_waitcnt vmcnt(16) lgkmcnt(0)
  s_barrier
  v_mfma_f32_16x16x32_bf16 v[208:211], a[144:147], a[80:83], v[208:211]
  ds_read_b128 a[128:131], v3 offset:28672
  v_mfma_f32_16x16x32_bf16 v[212:215], a[144:147], a[84:87], v[212:215]
  v_mfma_f32_16x16x32_bf16 v[216:219], a[144:147], a[88:91], v[216:219]
  s_add_u32 m0, s18, 28672
  v_mfma_f32_16x16x32_bf16 v[220:223], a[144:147], a[92:95], v[220:223]
  ds_read_b128 a[132:135], v3 offset:35840
  buffer_load_dwordx4 v4, s[8:11], s16 offen offset:0  lds
  v_mfma_f32_16x16x32_bf16 v[224:227], a[148:151], a[80:83], v[224:227]
  v_mfma_f32_16x16x32_bf16 v[228:231], a[148:151], a[84:87], v[228:231]
  v_mfma_f32_16x16x32_bf16 v[232:235], a[148:151], a[88:91], v[232:235]
  v_mfma_f32_16x16x32_bf16 v[236:239], a[148:151], a[92:95], v[236:239]
  ds_read_b128 a[136:139], v3 offset:29696
  v_mfma_f32_16x16x32_bf16 v[240:243], a[152:155], a[80:83], v[240:243]
  v_mfma_f32_16x16x32_bf16 v[244:247], a[152:155], a[84:87], v[244:247]
  v_mfma_f32_16x16x32_bf16 v[248:251], a[152:155], a[88:91], v[248:251]
  ds_read_b128 a[140:143], v3 offset:36864
  v_mfma_f32_16x16x32_bf16 v[252:255], a[152:155], a[92:95], v[252:255]
  buffer_load_dwordx4 v4, s[8:11], s16 offen offset:1024  lds
  s_waitcnt lgkmcnt(2)
  v_mfma_f32_16x16x32_bf16 v[32:35], a[128:131], a[96:99], v[32:35]
  v_mfma_f32_16x16x32_bf16 v[36:39], a[128:131], a[100:103], v[36:39]
  v_mfma_f32_16x16x32_bf16 v[40:43], a[128:131], a[104:107], v[40:43]
  ds_read_b128 a[144:147], v3 offset:30720
  v_mfma_f32_16x16x32_bf16 v[44:47], a[128:131], a[108:111], v[44:47]
  v_mfma_f32_16x16x32_bf16 v[48:51], a[132:135], a[96:99], v[48:51]
  v_mfma_f32_16x16x32_bf16 v[52:55], a[132:135], a[100:103], v[52:55]
  v_mfma_f32_16x16x32_bf16 v[56:59], a[132:135], a[104:107], v[56:59]
  ds_read_b128 a[148:151], v3 offset:37888
  buffer_load_dwordx4 v4, s[8:11], s16 offen offset:2048  lds
  v_mfma_f32_16x16x32_bf16 v[60:63], a[132:135], a[108:111], v[60:63]
  s_waitcnt lgkmcnt(2)
  v_mfma_f32_16x16x32_bf16 v[64:67], a[136:139], a[96:99], v[64:67]
  v_mfma_f32_16x16x32_bf16 v[68:71], a[136:139], a[100:103], v[68:71]
  ds_read_b128 a[152:155], v3 offset:31744
  v_mfma_f32_16x16x32_bf16 v[72:75], a[136:139], a[104:107], v[72:75]
  v_mfma_f32_16x16x32_bf16 v[76:79], a[136:139], a[108:111], v[76:79]
  v_mfma_f32_16x16x32_bf16 v[80:83], a[140:143], a[96:99], v[80:83]
  v_mfma_f32_16x16x32_bf16 v[84:87], a[140:143], a[100:103], v[84:87]
  ds_read_b128 a[128:131], v3 offset:38912
  buffer_load_dwordx4 v4, s[8:11], s16 offen offset:3072  lds
  v_mfma_f32_16x16x32_bf16 v[88:91], a[140:143], a[104:107], v[88:91]
  v_mfma_f32_16x16x32_bf16 v[92:95], a[140:143], a[108:111], v[92:95]
  s_waitcnt lgkmcnt(2)
  v_mfma_f32_16x16x32_bf16 v[96:99], a[144:147], a[96:99], v[96:99]
  v_mfma_f32_16x16x32_bf16 v[100:103], a[144:147], a[100:103], v[100:103]
  ds_read_b128 a[132:135], v3 offset:32768
  v_mfma_f32_16x16x32_bf16 v[104:107], a[144:147], a[104:107], v[104:107]
  v_mfma_f32_16x16x32_bf16 v[108:111], a[144:147], a[108:111], v[108:111]
  v_mfma_f32_16x16x32_bf16 v[112:115], a[148:151], a[96:99], v[112:115]
  ds_read_b128 a[136:139], v3 offset:39936
  s_add_u32 m0, s18, 32768
  v_mfma_f32_16x16x32_bf16 v[116:119], a[148:151], a[100:103], v[116:119]
  buffer_load_dwordx4 v5, s[8:11], s16 offen offset:0  lds
  v_mfma_f32_16x16x32_bf16 v[120:123], a[148:151], a[104:107], v[120:123]
  v_mfma_f32_16x16x32_bf16 v[124:127], a[148:151], a[108:111], v[124:127]
  s_waitcnt lgkmcnt(2)
  v_mfma_f32_16x16x32_bf16 v[128:131], a[152:155], a[96:99], v[128:131]
  ds_read_b128 a[140:143], v3 offset:33792
  v_mfma_f32_16x16x32_bf16 v[132:135], a[152:155], a[100:103], v[132:135]
  v_mfma_f32_16x16x32_bf16 v[136:139], a[152:155], a[104:107], v[136:139]
  v_mfma_f32_16x16x32_bf16 v[140:143], a[152:155], a[108:111], v[140:143]
  v_mfma_f32_16x16x32_bf16 v[144:147], a[128:131], a[96:99], v[144:147]
  ds_read_b128 a[144:147], v3 offset:40960
  buffer_load_dwordx4 v5, s[8:11], s16 offen offset:1024  lds
  v_mfma_f32_16x16x32_bf16 v[148:151], a[128:131], a[100:103], v[148:151]
  v_mfma_f32_16x16x32_bf16 v[152:155], a[128:131], a[104:107], v[152:155]
  v_mfma_f32_16x16x32_bf16 v[156:159], a[128:131], a[108:111], v[156:159]
  ds_read_b128 a[148:151], v13 offset:28672
  s_waitcnt lgkmcnt(2)
  v_mfma_f32_16x16x32_bf16 v[160:163], a[132:135], a[96:99], v[160:163]
  v_mfma_f32_16x16x32_bf16 v[164:167], a[132:135], a[100:103], v[164:167]
  v_mfma_f32_16x16x32_bf16 v[168:171], a[132:135], a[104:107], v[168:171]
  v_mfma_f32_16x16x32_bf16 v[172:175], a[132:135], a[108:111], v[172:175]
  ds_read_b128 a[152:155], v13 offset:35840
  buffer_load_dwordx4 v5, s[8:11], s16 offen offset:2048  lds
  s_add_u32 s16, s16, 917504
  v_mfma_f32_16x16x32_bf16 v[176:179], a[136:139], a[96:99], v[176:179]
  v_mfma_f32_16x16x32_bf16 v[180:183], a[136:139], a[100:103], v[180:183]
  v_mfma_f32_16x16x32_bf16 v[184:187], a[136:139], a[104:107], v[184:187]
  v_mfma_f32_16x16x32_bf16 v[188:191], a[136:139], a[108:111], v[188:191]
  ds_read_b128 a[128:131], v3 offset:43008
  v_mfma_f32_16x16x32_bf16 v[192:195], a[140:143], a[96:99], v[192:195]
  v_mfma_f32_16x16x32_bf16 v[196:199], a[140:143], a[100:103], v[196:199]
  v_mfma_f32_16x16x32_bf16 v[200:203], a[140:143], a[104:107], v[200:203]
  ds_read_b128 a[132:135], v3 offset:50176
  v_mfma_f32_16x16x32_bf16 v[204:207], a[140:143], a[108:111], v[204:207]
  buffer_load_dwordx4 a[32:35], v8, s[12:15], s17 offen offset:0 sc1
  s_waitcnt lgkmcnt(2)
  v_mfma_f32_16x16x32_bf16 v[208:211], a[144:147], a[96:99], v[208:211]
  v_mfma_f32_16x16x32_bf16 v[212:215], a[144:147], a[100:103], v[212:215]
  v_mfma_f32_16x16x32_bf16 v[216:219], a[144:147], a[104:107], v[216:219]
  ds_read_b128 a[136:139], v3 offset:44032
  v_mfma_f32_16x16x32_bf16 v[220:223], a[144:147], a[108:111], v[220:223]
  v_mfma_f32_16x16x32_bf16 v[224:227], a[148:151], a[96:99], v[224:227]
  v_mfma_f32_16x16x32_bf16 v[228:231], a[148:151], a[100:103], v[228:231]
  ds_read_b128 a[140:143], v3 offset:51200
  v_mfma_f32_16x16x32_bf16 v[232:235], a[148:151], a[104:107], v[232:235]
  buffer_load_dwordx4 a[36:39], v9, s[12:15], s17 offen offset:0 sc1
  v_mfma_f32_16x16x32_bf16 v[236:239], a[148:151], a[108:111], v[236:239]
  v_mfma_f32_16x16x32_bf16 v[240:243], a[152:155], a[96:99], v[240:243]
  v_mfma_f32_16x16x32_bf16 v[244:247], a[152:155], a[100:103], v[244:247]
  ds_read_b128 a[144:147], v3 offset:45056
  v_mfma_f32_16x16x32_bf16 v[248:251], a[152:155], a[104:107], v[248:251]
  v_mfma_f32_16x16x32_bf16 v[252:255], a[152:155], a[108:111], v[252:255]
  s_waitcnt lgkmcnt(2)
  v_mfma_f32_16x16x32_bf16 v[32:35], a[128:131], a[112:115], v[32:35]
  v_mfma_f32_16x16x32_bf16 v[36:39], a[128:131], a[116:119], v[36:39]
  ds_read_b128 a[148:151], v3 offset:52224
  buffer_load_dwordx4 a[40:43], v10, s[12:15], s17 offen offset:0 sc1
  v_mfma_f32_16x16x32_bf16 v[40:43], a[128:131], a[120:123], v[40:43]
  v_mfma_f32_16x16x32_bf16 v[44:47], a[128:131], a[124:127], v[44:47]
  v_mfma_f32_16x16x32_bf16 v[48:51], a[132:135], a[112:115], v[48:51]
  ds_read_b128 a[152:155], v3 offset:46080
  v_mfma_f32_16x16x32_bf16 v[52:55], a[132:135], a[116:119], v[52:55]
  v_mfma_f32_16x16x32_bf16 v[56:59], a[132:135], a[120:123], v[56:59]
  v_mfma_f32_16x16x32_bf16 v[60:63], a[132:135], a[124:127], v[60:63]
  v_mfma_f32_16x16x32_bf16 v[64:67], a[136:139], a[112:115], v[64:67]
  ds_read_b128 a[128:131], v3 offset:53248
  v_mfma_f32_16x16x32_bf16 v[68:71], a[136:139], a[116:119], v[68:71]
  buffer_load_dwordx4 a[44:47], v11, s[12:15], s17 offen offset:0 sc1
  v_mfma_f32_16x16x32_bf16 v[72:75], a[136:139], a[120:123], v[72:75]
  v_mfma_f32_16x16x32_bf16 v[76:79], a[136:139], a[124:127], v[76:79]
  s_waitcnt lgkmcnt(1)
  v_mfma_f32_16x16x32_bf16 v[80:83], a[140:143], a[112:115], v[80:83]
  ds_read_b128 a[132:135], v3 offset:47104
  v_mfma_f32_16x16x32_bf16 v[84:87], a[140:143], a[116:119], v[84:87]
  v_mfma_f32_16x16x32_bf16 v[88:91], a[140:143], a[120:123], v[88:91]
  v_mfma_f32_16x16x32_bf16 v[92:95], a[140:143], a[124:127], v[92:95]
  ds_read_b128 a[136:139], v3 offset:54272
  v_mfma_f32_16x16x32_bf16 v[96:99], a[144:147], a[112:115], v[96:99]
  buffer_load_dwordx4 a[48:51], v8, s[12:15], s17 offen offset:1024 sc1
  v_mfma_f32_16x16x32_bf16 v[100:103], a[144:147], a[116:119], v[100:103]
  v_mfma_f32_16x16x32_bf16 v[104:107], a[144:147], a[120:123], v[104:107]
  v_mfma_f32_16x16x32_bf16 v[108:111], a[144:147], a[124:127], v[108:111]
  ds_read_b128 a[140:143], v3 offset:48128
  v_mfma_f32_16x16x32_bf16 v[112:115], a[148:151], a[112:115], v[112:115]
  v_mfma_f32_16x16x32_bf16 v[116:119], a[148:151], a[116:119], v[116:119]
  v_mfma_f32_16x16x32_bf16 v[120:123], a[148:151], a[120:123], v[120:123]
  v_mfma_f32_16x16x32_bf16 v[124:127], a[148:151], a[124:127], v[124:127]
  ds_read_b128 a[144:147], v3 offset:55296
  buffer_load_dwordx4 a[52:55], v9, s[12:15], s17 offen offset:1024 sc1
  v_mfma_f32_16x16x32_bf16 v[128:131], a[152:155], a[112:115], v[128:131]
  v_mfma_f32_16x16x32_bf16 v[132:135], a[152:155], a[116:119], v[132:135]
  v_mfma_f32_16x16x32_bf16 v[136:139], a[152:155], a[120:123], v[136:139]
  ds_read_b128 a[148:151], v13 offset:43008
  v_mfma_f32_16x16x32_bf16 v[140:143], a[152:155], a[124:127], v[140:143]
  s_waitcnt lgkmcnt(2)
  v_mfma_f32_16x16x32_bf16 v[144:147], a[128:131], a[112:115], v[144:147]
  v_mfma_f32_16x16x32_bf16 v[148:151], a[128:131], a[116:119], v[148:151]
  v_mfma_f32_16x16x32_bf16 v[152:155], a[128:131], a[120:123], v[152:155]
  ds_read_b128 a[152:155], v13 offset:50176
  v_mfma_f32_16x16x32_bf16 v[156:159], a[128:131], a[124:127], v[156:159]
  buffer_load_dwordx4 a[56:59], v10, s[12:15], s17 offen offset:1024 sc1
  v_mfma_f32_16x16x32_bf16 v[160:163], a[132:135], a[112:115], v[160:163]
  v_mfma_f32_16x16x32_bf16 v[164:167], a[132:135], a[116:119], v[164:167]
  v_mfma_f32_16x16x32_bf16 v[168:171], a[132:135], a[120:123], v[168:171]
  v_mfma_f32_16x16x32_bf16 v[172:175], a[132:135], a[124:127], v[172:175]
  v_mfma_f32_16x16x32_bf16 v[176:179], a[136:139], a[112:115], v[176:179]
  v_mfma_f32_16x16x32_bf16 v[180:183], a[136:139], a[116:119], v[180:183]
  v_mfma_f32_16x16x32_bf16 v[184:187], a[136:139], a[120:123], v[184:187]
  buffer_load_dwordx4 a[60:63], v11, s[12:15], s17 offen offset:1024 sc1
  s_add_u32 s17, s17, 2048
  v_mfma_f32_16x16x32_bf16 v[188:191], a[136:139], a[124:127], v[188:191]
  v_mfma_f32_16x16x32_bf16 v[192:195], a[140:143], a[112:115], v[192:195]
  v_mfma_f32_16x16x32_bf16 v[196:199], a[140:143], a[116:119], v[196:199]
  v_mfma_f32_16x16x32_bf16 v[200:203], a[140:143], a[120:123], v[200:203]
  v_mfma_f32_16x16x32_bf16 v[204:207], a[140:143], a[124:127], v[204:207]
  s_waitcnt vmcnt(15) lgkmcnt(0)
  s_barrier
  v_mfma_f32_16x16x32_bf16 v[208:211], a[144:147], a[112:115], v[208:211]
  ds_read_b128 a[128:131], v7 offset:0
  v_mfma_f32_16x16x32_bf16 v[212:215], a[144:147], a[116:119], v[212:215]
  v_mfma_f32_16x16x32_bf16 v[216:219], a[144:147], a[120:123], v[216:219]
  s_add_u32 m0, s18, 57344
  v_mfma_f32_16x16x32_bf16 v[220:223], a[144:147], a[124:127], v[220:223]
  ds_read_b128 a[132:135], v7 offset:7168
  buffer_load_dwordx4 v4, s[8:11], s16 offen offset:0  lds
  v_mfma_f32_16x16x32_bf16 v[224:227], a[148:151], a[112:115], v[224:227]
  v_mfma_f32_16x16x32_bf16 v[228:231], a[148:151], a[116:119], v[228:231]
  v_mfma_f32_16x16x32_bf16 v[232:235], a[148:151], a[120:123], v[232:235]
  v_mfma_f32_16x16x32_bf16 v[236:239], a[148:151], a[124:127], v[236:239]
  ds_read_b128 a[136:139], v7 offset:1024
  v_mfma_f32_16x16x32_bf16 v[240:243], a[152:155], a[112:115], v[240:243]
  v_mfma_f32_16x16x32_bf16 v[244:247], a[152:155], a[116:119], v[244:247]
  v_mfma_f32_16x16x32_bf16 v[248:251], a[152:155], a[120:123], v[248:251]
  ds_read_b128 a[140:143], v7 offset:8192
  v_mfma_f32_16x16x32_bf16 v[252:255], a[152:155], a[124:127], v[252:255]
  buffer_load_dwordx4 v4, s[8:11], s16 offen offset:1024  lds
  s_sub_u32 s19, s19, 1
  s_cmp_lg_u32 s19, 0
  s_cbranch_scc1 L_gemm_38
L_gu_tail:
  s_waitcnt lgkmcnt(2)
  v_mfma_f32_16x16x32_bf16 v[32:35], a[128:131], a[0:3], v[32:35]
  ds_read_b128 v[24:27], v12 offset:320
  v_mfma_f32_16x16x32_bf16 v[36:39], a[128:131], a[4:7], v[36:39]
  ds_read_b128 v[28:31], v12 offset:1344
  v_mfma_f32_16x16x32_bf16 v[40:43], a[128:131], a[8:11], v[40:43]
  ds_read_b128 a[144:147], v7 offset:2048
  v_mfma_f32_16x16x32_bf16 v[44:47], a[128:131], a[12:15], v[44:47]
  v_mfma_f32_16x16x32_bf16 v[48:51], a[132:135], a[0:3], v[48:51]
  v_mfma_f32_16x16x32_bf16 v[52:55], a[132:135], a[4:7], v[52:55]
  v_mfma_f32_16x16x32_bf16 v[56:59], a[132:135], a[8:11], v[56:59]
  ds_read_b128 a[148:151], v7 offset:9216
  buffer_load_dwordx4 v4, s[8:11], s16 offen offset:2048  lds
  v_mfma_f32_16x16x32_bf16 v[60:63], a[132:135], a[12:15], v[60:63]
  s_waitcnt lgkmcnt(3)
  v_mfma_f32_16x16x32_bf16 v[64:67], a[136:139], a[0:3], v[64:67]
  v_mfma_f32_16x16x32_bf16 v[68:71], a[136:139], a[4:7], v[68:71]
  ds_read_b128 a[152:155], v7 offset:3072
  v_mfma_f32_16x16x32_bf16 v[72:75], a[136:139], a[8:11], v[72:75]
  v_fmac_f32 v192, v24, v17
  v_mfma_f32_16x16x32_bf16 v[76:79], a[136:139], a[12:15], v[76:79]
  v_fmac_f32 v193, v25, v17
  v_mfma_f32_16x16x32_bf16 v[80:83], a[140:143], a[0:3], v[80:83]
  v_fmac_f32 v194, v26, v17
  v_fmac_f32 v195, v27, v17
  v_mfma_f32_16x16x32_bf16 v[84:87], a[140:143], a[4:7], v[84:87]
  ds_read_b128 a[128:131], v7 offset:10240
  buffer_load_dwordx4 v4, s[8:11], s16 offen offset:3072  lds
  v_fmac_f32 v196, v24, v19
  v_mfma_f32_16x16x32_bf16 v[88:91], a[140:143], a[8:11], v[88:91]
  v_fmac_f32 v197, v25, v19
  v_fmac_f32 v198, v26, v19
  v_mfma_f32_16x16x32_bf16 v[92:95], a[140:143], a[12:15], v[92:95]
  v_fmac_f32 v199, v27, v19
  s_waitcnt lgkmcnt(2)
  v_mfma_f32_16x16x32_bf16 v[96:99], a[144:147], a[0:3], v[96:99]
  v_fmac_f32 v200, v24, v21
  v_fmac_f32 v201, v25, v21
  v_mfma_f32_16x16x32_bf16 v[100:103], a[144:147], a[4:7], v[100:103]
  ds_read_b128 a[132:135], v7 offset:4096
  v_fmac_f32 v202, v26, v21
  v_mfma_f32_16x16x32_bf16 v[104:107], a[144:147], a[8:11], v[104:107]
  v_fmac_f32 v203, v27, v21
  v_fmac_f32 v204, v24, v23
  v_mfma_f32_16x16x32_bf16 v[108:111], a[144:147], a[12:15], v[108:111]
  v_fmac_f32 v205, v25, v23
  v_mfma_f32_16x16x32_bf16 v[112:115], a[148:151], a[0:3], v[112:115]
  ds_read_b128 a[136:139], v7 offset:11264
  s_add_u32 m0, s18, 61440
  v_fmac_f32 v206, v26, v23
  v_fmac_f32 v207, v27, v23
  v_mfma_f32_16x16x32_bf16 v[116:119], a[148:151], a[4:7], v[116:119]
  buffer_load_dwordx4 v5, s[8:11], s16 offen offset:0  lds
  ds_read_b128 v[24:27], v12 offset:2112
  v_mfma_f32_16x16x32_bf16 v[120:123], a[148:151], a[8:11], v[120:123]
  v_fmac_f32 v192, v28, v16
  v_mfma_f32_16x16x32_bf16 v[124:127], a[148:151], a[12:15], v[124:127]
  v_fmac_f32 v193, v29, v16
  s_waitcnt lgkmcnt(3)
  v_mfma_f32_16x16x32_bf16 v[128:131], a[152:155], a[0:3], v[128:131]
  ds_read_b128 a[140:143], v7 offset:5120
  v_fmac_f32 v194, v30, v16
  v_fmac_f32 v195, v31, v16
  v_mfma_f32_16x16x32_bf16 v[132:135], a[152:155], a[4:7], v[132:135]
  v_fmac_f32 v196, v28, v18
  v_mfma_f32_16x16x32_bf16 v[136:139], a[152:155], a[8:11], v[136:139]
  v_fmac_f32 v197, v29, v18
  v_fmac_f32 v198, v30, v18
  v_mfma_f32_16x16x32_bf16 v[140:143], a[152:155], a[12:15], v[140:143]
  v_fmac_f32 v199, v31, v18
  v_mfma_f32_16x16x32_bf16 v[144:147], a[128:131], a[0:3], v[144:147]
  ds_read_b128 a[144:147], v7 offset:12288
  buffer_load_dwordx4 v5, s[8:11], s16 offen offset:1024  lds
  v_fmac_f32 v200, v28, v20
  v_fmac_f32 v201, v29, v20
  v_mfma_f32_16x16x32_bf16 v[148:151], a[128:131], a[4:7], v[148:151]
  v_fmac_f32 v202, v30, v20
  v_mfma_f32_16x16x32_bf16 v[152:155], a[128:131], a[8:11], v[152:155]
  v_fmac_f32 v203, v31, v20
  v_fmac_f32 v204, v28, v22
  v_mfma_f32_16x16x32_bf16 v[156:159], a[128:131], a[12:15], v[156:159]
  ds_read_b128 a[148:151], v1 offset:0
  v_fmac_f32 v205, v29, v22
  s_waitcnt lgkmcnt(2)
  v_mfma_f32_16x16x32_bf16 v[160:163], a[132:135], a[0:3], v[160:163]
  v_fmac_f32 v206, v30, v22
  v_fmac_f32 v207, v31, v22
  v_mfma_f32_16x16x32_bf16 v[164:167], a[132:135], a[4:7], v[164:167]
  ds_read_b128 v[28:31], v12 offset:3136
  v_mfma_f32_16x16x32_bf16 v[168:171], a[132:135], a[8:11], v[168:171]
  v_mfma_f32_16x16x32_bf16 v[172:175], a[132:135], a[12:15], v[172:175]
  ds_read_b128 a[152:155], v1 offset:7168
  buffer_load_dwordx4 v5, s[8:11], s16 offen offset:2048  lds
  s_add_u32 s16, s16, 917504
  v_mfma_f32_16x16x32_bf16 v[176:179], a[136:139], a[0:3], v[176:179]
  v_mfma_f32_16x16x32_bf16 v[180:183], a[136:139], a[4:7], v[180:183]
  v_mfma_f32_16x16x32_bf16 v[184:187], a[136:139], a[8:11], v[184:187]
  v_mfma_f32_16x16x32_bf16 v[188:191], a[136:139], a[12:15], v[188:191]
  ds_read_b128 a[128:131], v7 offset:14336
  v_fmac_f32 v80, v24, v17
  v_mfma_f32_16x16x32_bf16 v[192:195], a[140:143], a[0:3], v[192:195]
  v_fmac_f32 v81, v25, v17
  v_mfma_f32_16x16x32_bf16 v[196:199], a[140:143], a[4:7], v[196:199]
  v_fmac_f32 v82, v26, v17
  v_fmac_f32 v83, v27, v17
  v_mfma_f32_16x16x32_bf16 v[200:203], a[140:143], a[8:11], v[200:203]
  ds_read_b128 a[132:135], v7 offset:21504
  v_fmac_f32 v84, v24, v19
  v_mfma_f32_16x16x32_bf16 v[204:207], a[140:143], a[12:15], v[204:207]
  buffer_load_dwordx4 a[64:67], v8, s[12:15], s17 offen offset:0 sc1
  v_fmac_f32 v85, v25, v19
  v_fmac_f32 v86, v26, v19
  s_waitcnt lgkmcnt(2)
  v_mfma_f32_16x16x32_bf16 v[208:211], a[144:147], a[0:3], v[208:211]
  v_fmac_f32 v87, v27, v19
  v_mfma_f32_16x16x32_bf16 v[212:215], a[144:147], a[4:7], v[212:215]
  v_fmac_f32 v88, v24, v21
  v_fmac_f32 v89, v25, v21
  v_mfma_f32_16x16x32_bf16 v[216:219], a[144:147], a[8:11], v[216:219]
  ds_read_b128 a[136:139], v7 offset:15360
  v_fmac_f32 v90, v26, v21
  v_mfma_f32_16x16x32_bf16 v[220:223], a[144:147], a[12:15], v[220:223]
  v_fmac_f32 v91, v27, v21
  v_fmac_f32 v92, v24, v23
  v_mfma_f32_16x16x32_bf16 v[224:227], a[148:151], a[0:3], v[224:227]
  v_fmac_f32 v93, v25, v23
  v_mfma_f32_16x16x32_bf16 v[228:231], a[148:151], a[4:7], v[228:231]
  ds_read_b128 a[140:143], v7 offset:22528
  v_fmac_f32 v94, v26, v23
  v_fmac_f32 v95, v27, v23
  v_mfma_f32_16x16x32_bf16 v[232:235], a[148:151], a[8:11], v[232:235]
  buffer_load_dwordx4 a[68:71], v9, s[12:15], s17 offen offset:0 sc1
  ds_read_b128 v[24:27], v12 offset:0
  v_mfma_f32_16x16x32_bf16 v[236:239], a[148:151], a[12:15], v[236:239]
  v_fmac_f32 v80, v28, v16
  v_mfma_f32_16x16x32_bf16 v[240:243], a[152:155], a[0:3], v[240:243]
  v_fmac_f32 v81, v29, v16
  v_mfma_f32_16x16x32_bf16 v[244:247], a[152:155], a[4:7], v[244:247]
  ds_read_b128 a[144:147], v7 offset:16384
  v_fmac_f32 v82, v30, v16
  v_fmac_f32 v83, v31, v16
  v_mfma_f32_16x16x32_bf16 v[248:251], a[152:155], a[8:11], v[248:251]
  v_fmac_f32 v84, v28, v18
  v_mfma_f32_16x16x32_bf16 v[252:255], a[152:155], a[12:15], v[252:255]
  v_fmac_f32 v85, v29, v18
  v_fmac_f32 v86, v30, v18
  s_waitcnt lgkmcnt(3)
  v_mfma_f32_16x16x32_bf16 v[32:35], a[128:131], a[16:19], v[32:35]
  v_fmac_f32 v87, v31, v18
  v_mfma_f32_16x16x32_bf16 v[36:39], a[128:131], a[20:23], v[36:39]
  ds_read_b128 a[148:151], v7 offset:23552
  buffer_load_dwordx4 a[72:75], v10, s[12:15], s17 offen offset:0 sc1
  v_fmac_f32 v88, v28, v20
  v_fmac_f32 v89, v29, v20
  v_mfma_f32_16x16x32_bf16 v[40:43], a[128:131], a[24:27], v[40:43]
  v_fmac_f32 v90, v30, v20
  v_mfma_f32_16x16x32_bf16 v[44:47], a[128:131], a[28:31], v[44:47]
  v_fmac_f32 v91, v31, v20
  v_fmac_f32 v92, v28, v22
  v_mfma_f32_16x16x32_bf16 v[48:51], a[132:135], a[16:19], v[48:51]
  ds_read_b128 a[152:155], v7 offset:17408
  v_fmac_f32 v93, v29, v22
  v_mfma_f32_16x16x32_bf16 v[52:55], a[132:135], a[20:23], v[52:55]
  v_fmac_f32 v94, v30, v22
  v_fmac_f32 v95, v31, v22
  v_mfma_f32_16x16x32_bf16 v[56:59], a[132:135], a[24:27], v[56:59]
  ds_read_b128 v[28:31], v12 offset:1024
  v_mfma_f32_16x16x32_bf16 v[60:63], a[132:135], a[28:31], v[60:63]
  v_mfma_f32_16x16x32_bf16 v[64:67], a[136:139], a[16:19], v[64:67]
  ds_read_b128 a[128:131], v7 offset:24576
  v_mfma_f32_16x16x32_bf16 v[68:71], a[136:139], a[20:23], v[68:71]
  buffer_load_dwordx4 a[76:79], v11, s[12:15], s17 offen offset:0 sc1
  v_mfma_f32_16x16x32_bf16 v[72:75], a[136:139], a[24:27], v[72:75]
  v_mfma_f32_16x16x32_bf16 v[76:79], a[136:139], a[28:31], v[76:79]
  s_waitcnt lgkmcnt(2)
  v_mfma_f32_16x16x32_bf16 v[80:83], a[140:143], a[16:19], v[80:83]
  ds_read_b128 a[132:135], v7 offset:18432
  v_fmac_f32 v32, v24, v17
  v_mfma_f32_16x16x32_bf16 v[84:87], a[140:143], a[20:23], v[84:87]
  v_fmac_f32 v33, v25, v17
  v_mfma_f32_16x16x32_bf16 v[88:91], a[140:143], a[24:27], v[88:91]
  v_fmac_f32 v34, v26, v17
  v_fmac_f32 v35, v27, v17
  v_mfma_f32_16x16x32_bf16 v[92:95], a[140:143], a[28:31], v[92:95]
  ds_read_b128 a[136:139], v7 offset:25600
  v_fmac_f32 v36, v24, v19
  v_mfma_f32_16x16x32_bf16 v[96:99], a[144:147], a[16:19], v[96:99]
  buffer_load_dwordx4 a[80:83], v8, s[12:15], s17 offen offset:1024 sc1
  v_fmac_f32 v37, v25, v19
  v_fmac_f32 v38, v26, v19
  v_mfma_f32_16x16x32_bf16 v[100:103], a[144:147], a[20:23], v[100:103]
  v_fmac_f32 v39, v27, v19
  v_mfma_f32_16x16x32_bf16 v[104:107], a[144:147], a[24:27], v[104:107]
  v_fmac_f32 v40, v24, v21
  v_fmac_f32 v41, v25, v21
  v_mfma_f32_16x16x32_bf16 v[108:111], a[144:147], a[28:31], v[108:111]
  ds_read_b128 a[140:143], v7 offset:19456
  v_fmac_f32 v42, v26, v21
  v_mfma_f32_16x16x32_bf16 v[112:115], a[148:151], a[16:19], v[112:115]
  v_fmac_f32 v43, v27, v21
  v_fmac_f32 v44, v24, v23
  v_mfma_f32_16x16x32_bf16 v[116:119], a[148:151], a[20:23], v[116:119]
  v_fmac_f32 v45, v25, v23
  v_mfma_f32_16x16x32_bf16 v[120:123], a[148:151], a[24:27], v[120:123]
  v_fmac_f32 v46, v26, v23
  v_fmac_f32 v47, v27, v23
  v_mfma_f32_16x16x32_bf16 v[124:127], a[148:151], a[28:31], v[124:127]
  ds_read_b128 a[144:147], v7 offset:26624
  buffer_load_dwordx4 a[84:87], v9, s[12:15], s17 offen offset:1024 sc1
  ds_read_b128 v[24:27], v12 offset:128
  v_mfma_f32_16x16x32_bf16 v[128:131], a[152:155], a[16:19], v[128:131]
  s_waitcnt lgkmcnt(6)
  v_fmac_f32 v32, v28, v16
  v_mfma_f32_16x16x32_bf16 v[132:135], a[152:155], a[20:23], v[132:135]
  v_fmac_f32 v33, v29, v16
  v_mfma_f32_16x16x32_bf16 v[136:139], a[152:155], a[24:27], v[136:139]
  ds_read_b128 a[148:151], v1 offset:14336
  v_fmac_f32 v34, v30, v16
  v_fmac_f32 v35, v31, v16
  v_mfma_f32_16x16x32_bf16 v[140:143], a[152:155], a[28:31], v[140:143]
  v_fmac_f32 v36, v28, v18
  s_waitcnt lgkmcnt(3)
  v_mfma_f32_16x16x32_bf16 v[144:147], a[128:131], a[16:19], v[144:147]
  v_fmac_f32 v37, v29, v18
  v_fmac_f32 v38, v30, v18
  v_mfma_f32_16x16x32_bf16 v[148:151], a[128:131], a[20:23], v[148:151]
  v_fmac_f32 v39, v31, v18
  v_mfma_f32_16x16x32_bf16 v[152:155], a[128:131], a[24:27], v[152:155]
  ds_read_b128 a[152:155], v1 offset:21504
  v_fmac_f32 v40, v28, v20
  v_fmac_f32 v41, v29, v20
  v_mfma_f32_16x16x32_bf16 v[156:159], a[128:131], a[28:31], v[156:159]
  buffer_load_dwordx4 a[88:91], v10, s[12:15], s17 offen offset:1024 sc1
  v_fmac_f32 v42, v30, v20
  v_mfma_f32_16x16x32_bf16 v[160:163], a[132:135], a[16:19], v[160:163]
  v_fmac_f32 v43, v31, v20
  v_fmac_f32 v44, v28, v22
  v_mfma_f32_16x16x32_bf16 v[164:167], a[132:135], a[20:23], v[164:167]
  v_fmac_f32 v45, v29, v22
  v_mfma_f32_16x16x32_bf16 v[168:171], a[132:135], a[24:27], v[168:171]
  v_fmac_f32 v46, v30, v22
  v_fmac_f32 v47, v31, v22
  v_mfma_f32_16x16x32_bf16 v[172:175], a[132:135], a[28:31], v[172:175]
  ds_read_b128 v[28:31], v12 offset:1152
  v_mfma_f32_16x16x32_bf16 v[176:179], a[136:139], a[16:19], v[176:179]
  v_mfma_f32_16x16x32_bf16 v[180:183], a[136:139], a[20:23], v[180:183]
  v_mfma_f32_16x16x32_bf16 v[184:187], a[136:139], a[24:27], v[184:187]
  buffer_load_dwordx4 a[92:95], v11, s[12:15], s17 offen offset:1024 sc1
  s_add_u32 s17, s17, 2048
  v_mfma_f32_16x16x32_bf16 v[188:191], a[136:139], a[28:31], v[188:191]
  v_mfma_f32_16x16x32_bf16 v[192:195], a[140:143], a[16:19], v[192:195]
  v_mfma_f32_16x16x32_bf16 v[196:199], a[140:143], a[20:23], v[196:199]
  s_waitcnt lgkmcnt(3)
  v_fmac_f32 v96, v24, v17
  v_mfma_f32_16x16x32_bf16 v[200:203], a[140:143], a[24:27], v[200:203]
  v_fmac_f32 v97, v25, v17
  v_mfma_f32_16x16x32_bf16 v[204:207], a[140:143], a[28:31], v[204:207]
  v_fmac_f32 v98, v26, v17
  v_fmac_f32 v99, v27, v17
  s_waitcnt vmcnt(15) lgkmcnt(0)
  s_barrier
  v_mfma_f32_16x16x32_bf16 v[208:211], a[144:147], a[16:19], v[208:211]
  ds_read_b128 a[128:131], v7 offset:28672
  v_fmac_f32 v100, v24, v19
  v_mfma_f32_16x16x32_bf16 v[212:215], a[144:147], a[20:23], v[212:215]
  v_fmac_f32 v101, v25, v19
  v_fmac_f32 v102, v26, v19
  v_mfma_f32_16x16x32_bf16 v[216:219], a[144:147], a[24:27], v[216:219]
  s_add_u32 m0, s18, 86016
  v_fmac_f32 v103, v27, v19
  v_mfma_f32_16x16x32_bf16 v[220:223], a[144:147], a[28:31], v[220:223]
  ds_read_b128 a[132:135], v7 offset:35840
  buffer_load_dwordx4 v4, s[8:11], s16 offen offset:0  lds
  v_fmac_f32 v104, v24, v21
  v_fmac_f32 v105, v25, v21
  v_mfma_f32_16x16x32_bf16 v[224:227], a[148:151], a[16:19], v[224:227]
  v_fmac_f32 v106, v26, v21
  v_mfma_f32_16x16x32_bf16 v[228:231], a[148:151], a[20:23], v[228:231]
  v_fmac_f32 v107, v27, v21
  v_fmac_f32 v108, v24, v23
  v_mfma_f32_16x16x32_bf16 v[232:235], a[148:151], a[24:27], v[232:235]
  v_fmac_f32 v109, v25, v23
  v_mfma_f32_16x16x32_bf16 v[236:239], a[148:151], a[28:31], v[236:239]
  ds_read_b128 a[136:139], v7 offset:29696
  v_fmac_f32 v110, v26, v23
  v_fmac_f32 v111, v27, v23
  v_mfma_f32_16x16x32_bf16 v[240:243], a[152:155], a[16:19], v[240:243]
  ds_read_b128 v[24:27], v12 offset:2368
  v_mfma_f32_16x16x32_bf16 v[244:247], a[152:155], a[20:23], v[244:247]
  v_fmac_f32 v96, v28, v16
  v_mfma_f32_16x16x32_bf16 v[248:251], a[152:155], a[24:27], v[248:251]
  ds_read_b128 a[140:143], v7 offset:36864
  v_fmac_f32 v97, v29, v16
  v_mfma_f32_16x16x32_bf16 v[252:255], a[152:155], a[28:31], v[252:255]
  buffer_load_dwordx4 v4, s[8:11], s16 offen offset:1024  lds
  v_fmac_f32 v98, v30, v16
  v_fmac_f32 v99, v31, v16
  s_waitcnt lgkmcnt(3)
  v_mfma_f32_16x16x32_bf16 v[32:35], a[128:131], a[32:35], v[32:35]
  v_fmac_f32 v100, v28, v18
  v_mfma_f32_16x16x32_bf16 v[36:39], a[128:131], a[36:39], v[36:39]
  v_fmac_f32 v101, v29, v18
  v_fmac_f32 v102, v30, v18
  v_mfma_f32_16x16x32_bf16 v[40:43], a[128:131], a[40:43], v[40:43]
  ds_read_b128 a[144:147], v7 offset:30720
  v_fmac_f32 v103, v31, v18
  v_mfma_f32_16x16x32_bf16 v[44:47], a[128:131], a[44:47], v[44:47]
  v_fmac_f32 v104, v28, v20
  v_fmac_f32 v105, v29, v20
  v_mfma_f32_16x16x32_bf16 v[48:51], a[132:135], a[32:35], v[48:51]
  v_fmac_f32 v106, v30, v20
  v_mfma_f32_16x16x32_bf16 v[52:55], a[132:135], a[36:39], v[52:55]
  v_fmac_f32 v107, v31, v20
  v_fmac_f32 v108, v28, v22
  v_mfma_f32_16x16x32_bf16 v[56:59], a[132:135], a[40:43], v[56:59]
  ds_read_b128 a[148:151], v7 offset:37888
  buffer_load_dwordx4 v4, s[8:11], s16 offen offset:2048  lds
  v_fmac_f32 v109, v29, v22
  v_mfma_f32_16x16x32_bf16 v[60:63], a[132:135], a[44:47], v[60:63]
  v_fmac_f32 v110, v30, v22
  v_fmac_f32 v111, v31, v22
  s_waitcnt lgkmcnt(2)
  v_mfma_f32_16x16x32_bf16 v[64:67], a[136:139], a[32:35], v[64:67]
  ds_read_b128 v[28:31], v12 offset:3392
  v_mfma_f32_16x16x32_bf16 v[68:71], a[136:139], a[36:39], v[68:71]
  ds_read_b128 a[152:155], v7 offset:31744
  v_mfma_f32_16x16x32_bf16 v[72:75], a[136:139], a[40:43], v[72:75]
  v_mfma_f32_16x16x32_bf16 v[76:79], a[136:139], a[44:47], v[76:79]
  v_mfma_f32_16x16x32_bf16 v[80:83], a[140:143], a[32:35], v[80:83]
  v_mfma_f32_16x16x32_bf16 v[84:87], a[140:143], a[36:39], v[84:87]
  ds_read_b128 a[128:131], v7 offset:38912
  buffer_load_dwordx4 v4, s[8:11], s16 offen offset:3072  lds
  v_mfma_f32_16x16x32_bf16 v[88:91], a[140:143], a[40:43], v[88:91]
  v_fmac_f32 v208, v24, v17
  v_mfma_f32_16x16x32_bf16 v[92:95], a[140:143], a[44:47], v[92:95]
  v_fmac_f32 v209, v25, v17
  s_waitcnt lgkmcnt(2)
  v_mfma_f32_16x16x32_bf16 v[96:99], a[144:147], a[32:35], v[96:99]
  v_fmac_f32 v210, v26, v17
  v_fmac_f32 v211, v27, v17
  v_mfma_f32_16x16x32_bf16 v[100:103], a[144:147], a[36:39], v[100:103]
  ds_read_b128 a[132:135], v7 offset:32768
  v_fmac_f32 v212, v24, v19
  v_mfma_f32_16x16x32_bf16 v[104:107], a[144:147], a[40:43], v[104:107]
  v_fmac_f32 v213, v25, v19
  v_fmac_f32 v214, v26, v19
  v_mfma_f32_16x16x32_bf16 v[108:111], a[144:147], a[44:47], v[108:111]
  v_fmac_f32 v215, v27, v19
  v_mfma_f32_16x16x32_bf16 v[112:115], a[148:151], a[32:35], v[112:115]
  ds_read_b128 a[136:139], v7 offset:39936
  s_add_u32 m0, s18, 90112
  v_fmac_f32 v216, v24, v21
  v_fmac_f32 v217, v25, v21
  v_mfma_f32_16x16x32_bf16 v[116:119], a[148:151], a[36:39], v[116:119]
  buffer_load_dwordx4 v5, s[8:11], s16 offen offset:0  lds
  v_fmac_f32 v218, v26, v21
  v_mfma_f32_16x16x32_bf16 v[120:123], a[148:151], a[40:43], v[120:123]
  v_fmac_f32 v219, v27, v21
  v_fmac_f32 v220, v24, v23
  v_mfma_f32_16x16x32_bf16 v[124:127], a[148:151], a[44:47], v[124:127]
  v_fmac_f32 v221, v25, v23
  s_waitcnt lgkmcnt(2)
  v_mfma_f32_16x16x32_bf16 v[128:131], a[152:155], a[32:35], v[128:131]
  ds_read_b128 a[140:143], v7 offset:33792
  v_fmac_f32 v222, v26, v23
  v_fmac_f32 v223, v27, v23
  v_mfma_f32_16x16x32_bf16 v[132:135], a[152:155], a[36:39], v[132:135]
  ds_read_b128 v[24:27], v12 offset:2176
  v_mfma_f32_16x16x32_bf16 v[136:139], a[152:155], a[40:43], v[136:139]
  v_fmac_f32 v208, v28, v16
  v_mfma_f32_16x16x32_bf16 v[140:143], a[152:155], a[44:47], v[140:143]
  v_fmac_f32 v209, v29, v16
  v_mfma_f32_16x16x32_bf16 v[144:147], a[128:131], a[32:35], v[144:147]
  ds_read_b128 a[144:147], v7 offset:40960
  buffer_load_dwordx4 v5, s[8:11], s16 offen offset:1024  lds
  v_fmac_f32 v210, v30, v16
  v_fmac_f32 v211, v31, v16
  v_mfma_f32_16x16x32_bf16 v[148:151], a[128:131], a[36:39], v[148:151]
  v_fmac_f32 v212, v28, v18
  v_mfma_f32_16x16x32_bf16 v[152:155], a[128:131], a[40:43], v[152:155]
  v_fmac_f32 v213, v29, v18
  v_fmac_f32 v214, v30, v18
  v_mfma_f32_16x16x32_bf16 v[156:159], a[128:131], a[44:47], v[156:159]
  ds_read_b128 a[148:151], v1 offset:28672
  v_fmac_f32 v215, v31, v18
  s_waitcnt lgkmcnt(3)
  v_mfma_f32_16x16x32_bf16 v[160:163], a[132:135], a[32:35], v[160:163]
  v_fmac_f32 v216, v28, v20
  v_fmac_f32 v217, v29, v20
  v_mfma_f32_16x16x32_bf16 v[164:167], a[132:135], a[36:39], v[164:167]
  v_fmac_f32 v218, v30, v20
  v_mfma_f32_16x16x32_bf16 v[168:171], a[132:135], a[40:43], v[168:171]
  v_fmac_f32 v219, v31, v20
  v_fmac_f32 v220, v28, v22
  v_mfma_f32_16x16x32_bf16 v[172:175], a[132:135], a[44:47], v[172:175]
  ds_read_b128 a[152:155], v1 offset:35840
  buffer_load_dwordx4 v5, s[8:11], s16 offen offset:2048  lds
  s_add_u32 s16, s16, 917504
  v_fmac_f32 v221, v29, v22
  v_mfma_f32_16x16x32_bf16 v[176:179], a[136:139], a[32:35], v[176:179]
  v_fmac_f32 v222, v30, v22
  v_fmac_f32 v223, v31, v22
  v_mfma_f32_16x16x32_bf16 v[180:183], a[136:139], a[36:39], v[180:183]
  ds_read_b128 v[28:31], v12 offset:3200
  v_mfma_f32_16x16x32_bf16 v[184:187], a[136:139], a[40:43], v[184:187]
  v_mfma_f32_16x16x32_bf16 v[188:191], a[136:139], a[44:47], v[188:191]
  ds_read_b128 a[128:131], v7 offset:43008
  v_mfma_f32_16x16x32_bf16 v[192:195], a[140:143], a[32:35], v[192:195]
  v_mfma_f32_16x16x32_bf16 v[196:199], a[140:143], a[36:39], v[196:199]
  v_mfma_f32_16x16x32_bf16 v[200:203], a[140:143], a[40:43], v[200:203]
  ds_read_b128 a[132:135], v7 offset:50176
  v_mfma_f32_16x16x32_bf16 v[204:207], a[140:143], a[44:47], v[204:207]
  buffer_load_dwordx4 a[96:99], v8, s[12:15], s17 offen offset:0 sc1
  s_waitcnt lgkmcnt(6)
  v_fmac_f32 v112, v24, v17
  s_waitcnt lgkmcnt(3)
  v_mfma_f32_16x16x32_bf16 v[208:211], a[144:147], a[32:35], v[208:211]
  v_fmac_f32 v113, v25, v17
  v_mfma_f32_16x16x32_bf16 v[212:215], a[144:147], a[36:39], v[212:215]
  v_fmac_f32 v114, v26, v17
  v_fmac_f32 v115, v27, v17
  v_mfma_f32_16x16x32_bf16 v[216:219], a[144:147], a[40:43], v[216:219]
  ds_read_b128 a[136:139], v7 offset:44032
  v_fmac_f32 v116, v24, v19
  v_mfma_f32_16x16x32_bf16 v[220:223], a[144:147], a[44:47], v[220:223]
  v_fmac_f32 v117, v25, v19
  v_fmac_f32 v118, v26, v19
  v_mfma_f32_16x16x32_bf16 v[224:227], a[148:151], a[32:35], v[224:227]
  v_fmac_f32 v119, v27, v19
  v_mfma_f32_16x16x32_bf16 v[228:231], a[148:151], a[36:39], v[228:231]
  ds_read_b128 a[140:143], v7 offset:51200
  v_fmac_f32 v120, v24, v21
  v_fmac_f32 v121, v25, v21
  v_mfma_f32_16x16x32_bf16 v[232:235], a[148:151], a[40:43], v[232:235]
  buffer_load_dwordx4 a[100:103], v9, s[12:15], s17 offen offset:0 sc1
  v_fmac_f32 v122, v26, v21
  v_mfma_f32_16x16x32_bf16 v[236:239], a[148:151], a[44:47], v[236:239]
  v_fmac_f32 v123, v27, v21
  v_fmac_f32 v124, v24, v23
  v_mfma_f32_16x16x32_bf16 v[240:243], a[152:155], a[32:35], v[240:243]
  v_fmac_f32 v125, v25, v23
  v_mfma_f32_16x16x32_bf16 v[244:247], a[152:155], a[36:39], v[244:247]
  ds_read_b128 a[144:147], v7 offset:45056
  v_fmac_f32 v126, v26, v23
  v_fmac_f32 v127, v27, v23
  v_mfma_f32_16x16x32_bf16 v[248:251], a[152:155], a[40:43], v[248:251]
  ds_read_b128 v[24:27], v12 offset:2048
  v_mfma_f32_16x16x32_bf16 v[252:255], a[152:155], a[44:47], v[252:255]
  s_waitcnt lgkmcnt(6)
  v_fmac_f32 v112, v28, v16
  s_waitcnt lgkmcnt(3)
  v_mfma_f32_16x16x32_bf16 v[32:35], a[128:131], a[48:51], v[32:35]
  v_fmac_f32 v113, v29, v16
  v_mfma_f32_16x16x32_bf16 v[36:39], a[128:131], a[52:55], v[36:39]
  ds_read_b128 a[148:151], v7 offset:52224
  buffer_load_dwordx4 a[104:107], v10, s[12:15], s17 offen offset:0 sc1
  v_fmac_f32 v114, v30, v16
  v_fmac_f32 v115, v31, v16
  v_mfma_f32_16x16x32_bf16 v[40:43], a[128:131], a[56:59], v[40:43]
  v_fmac_f32 v116, v28, v18
  v_mfma_f32_16x16x32_bf16 v[44:47], a[128:131], a[60:63], v[44:47]
  v_fmac_f32 v117, v29, v18
  v_fmac_f32 v118, v30, v18
  v_mfma_f32_16x16x32_bf16 v[48:51], a[132:135], a[48:51], v[48:51]
  ds_read_b128 a[152:155], v7 offset:46080
  v_fmac_f32 v119, v31, v18
  v_mfma_f32_16x16x32_bf16 v[52:55], a[132:135], a[52:55], v[52:55]
  v_fmac_f32 v120, v28, v20
  v_fmac_f32 v121, v29, v20
  v_mfma_f32_16x16x32_bf16 v[56:59], a[132:135], a[56:59], v[56:59]
  v_fmac_f32 v122, v30, v20
  v_mfma_f32_16x16x32_bf16 v[60:63], a[132:135], a[60:63], v[60:63]
  v_fmac_f32 v123, v31, v20
  v_fmac_f32 v124, v28, v22
  v_mfma_f32_16x16x32_bf16 v[64:67], a[136:139], a[48:51], v[64:67]
  ds_read_b128 a[128:131], v7 offset:53248
  v_fmac_f32 v125, v29, v22
  v_mfma_f32_16x16x32_bf16 v[68:71], a[136:139], a[52:55], v[68:71]
  buffer_load_dwordx4 a[108:111], v11, s[12:15], s17 offen offset:0 sc1
  v_fmac_f32 v126, v30, v22
  v_fmac_f32 v127, v31, v22
  v_mfma_f32_16x16x32_bf16 v[72:75], a[136:139], a[56:59], v[72:75]
  ds_read_b128 v[28:31], v12 offset:3072
  v_mfma_f32_16x16x32_bf16 v[76:79], a[136:139], a[60:63], v[76:79]
  s_waitcnt lgkmcnt(2)
  v_mfma_f32_16x16x32_bf16 v[80:83], a[140:143], a[48:51], v[80:83]
  ds_read_b128 a[132:135], v7 offset:47104
  v_mfma_f32_16x16x32_bf16 v[84:87], a[140:143], a[52:55], v[84:87]
  v_mfma_f32_16x16x32_bf16 v[88:91], a[140:143], a[56:59], v[88:91]
  v_mfma_f32_16x16x32_bf16 v[92:95], a[140:143], a[60:63], v[92:95]
  ds_read_b128 a[136:139], v7 offset:54272
  v_mfma_f32_16x16x32_bf16 v[96:99], a[144:147], a[48:51], v[96:99]
  buffer_load_dwordx4 a[112:115], v8, s[12:15], s17 offen offset:1024 sc1
  v_fmac_f32 v48, v24, v17
  v_mfma_f32_16x16x32_bf16 v[100:103], a[144:147], a[52:55], v[100:103]
  v_fmac_f32 v49, v25, v17
  v_mfma_f32_16x16x32_bf16 v[104:107], a[144:147], a[56:59], v[104:107]
  v_fmac_f32 v50, v26, v17
  v_fmac_f32 v51, v27, v17
  v_mfma_f32_16x16x32_bf16 v[108:111], a[144:147], a[60:63], v[108:111]
  ds_read_b128 a[140:143], v7 offset:48128
  v_fmac_f32 v52, v24, v19
  v_mfma_f32_16x16x32_bf16 v[112:115], a[148:151], a[48:51], v[112:115]
  v_fmac_f32 v53, v25, v19
  v_fmac_f32 v54, v26, v19
  v_mfma_f32_16x16x32_bf16 v[116:119], a[148:151], a[52:55], v[116:119]
  v_fmac_f32 v55, v27, v19
  v_mfma_f32_16x16x32_bf16 v[120:123], a[148:151], a[56:59], v[120:123]
  v_fmac_f32 v56, v24, v21
  v_fmac_f32 v57, v25, v21
  v_mfma_f32_16x16x32_bf16 v[124:127], a[148:151], a[60:63], v[124:127]
  ds_read_b128 a[144:147], v7 offset:55296
  buffer_load_dwordx4 a[116:119], v9, s[12:15], s17 offen offset:1024 sc1
  v_fmac_f32 v58, v26, v21
  v_mfma_f32_16x16x32_bf16 v[128:131], a[152:155], a[48:51], v[128:131]
  v_fmac_f32 v59, v27, v21
  v_fmac_f32 v60, v24, v23
  v_mfma_f32_16x16x32_bf16 v[132:135], a[152:155], a[52:55], v[132:135]
  v_fmac_f32 v61, v25, v23
  v_mfma_f32_16x16x32_bf16 v[136:139], a[152:155], a[56:59], v[136:139]
  ds_read_b128 a[148:151], v1 offset:43008
  v_fmac_f32 v62, v26, v23
  v_fmac_f32 v63, v27, v23
  v_mfma_f32_16x16x32_bf16 v[140:143], a[152:155], a[60:63], v[140:143]
  ds_read_b128 v[24:27], v12 offset:192
  s_waitcnt lgkmcnt(3)
  v_mfma_f32_16x16x32_bf16 v[144:147], a[128:131], a[48:51], v[144:147]
  v_fmac_f32 v48, v28, v16
  v_mfma_f32_16x16x32_bf16 v[148:151], a[128:131], a[52:55], v[148:151]
  v_fmac_f32 v49, v29, v16
  v_mfma_f32_16x16x32_bf16 v[152:155], a[128:131], a[56:59], v[152:155]
  ds_read_b128 a[152:155], v1 offset:50176
  v_fmac_f32 v50, v30, v16
  v_fmac_f32 v51, v31, v16
  v_mfma_f32_16x16x32_bf16 v[156:159], a[128:131], a[60:63], v[156:159]
  buffer_load_dwordx4 a[120:123], v10, s[12:15], s17 offen offset:1024 sc1
  v_fmac_f32 v52, v28, v18
  v_mfma_f32_16x16x32_bf16 v[160:163], a[132:135], a[48:51], v[160:163]
  v_fmac_f32 v53, v29, v18
  v_fmac_f32 v54, v30, v18
  v_mfma_f32_16x16x32_bf16 v[164:167], a[132:135], a[52:55], v[164:167]
  v_fmac_f32 v55, v31, v18
  v_mfma_f32_16x16x32_bf16 v[168:171], a[132:135], a[56:59], v[168:171]
  v_fmac_f32 v56, v28, v20
  v_fmac_f32 v57, v29, v20
  v_mfma_f32_16x16x32_bf16 v[172:175], a[132:135], a[60:63], v[172:175]
  v_fmac_f32 v58, v30, v20
  v_mfma_f32_16x16x32_bf16 v[176:179], a[136:139], a[48:51], v[176:179]
  v_fmac_f32 v59, v31, v20
  v_fmac_f32 v60, v28, v22
  v_mfma_f32_16x16x32_bf16 v[180:183], a[136:139], a[52:55], v[180:183]
  v_fmac_f32 v61, v29, v22
  v_mfma_f32_16x16x32_bf16 v[184:187], a[136:139], a[56:59], v[184:187]
  buffer_load_dwordx4 a[124:127], v11, s[12:15], s17 offen offset:1024 sc1
  s_add_u32 s17, s17, 2048
  v_fmac_f32 v62, v30, v22
  v_fmac_f32 v63, v31, v22
  v_mfma_f32_16x16x32_bf16 v[188:191], a[136:139], a[60:63], v[188:191]
  ds_read_b128 v[28:31], v12 offset:1216
  v_mfma_f32_16x16x32_bf16 v[192:195], a[140:143], a[48:51], v[192:195]
  v_mfma_f32_16x16x32_bf16 v[196:199], a[140:143], a[52:55], v[196:199]
  v_mfma_f32_16x16x32_bf16 v[200:203], a[140:143], a[56:59], v[200:203]
  v_mfma_f32_16x16x32_bf16 v[204:207], a[140:143], a[60:63], v[204:207]
  s_waitcnt vmcnt(15) lgkmcnt(0)
  s_barrier
  v_mfma_f32_16x16x32_bf16 v[208:211], a[144:147], a[48:51], v[208:211]
  ds_read_b128 a[128:131], v3 offset:0
  v_mfma_f32_16x16x32_bf16 v[212:215], a[144:147], a[52:55], v[212:215]
  v_fmac_f32 v128, v24, v17
  v_mfma_f32_16x16x32_bf16 v[216:219], a[144:147], a[56:59], v[216:219]
  v_fmac_f32 v129, v25, v17
  v_mfma_f32_16x16x32_bf16 v[220:223], a[144:147], a[60:63], v[220:223]
  ds_read_b128 a[132:135], v3 offset:7168
  v_fmac_f32 v130, v26, v17
  v_fmac_f32 v131, v27, v17
  v_mfma_f32_16x16x32_bf16 v[224:227], a[148:151], a[48:51], v[224:227]
  v_fmac_f32 v132, v24, v19
  v_mfma_f32_16x16x32_bf16 v[228:231], a[148:151], a[52:55], v[228:231]
  v_fmac_f32 v133, v25, v19
  v_fmac_f32 v134, v26, v19
  v_mfma_f32_16x16x32_bf16 v[232:235], a[148:151], a[56:59], v[232:235]
  v_fmac_f32 v135, v27, v19
  v_mfma_f32_16x16x32_bf16 v[236:239], a[148:151], a[60:63], v[236:239]
  ds_read_b128 a[136:139], v3 offset:1024
  v_fmac_f32 v136, v24, v21
  v_fmac_f32 v137, v25, v21
  v_mfma_f32_16x16x32_bf16 v[240:243], a[152:155], a[48:51], v[240:243]
  v_fmac_f32 v138, v26, v21
  v_mfma_f32_16x16x32_bf16 v[244:247], a[152:155], a[52:55], v[244:247]
  v_fmac_f32 v139, v27, v21
  v_fmac_f32 v140, v24, v23
  v_mfma_f32_16x16x32_bf16 v[248:251], a[152:155], a[56:59], v[248:251]
  ds_read_b128 a[140:143], v3 offset:8192
  v_fmac_f32 v141, v25, v23
  v_mfma_f32_16x16x32_bf16 v[252:255], a[152:155], a[60:63], v[252:255]
  v_fmac_f32 v142, v26, v23
  v_fmac_f32 v143, v27, v23
  s_waitcnt lgkmcnt(2)
  v_mfma_f32_16x16x32_bf16 v[32:35], a[128:131], a[64:67], v[32:35]
  ds_read_b128 v[24:27], v12 offset:384
  v_mfma_f32_16x16x32_bf16 v[36:39], a[128:131], a[68:71], v[36:39]
  v_fmac_f32 v128, v28, v16
  v_mfma_f32_16x16x32_bf16 v[40:43], a[128:131], a[72:75], v[40:43]
  ds_read_b128 a[144:147], v3 offset:2048
  v_fmac_f32 v129, v29, v16
  v_mfma_f32_16x16x32_bf16 v[44:47], a[128:131], a[76:79], v[44:47]
  v_fmac_f32 v130, v30, v16
  v_fmac_f32 v131, v31, v16
  v_mfma_f32_16x16x32_bf16 v[48:51], a[132:135], a[64:67], v[48:51]
  v_fmac_f32 v132, v28, v18
  v_mfma_f32_16x16x32_bf16 v[52:55], a[132:135], a[68:71], v[52:55]
  v_fmac_f32 v133, v29, v18
  v_fmac_f32 v134, v30, v18
  v_mfma_f32_16x16x32_bf16 v[56:59], a[132:135], a[72:75], v[56:59]
  ds_read_b128 a[148:151], v3 offset:9216
  v_fmac_f32 v135, v31, v18
  v_mfma_f32_16x16x32_bf16 v[60:63], a[132:135], a[76:79], v[60:63]
  v_fmac_f32 v136, v28, v20
  v_fmac_f32 v137, v29, v20
  s_waitcnt lgkmcnt(2)
  v_mfma_f32_16x16x32_bf16 v[64:67], a[136:139], a[64:67], v[64:67]
  v_fmac_f32 v138, v30, v20
  v_mfma_f32_16x16x32_bf16 v[68:71], a[136:139], a[68:71], v[68:71]
  ds_read_b128 a[152:155], v3 offset:3072
  v_fmac_f32 v139, v31, v20
  v_fmac_f32 v140, v28, v22
  v_mfma_f32_16x16x32_bf16 v[72:75], a[136:139], a[72:75], v[72:75]
  v_fmac_f32 v141, v29, v22
  v_mfma_f32_16x16x32_bf16 v[76:79], a[136:139], a[76:79], v[76:79]
  v_fmac_f32 v142, v30, v22
  v_fmac_f32 v143, v31, v22
  v_mfma_f32_16x16x32_bf16 v[80:83], a[140:143], a[64:67], v[80:83]
  ds_read_b128 v[28:31], v12 offset:1408
  v_mfma_f32_16x16x32_bf16 v[84:87], a[140:143], a[68:71], v[84:87]
  ds_read_b128 a[128:131], v3 offset:10240
  v_mfma_f32_16x16x32_bf16 v[88:91], a[140:143], a[72:75], v[88:91]
  v_mfma_f32_16x16x32_bf16 v[92:95], a[140:143], a[76:79], v[92:95]
  s_waitcnt lgkmcnt(3)
  v_mfma_f32_16x16x32_bf16 v[96:99], a[144:147], a[64:67], v[96:99]
  v_mfma_f32_16x16x32_bf16 v[100:103], a[144:147], a[68:71], v[100:103]
  ds_read_b128 a[132:135], v3 offset:4096
  v_mfma_f32_16x16x32_bf16 v[104:107], a[144:147], a[72:75], v[104:107]
  v_fmac_f32 v224, v24, v17
  v_mfma_f32_16x16x32_bf16 v[108:111], a[144:147], a[76:79], v[108:111]
  v_fmac_f32 v225, v25, v17
  v_mfma_f32_16x16x32_bf16 v[112:115], a[148:151], a[64:67], v[112:115]
  ds_read_b128 a[136:139], v3 offset:11264
  v_fmac_f32 v226, v26, v17
  v_fmac_f32 v227, v27, v17
  v_mfma_f32_16x16x32_bf16 v[116:119], a[148:151], a[68:71], v[116:119]
  v_fmac_f32 v228, v24, v19
  v_mfma_f32_16x16x32_bf16 v[120:123], a[148:151], a[72:75], v[120:123]
  v_fmac_f32 v229, v25, v19
  v_fmac_f32 v230, v26, v19
  v_mfma_f32_16x16x32_bf16 v[124:127], a[148:151], a[76:79], v[124:127]
  v_fmac_f32 v231, v27, v19
  s_waitcnt lgkmcnt(2)
  v_mfma_f32_16x16x32_bf16 v[128:131], a[152:155], a[64:67], v[128:131]
  ds_read_b128 a[140:143], v3 offset:5120
  v_fmac_f32 v232, v24, v21
  v_fmac_f32 v233, v25, v21
  v_mfma_f32_16x16x32_bf16 v[132:135], a[152:155], a[68:71], v[132:135]
  v_fmac_f32 v234, v26, v21
  v_mfma_f32_16x16x32_bf16 v[136:139], a[152:155], a[72:75], v[136:139]
  v_fmac_f32 v235, v27, v21
  v_fmac_f32 v236, v24, v23
  v_mfma_f32_16x16x32_bf16 v[140:143], a[152:155], a[76:79], v[140:143]
  v_fmac_f32 v237, v25, v23
  v_mfma_f32_16x16x32_bf16 v[144:147], a[128:131], a[64:67], v[144:147]
  ds_read_b128 a[144:147], v3 offset:12288
  v_fmac_f32 v238, v26, v23
  v_fmac_f32 v239, v27, v23
  v_mfma_f32_16x16x32_bf16 v[148:151], a[128:131], a[68:71], v[148:151]
  ds_read_b128 v[24:27], v12 offset:2240
  v_mfma_f32_16x16x32_bf16 v[152:155], a[128:131], a[72:75], v[152:155]
  v_fmac_f32 v224, v28, v16
  v_mfma_f32_16x16x32_bf16 v[156:159], a[128:131], a[76:79], v[156:159]
  ds_read_b128 a[148:151], v13 offset:0
  v_fmac_f32 v225, v29, v16
  s_waitcnt lgkmcnt(3)
  v_mfma_f32_16x16x32_bf16 v[160:163], a[132:135], a[64:67], v[160:163]
  v_fmac_f32 v226, v30, v16
  v_fmac_f32 v227, v31, v16
  v_mfma_f32_16x16x32_bf16 v[164:167], a[132:135], a[68:71], v[164:167]
  v_fmac_f32 v228, v28, v18
  v_mfma_f32_16x16x32_bf16 v[168:171], a[132:135], a[72:75], v[168:171]
  v_fmac_f32 v229, v29, v18
  v_fmac_f32 v230, v30, v18
  v_mfma_f32_16x16x32_bf16 v[172:175], a[132:135], a[76:79], v[172:175]
  ds_read_b128 a[152:155], v13 offset:7168
  v_fmac_f32 v231, v31, v18
  v_mfma_f32_16x16x32_bf16 v[176:179], a[136:139], a[64:67], v[176:179]
  v_fmac_f32 v232, v28, v20
  v_fmac_f32 v233, v29, v20
  v_mfma_f32_16x16x32_bf16 v[180:183], a[136:139], a[68:71], v[180:183]
  v_fmac_f32 v234, v30, v20
  v_mfma_f32_16x16x32_bf16 v[184:187], a[136:139], a[72:75], v[184:187]
  v_fmac_f32 v235, v31, v20
  v_fmac_f32 v236, v28, v22
  v_mfma_f32_16x16x32_bf16 v[188:191], a[136:139], a[76:79], v[188:191]
  ds_read_b128 a[128:131], v3 offset:14336
  v_fmac_f32 v237, v29, v22
  v_mfma_f32_16x16x32_bf16 v[192:195], a[140:143], a[64:67], v[192:195]
  v_fmac_f32 v238, v30, v22
  v_fmac_f32 v239, v31, v22
  v_mfma_f32_16x16x32_bf16 v[196:199], a[140:143], a[68:71], v[196:199]
  ds_read_b128 v[28:31], v12 offset:3264
  v_mfma_f32_16x16x32_bf16 v[200:203], a[140:143], a[72:75], v[200:203]
  ds_read_b128 a[132:135], v3 offset:21504
  v_mfma_f32_16x16x32_bf16 v[204:207], a[140:143], a[76:79], v[204:207]
  s_waitcnt lgkmcnt(3)
  v_mfma_f32_16x16x32_bf16 v[208:211], a[144:147], a[64:67], v[208:211]
  v_mfma_f32_16x16x32_bf16 v[212:215], a[144:147], a[68:71], v[212:215]
  v_mfma_f32_16x16x32_bf16 v[216:219], a[144:147], a[72:75], v[216:219]
  ds_read_b128 a[136:139], v3 offset:15360
  v_mfma_f32_16x16x32_bf16 v[220:223], a[144:147], a[76:79], v[220:223]
  v_fmac_f32 v144, v24, v17
  v_mfma_f32_16x16x32_bf16 v[224:227], a[148:151], a[64:67], v[224:227]
  v_fmac_f32 v145, v25, v17
  v_mfma_f32_16x16x32_bf16 v[228:231], a[148:151], a[68:71], v[228:231]
  ds_read_b128 a[140:143], v3 offset:22528
  v_fmac_f32 v146, v26, v17
  v_fmac_f32 v147, v27, v17
  v_mfma_f32_16x16x32_bf16 v[232:235], a[148:151], a[72:75], v[232:235]
  v_fmac_f32 v148, v24, v19
  v_mfma_f32_16x16x32_bf16 v[236:239], a[148:151], a[76:79], v[236:239]
  v_fmac_f32 v149, v25, v19
  v_fmac_f32 v150, v26, v19
  v_mfma_f32_16x16x32_bf16 v[240:243], a[152:155], a[64:67], v[240:243]
  v_fmac_f32 v151, v27, v19
  v_mfma_f32_16x16x32_bf16 v[244:247], a[152:155], a[68:71], v[244:247]
  ds_read_b128 a[144:147], v3 offset:16384
  v_fmac_f32 v152, v24, v21
  v_fmac_f32 v153, v25, v21
  v_mfma_f32_16x16x32_bf16 v[248:251], a[152:155], a[72:75], v[248:251]
  v_fmac_f32 v154, v26, v21
  v_mfma_f32_16x16x32_bf16 v[252:255], a[152:155], a[76:79], v[252:255]
  v_fmac_f32 v155, v27, v21
  v_fmac_f32 v156, v24, v23
  s_waitcnt lgkmcnt(2)
  v_mfma_f32_16x16x32_bf16 v[32:35], a[128:131], a[80:83], v[32:35]
  v_fmac_f32 v157, v25, v23
  v_mfma_f32_16x16x32_bf16 v[36:39], a[128:131], a[84:87], v[36:39]
  ds_read_b128 a[148:151], v3 offset:23552
  v_fmac_f32 v158, v26, v23
  v_fmac_f32 v159, v27, v23
  v_mfma_f32_16x16x32_bf16 v[40:43], a[128:131], a[88:91], v[40:43]
  ds_read_b128 v[24:27], v12 offset:64
  v_mfma_f32_16x16x32_bf16 v[44:47], a[128:131], a[92:95], v[44:47]
  v_fmac_f32 v144, v28, v16
  v_mfma_f32_16x16x32_bf16 v[48:51], a[132:135], a[80:83], v[48:51]
  ds_read_b128 a[152:155], v3 offset:17408
  v_fmac_f32 v145, v29, v16
  v_mfma_f32_16x16x32_bf16 v[52:55], a[132:135], a[84:87], v[52:55]
  v_fmac_f32 v146, v30, v16
  v_fmac_f32 v147, v31, v16
  v_mfma_f32_16x16x32_bf16 v[56:59], a[132:135], a[88:91], v[56:59]
  v_fmac_f32 v148, v28, v18
  v_mfma_f32_16x16x32_bf16 v[60:63], a[132:135], a[92:95], v[60:63]
  v_fmac_f32 v149, v29, v18
  v_fmac_f32 v150, v30, v18
  v_mfma_f32_16x16x32_bf16 v[64:67], a[136:139], a[80:83], v[64:67]
  ds_read_b128 a[128:131], v3 offset:24576
  v_fmac_f32 v151, v31, v18
  v_mfma_f32_16x16x32_bf16 v[68:71], a[136:139], a[84:87], v[68:71]
  v_fmac_f32 v152, v28, v20
  v_fmac_f32 v153, v29, v20
  v_mfma_f32_16x16x32_bf16 v[72:75], a[136:139], a[88:91], v[72:75]
  v_fmac_f32 v154, v30, v20
  v_mfma_f32_16x16x32_bf16 v[76:79], a[136:139], a[92:95], v[76:79]
  v_fmac_f32 v155, v31, v20
  v_fmac_f32 v156, v28, v22
  s_waitcnt lgkmcnt(1)
  v_mfma_f32_16x16x32_bf16 v[80:83], a[140:143], a[80:83], v[80:83]
  ds_read_b128 a[132:135], v3 offset:18432
  v_fmac_f32 v157, v29, v22
  v_mfma_f32_16x16x32_bf16 v[84:87], a[140:143], a[84:87], v[84:87]
  v_fmac_f32 v158, v30, v22
  v_fmac_f32 v159, v31, v22
  v_mfma_f32_16x16x32_bf16 v[88:91], a[140:143], a[88:91], v[88:91]
  ds_read_b128 v[28:31], v12 offset:1088
  v_mfma_f32_16x16x32_bf16 v[92:95], a[140:143], a[92:95], v[92:95]
  ds_read_b128 a[136:139], v3 offset:25600
  v_mfma_f32_16x16x32_bf16 v[96:99], a[144:147], a[80:83], v[96:99]
  v_mfma_f32_16x16x32_bf16 v[100:103], a[144:147], a[84:87], v[100:103]
  v_mfma_f32_16x16x32_bf16 v[104:107], a[144:147], a[88:91], v[104:107]
  v_mfma_f32_16x16x32_bf16 v[108:111], a[144:147], a[92:95], v[108:111]
  ds_read_b128 a[140:143], v3 offset:19456
  v_mfma_f32_16x16x32_bf16 v[112:115], a[148:151], a[80:83], v[112:115]
  v_fmac_f32 v64, v24, v17
  v_mfma_f32_16x16x32_bf16 v[116:119], a[148:151], a[84:87], v[116:119]
  v_fmac_f32 v65, v25, v17
  v_mfma_f32_16x16x32_bf16 v[120:123], a[148:151], a[88:91], v[120:123]
  v_fmac_f32 v66, v26, v17
  v_fmac_f32 v67, v27, v17
  v_mfma_f32_16x16x32_bf16 v[124:127], a[148:151], a[92:95], v[124:127]
  ds_read_b128 a[144:147], v3 offset:26624
  v_fmac_f32 v68, v24, v19
  v_mfma_f32_16x16x32_bf16 v[128:131], a[152:155], a[80:83], v[128:131]
  v_fmac_f32 v69, v25, v19
  v_fmac_f32 v70, v26, v19
  v_mfma_f32_16x16x32_bf16 v[132:135], a[152:155], a[84:87], v[132:135]
  v_fmac_f32 v71, v27, v19
  v_mfma_f32_16x16x32_bf16 v[136:139], a[152:155], a[88:91], v[136:139]
  ds_read_b128 a[148:151], v13 offset:14336
  v_fmac_f32 v72, v24, v21
  v_fmac_f32 v73, v25, v21
  v_mfma_f32_16x16x32_bf16 v[140:143], a[152:155], a[92:95], v[140:143]
  v_fmac_f32 v74, v26, v21
  s_waitcnt lgkmcnt(2)
  v_mfma_f32_16x16x32_bf16 v[144:147], a[128:131], a[80:83], v[144:147]
  v_fmac_f32 v75, v27, v21
  v_fmac_f32 v76, v24, v23
  v_mfma_f32_16x16x32_bf16 v[148:151], a[128:131], a[84:87], v[148:151]
  v_fmac_f32 v77, v25, v23
  v_mfma_f32_16x16x32_bf16 v[152:155], a[128:131], a[88:91], v[152:155]
  ds_read_b128 a[152:155], v13 offset:21504
  v_fmac_f32 v78, v26, v23
  v_fmac_f32 v79, v27, v23
  v_mfma_f32_16x16x32_bf16 v[156:159], a[128:131], a[92:95], v[156:159]
  ds_read_b128 v[24:27], v12 offset:256
  v_mfma_f32_16x16x32_bf16 v[160:163], a[132:135], a[80:83], v[160:163]
  v_fmac_f32 v64, v28, v16
  v_mfma_f32_16x16x32_bf16 v[164:167], a[132:135], a[84:87], v[164:167]
  v_fmac_f32 v65, v29, v16
  v_mfma_f32_16x16x32_bf16 v[168:171], a[132:135], a[88:91], v[168:171]
  v_fmac_f32 v66, v30, v16
  v_fmac_f32 v67, v31, v16
  v_mfma_f32_16x16x32_bf16 v[172:175], a[132:135], a[92:95], v[172:175]
  v_fmac_f32 v68, v28, v18
  v_mfma_f32_16x16x32_bf16 v[176:179], a[136:139], a[80:83], v[176:179]
  v_fmac_f32 v69, v29, v18
  v_fmac_f32 v70, v30, v18
  v_mfma_f32_16x16x32_bf16 v[180:183], a[136:139], a[84:87], v[180:183]
  v_fmac_f32 v71, v31, v18
  v_mfma_f32_16x16x32_bf16 v[184:187], a[136:139], a[88:91], v[184:187]
  v_fmac_f32 v72, v28, v20
  v_fmac_f32 v73, v29, v20
  v_mfma_f32_16x16x32_bf16 v[188:191], a[136:139], a[92:95], v[188:191]
  v_fmac_f32 v74, v30, v20
  v_mfma_f32_16x16x32_bf16 v[192:195], a[140:143], a[80:83], v[192:195]
  v_fmac_f32 v75, v31, v20
  v_fmac_f32 v76, v28, v22
  v_mfma_f32_16x16x32_bf16 v[196:199], a[140:143], a[84:87], v[196:199]
  v_fmac_f32 v77, v29, v22
  v_mfma_f32_16x16x32_bf16 v[200:203], a[140:143], a[88:91], v[200:203]
  v_fmac_f32 v78, v30, v22
  v_fmac_f32 v79, v31, v22
  v_mfma_f32_16x16x32_bf16 v[204:207], a[140:143], a[92:95], v[204:207]
  ds_read_b128 v[28:31], v12 offset:1280
  s_waitcnt vmcnt(0) lgkmcnt(0)
  s_barrier
  v_mfma_f32_16x16x32_bf16 v[208:211], a[144:147], a[80:83], v[208:211]
  ds_read_b128 a[128:131], v3 offset:28672
  v_mfma_f32_16x16x32_bf16 v[212:215], a[144:147], a[84:87], v[212:215]
  v_mfma_f32_16x16x32_bf16 v[216:219], a[144:147], a[88:91], v[216:219]
  v_mfma_f32_16x16x32_bf16 v[220:223], a[144:147], a[92:95], v[220:223]
  v_mfma_f32_16x16x32_bf16 v[224:227], a[148:151], a[80:83], v[224:227]
  ds_read_b128 a[132:135], v3 offset:35840
  v_mfma_f32_16x16x32_bf16 v[228:231], a[148:151], a[84:87], v[228:231]
  v_fmac_f32 v160, v24, v17
  v_mfma_f32_16x16x32_bf16 v[232:235], a[148:151], a[88:91], v[232:235]
  v_fmac_f32 v161, v25, v17
  v_mfma_f32_16x16x32_bf16 v[236:239], a[148:151], a[92:95], v[236:239]
  v_fmac_f32 v162, v26, v17
  v_fmac_f32 v163, v27, v17
  v_mfma_f32_16x16x32_bf16 v[240:243], a[152:155], a[80:83], v[240:243]
  ds_read_b128 a[136:139], v3 offset:29696
  v_fmac_f32 v164, v24, v19
  v_mfma_f32_16x16x32_bf16 v[244:247], a[152:155], a[84:87], v[244:247]
  v_fmac_f32 v165, v25, v19
  v_fmac_f32 v166, v26, v19
  v_mfma_f32_16x16x32_bf16 v[248:251], a[152:155], a[88:91], v[248:251]
  v_fmac_f32 v167, v27, v19
  v_mfma_f32_16x16x32_bf16 v[252:255], a[152:155], a[92:95], v[252:255]
  v_fmac_f32 v168, v24, v21
  v_fmac_f32 v169, v25, v21
  s_waitcnt lgkmcnt(1)
  v_mfma_f32_16x16x32_bf16 v[32:35], a[128:131], a[96:99], v[32:35]
  ds_read_b128 a[140:143], v3 offset:36864
  v_fmac_f32 v170, v26, v21
  v_mfma_f32_16x16x32_bf16 v[36:39], a[128:131], a[100:103], v[36:39]
  v_fmac_f32 v171, v27, v21
  v_fmac_f32 v172, v24, v23
  v_mfma_f32_16x16x32_bf16 v[40:43], a[128:131], a[104:107], v[40:43]
  v_fmac_f32 v173, v25, v23
  v_mfma_f32_16x16x32_bf16 v[44:47], a[128:131], a[108:111], v[44:47]
  v_fmac_f32 v174, v26, v23
  v_fmac_f32 v175, v27, v23
  v_mfma_f32_16x16x32_bf16 v[48:51], a[132:135], a[96:99], v[48:51]
  ds_read_b128 a[144:147], v3 offset:30720
  ds_read_b128 v[24:27], v12 offset:2432
  v_mfma_f32_16x16x32_bf16 v[52:55], a[132:135], a[100:103], v[52:55]
  v_fmac_f32 v160, v28, v16
  v_mfma_f32_16x16x32_bf16 v[56:59], a[132:135], a[104:107], v[56:59]
  v_fmac_f32 v161, v29, v16
  v_mfma_f32_16x16x32_bf16 v[60:63], a[132:135], a[108:111], v[60:63]
  v_fmac_f32 v162, v30, v16
  v_fmac_f32 v163, v31, v16
  s_waitcnt lgkmcnt(2)
  v_mfma_f32_16x16x32_bf16 v[64:67], a[136:139], a[96:99], v[64:67]
  ds_read_b128 a[148:151], v3 offset:37888
  v_fmac_f32 v164, v28, v18
  v_mfma_f32_16x16x32_bf16 v[68:71], a[136:139], a[100:103], v[68:71]
  v_fmac_f32 v165, v29, v18
  v_fmac_f32 v166, v30, v18
  v_mfma_f32_16x16x32_bf16 v[72:75], a[136:139], a[104:107], v[72:75]
  v_fmac_f32 v167, v31, v18
  v_mfma_f32_16x16x32_bf16 v[76:79], a[136:139], a[108:111], v[76:79]
  v_fmac_f32 v168, v28, v20
  v_fmac_f32 v169, v29, v20
  v_mfma_f32_16x16x32_bf16 v[80:83], a[140:143], a[96:99], v[80:83]
  ds_read_b128 a[152:155], v3 offset:31744
  v_fmac_f32 v170, v30, v20
  v_mfma_f32_16x16x32_bf16 v[84:87], a[140:143], a[100:103], v[84:87]
  v_fmac_f32 v171, v31, v20
  v_fmac_f32 v172, v28, v22
  v_mfma_f32_16x16x32_bf16 v[88:91], a[140:143], a[104:107], v[88:91]
  v_fmac_f32 v173, v29, v22
  v_mfma_f32_16x16x32_bf16 v[92:95], a[140:143], a[108:111], v[92:95]
  v_fmac_f32 v174, v30, v22
  v_fmac_f32 v175, v31, v22
  s_waitcnt lgkmcnt(1)
  v_mfma_f32_16x16x32_bf16 v[96:99], a[144:147], a[96:99], v[96:99]
  ds_read_b128 a[128:131], v3 offset:38912
  ds_read_b128 v[28:31], v12 offset:3456
  v_mfma_f32_16x16x32_bf16 v[100:103], a[144:147], a[100:103], v[100:103]
  v_mfma_f32_16x16x32_bf16 v[104:107], a[144:147], a[104:107], v[104:107]
  v_mfma_f32_16x16x32_bf16 v[108:111], a[144:147], a[108:111], v[108:111]
  v_mfma_f32_16x16x32_bf16 v[112:115], a[148:151], a[96:99], v[112:115]
  ds_read_b128 a[132:135], v3 offset:32768
  v_mfma_f32_16x16x32_bf16 v[116:119], a[148:151], a[100:103], v[116:119]
  v_mfma_f32_16x16x32_bf16 v[120:123], a[148:151], a[104:107], v[120:123]
  v_fmac_f32 v240, v24, v17
  v_mfma_f32_16x16x32_bf16 v[124:127], a[148:151], a[108:111], v[124:127]
  v_fmac_f32 v241, v25, v17
  s_waitcnt lgkmcnt(1)
  v_mfma_f32_16x16x32_bf16 v[128:131], a[152:155], a[96:99], v[128:131]
  ds_read_b128 a[136:139], v3 offset:39936
  v_fmac_f32 v242, v26, v17
  v_fmac_f32 v243, v27, v17
  v_mfma_f32_16x16x32_bf16 v[132:135], a[152:155], a[100:103], v[132:135]
  v_fmac_f32 v244, v24, v19
  v_mfma_f32_16x16x32_bf16 v[136:139], a[152:155], a[104:107], v[136:139]
  v_fmac_f32 v245, v25, v19
  v_fmac_f32 v246, v26, v19
  v_mfma_f32_16x16x32_bf16 v[140:143], a[152:155], a[108:111], v[140:143]
  v_fmac_f32 v247, v27, v19
  v_mfma_f32_16x16x32_bf16 v[144:147], a[128:131], a[96:99], v[144:147]
  ds_read_b128 a[140:143], v3 offset:33792
  v_fmac_f32 v248, v24, v21
  v_fmac_f32 v249, v25, v21
  v_mfma_f32_16x16x32_bf16 v[148:151], a[128:131], a[100:103], v[148:151]
  v_fmac_f32 v250, v26, v21
  v_mfma_f32_16x16x32_bf16 v[152:155], a[128:131], a[104:107], v[152:155]
  v_fmac_f32 v251, v27, v21
  v_fmac_f32 v252, v24, v23
  v_mfma_f32_16x16x32_bf16 v[156:159], a[128:131], a[108:111], v[156:159]
  v_fmac_f32 v253, v25, v23
  s_waitcnt lgkmcnt(1)
  v_mfma_f32_16x16x32_bf16 v[160:163], a[132:135], a[96:99], v[160:163]
  ds_read_b128 a[144:147], v3 offset:40960
  v_fmac_f32 v254, v26, v23
  v_fmac_f32 v255, v27, v23
  v_mfma_f32_16x16x32_bf16 v[164:167], a[132:135], a[100:103], v[164:167]
  ds_read_b128 v[24:27], v12 offset:2304
  v_mfma_f32_16x16x32_bf16 v[168:171], a[132:135], a[104:107], v[168:171]
  v_fmac_f32 v240, v28, v16
  v_mfma_f32_16x16x32_bf16 v[172:175], a[132:135], a[108:111], v[172:175]
  v_fmac_f32 v241, v29, v16
  v_mfma_f32_16x16x32_bf16 v[176:179], a[136:139], a[96:99], v[176:179]
  ds_read_b128 a[148:151], v13 offset:28672
  v_fmac_f32 v242, v30, v16
  v_fmac_f32 v243, v31, v16
  v_mfma_f32_16x16x32_bf16 v[180:183], a[136:139], a[100:103], v[180:183]
  v_fmac_f32 v244, v28, v18
  v_mfma_f32_16x16x32_bf16 v[184:187], a[136:139], a[104:107], v[184:187]
  v_fmac_f32 v245, v29, v18
  v_fmac_f32 v246, v30, v18
  v_mfma_f32_16x16x32_bf16 v[188:191], a[136:139], a[108:111], v[188:191]
  v_fmac_f32 v247, v31, v18
  s_waitcnt lgkmcnt(2)
  v_mfma_f32_16x16x32_bf16 v[192:195], a[140:143], a[96:99], v[192:195]
  ds_read_b128 a[152:155], v13 offset:35840
  v_fmac_f32 v248, v28, v20
  v_fmac_f32 v249, v29, v20
  v_mfma_f32_16x16x32_bf16 v[196:199], a[140:143], a[100:103], v[196:199]
  v_fmac_f32 v250, v30, v20
  v_mfma_f32_16x16x32_bf16 v[200:203], a[140:143], a[104:107], v[200:203]
  v_fmac_f32 v251, v31, v20
  v_fmac_f32 v252, v28, v22
  v_mfma_f32_16x16x32_bf16 v[204:207], a[140:143], a[108:111], v[204:207]
  v_fmac_f32 v253, v29, v22
  v_mfma_f32_16x16x32_bf16 v[208:211], a[144:147], a[96:99], v[208:211]
  ds_read_b128 a[128:131], v3 offset:43008
  v_fmac_f32 v254, v30, v22
  v_fmac_f32 v255, v31, v22
  v_mfma_f32_16x16x32_bf16 v[212:215], a[144:147], a[100:103], v[212:215]
  ds_read_b128 v[28:31], v12 offset:3328
  v_mfma_f32_16x16x32_bf16 v[216:219], a[144:147], a[104:107], v[216:219]
  v_mfma_f32_16x16x32_bf16 v[220:223], a[144:147], a[108:111], v[220:223]
  s_waitcnt lgkmcnt(2)
  v_mfma_f32_16x16x32_bf16 v[224:227], a[148:151], a[96:99], v[224:227]
  ds_read_b128 a[132:135], v3 offset:50176
  v_mfma_f32_16x16x32_bf16 v[228:231], a[148:151], a[100:103], v[228:231]
  v_mfma_f32_16x16x32_bf16 v[232:235], a[148:151], a[104:107], v[232:235]
  v_mfma_f32_16x16x32_bf16 v[236:239], a[148:151], a[108:111], v[236:239]
  v_fmac_f32 v176, v24, v17
  v_mfma_f32_16x16x32_bf16 v[240:243], a[152:155], a[96:99], v[240:243]
  ds_read_b128 a[136:139], v3 offset:44032
  v_fmac_f32 v177, v25, v17
  v_mfma_f32_16x16x32_bf16 v[244:247], a[152:155], a[100:103], v[244:247]
  v_fmac_f32 v178, v26, v17
  v_fmac_f32 v179, v27, v17
  v_mfma_f32_16x16x32_bf16 v[248:251], a[152:155], a[104:107], v[248:251]
  v_fmac_f32 v180, v24, v19
  v_mfma_f32_16x16x32_bf16 v[252:255], a[152:155], a[108:111], v[252:255]
  v_fmac_f32 v181, v25, v19
  v_fmac_f32 v182, v26, v19
  s_waitcnt lgkmcnt(1)
  v_mfma_f32_16x16x32_bf16 v[32:35], a[128:131], a[112:115], v[32:35]
  ds_read_b128 a[140:143], v3 offset:51200
  v_fmac_f32 v183, v27, v19
  v_mfma_f32_16x16x32_bf16 v[36:39], a[128:131], a[116:119], v[36:39]
  v_fmac_f32 v184, v24, v21
  v_mfma_f32_16x16x32_bf16 v[40:43], a[128:131], a[120:123], v[40:43]
  v_fmac_f32 v185, v25, v21
  v_fmac_f32 v186, v26, v21
  v_mfma_f32_16x16x32_bf16 v[44:47], a[128:131], a[124:127], v[44:47]
  v_fmac_f32 v187, v27, v21
  v_mfma_f32_16x16x32_bf16 v[48:51], a[132:135], a[112:115], v[48:51]
  ds_read_b128 a[144:147], v3 offset:45056
  v_fmac_f32 v188, v24, v23
  v_fmac_f32 v189, v25, v23
  v_mfma_f32_16x16x32_bf16 v[52:55], a[132:135], a[116:119], v[52:55]
  v_fmac_f32 v190, v26, v23
  v_mfma_f32_16x16x32_bf16 v[56:59], a[132:135], a[120:123], v[56:59]
  v_fmac_f32 v191, v27, v23
  v_mfma_f32_16x16x32_bf16 v[60:63], a[132:135], a[124:127], v[60:63]
  v_fmac_f32 v176, v28, v16
  s_waitcnt lgkmcnt(1)
  v_mfma_f32_16x16x32_bf16 v[64:67], a[136:139], a[112:115], v[64:67]
  ds_read_b128 a[148:151], v3 offset:52224
  v_fmac_f32 v177, v29, v16
  v_mfma_f32_16x16x32_bf16 v[68:71], a[136:139], a[116:119], v[68:71]
  v_fmac_f32 v178, v30, v16
  v_fmac_f32 v179, v31, v16
  v_mfma_f32_16x16x32_bf16 v[72:75], a[136:139], a[120:123], v[72:75]
  v_fmac_f32 v180, v28, v18
  v_mfma_f32_16x16x32_bf16 v[76:79], a[136:139], a[124:127], v[76:79]
  v_fmac_f32 v181, v29, v18
  v_fmac_f32 v182, v30, v18
  v_mfma_f32_16x16x32_bf16 v[80:83], a[140:143], a[112:115], v[80:83]
  ds_read_b128 a[152:155], v3 offset:46080
  v_fmac_f32 v183, v31, v18
  v_mfma_f32_16x16x32_bf16 v[84:87], a[140:143], a[116:119], v[84:87]
  v_fmac_f32 v184, v28, v20
  v_mfma_f32_16x16x32_bf16 v[88:91], a[140:143], a[120:123], v[88:91]
  v_fmac_f32 v185, v29, v20
  v_fmac_f32 v186, v30, v20
  v_mfma_f32_16x16x32_bf16 v[92:95], a[140:143], a[124:127], v[92:95]
  v_fmac_f32 v187, v31, v20
  s_waitcnt lgkmcnt(1)
  v_mfma_f32_16x16x32_bf16 v[96:99], a[144:147], a[112:115], v[96:99]
  ds_read_b128 a[128:131], v3 offset:53248
  v_fmac_f32 v188, v28, v22
  v_fmac_f32 v189, v29, v22
  v_mfma_f32_16x16x32_bf16 v[100:103], a[144:147], a[116:119], v[100:103]
  v_fmac_f32 v190, v30, v22
  v_mfma_f32_16x16x32_bf16 v[104:107], a[144:147], a[120:123], v[104:107]
  v_fmac_f32 v191, v31, v22
  v_mfma_f32_16x16x32_bf16 v[108:111], a[144:147], a[124:127], v[108:111]
  v_mul_f32 v24, v16, v16
  v_mfma_f32_16x16x32_bf16 v[112:115], a[148:151], a[112:115], v[112:115]
  ds_read_b128 a[132:135], v3 offset:47104
  v_mul_f32 v26, v18, v18
  v_mfma_f32_16x16x32_bf16 v[116:119], a[148:151], a[116:119], v[116:119]
  v_mul_f32 v28, v20, v20
  v_mfma_f32_16x16x32_bf16 v[120:123], a[148:151], a[120:123], v[120:123]
  v_mul_f32 v30, v22, v22
  v_mfma_f32_16x16x32_bf16 v[124:127], a[148:151], a[124:127], v[124:127]
  v_rcp_f32 v16, v16
  s_waitcnt lgkmcnt(1)
  v_mfma_f32_16x16x32_bf16 v[128:131], a[152:155], a[112:115], v[128:131]
  ds_read_b128 a[136:139], v3 offset:54272
  v_mfma_f32_16x16x32_bf16 v[132:135], a[152:155], a[116:119], v[132:135]
  v_rcp_f32 v18, v18
  v_mfma_f32_16x16x32_bf16 v[136:139], a[152:155], a[120:123], v[136:139]
  v_rcp_f32 v20, v20
  v_mfma_f32_16x16x32_bf16 v[140:143], a[152:155], a[124:127], v[140:143]
  v_rcp_f32 v22, v22
  v_mfma_f32_16x16x32_bf16 v[144:147], a[128:131], a[112:115], v[144:147]
  ds_read_b128 a[140:143], v3 offset:48128
  s_nop 0
  v_mfma_f32_16x16x32_bf16 v[148:151], a[128:131], a[116:119], v[148:151]
  v_mul_f32 v17, v16, v16
  v_mfma_f32_16x16x32_bf16 v[152:155], a[128:131], a[120:123], v[152:155]
  v_mfma_f32_16x16x32_bf16 v[156:159], a[128:131], a[124:127], v[156:159]
  v_mul_f32 v19, v18, v18
  s_waitcnt lgkmcnt(1)
  v_mfma_f32_16x16x32_bf16 v[160:163], a[132:135], a[112:115], v[160:163]
  ds_read_b128 a[144:147], v3 offset:55296
  v_mul_f32 v21, v20, v20
  v_mfma_f32_16x16x32_bf16 v[164:167], a[132:135], a[116:119], v[164:167]
  v_mul_f32 v23, v22, v22
  v_mfma_f32_16x16x32_bf16 v[168:171], a[132:135], a[120:123], v[168:171]
  v_mul_f32 v17, v17, v16
  v_mfma_f32_16x16x32_bf16 v[172:175], a[132:135], a[124:127], v[172:175]
  v_mul_f32 v19, v19, v18
  v_mfma_f32_16x16x32_bf16 v[176:179], a[136:139], a[112:115], v[176:179]
  ds_read_b128 a[148:151], v13 offset:43008
  v_mfma_f32_16x16x32_bf16 v[180:183], a[136:139], a[116:119], v[180:183]
  v_mul_f32 v21, v21, v20
  v_mfma_f32_16x16x32_bf16 v[184:187], a[136:139], a[120:123], v[184:187]
  v_mul_f32 v23, v23, v22
  v_mfma_f32_16x16x32_bf16 v[188:191], a[136:139], a[124:127], v[188:191]
  v_mul_f32 v17, s57, v17
  s_waitcnt lgkmcnt(1)
  v_mfma_f32_16x16x32_bf16 v[192:195], a[140:143], a[112:115], v[192:195]
  ds_read_b128 a[152:155], v13 offset:50176
  v_mul_f32 v19, s57, v19
  v_mfma_f32_16x16x32_bf16 v[196:199], a[140:143], a[116:119], v[196:199]
  v_mul_f32 v21, s57, v21
  v_mfma_f32_16x16x32_bf16 v[200:203], a[140:143], a[120:123], v[200:203]
  v_mfma_f32_16x16x32_bf16 v[204:207], a[140:143], a[124:127], v[204:207]
  v_mul_f32 v23, s57, v23
  v_mfma_f32_16x16x32_bf16 v[208:211], a[144:147], a[112:115], v[208:211]
  v_mul_f32 v16, s56, v16
  v_mfma_f32_16x16x32_bf16 v[212:215], a[144:147], a[116:119], v[212:215]
  v_mul_f32 v18, s56, v18
  v_mfma_f32_16x16x32_bf16 v[216:219], a[144:147], a[120:123], v[216:219]
  v_mul_f32 v20, s56, v20
  v_mfma_f32_16x16x32_bf16 v[220:223], a[144:147], a[124:127], v[220:223]
  v_mul_f32 v22, s56, v22
  s_waitcnt lgkmcnt(0)
  v_mfma_f32_16x16x32_bf16 v[224:227], a[148:151], a[112:115], v[224:227]
  v_mfma_f32_16x16x32_bf16 v[228:231], a[148:151], a[116:119], v[228:231]
  v_mfma_f32_16x16x32_bf16 v[232:235], a[148:151], a[120:123], v[232:235]
  v_mfma_f32_16x16x32_bf16 v[236:239], a[148:151], a[124:127], v[236:239]
  v_mfma_f32_16x16x32_bf16 v[240:243], a[152:155], a[112:115], v[240:243]
  v_mfma_f32_16x16x32_bf16 v[244:247], a[152:155], a[116:119], v[244:247]
  v_mfma_f32_16x16x32_bf16 v[248:251], a[152:155], a[120:123], v[248:251]
  v_mfma_f32_16x16x32_bf16 v[252:255], a[152:155], a[124:127], v[252:255]
  s_barrier
  s_mov_b32 s28, s68
  s_mov_b32 s29, s69
  s_lshr_b32 s21, s23, 1
  s_lshl_b32 s21, s21, 2
  s_and_b32 s25, s24, 3
  s_add_u32 s21, s21, s25
  s_lshr_b32 s22, s24, 2
  s_and_b32 s58, s23, 1
  s_lshl_b32 s25, s21, 2
  s_add_u32 s27, s25, s20
  s_lshl_b32 s26, s27, 1
  s_mul_i32 s59, s58, 458752
  s_mul_i32 s60, s58, 57344
  s_mul_i32 s18, s20, 4096
  s_mul_i32 s16, s22, 917504
  s_add_u32 s16, s16, s18
  s_mul_i32 s25, s26, 114688
  s_add_u32 s25, s25, 30408704
  s_mov_b32 s17, s60
  s_add_u32 s16, s16, s59
  s_waitcnt lgkmcnt(0)
  s_add_u32 s8, s4, 0x4100000
  s_addc_u32 s9, s5, 0
  s_mov_b32 s10, 0x700000
  s_mov_b32 s11, 0x20000
  s_add_u32 s12, s4, s25
  s_addc_u32 s13, s5, 0
  s_mov_b32 s14, 0x38000
  s_mov_b32 s15, 0x20000
  s_lshl_b32 s25, s58, 12
  s_xor_b32 s16, s16, s25
  v_pk_mul_f32 v[12:13], v[32:33], v[32:33]
  v_pk_mul_f32 v[14:15], v[34:35], v[34:35]
  v_pk_fma_f32 v[12:13], v[12:13], v[16:17], v[16:17] op_sel:[0,1,0] op_sel_hi:[1,1,0]
  v_pk_fma_f32 v[14:15], v[14:15], v[16:17], v[16:17] op_sel:[0,1,0] op_sel_hi:[1,1,0]
  v_pk_mul_f32 v[12:13], v[12:13], v[32:33]
  v_pk_mul_f32 v[14:15], v[14:15], v[34:35]
  v_exp_f32 v12, v12
  v_exp_f32 v13, v13
  v_exp_f32 v14, v14
  v_exp_f32 v15, v15
  v_pk_mul_f32 v[48:49], v[48:49], v[32:33]
  v_pk_mul_f32 v[50:51], v[50:51], v[34:35]
  v_pk_fma_f32 v[12:13], v[12:13], v[24:25], v[24:25] op_sel_hi:[1,0,0]
  v_pk_fma_f32 v[14:15], v[14:15], v[24:25], v[24:25] op_sel_hi:[1,0,0]
  v_rcp_f32 v12, v12
  v_rcp_f32 v13, v13
  v_rcp_f32 v14, v14
  v_rcp_f32 v15, v15
  s_nop 0
  v_pk_mul_f32 v[48:49], v[48:49], v[12:13]
  v_pk_mul_f32 v[50:51], v[50:51], v[14:15]
  v_cvt_pk_bf16_f32 v32, v48, v49
  v_cvt_pk_bf16_f32 v33, v50, v51
  v_pk_mul_f32 v[12:13], v[36:37], v[36:37]
  v_pk_mul_f32 v[14:15], v[38:39], v[38:39]
  v_pk_fma_f32 v[12:13], v[12:13], v[18:19], v[18:19] op_sel:[0,1,0] op_sel_hi:[1,1,0]
  v_pk_fma_f32 v[14:15], v[14:15], v[18:19], v[18:19] op_sel:[0,1,0] op_sel_hi:[1,1,0]
  v_pk_mul_f32 v[12:13], v[12:13], v[36:37]
  v_pk_mul_f32 v[14:15], v[14:15], v[38:39]
  v_exp_f32 v12, v12
  v_exp_f32 v13, v13
  v_exp_f32 v14, v14
  v_exp_f32 v15, v15
  v_pk_mul_f32 v[52:53], v[52:53], v[36:37]
  v_pk_mul_f32 v[54:55], v[54:55], v[38:39]
  v_pk_fma_f32 v[12:13], v[12:13], v[26:27], v[26:27] op_sel_hi:[1,0,0]
  v_pk_fma_f32 v[14:15], v[14:15], v[26:27], v[26:27] op_sel_hi:[1,0,0]
  v_rcp_f32 v12, v12
  v_rcp_f32 v13, v13
  v_rcp_f32 v14, v14
  v_rcp_f32 v15, v15
  s_nop 0
  v_pk_mul_f32 v[52:53], v[52:53], v[12:13]
  v_pk_mul_f32 v[54:55], v[54:55], v[14:15]
  v_cvt_pk_bf16_f32 v36, v52, v53
  v_cvt_pk_bf16_f32 v37, v54, v55
  v_pk_mul_f32 v[12:13], v[40:41], v[40:41]
  v_pk_mul_f32 v[14:15], v[42:43], v[42:43]
  v_pk_fma_f32 v[12:13], v[12:13], v[20:21], v[20:21] op_sel:[0,1,0] op_sel_hi:[1,1,0]
  v_pk_fma_f32 v[14:15], v[14:15], v[20:21], v[20:21] op_sel:[0,1,0] op_sel_hi:[1,1,0]
  v_pk_mul_f32 v[12:13], v[12:13], v[40:41]
  v_pk_mul_f32 v[14:15], v[14:15], v[42:43]
  v_exp_f32 v12, v12
  v_exp_f32 v13, v13
  v_exp_f32 v14, v14
  v_exp_f32 v15, v15
  v_pk_mul_f32 v[56:57], v[56:57], v[40:41]
  v_pk_mul_f32 v[58:59], v[58:59], v[42:43]
  v_pk_fma_f32 v[12:13], v[12:13], v[28:29], v[28:29] op_sel_hi:[1,0,0]
  v_pk_fma_f32 v[14:15], v[14:15], v[28:29], v[28:29] op_sel_hi:[1,0,0]
  v_rcp_f32 v12, v12
  v_rcp_f32 v13, v13
  v_rcp_f32 v14, v14
  v_rcp_f32 v15, v15
  s_nop 0
  v_pk_mul_f32 v[56:57], v[56:57], v[12:13]
  v_pk_mul_f32 v[58:59], v[58:59], v[14:15]
  v_cvt_pk_bf16_f32 v40, v56, v57
  v_cvt_pk_bf16_f32 v41, v58, v59
  v_pk_mul_f32 v[12:13], v[44:45], v[44:45]
  v_pk_mul_f32 v[14:15], v[46:47], v[46:47]
  v_pk_fma_f32 v[12:13], v[12:13], v[22:23], v[22:23] op_sel:[0,1,0] op_sel_hi:[1,1,0]
  v_pk_fma_f32 v[14:15], v[14:15], v[22:23], v[22:23] op_sel:[0,1,0] op_sel_hi:[1,1,0]
  v_pk_mul_f32 v[12:13], v[12:13], v[44:45]
  v_pk_mul_f32 v[14:15], v[14:15], v[46:47]
  v_exp_f32 v12, v12
  v_exp_f32 v13, v13
  v_exp_f32 v14, v14
  v_exp_f32 v15, v15
  v_pk_mul_f32 v[60:61], v[60:61], v[44:45]
  v_pk_mul_f32 v[62:63], v[62:63], v[46:47]
  v_pk_fma_f32 v[12:13], v[12:13], v[30:31], v[30:31] op_sel_hi:[1,0,0]
  v_pk_fma_f32 v[14:15], v[14:15], v[30:31], v[30:31] op_sel_hi:[1,0,0]
  v_rcp_f32 v12, v12
  v_rcp_f32 v13, v13
  v_rcp_f32 v14, v14
  v_rcp_f32 v15, v15
  s_nop 0
  v_pk_mul_f32 v[60:61], v[60:61], v[12:13]
  v_pk_mul_f32 v[62:63], v[62:63], v[14:15]
  v_cvt_pk_bf16_f32 v44, v60, v61
  v_cvt_pk_bf16_f32 v45, v62, v63
  v_pk_mul_f32 v[12:13], v[64:65], v[64:65]
  v_pk_mul_f32 v[14:15], v[66:67], v[66:67]
  v_pk_fma_f32 v[12:13], v[12:13], v[16:17], v[16:17] op_sel:[0,1,0] op_sel_hi:[1,1,0]
  v_pk_fma_f32 v[14:15], v[14:15], v[16:17], v[16:17] op_sel:[0,1,0] op_sel_hi:[1,1,0]
  v_pk_mul_f32 v[12:13], v[12:13], v[64:65]
  v_pk_mul_f32 v[14:15], v[14:15], v[66:67]
  v_exp_f32 v12, v12
  v_exp_f32 v13, v13
  v_exp_f32 v14, v14
  v_exp_f32 v15, v15
  v_pk_mul_f32 v[80:81], v[80:81], v[64:65]
  v_pk_mul_f32 v[82:83], v[82:83], v[66:67]
  v_pk_fma_f32 v[12:13], v[12:13], v[24:25], v[24:25] op_sel_hi:[1,0,0]
  v_pk_fma_f32 v[14:15], v[14:15], v[24:25], v[24:25] op_sel_hi:[1,0,0]
  v_rcp_f32 v12, v12
  v_rcp_f32 v13, v13
  v_rcp_f32 v14, v14
  v_rcp_f32 v15, v15
  s_nop 0
  v_pk_mul_f32 v[80:81], v[80:81], v[12:13]
  v_pk_mul_f32 v[82:83], v[82:83], v[14:15]
  v_cvt_pk_bf16_f32 v34, v80, v81
  v_cvt_pk_bf16_f32 v35, v82, v83
  buffer_store_dwordx4 v[32:35], v2, s[44:47], s48 offen offset:0 sc1
  v_pk_mul_f32 v[12:13], v[68:69], v[68:69]
  v_pk_mul_f32 v[14:15], v[70:71], v[70:71]
  v_pk_fma_f32 v[12:13], v[12:13], v[18:19], v[18:19] op_sel:[0,1,0] op_sel_hi:[1,1,0]
  v_pk_fma_f32 v[14:15], v[14:15], v[18:19], v[18:19] op_sel:[0,1,0] op_sel_hi:[1,1,0]
  v_pk_mul_f32 v[12:13], v[12:13], v[68:69]
  v_pk_mul_f32 v[14:15], v[14:15], v[70:71]
  v_exp_f32 v12, v12
  v_exp_f32 v13, v13
  v_exp_f32 v14, v14
  v_exp_f32 v15, v15
  v_pk_mul_f32 v[84:85], v[84:85], v[68:69]
  v_pk_mul_f32 v[86:87], v[86:87], v[70:71]
  v_pk_fma_f32 v[12:13], v[12:13], v[26:27], v[26:27] op_sel_hi:[1,0,0]
  v_pk_fma_f32 v[14:15], v[14:15], v[26:27], v[26:27] op_sel_hi:[1,0,0]
  v_rcp_f32 v12, v12
  v_rcp_f32 v13, v13
  v_rcp_f32 v14, v14
  v_rcp_f32 v15, v15
  s_nop 0
  v_pk_mul_f32 v[84:85], v[84:85], v[12:13]
  v_pk_mul_f32 v[86:87], v[86:87], v[14:15]
  v_cvt_pk_bf16_f32 v38, v84, v85
  v_cvt_pk_bf16_f32 v39, v86, v87
  buffer_store_dwordx4 v[36:39], v2, s[44:47], s49 offen offset:0 sc1
  v_pk_mul_f32 v[12:13], v[72:73], v[72:73]
  v_pk_mul_f32 v[14:15], v[74:75], v[74:75]
  v_pk_fma_f32 v[12:13], v[12:13], v[20:21], v[20:21] op_sel:[0,1,0] op_sel_hi:[1,1,0]
  v_pk_fma_f32 v[14:15], v[14:15], v[20:21], v[20:21] op_sel:[0,1,0] op_sel_hi:[1,1,0]
  v_pk_mul_f32 v[12:13], v[12:13], v[72:73]
  v_pk_mul_f32 v[14:15], v[14:15], v[74:75]
  v_exp_f32 v12, v12
  v_exp_f32 v13, v13
  v_exp_f32 v14, v14
  v_exp_f32 v15, v15
  v_pk_mul_f32 v[88:89], v[88:89], v[72:73]
  v_pk_mul_f32 v[90:91], v[90:91], v[74:75]
  v_pk_fma_f32 v[12:13], v[12:13], v[28:29], v[28:29] op_sel_hi:[1,0,0]
  v_pk_fma_f32 v[14:15], v[14:15], v[28:29], v[28:29] op_sel_hi:[1,0,0]
  v_rcp_f32 v12, v12
  v_rcp_f32 v13, v13
  v_rcp_f32 v14, v14
  v_rcp_f32 v15, v15
  s_nop 0
  v_pk_mul_f32 v[88:89], v[88:89], v[12:13]
  v_pk_mul_f32 v[90:91], v[90:91], v[14:15]
  v_cvt_pk_bf16_f32 v42, v88, v89
  v_cvt_pk_bf16_f32 v43, v90, v91
  buffer_store_dwordx4 v[40:43], v2, s[44:47], s50 offen offset:0 sc1
  v_pk_mul_f32 v[12:13], v[76:77], v[76:77]
  v_pk_mul_f32 v[14:15], v[78:79], v[78:79]
  v_pk_fma_f32 v[12:13], v[12:13], v[22:23], v[22:23] op_sel:[0,1,0] op_sel_hi:[1,1,0]
  v_pk_fma_f32 v[14:15], v[14:15], v[22:23], v[22:23] op_sel:[0,1,0] op_sel_hi:[1,1,0]
  v_pk_mul_f32 v[12:13], v[12:13], v[76:77]
  v_pk_mul_f32 v[14:15], v[14:15], v[78:79]
  v_exp_f32 v12, v12
  v_exp_f32 v13, v13
  v_exp_f32 v14, v14
  v_exp_f32 v15, v15
  v_pk_mul_f32 v[92:93], v[92:93], v[76:77]
  v_pk_mul_f32 v[94:95], v[94:95], v[78:79]
  v_pk_fma_f32 v[12:13], v[12:13], v[30:31], v[30:31] op_sel_hi:[1,0,0]
  v_pk_fma_f32 v[14:15], v[14:15], v[30:31], v[30:31] op_sel_hi:[1,0,0]
  v_rcp_f32 v12, v12
  v_rcp_f32 v13, v13
  v_rcp_f32 v14, v14
  v_rcp_f32 v15, v15
  s_nop 0
  v_pk_mul_f32 v[92:93], v[92:93], v[12:13]
  v_pk_mul_f32 v[94:95], v[94:95], v[14:15]
  v_cvt_pk_bf16_f32 v46, v92, v93
  v_cvt_pk_bf16_f32 v47, v94, v95
  buffer_store_dwordx4 v[44:47], v2, s[44:47], s51 offen offset:0 sc1
  v_pk_mul_f32 v[12:13], v[96:97], v[96:97]
  v_pk_mul_f32 v[14:15], v[98:99], v[98:99]
  v_pk_fma_f32 v[12:13], v[12:13], v[16:17], v[16:17] op_sel:[0,1,0] op_sel_hi:[1,1,0]
  v_pk_fma_f32 v[14:15], v[14:15], v[16:17], v[16:17] op_sel:[0,1,0] op_sel_hi:[1,1,0]
  v_pk_mul_f32 v[12:13], v[12:13], v[96:97]
  v_pk_mul_f32 v[14:15], v[14:15], v[98:99]
  v_exp_f32 v12, v12
  v_exp_f32 v13, v13
  v_exp_f32 v14, v14
  v_exp_f32 v15, v15
  v_pk_mul_f32 v[112:113], v[112:113], v[96:97]
  v_pk_mul_f32 v[114:115], v[114:115], v[98:99]
  v_pk_fma_f32 v[12:13], v[12:13], v[24:25], v[24:25] op_sel_hi:[1,0,0]
  v_pk_fma_f32 v[14:15], v[14:15], v[24:25], v[24:25] op_sel_hi:[1,0,0]
  v_rcp_f32 v12, v12
  v_rcp_f32 v13, v13
  v_rcp_f32 v14, v14
  v_rcp_f32 v15, v15
  s_nop 0
  v_pk_mul_f32 v[112:113], v[112:113], v[12:13]
  v_pk_mul_f32 v[114:115], v[114:115], v[14:15]
  v_cvt_pk_bf16_f32 v96, v112, v113
  v_cvt_pk_bf16_f32 v97, v114, v115
  v_pk_mul_f32 v[12:13], v[100:101], v[100:101]
  v_pk_mul_f32 v[14:15], v[102:103], v[102:103]
  v_pk_fma_f32 v[12:13], v[12:13], v[18:19], v[18:19] op_sel:[0,1,0] op_sel_hi:[1,1,0]
  v_pk_fma_f32 v[14:15], v[14:15], v[18:19], v[18:19] op_sel:[0,1,0] op_sel_hi:[1,1,0]
  v_pk_mul_f32 v[12:13], v[12:13], v[100:101]
  v_pk_mul_f32 v[14:15], v[14:15], v[102:103]
  v_exp_f32 v12, v12
  v_exp_f32 v13, v13
  v_exp_f32 v14, v14
  v_exp_f32 v15, v15
  v_pk_mul_f32 v[116:117], v[116:117], v[100:101]
  v_pk_mul_f32 v[118:119], v[118:119], v[102:103]
  v_pk_fma_f32 v[12:13], v[12:13], v[26:27], v[26:27] op_sel_hi:[1,0,0]
  v_pk_fma_f32 v[14:15], v[14:15], v[26:27], v[26:27] op_sel_hi:[1,0,0]
  v_rcp_f32 v12, v12
  v_rcp_f32 v13, v13
  v_rcp_f32 v14, v14
  v_rcp_f32 v15, v15
  s_nop 0
  v_pk_mul_f32 v[116:117], v[116:117], v[12:13]
  v_pk_mul_f32 v[118:119], v[118:119], v[14:15]
  v_cvt_pk_bf16_f32 v100, v116, v117
  v_cvt_pk_bf16_f32 v101, v118, v119
  v_pk_mul_f32 v[12:13], v[104:105], v[104:105]
  v_pk_mul_f32 v[14:15], v[106:107], v[106:107]
  v_pk_fma_f32 v[12:13], v[12:13], v[20:21], v[20:21] op_sel:[0,1,0] op_sel_hi:[1,1,0]
  v_pk_fma_f32 v[14:15], v[14:15], v[20:21], v[20:21] op_sel:[0,1,0] op_sel_hi:[1,1,0]
  v_pk_mul_f32 v[12:13], v[12:13], v[104:105]
  v_pk_mul_f32 v[14:15], v[14:15], v[106:107]
  v_exp_f32 v12, v12
  v_exp_f32 v13, v13
  v_exp_f32 v14, v14
  v_exp_f32 v15, v15
  v_pk_mul_f32 v[120:121], v[120:121], v[104:105]
  v_pk_mul_f32 v[122:123], v[122:123], v[106:107]
  v_pk_fma_f32 v[12:13], v[12:13], v[28:29], v[28:29] op_sel_hi:[1,0,0]
  v_pk_fma_f32 v[14:15], v[14:15], v[28:29], v[28:29] op_sel_hi:[1,0,0]
  v_rcp_f32 v12, v12
  v_rcp_f32 v13, v13
  v_rcp_f32 v14, v14
  v_rcp_f32 v15, v15
  s_nop 0
  v_pk_mul_f32 v[120:121], v[120:121], v[12:13]
  v_pk_mul_f32 v[122:123], v[122:123], v[14:15]
  v_cvt_pk_bf16_f32 v104, v120, v121
  v_cvt_pk_bf16_f32 v105, v122, v123
  v_pk_mul_f32 v[12:13], v[108:109], v[108:109]
  v_pk_mul_f32 v[14:15], v[110:111], v[110:111]
  v_pk_fma_f32 v[12:13], v[12:13], v[22:23], v[22:23] op_sel:[0,1,0] op_sel_hi:[1,1,0]
  v_pk_fma_f32 v[14:15], v[14:15], v[22:23], v[22:23] op_sel:[0,1,0] op_sel_hi:[1,1,0]
  v_pk_mul_f32 v[12:13], v[12:13], v[108:109]
  v_pk_mul_f32 v[14:15], v[14:15], v[110:111]
  v_exp_f32 v12, v12
  v_exp_f32 v13, v13
  v_exp_f32 v14, v14
  v_exp_f32 v15, v15
  v_pk_mul_f32 v[124:125], v[124:125], v[108:109]
  v_pk_mul_f32 v[126:127], v[126:127], v[110:111]
  v_pk_fma_f32 v[12:13], v[12:13], v[30:31], v[30:31] op_sel_hi:[1,0,0]
  v_pk_fma_f32 v[14:15], v[14:15], v[30:31], v[30:31] op_sel_hi:[1,0,0]
  v_rcp_f32 v12, v12
  v_rcp_f32 v13, v13
  v_rcp_f32 v14, v14
  v_rcp_f32 v15, v15
  s_nop 0
  v_pk_mul_f32 v[124:125], v[124:125], v[12:13]
  v_pk_mul_f32 v[126:127], v[126:127], v[14:15]
  v_cvt_pk_bf16_f32 v108, v124, v125
  v_cvt_pk_bf16_f32 v109, v126, v127
  v_pk_mul_f32 v[12:13], v[128:129], v[128:129]
  v_pk_mul_f32 v[14:15], v[130:131], v[130:131]
  v_pk_fma_f32 v[12:13], v[12:13], v[16:17], v[16:17] op_sel:[0,1,0] op_sel_hi:[1,1,0]
  v_pk_fma_f32 v[14:15], v[14:15], v[16:17], v[16:17] op_sel:[0,1,0] op_sel_hi:[1,1,0]
  v_pk_mul_f32 v[12:13], v[12:13], v[128:129]
  v_pk_mul_f32 v[14:15], v[14:15], v[130:131]
  v_exp_f32 v12, v12
  v_exp_f32 v13, v13
  v_exp_f32 v14, v14
  v_exp_f32 v15, v15
  v_pk_mul_f32 v[144:145], v[144:145], v[128:129]
  v_pk_mul_f32 v[146:147], v[146:147], v[130:131]
  v_pk_fma_f32 v[12:13], v[12:13], v[24:25], v[24:25] op_sel_hi:[1,0,0]
  v_pk_fma_f32 v[14:15], v[14:15], v[24:25], v[24:25] op_sel_hi:[1,0,0]
  v_rcp_f32 v12, v12
  v_rcp_f32 v13, v13
  v_rcp_f32 v14, v14
  v_rcp_f32 v15, v15
  s_nop 0
  v_pk_mul_f32 v[144:145], v[144:145], v[12:13]
  v_pk_mul_f32 v[146:147], v[146:147], v[14:15]
  v_cvt_pk_bf16_f32 v98, v144, v145
  v_cvt_pk_bf16_f32 v99, v146, v147
  buffer_store_dwordx4 v[96:99], v2, s[44:47], s48 offen offset:1024 sc1
  v_pk_mul_f32 v[12:13], v[132:133], v[132:133]
  v_pk_mul_f32 v[14:15], v[134:135], v[134:135]
  v_pk_fma_f32 v[12:13], v[12:13], v[18:19], v[18:19] op_sel:[0,1,0] op_sel_hi:[1,1,0]
  v_pk_fma_f32 v[14:15], v[14:15], v[18:19], v[18:19] op_sel:[0,1,0] op_sel_hi:[1,1,0]
  v_pk_mul_f32 v[12:13], v[12:13], v[132:133]
  v_pk_mul_f32 v[14:15], v[14:15], v[134:135]
  v_exp_f32 v12, v12
  v_exp_f32 v13, v13
  v_exp_f32 v14, v14
  v_exp_f32 v15, v15
  v_pk_mul_f32 v[148:149], v[148:149], v[132:133]
  v_pk_mul_f32 v[150:151], v[150:151], v[134:135]
  v_pk_fma_f32 v[12:13], v[12:13], v[26:27], v[26:27] op_sel_hi:[1,0,0]
  v_pk_fma_f32 v[14:15], v[14:15], v[26:27], v[26:27] op_sel_hi:[1,0,0]
  v_rcp_f32 v12, v12
  v_rcp_f32 v13, v13
  v_rcp_f32 v14, v14
  v_rcp_f32 v15, v15
  s_nop 0
  v_pk_mul_f32 v[148:149], v[148:149], v[12:13]
  v_pk_mul_f32 v[150:151], v[150:151], v[14:15]
  v_cvt_pk_bf16_f32 v102, v148, v149
  v_cvt_pk_bf16_f32 v103, v150, v151
  buffer_store_dwordx4 v[100:103], v2, s[44:47], s49 offen offset:1024 sc1
  v_pk_mul_f32 v[12:13], v[136:137], v[136:137]
  v_pk_mul_f32 v[14:15], v[138:139], v[138:139]
  v_pk_fma_f32 v[12:13], v[12:13], v[20:21], v[20:21] op_sel:[0,1,0] op_sel_hi:[1,1,0]
  v_pk_fma_f32 v[14:15], v[14:15], v[20:21], v[20:21] op_sel:[0,1,0] op_sel_hi:[1,1,0]
  v_pk_mul_f32 v[12:13], v[12:13], v[136:137]
  v_pk_mul_f32 v[14:15], v[14:15], v[138:139]
  v_exp_f32 v12, v12
  v_exp_f32 v13, v13
  v_exp_f32 v14, v14
  v_exp_f32 v15, v15
  v_pk_mul_f32 v[152:153], v[152:153], v[136:137]
  v_pk_mul_f32 v[154:155], v[154:155], v[138:139]
  v_pk_fma_f32 v[12:13], v[12:13], v[28:29], v[28:29] op_sel_hi:[1,0,0]
  v_pk_fma_f32 v[14:15], v[14:15], v[28:29], v[28:29] op_sel_hi:[1,0,0]
  v_rcp_f32 v12, v12
  v_rcp_f32 v13, v13
  v_rcp_f32 v14, v14
  v_rcp_f32 v15, v15
  s_nop 0
  v_pk_mul_f32 v[152:153], v[152:153], v[12:13]
  v_pk_mul_f32 v[154:155], v[154:155], v[14:15]
  v_cvt_pk_bf16_f32 v106, v152, v153
  v_cvt_pk_bf16_f32 v107, v154, v155
  buffer_store_dwordx4 v[104:107], v2, s[44:47], s50 offen offset:1024 sc1
  v_pk_mul_f32 v[12:13], v[140:141], v[140:141]
  v_pk_mul_f32 v[14:15], v[142:143], v[142:143]
  v_pk_fma_f32 v[12:13], v[12:13], v[22:23], v[22:23] op_sel:[0,1,0] op_sel_hi:[1,1,0]
  v_pk_fma_f32 v[14:15], v[14:15], v[22:23], v[22:23] op_sel:[0,1,0] op_sel_hi:[1,1,0]
  v_pk_mul_f32 v[12:13], v[12:13], v[140:141]
  v_pk_mul_f32 v[14:15], v[14:15], v[142:143]
  v_exp_f32 v12, v12
  v_exp_f32 v13, v13
  v_exp_f32 v14, v14
  v_exp_f32 v15, v15
  v_pk_mul_f32 v[156:157], v[156:157], v[140:141]
  v_pk_mul_f32 v[158:159], v[158:159], v[142:143]
  v_pk_fma_f32 v[12:13], v[12:13], v[30:31], v[30:31] op_sel_hi:[1,0,0]
  v_pk_fma_f32 v[14:15], v[14:15], v[30:31], v[30:31] op_sel_hi:[1,0,0]
  v_rcp_f32 v12, v12
  v_rcp_f32 v13, v13
  v_rcp_f32 v14, v14
  v_rcp_f32 v15, v15
  s_nop 0
  v_pk_mul_f32 v[156:157], v[156:157], v[12:13]
  v_pk_mul_f32 v[158:159], v[158:159], v[14:15]
  v_cvt_pk_bf16_f32 v110, v156, v157
  v_cvt_pk_bf16_f32 v111, v158, v159
  buffer_store_dwordx4 v[108:111], v2, s[44:47], s51 offen offset:1024 sc1
  v_pk_mul_f32 v[12:13], v[160:161], v[160:161]
  v_pk_mul_f32 v[14:15], v[162:163], v[162:163]
  v_pk_fma_f32 v[12:13], v[12:13], v[16:17], v[16:17] op_sel:[0,1,0] op_sel_hi:[1,1,0]
  v_pk_fma_f32 v[14:15], v[14:15], v[16:17], v[16:17] op_sel:[0,1,0] op_sel_hi:[1,1,0]
  v_pk_mul_f32 v[12:13], v[12:13], v[160:161]
  v_pk_mul_f32 v[14:15], v[14:15], v[162:163]
  v_exp_f32 v12, v12
  v_exp_f32 v13, v13
  v_exp_f32 v14, v14
  v_exp_f32 v15, v15
  v_pk_mul_f32 v[176:177], v[176:177], v[160:161]
  v_pk_mul_f32 v[178:179], v[178:179], v[162:163]
  v_pk_fma_f32 v[12:13], v[12:13], v[24:25], v[24:25] op_sel_hi:[1,0,0]
  v_pk_fma_f32 v[14:15], v[14:15], v[24:25], v[24:25] op_sel_hi:[1,0,0]
  v_rcp_f32 v12, v12
  v_rcp_f32 v13, v13
  v_rcp_f32 v14, v14
  v_rcp_f32 v15, v15
  s_nop 0
  v_pk_mul_f32 v[176:177], v[176:177], v[12:13]
  v_pk_mul_f32 v[178:179], v[178:179], v[14:15]
  v_cvt_pk_bf16_f32 v160, v176, v177
  v_cvt_pk_bf16_f32 v161, v178, v179
  v_pk_mul_f32 v[12:13], v[164:165], v[164:165]
  v_pk_mul_f32 v[14:15], v[166:167], v[166:167]
  v_pk_fma_f32 v[12:13], v[12:13], v[18:19], v[18:19] op_sel:[0,1,0] op_sel_hi:[1,1,0]
  v_pk_fma_f32 v[14:15], v[14:15], v[18:19], v[18:19] op_sel:[0,1,0] op_sel_hi:[1,1,0]
  v_pk_mul_f32 v[12:13], v[12:13], v[164:165]
  v_pk_mul_f32 v[14:15], v[14:15], v[166:167]
  v_exp_f32 v12, v12
  v_exp_f32 v13, v13
  v_exp_f32 v14, v14
  v_exp_f32 v15, v15
  v_pk_mul_f32 v[180:181], v[180:181], v[164:165]
  v_pk_mul_f32 v[182:183], v[182:183], v[166:167]
  v_pk_fma_f32 v[12:13], v[12:13], v[26:27], v[26:27] op_sel_hi:[1,0,0]
  v_pk_fma_f32 v[14:15], v[14:15], v[26:27], v[26:27] op_sel_hi:[1,0,0]
  v_rcp_f32 v12, v12
  v_rcp_f32 v13, v13
  v_rcp_f32 v14, v14
  v_rcp_f32 v15, v15
  s_nop 0
  v_pk_mul_f32 v[180:181], v[180:181], v[12:13]
  v_pk_mul_f32 v[182:183], v[182:183], v[14:15]
  v_cvt_pk_bf16_f32 v164, v180, v181
  v_cvt_pk_bf16_f32 v165, v182, v183
  v_pk_mul_f32 v[12:13], v[168:169], v[168:169]
  v_pk_mul_f32 v[14:15], v[170:171], v[170:171]
  v_pk_fma_f32 v[12:13], v[12:13], v[20:21], v[20:21] op_sel:[0,1,0] op_sel_hi:[1,1,0]
  v_pk_fma_f32 v[14:15], v[14:15], v[20:21], v[20:21] op_sel:[0,1,0] op_sel_hi:[1,1,0]
  v_pk_mul_f32 v[12:13], v[12:13], v[168:169]
  v_pk_mul_f32 v[14:15], v[14:15], v[170:171]
  v_exp_f32 v12, v12
  v_exp_f32 v13, v13
  v_exp_f32 v14, v14
  v_exp_f32 v15, v15
  v_pk_mul_f32 v[184:185], v[184:185], v[168:169]
  v_pk_mul_f32 v[186:187], v[186:187], v[170:171]
  v_pk_fma_f32 v[12:13], v[12:13], v[28:29], v[28:29] op_sel_hi:[1,0,0]
  v_pk_fma_f32 v[14:15], v[14:15], v[28:29], v[28:29] op_sel_hi:[1,0,0]
  v_rcp_f32 v12, v12
  v_rcp_f32 v13, v13
  v_rcp_f32 v14, v14
  v_rcp_f32 v15, v15
  s_nop 0
  v_pk_mul_f32 v[184:185], v[184:185], v[12:13]
  v_pk_mul_f32 v[186:187], v[186:187], v[14:15]
  v_cvt_pk_bf16_f32 v168, v184, v185
  v_cvt_pk_bf16_f32 v169, v186, v187
  v_pk_mul_f32 v[12:13], v[172:173], v[172:173]
  v_pk_mul_f32 v[14:15], v[174:175], v[174:175]
  v_pk_fma_f32 v[12:13], v[12:13], v[22:23], v[22:23] op_sel:[0,1,0] op_sel_hi:[1,1,0]
  v_pk_fma_f32 v[14:15], v[14:15], v[22:23], v[22:23] op_sel:[0,1,0] op_sel_hi:[1,1,0]
  v_pk_mul_f32 v[12:13], v[12:13], v[172:173]
  v_pk_mul_f32 v[14:15], v[14:15], v[174:175]
  v_exp_f32 v12, v12
  v_exp_f32 v13, v13
  v_exp_f32 v14, v14
  v_exp_f32 v15, v15
  v_pk_mul_f32 v[188:189], v[188:189], v[172:173]
  v_pk_mul_f32 v[190:191], v[190:191], v[174:175]
  v_pk_fma_f32 v[12:13], v[12:13], v[30:31], v[30:31] op_sel_hi:[1,0,0]
  v_pk_fma_f32 v[14:15], v[14:15], v[30:31], v[30:31] op_sel_hi:[1,0,0]
  v_rcp_f32 v12, v12
  v_rcp_f32 v13, v13
  v_rcp_f32 v14, v14
  v_rcp_f32 v15, v15
  s_nop 0
  v_pk_mul_f32 v[188:189], v[188:189], v[12:13]
  v_pk_mul_f32 v[190:191], v[190:191], v[14:15]
  v_cvt_pk_bf16_f32 v172, v188, v189
  v_cvt_pk_bf16_f32 v173, v190, v191
  v_pk_mul_f32 v[12:13], v[192:193], v[192:193]
  v_pk_mul_f32 v[14:15], v[194:195], v[194:195]
  v_pk_fma_f32 v[12:13], v[12:13], v[16:17], v[16:17] op_sel:[0,1,0] op_sel_hi:[1,1,0]
  v_pk_fma_f32 v[14:15], v[14:15], v[16:17], v[16:17] op_sel:[0,1,0] op_sel_hi:[1,1,0]
  v_pk_mul_f32 v[12:13], v[12:13], v[192:193]
  v_pk_mul_f32 v[14:15], v[14:15], v[194:195]
  v_exp_f32 v12, v12
  v_exp_f32 v13, v13
  v_exp_f32 v14, v14
  v_exp_f32 v15, v15
  v_pk_mul_f32 v[208:209], v[208:209], v[192:193]
  v_pk_mul_f32 v[210:211], v[210:211], v[194:195]
  v_pk_fma_f32 v[12:13], v[12:13], v[24:25], v[24:25] op_sel_hi:[1,0,0]
  v_pk_fma_f32 v[14:15], v[14:15], v[24:25], v[24:25] op_sel_hi:[1,0,0]
  v_rcp_f32 v12, v12
  v_rcp_f32 v13, v13
  v_rcp_f32 v14, v14
  v_rcp_f32 v15, v15
  s_nop 0
  v_pk_mul_f32 v[208:209], v[208:209], v[12:13]
  v_pk_mul_f32 v[210:211], v[210:211], v[14:15]
  v_cvt_pk_bf16_f32 v162, v208, v209
  v_cvt_pk_bf16_f32 v163, v210, v211
  buffer_store_dwordx4 v[160:163], v2, s[44:47], s48 offen offset:2048 sc1
  v_pk_mul_f32 v[12:13], v[196:197], v[196:197]
  v_pk_mul_f32 v[14:15], v[198:199], v[198:199]
  v_pk_fma_f32 v[12:13], v[12:13], v[18:19], v[18:19] op_sel:[0,1,0] op_sel_hi:[1,1,0]
  v_pk_fma_f32 v[14:15], v[14:15], v[18:19], v[18:19] op_sel:[0,1,0] op_sel_hi:[1,1,0]
  v_pk_mul_f32 v[12:13], v[12:13], v[196:197]
  v_pk_mul_f32 v[14:15], v[14:15], v[198:199]
  v_exp_f32 v12, v12
  v_exp_f32 v13, v13
  v_exp_f32 v14, v14
  v_exp_f32 v15, v15
  v_pk_mul_f32 v[212:213], v[212:213], v[196:197]
  v_pk_mul_f32 v[214:215], v[214:215], v[198:199]
  v_pk_fma_f32 v[12:13], v[12:13], v[26:27], v[26:27] op_sel_hi:[1,0,0]
  v_pk_fma_f32 v[14:15], v[14:15], v[26:27], v[26:27] op_sel_hi:[1,0,0]
  v_rcp_f32 v12, v12
  v_rcp_f32 v13, v13
  v_rcp_f32 v14, v14
  v_rcp_f32 v15, v15
  s_nop 0
  v_pk_mul_f32 v[212:213], v[212:213], v[12:13]
  v_pk_mul_f32 v[214:215], v[214:215], v[14:15]
  v_cvt_pk_bf16_f32 v166, v212, v213
  v_cvt_pk_bf16_f32 v167, v214, v215
  buffer_store_dwordx4 v[164:167], v2, s[44:47], s49 offen offset:2048 sc1
  v_pk_mul_f32 v[12:13], v[200:201], v[200:201]
  v_pk_mul_f32 v[14:15], v[202:203], v[202:203]
  v_pk_fma_f32 v[12:13], v[12:13], v[20:21], v[20:21] op_sel:[0,1,0] op_sel_hi:[1,1,0]
  v_pk_fma_f32 v[14:15], v[14:15], v[20:21], v[20:21] op_sel:[0,1,0] op_sel_hi:[1,1,0]
  v_pk_mul_f32 v[12:13], v[12:13], v[200:201]
  v_pk_mul_f32 v[14:15], v[14:15], v[202:203]
  v_exp_f32 v12, v12
  v_exp_f32 v13, v13
  v_exp_f32 v14, v14
  v_exp_f32 v15, v15
  v_pk_mul_f32 v[216:217], v[216:217], v[200:201]
  v_pk_mul_f32 v[218:219], v[218:219], v[202:203]
  v_pk_fma_f32 v[12:13], v[12:13], v[28:29], v[28:29] op_sel_hi:[1,0,0]
  v_pk_fma_f32 v[14:15], v[14:15], v[28:29], v[28:29] op_sel_hi:[1,0,0]
  v_rcp_f32 v12, v12
  v_rcp_f32 v13, v13
  v_rcp_f32 v14, v14
  v_rcp_f32 v15, v15
  s_nop 0
  v_pk_mul_f32 v[216:217], v[216:217], v[12:13]
  v_pk_mul_f32 v[218:219], v[218:219], v[14:15]
  v_cvt_pk_bf16_f32 v170, v216, v217
  v_cvt_pk_bf16_f32 v171, v218, v219
  buffer_store_dwordx4 v[168:171], v2, s[44:47], s50 offen offset:2048 sc1
  v_pk_mul_f32 v[12:13], v[204:205], v[204:205]
  v_pk_mul_f32 v[14:15], v[206:207], v[206:207]
  v_pk_fma_f32 v[12:13], v[12:13], v[22:23], v[22:23] op_sel:[0,1,0] op_sel_hi:[1,1,0]
  v_pk_fma_f32 v[14:15], v[14:15], v[22:23], v[22:23] op_sel:[0,1,0] op_sel_hi:[1,1,0]
  v_pk_mul_f32 v[12:13], v[12:13], v[204:205]
  v_pk_mul_f32 v[14:15], v[14:15], v[206:207]
  v_exp_f32 v12, v12
  v_exp_f32 v13, v13
  v_exp_f32 v14, v14
  v_exp_f32 v15, v15
  v_pk_mul_f32 v[220:221], v[220:221], v[204:205]
  v_pk_mul_f32 v[222:223], v[222:223], v[206:207]
  v_pk_fma_f32 v[12:13], v[12:13], v[30:31], v[30:31] op_sel_hi:[1,0,0]
  v_pk_fma_f32 v[14:15], v[14:15], v[30:31], v[30:31] op_sel_hi:[1,0,0]
  v_rcp_f32 v12, v12
  v_rcp_f32 v13, v13
  v_rcp_f32 v14, v14
  v_rcp_f32 v15, v15
  s_nop 0
  v_pk_mul_f32 v[220:221], v[220:221], v[12:13]
  v_pk_mul_f32 v[222:223], v[222:223], v[14:15]
  v_cvt_pk_bf16_f32 v174, v220, v221
  v_cvt_pk_bf16_f32 v175, v222, v223
  buffer_store_dwordx4 v[172:175], v2, s[44:47], s51 offen offset:2048 sc1
  v_pk_mul_f32 v[12:13], v[224:225], v[224:225]
  v_pk_mul_f32 v[14:15], v[226:227], v[226:227]
  v_pk_fma_f32 v[12:13], v[12:13], v[16:17], v[16:17] op_sel:[0,1,0] op_sel_hi:[1,1,0]
  v_pk_fma_f32 v[14:15], v[14:15], v[16:17], v[16:17] op_sel:[0,1,0] op_sel_hi:[1,1,0]
  v_pk_mul_f32 v[12:13], v[12:13], v[224:225]
  v_pk_mul_f32 v[14:15], v[14:15], v[226:227]
  v_exp_f32 v12, v12
  v_exp_f32 v13, v13
  v_exp_f32 v14, v14
  v_exp_f32 v15, v15
  v_pk_mul_f32 v[240:241], v[240:241], v[224:225]
  v_pk_mul_f32 v[242:243], v[242:243], v[226:227]
  v_pk_fma_f32 v[12:13], v[12:13], v[24:25], v[24:25] op_sel_hi:[1,0,0]
  v_pk_fma_f32 v[14:15], v[14:15], v[24:25], v[24:25] op_sel_hi:[1,0,0]
  v_rcp_f32 v12, v12
  v_rcp_f32 v13, v13
  v_rcp_f32 v14, v14
  v_rcp_f32 v15, v15
  s_nop 0
  v_pk_mul_f32 v[240:241], v[240:241], v[12:13]
  v_pk_mul_f32 v[242:243], v[242:243], v[14:15]
  v_cvt_pk_bf16_f32 v224, v240, v241
  v_cvt_pk_bf16_f32 v225, v242, v243
  v_pk_mul_f32 v[12:13], v[228:229], v[228:229]
  v_pk_mul_f32 v[14:15], v[230:231], v[230:231]
  v_pk_fma_f32 v[12:13], v[12:13], v[18:19], v[18:19] op_sel:[0,1,0] op_sel_hi:[1,1,0]
  v_pk_fma_f32 v[14:15], v[14:15], v[18:19], v[18:19] op_sel:[0,1,0] op_sel_hi:[1,1,0]
  v_pk_mul_f32 v[12:13], v[12:13], v[228:229]
  v_pk_mul_f32 v[14:15], v[14:15], v[230:231]
  v_exp_f32 v12, v12
  v_exp_f32 v13, v13
  v_exp_f32 v14, v14
  v_exp_f32 v15, v15
  v_pk_mul_f32 v[244:245], v[244:245], v[228:229]
  v_pk_mul_f32 v[246:247], v[246:247], v[230:231]
  v_pk_fma_f32 v[12:13], v[12:13], v[26:27], v[26:27] op_sel_hi:[1,0,0]
  v_pk_fma_f32 v[14:15], v[14:15], v[26:27], v[26:27] op_sel_hi:[1,0,0]
  v_rcp_f32 v12, v12
  v_rcp_f32 v13, v13
  v_rcp_f32 v14, v14
  v_rcp_f32 v15, v15
  s_nop 0
  v_pk_mul_f32 v[244:245], v[244:245], v[12:13]
  v_pk_mul_f32 v[246:247], v[246:247], v[14:15]
  v_cvt_pk_bf16_f32 v226, v244, v245
  v_cvt_pk_bf16_f32 v227, v246, v247
  s_nop 1
  v_permlane16_swap_b32 v224, v226
  v_permlane16_swap_b32 v225, v227
  s_nop 1
  buffer_store_dwordx4 v[224:227], v6, s[44:47], s52 offen sc1
  v_pk_mul_f32 v[12:13], v[232:233], v[232:233]
  v_pk_mul_f32 v[14:15], v[234:235], v[234:235]
  v_pk_fma_f32 v[12:13], v[12:13], v[20:21], v[20:21] op_sel:[0,1,0] op_sel_hi:[1,1,0]
  v_pk_fma_f32 v[14:15], v[14:15], v[20:21], v[20:21] op_sel:[0,1,0] op_sel_hi:[1,1,0]
  v_pk_mul_f32 v[12:13], v[12:13], v[232:233]
  v_pk_mul_f32 v[14:15], v[14:15], v[234:235]
  v_exp_f32 v12, v12
  v_exp_f32 v13, v13
  v_exp_f32 v14, v14
  v_exp_f32 v15, v15
  v_pk_mul_f32 v[248:249], v[248:249], v[232:233]
  v_pk_mul_f32 v[250:251], v[250:251], v[234:235]
  v_pk_fma_f32 v[12:13], v[12:13], v[28:29], v[28:29] op_sel_hi:[1,0,0]
  v_pk_fma_f32 v[14:15], v[14:15], v[28:29], v[28:29] op_sel_hi:[1,0,0]
  v_rcp_f32 v12, v12
  v_rcp_f32 v13, v13
  v_rcp_f32 v14, v14
  v_rcp_f32 v15, v15
  s_nop 0
  v_pk_mul_f32 v[248:249], v[248:249], v[12:13]
  v_pk_mul_f32 v[250:251], v[250:251], v[14:15]
  v_cvt_pk_bf16_f32 v232, v248, v249
  v_cvt_pk_bf16_f32 v233, v250, v251
  v_pk_mul_f32 v[12:13], v[236:237], v[236:237]
  v_pk_mul_f32 v[14:15], v[238:239], v[238:239]
  v_pk_fma_f32 v[12:13], v[12:13], v[22:23], v[22:23] op_sel:[0,1,0] op_sel_hi:[1,1,0]
  v_pk_fma_f32 v[14:15], v[14:15], v[22:23], v[22:23] op_sel:[0,1,0] op_sel_hi:[1,1,0]
  v_pk_mul_f32 v[12:13], v[12:13], v[236:237]
  v_pk_mul_f32 v[14:15], v[14:15], v[238:239]
  v_exp_f32 v12, v12
  v_exp_f32 v13, v13
  v_exp_f32 v14, v14
  v_exp_f32 v15, v15
  v_pk_mul_f32 v[252:253], v[252:253], v[236:237]
  v_pk_mul_f32 v[254:255], v[254:255], v[238:239]
  v_pk_fma_f32 v[12:13], v[12:13], v[30:31], v[30:31] op_sel_hi:[1,0,0]
  v_pk_fma_f32 v[14:15], v[14:15], v[30:31], v[30:31] op_sel_hi:[1,0,0]
  v_rcp_f32 v12, v12
  v_rcp_f32 v13, v13
  v_rcp_f32 v14, v14
  v_rcp_f32 v15, v15
  s_nop 0
  v_pk_mul_f32 v[252:253], v[252:253], v[12:13]
  v_pk_mul_f32 v[254:255], v[254:255], v[14:15]
  v_cvt_pk_bf16_f32 v234, v252, v253
  v_cvt_pk_bf16_f32 v235, v254, v255
  s_nop 1
  v_permlane16_swap_b32 v232, v234
  v_permlane16_swap_b32 v233, v235
  s_nop 1
  buffer_store_dwordx4 v[232:235], v6, s[44:47], s53 offen sc1
  v_add_u32 v8, 0, v2
  v_add_u32 v9, 114688, v2
  s_mov_b32 s30, 0x400000
  s_mov_b32 s31, 0x20000
  s_add_u32 s32, s4, 0x28000
  s_addc_u32 s33, s5, 0
  s_mov_b32 s34, 0x10000
  s_mov_b32 s35, 0x20000
  s_add_u32 s40, s4, 0x1900000
  s_addc_u32 s41, s5, 0
  s_mov_b32 s42, 0x400000
  s_mov_b32 s43, 0x20000
  s_add_u32 s44, s4, 0x4800000
  s_addc_u32 s45, s5, 0
  s_mov_b32 s46, 0x800000
  s_mov_b32 s47, 0x20000
  s_add_u32 s48, s4, 0x5000000
  s_addc_u32 s49, s5, 0
  s_mov_b32 s50, 0x20000
  s_mov_b32 s51, 0x20000
  v_lshrrev_b32 v21, 4, v0
  v_lshlrev_b32 v23, 4, v21
  s_lshl_b32 s61, s22, 1
  s_add_u32 s61, s61, s58
  s_lshl_b32 s36, s27, 16
  s_lshl_b32 s25, s61, 11
  s_add_u32 s36, s36, s25
  s_add_u32 s37, s36, 32768
  s_lshl_b32 s25, s61, 8
  s_add_u32 s38, s25, 12288
  s_lshl_b32 s25, s20, 8
  s_add_u32 s25, s25, 65536
  v_add_u32 v23, s25, v23
  v_lshlrev_b32 v28, 2, v0
  v_add_u32 v29, s25, v28
  s_lshl_b32 s25, s2, 2
  s_add_u32 s25, s25, s20
  s_lshl_b32 s52, s25, 13
  s_add_u32 s53, s52, 4096
  s_xor_b32 s54, s52, 32768
  s_add_u32 s55, s54, 4096
  s_lshl_b32 s56, s25, 7
  s_xor_b32 s57, s56, 512
  v_and_b32 v20, 15, v0
  v_lshlrev_b32 v22, 11, v20
  v_and_b32 v24, 1, v21
  v_lshl_add_u32 v22, v24, 5, v22
  v_lshrrev_b32 v24, 1, v21
  v_lshl_add_u32 v22, v24, 4, v22
  s_lshl_b32 s62, s27, 16
  s_lshl_b32 s25, s61, 7
  s_add_u32 s62, s62, s25
  s_add_u32 s63, s62, 32768
  v_mov_b32 v25, 0
  v_mov_b32 v26, 1
  s_add_u32 s72, s4, 0xe0000
  s_addc_u32 s73, s5, 0
  s_mov_b32 s74, 0x20000
  s_mov_b32 s75, 0x20000
  v_and_b32 v14, 15, v0
  v_lshrrev_b32 v15, 3, v14
  v_and_b32 v14, 7, v14
  v_lshlrev_b32 v14, 5, v14
  v_lshl_add_u32 v14, v15, 1, v14
  s_lshr_b32 s76, s21, 1
  s_lshr_b32 s77, s76, 2
  s_and_b32 s76, s76, 3
  s_lshl_b32 s76, s76, 3
  s_add_u32 s76, s76, s77
  s_lshl_b32 s77, s58, 2
  s_add_u32 s76, s76, s77
  s_lshl_b32 s76, s76, 2
  s_and_b32 s77, s21, 1
  s_lshl_b32 s77, s77, 1
  s_add_u32 s76, s76, s77
  s_lshr_b32 s77, s20, 1
  s_add_u32 s76, s76, s77
  v_lshl_add_u32 v14, v14, 2, s76
  v_lshlrev_b32 v14, 7, v14
  s_lshl_b32 s76, s2, 2
  s_add_u32 s76, s76, s20
  s_lshl_b32 s76, s76, 7
  v_mov_b32 v13, 0
  v_mov_b32 v15, 1
  s_mov_b32 s77, 0x100000
  s_waitcnt vmcnt(0)
  buffer_store_dword v15, v13, s[72:75], s76 offen sc1
  s_add_u32 m0, s18, 0
  s_nop 0
  buffer_load_dwordx4 v4, s[8:11], s16 offen offset:0  lds
  buffer_load_dwordx4 v4, s[8:11], s16 offen offset:1024  lds
  buffer_load_dwordx4 v4, s[8:11], s16 offen offset:2048  lds
  buffer_load_dwordx4 v4, s[8:11], s16 offen offset:3072  lds
  s_add_u32 s16, s16, 16384
  s_add_u32 m0, s18, 16384
  s_nop 0
  buffer_load_dwordx4 v4, s[8:11], s16 offen offset:0  lds
  buffer_load_dwordx4 v4, s[8:11], s16 offen offset:1024  lds
  buffer_load_dwordx4 v4, s[8:11], s16 offen offset:2048  lds
  buffer_load_dwordx4 v4, s[8:11], s16 offen offset:3072  lds
  s_add_u32 s16, s16, 16384
  s_add_u32 m0, s18, 32768
  s_nop 0
  buffer_load_dwordx4 v4, s[8:11], s16 offen offset:0  lds
  buffer_load_dwordx4 v4, s[8:11], s16 offen offset:1024  lds
  buffer_load_dwordx4 v4, s[8:11], s16 offen offset:2048  lds
  buffer_load_dwordx4 v4, s[8:11], s16 offen offset:3072  lds
  s_add_u32 s16, s16, 16384
L_poll_39:
  buffer_load_dword v13, v14, s[72:75], 0 offen sc1
  s_waitcnt vmcnt(0)
  v_cmp_ne_u32 vcc, 1, v13
  s_nop 1
  s_sub_u32 s77, s77, 1
  s_cselect_b64 s[78:79], 0, vcc
  s_cmp_lg_u64 s[78:79], 0
  s_cbranch_scc1 L_poll_39
  buffer_load_dwordx4 a[0:3], v8, s[12:15], s17 offen offset:0 sc1
  buffer_load_dwordx4 a[4:7], v9, s[12:15], s17 offen offset:0 sc1
  buffer_load_dwordx4 a[8:11], v8, s[12:15], s17 offen offset:1024 sc1
  buffer_load_dwordx4 a[12:15], v9, s[12:15], s17 offen offset:1024 sc1
  s_add_u32 s17, s17, 2048
  buffer_load_dwordx4 a[16:19], v8, s[12:15], s17 offen offset:0 sc1
  buffer_load_dwordx4 a[20:23], v9, s[12:15], s17 offen offset:0 sc1
  buffer_load_dwordx4 a[24:27], v8, s[12:15], s17 offen offset:1024 sc1
  buffer_load_dwordx4 a[28:31], v9, s[12:15], s17 offen offset:1024 sc1
  s_add_u32 s17, s17, 2048
  s_waitcnt vmcnt(4) lgkmcnt(0)
  s_barrier
  ds_read_b128 a[64:67], v2 offset:0
  ds_read_b128 a[68:71], v2 offset:1024
  buffer_load_dwordx4 a[32:35], v8, s[12:15], s17 offen offset:0 sc1
  ds_read_b128 a[72:75], v2 offset:2048
  buffer_load_dwordx4 a[36:39], v9, s[12:15], s17 offen offset:0 sc1
  ds_read_b128 a[76:79], v2 offset:3072
  buffer_load_dwordx4 a[40:43], v8, s[12:15], s17 offen offset:1024 sc1
  ds_read_b128 a[80:83], v2 offset:4096
  s_waitcnt lgkmcnt(3)
  v_mfma_f32_16x16x32_bf16 v[32:35], a[64:67], a[0:3], 0
  buffer_load_dwordx4 a[44:47], v9, s[12:15], s17 offen offset:1024 sc1
  s_add_u32 s17, s17, 2048
  v_mfma_f32_16x16x32_bf16 v[36:39], a[64:67], a[4:7], 0
  ds_read_b128 a[84:87], v2 offset:5120
  v_mfma_f32_16x16x32_bf16 v[40:43], a[68:71], a[0:3], 0
  ds_read_b128 a[88:91], v2 offset:6144
  v_mfma_f32_16x16x32_bf16 v[44:47], a[68:71], a[4:7], 0
  s_add_u32 m0, s18, 49152
  s_waitcnt lgkmcnt(2)
  v_mfma_f32_16x16x32_bf16 v[48:51], a[72:75], a[0:3], 0
  ds_read_b128 a[92:95], v2 offset:7168
  buffer_load_dwordx4 v4, s[8:11], s16 offen offset:0  lds
  v_mfma_f32_16x16x32_bf16 v[52:55], a[72:75], a[4:7], 0
  v_mfma_f32_16x16x32_bf16 v[56:59], a[76:79], a[0:3], 0
  ds_read_b128 a[64:67], v2 offset:8192
  buffer_load_dwordx4 v4, s[8:11], s16 offen offset:1024  lds
  v_mfma_f32_16x16x32_bf16 v[60:63], a[76:79], a[4:7], 0
  ds_read_b128 a[68:71], v2 offset:9216
  v_mfma_f32_16x16x32_bf16 v[64:67], a[80:83], a[0:3], 0
  v_mfma_f32_16x16x32_bf16 v[68:71], a[80:83], a[4:7], 0
  ds_read_b128 a[72:75], v2 offset:10240
  buffer_load_dwordx4 v4, s[8:11], s16 offen offset:2048  lds
  s_waitcnt lgkmcnt(3)
  v_mfma_f32_16x16x32_bf16 v[72:75], a[84:87], a[0:3], 0
  ds_read_b128 a[76:79], v2 offset:11264
  v_mfma_f32_16x16x32_bf16 v[76:79], a[84:87], a[4:7], 0
  buffer_load_dwordx4 v4, s[8:11], s16 offen offset:3072  lds
  s_add_u32 s16, s16, 16384
  v_mfma_f32_16x16x32_bf16 v[80:83], a[88:91], a[0:3], 0
  ds_read_b128 a[80:83], v2 offset:12288
  v_mfma_f32_16x16x32_bf16 v[84:87], a[88:91], a[4:7], 0
  v_mfma_f32_16x16x32_bf16 v[88:91], a[92:95], a[0:3], 0
  ds_read_b128 a[84:87], v2 offset:13312
  buffer_load_dwordx4 a[48:51], v8, s[12:15], s17 offen offset:0 sc1
  v_mfma_f32_16x16x32_bf16 v[92:95], a[92:95], a[4:7], 0
  ds_read_b128 a[88:91], v2 offset:14336
  s_waitcnt lgkmcnt(3)
  v_mfma_f32_16x16x32_bf16 v[32:35], a[64:67], a[8:11], v[32:35]
  buffer_load_dwordx4 a[52:55], v9, s[12:15], s17 offen offset:0 sc1
  v_mfma_f32_16x16x32_bf16 v[36:39], a[64:67], a[12:15], v[36:39]
  ds_read_b128 a[92:95], v2 offset:15360
  v_mfma_f32_16x16x32_bf16 v[40:43], a[68:71], a[8:11], v[40:43]
  v_mfma_f32_16x16x32_bf16 v[44:47], a[68:71], a[12:15], v[44:47]
  buffer_load_dwordx4 a[56:59], v8, s[12:15], s17 offen offset:1024 sc1
  v_mfma_f32_16x16x32_bf16 v[48:51], a[72:75], a[8:11], v[48:51]
  v_mfma_f32_16x16x32_bf16 v[52:55], a[72:75], a[12:15], v[52:55]
  buffer_load_dwordx4 a[60:63], v9, s[12:15], s17 offen offset:1024 sc1
  s_add_u32 s17, s17, 2048
  v_mfma_f32_16x16x32_bf16 v[56:59], a[76:79], a[8:11], v[56:59]
  v_mfma_f32_16x16x32_bf16 v[60:63], a[76:79], a[12:15], v[60:63]
  s_waitcnt lgkmcnt(0)
  v_mfma_f32_16x16x32_bf16 v[64:67], a[80:83], a[8:11], v[64:67]
  s_waitcnt vmcnt(12) lgkmcnt(0)
  s_barrier
  v_mfma_f32_16x16x32_bf16 v[68:71], a[80:83], a[12:15], v[68:71]
  ds_read_b128 a[64:67], v2 offset:16384
  s_add_u32 m0, s18, 0
  v_mfma_f32_16x16x32_bf16 v[72:75], a[84:87], a[8:11], v[72:75]
  ds_read_b128 a[68:71], v2 offset:17408
  buffer_load_dwordx4 v4, s[8:11], s16 offen offset:0  lds
  v_mfma_f32_16x16x32_bf16 v[76:79], a[84:87], a[12:15], v[76:79]
  v_mfma_f32_16x16x32_bf16 v[80:83], a[88:91], a[8:11], v[80:83]
  ds_read_b128 a[72:75], v2 offset:18432
  buffer_load_dwordx4 v4, s[8:11], s16 offen offset:1024  lds
  v_mfma_f32_16x16x32_bf16 v[84:87], a[88:91], a[12:15], v[84:87]
  ds_read_b128 a[76:79], v2 offset:19456
  v_mfma_f32_16x16x32_bf16 v[88:91], a[92:95], a[8:11], v[88:91]
  v_mfma_f32_16x16x32_bf16 v[92:95], a[92:95], a[12:15], v[92:95]
  ds_read_b128 a[80:83], v2 offset:20480
  buffer_load_dwordx4 v4, s[8:11], s16 offen offset:2048  lds
  s_waitcnt lgkmcnt(3)
  v_mfma_f32_16x16x32_bf16 v[32:35], a[64:67], a[16:19], v[32:35]
  v_mfma_f32_16x16x32_bf16 v[36:39], a[64:67], a[20:23], v[36:39]
  ds_read_b128 a[84:87], v2 offset:21504
  buffer_load_dwordx4 v4, s[8:11], s16 offen offset:3072  lds
  s_add_u32 s16, s16, 16384
  v_mfma_f32_16x16x32_bf16 v[40:43], a[68:71], a[16:19], v[40:43]
  ds_read_b128 a[88:91], v2 offset:22528
  v_mfma_f32_16x16x32_bf16 v[44:47], a[68:71], a[20:23], v[44:47]
  s_waitcnt lgkmcnt(2)
  v_mfma_f32_16x16x32_bf16 v[48:51], a[72:75], a[16:19], v[48:51]
  ds_read_b128 a[92:95], v2 offset:23552
  buffer_load_dwordx4 a[0:3], v8, s[12:15], s17 offen offset:0 sc1
  v_mfma_f32_16x16x32_bf16 v[52:55], a[72:75], a[20:23], v[52:55]
  v_mfma_f32_16x16x32_bf16 v[56:59], a[76:79], a[16:19], v[56:59]
  ds_read_b128 a[64:67], v2 offset:24576
  buffer_load_dwordx4 a[4:7], v9, s[12:15], s17 offen offset:0 sc1
  v_mfma_f32_16x16x32_bf16 v[60:63], a[76:79], a[20:23], v[60:63]
  ds_read_b128 a[68:71], v2 offset:25600
  v_mfma_f32_16x16x32_bf16 v[64:67], a[80:83], a[16:19], v[64:67]
  v_mfma_f32_16x16x32_bf16 v[68:71], a[80:83], a[20:23], v[68:71]
  ds_read_b128 a[72:75], v2 offset:26624
  buffer_load_dwordx4 a[8:11], v8, s[12:15], s17 offen offset:1024 sc1
  s_waitcnt lgkmcnt(3)
  v_mfma_f32_16x16x32_bf16 v[72:75], a[84:87], a[16:19], v[72:75]
  ds_read_b128 a[76:79], v2 offset:27648
  v_mfma_f32_16x16x32_bf16 v[76:79], a[84:87], a[20:23], v[76:79]
  buffer_load_dwordx4 a[12:15], v9, s[12:15], s17 offen offset:1024 sc1
  s_add_u32 s17, s17, 2048
  v_mfma_f32_16x16x32_bf16 v[80:83], a[88:91], a[16:19], v[80:83]
  ds_read_b128 a[80:83], v2 offset:28672
  v_mfma_f32_16x16x32_bf16 v[84:87], a[88:91], a[20:23], v[84:87]
  v_mfma_f32_16x16x32_bf16 v[88:91], a[92:95], a[16:19], v[88:91]
  ds_read_b128 a[84:87], v2 offset:29696
  buffer_load_dword v16, v28, s[32:35], s38 offen sc1
  v_mfma_f32_16x16x32_bf16 v[92:95], a[92:95], a[20:23], v[92:95]
  ds_read_b128 a[88:91], v2 offset:30720
  s_add_u32 s38, s38, 16384
  s_waitcnt lgkmcnt(3)
  v_mfma_f32_16x16x32_bf16 v[32:35], a[64:67], a[24:27], v[32:35]
  buffer_load_dword v17, v28, s[32:35], s38 offen sc1
  v_mfma_f32_16x16x32_bf16 v[36:39], a[64:67], a[28:31], v[36:39]
  ds_read_b128 a[92:95], v2 offset:31744
  v_mfma_f32_16x16x32_bf16 v[40:43], a[68:71], a[24:27], v[40:43]
  s_add_u32 s38, s38, 16384
  v_mfma_f32_16x16x32_bf16 v[44:47], a[68:71], a[28:31], v[44:47]
  buffer_load_dword v18, v28, s[32:35], s38 offen sc1
  v_mfma_f32_16x16x32_bf16 v[48:51], a[72:75], a[24:27], v[48:51]
  s_add_u32 s38, s38, 16384
  v_mfma_f32_16x16x32_bf16 v[52:55], a[72:75], a[28:31], v[52:55]
  buffer_load_dword v19, v28, s[32:35], s38 offen sc1
  v_mfma_f32_16x16x32_bf16 v[56:59], a[76:79], a[24:27], v[56:59]
  v_mfma_f32_16x16x32_bf16 v[60:63], a[76:79], a[28:31], v[60:63]
  s_waitcnt lgkmcnt(0)
  v_mfma_f32_16x16x32_bf16 v[64:67], a[80:83], a[24:27], v[64:67]
  s_waitcnt vmcnt(20) lgkmcnt(0)
  s_barrier
  v_mfma_f32_16x16x32_bf16 v[68:71], a[80:83], a[28:31], v[68:71]
  ds_read_b128 a[64:67], v2 offset:32768
  s_add_u32 m0, s18, 16384
  v_mfma_f32_16x16x32_bf16 v[72:75], a[84:87], a[24:27], v[72:75]
  ds_read_b128 a[68:71], v2 offset:33792
  buffer_load_dwordx4 v4, s[8:11], s16 offen offset:0  lds
  v_mfma_f32_16x16x32_bf16 v[76:79], a[84:87], a[28:31], v[76:79]
  v_mfma_f32_16x16x32_bf16 v[80:83], a[88:91], a[24:27], v[80:83]
  ds_read_b128 a[72:75], v2 offset:34816
  v_mfma_f32_16x16x32_bf16 v[84:87], a[88:91], a[28:31], v[84:87]
  ds_read_b128 a[76:79], v2 offset:35840
  v_mfma_f32_16x16x32_bf16 v[88:91], a[92:95], a[24:27], v[88:91]
  buffer_load_dwordx4 v4, s[8:11], s16 offen offset:1024  lds
  v_mfma_f32_16x16x32_bf16 v[92:95], a[92:95], a[28:31], v[92:95]
  ds_read_b128 a[80:83], v2 offset:36864
  s_waitcnt lgkmcnt(3)
  v_mfma_f32_16x16x32_bf16 v[32:35], a[64:67], a[32:35], v[32:35]
  v_mfma_f32_16x16x32_bf16 v[36:39], a[64:67], a[36:39], v[36:39]
  ds_read_b128 a[84:87], v2 offset:37888
  v_mfma_f32_16x16x32_bf16 v[40:43], a[68:71], a[32:35], v[40:43]
  ds_read_b128 a[88:91], v2 offset:38912
  buffer_load_dwordx4 v4, s[8:11], s16 offen offset:2048  lds
  v_mfma_f32_16x16x32_bf16 v[44:47], a[68:71], a[36:39], v[44:47]
  s_waitcnt lgkmcnt(2)
  v_mfma_f32_16x16x32_bf16 v[48:51], a[72:75], a[32:35], v[48:51]
  ds_read_b128 a[92:95], v2 offset:39936
  v_mfma_f32_16x16x32_bf16 v[52:55], a[72:75], a[36:39], v[52:55]
  v_mfma_f32_16x16x32_bf16 v[56:59], a[76:79], a[32:35], v[56:59]
  ds_read_b128 a[64:67], v2 offset:40960
  buffer_load_dwordx4 v4, s[8:11], s16 offen offset:3072  lds
  s_add_u32 s16, s16, 16384
  v_mfma_f32_16x16x32_bf16 v[60:63], a[76:79], a[36:39], v[60:63]
  ds_read_b128 a[68:71], v2 offset:41984
  v_mfma_f32_16x16x32_bf16 v[64:67], a[80:83], a[32:35], v[64:67]
  v_mfma_f32_16x16x32_bf16 v[68:71], a[80:83], a[36:39], v[68:71]
  ds_read_b128 a[72:75], v2 offset:43008
  buffer_load_dwordx4 a[16:19], v8, s[12:15], s17 offen offset:0 sc1
  s_waitcnt lgkmcnt(3)
  v_mfma_f32_16x16x32_bf16 v[72:75], a[84:87], a[32:35], v[72:75]
  ds_read_b128 a[76:79], v2 offset:44032
  v_mfma_f32_16x16x32_bf16 v[76:79], a[84:87], a[36:39], v[76:79]
  v_mfma_f32_16x16x32_bf16 v[80:83], a[88:91], a[32:35], v[80:83]
  ds_read_b128 a[80:83], v2 offset:45056
  v_mfma_f32_16x16x32_bf16 v[84:87], a[88:91], a[36:39], v[84:87]
  buffer_load_dwordx4 a[20:23], v9, s[12:15], s17 offen offset:0 sc1
  v_mfma_f32_16x16x32_bf16 v[88:91], a[92:95], a[32:35], v[88:91]
  ds_read_b128 a[84:87], v2 offset:46080
  v_mfma_f32_16x16x32_bf16 v[92:95], a[92:95], a[36:39], v[92:95]
  ds_read_b128 a[88:91], v2 offset:47104
  s_waitcnt lgkmcnt(3)
  v_mfma_f32_16x16x32_bf16 v[32:35], a[64:67], a[40:43], v[32:35]
  v_mfma_f32_16x16x32_bf16 v[36:39], a[64:67], a[44:47], v[36:39]
  ds_read_b128 a[92:95], v2 offset:48128
  buffer_load_dwordx4 a[24:27], v8, s[12:15], s17 offen offset:1024 sc1
  v_mfma_f32_16x16x32_bf16 v[40:43], a[68:71], a[40:43], v[40:43]
  v_mfma_f32_16x16x32_bf16 v[44:47], a[68:71], a[44:47], v[44:47]
  v_mfma_f32_16x16x32_bf16 v[48:51], a[72:75], a[40:43], v[48:51]
  v_mfma_f32_16x16x32_bf16 v[52:55], a[72:75], a[44:47], v[52:55]
  buffer_load_dwordx4 a[28:31], v9, s[12:15], s17 offen offset:1024 sc1
  s_add_u32 s17, s17, 2048
  v_mfma_f32_16x16x32_bf16 v[56:59], a[76:79], a[40:43], v[56:59]
  v_mfma_f32_16x16x32_bf16 v[60:63], a[76:79], a[44:47], v[60:63]
  s_waitcnt lgkmcnt(0)
  v_mfma_f32_16x16x32_bf16 v[64:67], a[80:83], a[40:43], v[64:67]
  s_waitcnt vmcnt(20) lgkmcnt(0)
  s_barrier
  v_mfma_f32_16x16x32_bf16 v[68:71], a[80:83], a[44:47], v[68:71]
  ds_read_b128 a[64:67], v2 offset:49152
  s_add_u32 m0, s18, 32768
  v_mfma_f32_16x16x32_bf16 v[72:75], a[84:87], a[40:43], v[72:75]
  ds_read_b128 a[68:71], v2 offset:50176
  buffer_load_dwordx4 v4, s[8:11], s16 offen offset:0  lds
  v_mfma_f32_16x16x32_bf16 v[76:79], a[84:87], a[44:47], v[76:79]
  v_mfma_f32_16x16x32_bf16 v[80:83], a[88:91], a[40:43], v[80:83]
  ds_read_b128 a[72:75], v2 offset:51200
  v_mfma_f32_16x16x32_bf16 v[84:87], a[88:91], a[44:47], v[84:87]
  ds_read_b128 a[76:79], v2 offset:52224
  v_mfma_f32_16x16x32_bf16 v[88:91], a[92:95], a[40:43], v[88:91]
  buffer_load_dwordx4 v4, s[8:11], s16 offen offset:1024  lds
  v_mfma_f32_16x16x32_bf16 v[92:95], a[92:95], a[44:47], v[92:95]
  ds_read_b128 a[80:83], v2 offset:53248
  s_waitcnt lgkmcnt(3)
  v_mfma_f32_16x16x32_bf16 v[32:35], a[64:67], a[48:51], v[32:35]
  v_mfma_f32_16x16x32_bf16 v[36:39], a[64:67], a[52:55], v[36:39]
  ds_read_b128 a[84:87], v2 offset:54272
  v_mfma_f32_16x16x32_bf16 v[40:43], a[68:71], a[48:51], v[40:43]
  ds_read_b128 a[88:91], v2 offset:55296
  buffer_load_dwordx4 v4, s[8:11], s16 offen offset:2048  lds
  v_mfma_f32_16x16x32_bf16 v[44:47], a[68:71], a[52:55], v[44:47]
  s_waitcnt lgkmcnt(2)
  v_mfma_f32_16x16x32_bf16 v[48:51], a[72:75], a[48:51], v[48:51]
  ds_read_b128 a[92:95], v2 offset:56320
  v_mfma_f32_16x16x32_bf16 v[52:55], a[72:75], a[52:55], v[52:55]
  v_mfma_f32_16x16x32_bf16 v[56:59], a[76:79], a[48:51], v[56:59]
  ds_read_b128 a[64:67], v2 offset:57344
  buffer_load_dwordx4 v4, s[8:11], s16 offen offset:3072  lds
  s_add_u32 s16, s16, 16384
  v_mfma_f32_16x16x32_bf16 v[60:63], a[76:79], a[52:55], v[60:63]
  ds_read_b128 a[68:71], v2 offset:58368
  v_mfma_f32_16x16x32_bf16 v[64:67], a[80:83], a[48:51], v[64:67]
  v_mfma_f32_16x16x32_bf16 v[68:71], a[80:83], a[52:55], v[68:71]
  ds_read_b128 a[72:75], v2 offset:59392
  buffer_load_dwordx4 a[32:35], v8, s[12:15], s17 offen offset:0 sc1
  s_waitcnt lgkmcnt(3)
  v_mfma_f32_16x16x32_bf16 v[72:75], a[84:87], a[48:51], v[72:75]
  ds_read_b128 a[76:79], v2 offset:60416
  v_mfma_f32_16x16x32_bf16 v[76:79], a[84:87], a[52:55], v[76:79]
  v_mfma_f32_16x16x32_bf16 v[80:83], a[88:91], a[48:51], v[80:83]
  ds_read_b128 a[80:83], v2 offset:61440
  v_mfma_f32_16x16x32_bf16 v[84:87], a[88:91], a[52:55], v[84:87]
  buffer_load_dwordx4 a[36:39], v9, s[12:15], s17 offen offset:0 sc1
  v_mfma_f32_16x16x32_bf16 v[88:91], a[92:95], a[48:51], v[88:91]
  ds_read_b128 a[84:87], v2 offset:62464
  v_mfma_f32_16x16x32_bf16 v[92:95], a[92:95], a[52:55], v[92:95]
  ds_read_b128 a[88:91], v2 offset:63488
  s_waitcnt lgkmcnt(3)
  v_mfma_f32_16x16x32_bf16 v[32:35], a[64:67], a[56:59], v[32:35]
  v_mfma_f32_16x16x32_bf16 v[36:39], a[64:67], a[60:63], v[36:39]
  ds_read_b128 a[92:95], v2 offset:64512
  buffer_load_dwordx4 a[40:43], v8, s[12:15], s17 offen offset:1024 sc1
  v_mfma_f32_16x16x32_bf16 v[40:43], a[68:71], a[56:59], v[40:43]
  v_mfma_f32_16x16x32_bf16 v[44:47], a[68:71], a[60:63], v[44:47]
  v_mfma_f32_16x16x32_bf16 v[48:51], a[72:75], a[56:59], v[48:51]
  v_mfma_f32_16x16x32_bf16 v[52:55], a[72:75], a[60:63], v[52:55]
  buffer_load_dwordx4 a[44:47], v9, s[12:15], s17 offen offset:1024 sc1
  s_add_u32 s17, s17, 2048
  v_mfma_f32_16x16x32_bf16 v[56:59], a[76:79], a[56:59], v[56:59]
  v_mfma_f32_16x16x32_bf16 v[60:63], a[76:79], a[60:63], v[60:63]
  s_waitcnt lgkmcnt(0)
  v_mfma_f32_16x16x32_bf16 v[64:67], a[80:83], a[56:59], v[64:67]
  s_waitcnt vmcnt(20) lgkmcnt(0)
  s_barrier
  v_mfma_f32_16x16x32_bf16 v[68:71], a[80:83], a[60:63], v[68:71]
  ds_read_b128 a[64:67], v2 offset:0
  s_add_u32 m0, s18, 49152
  v_mfma_f32_16x16x32_bf16 v[72:75], a[84:87], a[56:59], v[72:75]
  ds_read_b128 a[68:71], v2 offset:1024
  buffer_load_dwordx4 v4, s[8:11], s16 offen offset:0  lds
  v_mfma_f32_16x16x32_bf16 v[76:79], a[84:87], a[60:63], v[76:79]
  v_mfma_f32_16x16x32_bf16 v[80:83], a[88:91], a[56:59], v[80:83]
  ds_read_b128 a[72:75], v2 offset:2048
  v_mfma_f32_16x16x32_bf16 v[84:87], a[88:91], a[60:63], v[84:87]
  ds_read_b128 a[76:79], v2 offset:3072
  v_mfma_f32_16x16x32_bf16 v[88:91], a[92:95], a[56:59], v[88:91]
  buffer_load_dwordx4 v4, s[8:11], s16 offen offset:1024  lds
  v_mfma_f32_16x16x32_bf16 v[92:95], a[92:95], a[60:63], v[92:95]
  ds_read_b128 a[80:83], v2 offset:4096
  s_mov_b32 s19, 5
.p2align 4
L_gemm_40:
  s_waitcnt lgkmcnt(3)
  v_mfma_f32_16x16x32_bf16 v[32:35], a[64:67], a[0:3], v[32:35]
  v_mfma_f32_16x16x32_bf16 v[36:39], a[64:67], a[4:7], v[36:39]
  ds_read_b128 a[84:87], v2 offset:5120
  v_mfma_f32_16x16x32_bf16 v[40:43], a[68:71], a[0:3], v[40:43]
  ds_read_b128 a[88:91], v2 offset:6144
  buffer_load_dwordx4 v4, s[8:11], s16 offen offset:2048  lds
  v_mfma_f32_16x16x32_bf16 v[44:47], a[68:71], a[4:7], v[44:47]
  s_waitcnt lgkmcnt(2)
  v_mfma_f32_16x16x32_bf16 v[48:51], a[72:75], a[0:3], v[48:51]
  ds_read_b128 a[92:95], v2 offset:7168
  v_mfma_f32_16x16x32_bf16 v[52:55], a[72:75], a[4:7], v[52:55]
  v_mfma_f32_16x16x32_bf16 v[56:59], a[76:79], a[0:3], v[56:59]
  ds_read_b128 a[64:67], v2 offset:8192
  buffer_load_dwordx4 v4, s[8:11], s16 offen offset:3072  lds
  s_add_u32 s16, s16, 16384
  v_mfma_f32_16x16x32_bf16 v[60:63], a[76:79], a[4:7], v[60:63]
  ds_read_b128 a[68:71], v2 offset:9216
  v_mfma_f32_16x16x32_bf16 v[64:67], a[80:83], a[0:3], v[64:67]
  v_mfma_f32_16x16x32_bf16 v[68:71], a[80:83], a[4:7], v[68:71]
  ds_read_b128 a[72:75], v2 offset:10240
  buffer_load_dwordx4 a[48:51], v8, s[12:15], s17 offen offset:0 sc1
  s_waitcnt lgkmcnt(3)
  v_mfma_f32_16x16x32_bf16 v[72:75], a[84:87], a[0:3], v[72:75]
  ds_read_b128 a[76:79], v2 offset:11264
  v_mfma_f32_16x16x32_bf16 v[76:79], a[84:87], a[4:7], v[76:79]
  v_mfma_f32_16x16x32_bf16 v[80:83], a[88:91], a[0:3], v[80:83]
  ds_read_b128 a[80:83], v2 offset:12288
  v_mfma_f32_16x16x32_bf16 v[84:87], a[88:91], a[4:7], v[84:87]
  buffer_load_dwordx4 a[52:55], v9, s[12:15], s17 offen offset:0 sc1
  v_mfma_f32_16x16x32_bf16 v[88:91], a[92:95], a[0:3], v[88:91]
  ds_read_b128 a[84:87], v2 offset:13312
  v_mfma_f32_16x16x32_bf16 v[92:95], a[92:95], a[4:7], v[92:95]
  ds_read_b128 a[88:91], v2 offset:14336
  s_waitcnt lgkmcnt(3)
  v_mfma_f32_16x16x32_bf16 v[32:35], a[64:67], a[8:11], v[32:35]
  v_mfma_f32_16x16x32_bf16 v[36:39], a[64:67], a[12:15], v[36:39]
  ds_read_b128 a[92:95], v2 offset:15360
  buffer_load_dwordx4 a[56:59], v8, s[12:15], s17 offen offset:1024 sc1
  v_mfma_f32_16x16x32_bf16 v[40:43], a[68:71], a[8:11], v[40:43]
  v_mfma_f32_16x16x32_bf16 v[44:47], a[68:71], a[12:15], v[44:47]
  v_mfma_f32_16x16x32_bf16 v[48:51], a[72:75], a[8:11], v[48:51]
  v_mfma_f32_16x16x32_bf16 v[52:55], a[72:75], a[12:15], v[52:55]
  buffer_load_dwordx4 a[60:63], v9, s[12:15], s17 offen offset:1024 sc1
  s_add_u32 s17, s17, 2048
  v_mfma_f32_16x16x32_bf16 v[56:59], a[76:79], a[8:11], v[56:59]
  v_mfma_f32_16x16x32_bf16 v[60:63], a[76:79], a[12:15], v[60:63]
  s_waitcnt lgkmcnt(0)
  v_mfma_f32_16x16x32_bf16 v[64:67], a[80:83], a[8:11], v[64:67]
  s_waitcnt vmcnt(16) lgkmcnt(0)
  s_barrier
  v_mfma_f32_16x16x32_bf16 v[68:71], a[80:83], a[12:15], v[68:71]
  ds_read_b128 a[64:67], v2 offset:16384
  s_add_u32 m0, s18, 0
  v_mfma_f32_16x16x32_bf16 v[72:75], a[84:87], a[8:11], v[72:75]
  ds_read_b128 a[68:71], v2 offset:17408
  buffer_load_dwordx4 v4, s[8:11], s16 offen offset:0  lds
  v_mfma_f32_16x16x32_bf16 v[76:79], a[84:87], a[12:15], v[76:79]
  v_mfma_f32_16x16x32_bf16 v[80:83], a[88:91], a[8:11], v[80:83]
  ds_read_b128 a[72:75], v2 offset:18432
  v_mfma_f32_16x16x32_bf16 v[84:87], a[88:91], a[12:15], v[84:87]
  ds_read_b128 a[76:79], v2 offset:19456
  v_mfma_f32_16x16x32_bf16 v[88:91], a[92:95], a[8:11], v[88:91]
  buffer_load_dwordx4 v4, s[8:11], s16 offen offset:1024  lds
  v_mfma_f32_16x16x32_bf16 v[92:95], a[92:95], a[12:15], v[92:95]
  ds_read_b128 a[80:83], v2 offset:20480
  s_waitcnt lgkmcnt(3)
  v_mfma_f32_16x16x32_bf16 v[32:35], a[64:67], a[16:19], v[32:35]
  v_mfma_f32_16x16x32_bf16 v[36:39], a[64:67], a[20:23], v[36:39]
  ds_read_b128 a[84:87], v2 offset:21504
  v_mfma_f32_16x16x32_bf16 v[40:43], a[68:71], a[16:19], v[40:43]
  ds_read_b128 a[88:91], v2 offset:22528
  buffer_load_dwordx4 v4, s[8:11], s16 offen offset:2048  lds
  v_mfma_f32_16x16x32_bf16 v[44:47], a[68:71], a[20:23], v[44:47]
  s_waitcnt lgkmcnt(2)
  v_mfma_f32_16x16x32_bf16 v[48:51], a[72:75], a[16:19], v[48:51]
  ds_read_b128 a[92:95], v2 offset:23552
  v_mfma_f32_16x16x32_bf16 v[52:55], a[72:75], a[20:23], v[52:55]
  v_mfma_f32_16x16x32_bf16 v[56:59], a[76:79], a[16:19], v[56:59]
  ds_read_b128 a[64:67], v2 offset:24576
  buffer_load_dwordx4 v4, s[8:11], s16 offen offset:3072  lds
  s_add_u32 s16, s16, 16384
  v_mfma_f32_16x16x32_bf16 v[60:63], a[76:79], a[20:23], v[60:63]
  ds_read_b128 a[68:71], v2 offset:25600
  v_mfma_f32_16x16x32_bf16 v[64:67], a[80:83], a[16:19], v[64:67]
  v_mfma_f32_16x16x32_bf16 v[68:71], a[80:83], a[20:23], v[68:71]
  ds_read_b128 a[72:75], v2 offset:26624
  buffer_load_dwordx4 a[0:3], v8, s[12:15], s17 offen offset:0 sc1
  s_waitcnt lgkmcnt(3)
  v_mfma_f32_16x16x32_bf16 v[72:75], a[84:87], a[16:19], v[72:75]
  ds_read_b128 a[76:79], v2 offset:27648
  v_mfma_f32_16x16x32_bf16 v[76:79], a[84:87], a[20:23], v[76:79]
  v_mfma_f32_16x16x32_bf16 v[80:83], a[88:91], a[16:19], v[80:83]
  ds_read_b128 a[80:83], v2 offset:28672
  v_mfma_f32_16x16x32_bf16 v[84:87], a[88:91], a[20:23], v[84:87]
  buffer_load_dwordx4 a[4:7], v9, s[12:15], s17 offen offset:0 sc1
  v_mfma_f32_16x16x32_bf16 v[88:91], a[92:95], a[16:19], v[88:91]
  ds_read_b128 a[84:87], v2 offset:29696
  v_mfma_f32_16x16x32_bf16 v[92:95], a[92:95], a[20:23], v[92:95]
  ds_read_b128 a[88:91], v2 offset:30720
  s_waitcnt lgkmcnt(3)
  v_mfma_f32_16x16x32_bf16 v[32:35], a[64:67], a[24:27], v[32:35]
  v_mfma_f32_16x16x32_bf16 v[36:39], a[64:67], a[28:31], v[36:39]
  ds_read_b128 a[92:95], v2 offset:31744
  buffer_load_dwordx4 a[8:11], v8, s[12:15], s17 offen offset:1024 sc1
  v_mfma_f32_16x16x32_bf16 v[40:43], a[68:71], a[24:27], v[40:43]
  v_mfma_f32_16x16x32_bf16 v[44:47], a[68:71], a[28:31], v[44:47]
  v_mfma_f32_16x16x32_bf16 v[48:51], a[72:75], a[24:27], v[48:51]
  v_mfma_f32_16x16x32_bf16 v[52:55], a[72:75], a[28:31], v[52:55]
  buffer_load_dwordx4 a[12:15], v9, s[12:15], s17 offen offset:1024 sc1
  s_add_u32 s17, s17, 2048
  v_mfma_f32_16x16x32_bf16 v[56:59], a[76:79], a[24:27], v[56:59]
  v_mfma_f32_16x16x32_bf16 v[60:63], a[76:79], a[28:31], v[60:63]
  s_waitcnt lgkmcnt(0)
  v_mfma_f32_16x16x32_bf16 v[64:67], a[80:83], a[24:27], v[64:67]
  s_waitcnt vmcnt(16) lgkmcnt(0)
  s_barrier
  v_mfma_f32_16x16x32_bf16 v[68:71], a[80:83], a[28:31], v[68:71]
  ds_read_b128 a[64:67], v2 offset:32768
  s_add_u32 m0, s18, 16384
  v_mfma_f32_16x16x32_bf16 v[72:75], a[84:87], a[24:27], v[72:75]
  ds_read_b128 a[68:71], v2 offset:33792
  buffer_load_dwordx4 v4, s[8:11], s16 offen offset:0  lds
  v_mfma_f32_16x16x32_bf16 v[76:79], a[84:87], a[28:31], v[76:79]
  v_mfma_f32_16x16x32_bf16 v[80:83], a[88:91], a[24:27], v[80:83]
  ds_read_b128 a[72:75], v2 offset:34816
  v_mfma_f32_16x16x32_bf16 v[84:87], a[88:91], a[28:31], v[84:87]
  ds_read_b128 a[76:79], v2 offset:35840
  v_mfma_f32_16x16x32_bf16 v[88:91], a[92:95], a[24:27], v[88:91]
  buffer_load_dwordx4 v4, s[8:11], s16 offen offset:1024  lds
  v_mfma_f32_16x16x32_bf16 v[92:95], a[92:95], a[28:31], v[92:95]
  ds_read_b128 a[80:83], v2 offset:36864
  s_waitcnt lgkmcnt(3)
  v_mfma_f32_16x16x32_bf16 v[32:35], a[64:67], a[32:35], v[32:35]
  v_mfma_f32_16x16x32_bf16 v[36:39], a[64:67], a[36:39], v[36:39]
  ds_read_b128 a[84:87], v2 offset:37888
  v_mfma_f32_16x16x32_bf16 v[40:43], a[68:71], a[32:35], v[40:43]
  ds_read_b128 a[88:91], v2 offset:38912
  buffer_load_dwordx4 v4, s[8:11], s16 offen offset:2048  lds
  v_mfma_f32_16x16x32_bf16 v[44:47], a[68:71], a[36:39], v[44:47]
  s_waitcnt lgkmcnt(2)
  v_mfma_f32_16x16x32_bf16 v[48:51], a[72:75], a[32:35], v[48:51]
  ds_read_b128 a[92:95], v2 offset:39936
  v_mfma_f32_16x16x32_bf16 v[52:55], a[72:75], a[36:39], v[52:55]
  v_mfma_f32_16x16x32_bf16 v[56:59], a[76:79], a[32:35], v[56:59]
  ds_read_b128 a[64:67], v2 offset:40960
  buffer_load_dwordx4 v4, s[8:11], s16 offen offset:3072  lds
  s_add_u32 s16, s16, 16384
  v_mfma_f32_16x16x32_bf16 v[60:63], a[76:79], a[36:39], v[60:63]
  ds_read_b128 a[68:71], v2 offset:41984
  v_mfma_f32_16x16x32_bf16 v[64:67], a[80:83], a[32:35], v[64:67]
  v_mfma_f32_16x16x32_bf16 v[68:71], a[80:83], a[36:39], v[68:71]
  ds_read_b128 a[72:75], v2 offset:43008
  buffer_load_dwordx4 a[16:19], v8, s[12:15], s17 offen offset:0 sc1
  s_waitcnt lgkmcnt(3)
  v_mfma_f32_16x16x32_bf16 v[72:75], a[84:87], a[32:35], v[72:75]
  ds_read_b128 a[76:79], v2 offset:44032
  v_mfma_f32_16x16x32_bf16 v[76:79], a[84:87], a[36:39], v[76:79]
  v_mfma_f32_16x16x32_bf16 v[80:83], a[88:91], a[32:35], v[80:83]
  ds_read_b128 a[80:83], v2 offset:45056
  v_mfma_f32_16x16x32_bf16 v[84:87], a[88:91], a[36:39], v[84:87]
  buffer_load_dwordx4 a[20:23], v9, s[12:15], s17 offen offset:0 sc1
  v_mfma_f32_16x16x32_bf16 v[88:91], a[92:95], a[32:35], v[88:91]
  ds_read_b128 a[84:87], v2 offset:46080
  v_mfma_f32_16x16x32_bf16 v[92:95], a[92:95], a[36:39], v[92:95]
  ds_read_b128 a[88:91], v2 offset:47104
  s_waitcnt lgkmcnt(3)
  v_mfma_f32_16x16x32_bf16 v[32:35], a[64:67], a[40:43], v[32:35]
  v_mfma_f32_16x16x32_bf16 v[36:39], a[64:67], a[44:47], v[36:39]
  ds_read_b128 a[92:95], v2 offset:48128
  buffer_load_dwordx4 a[24:27], v8, s[12:15], s17 offen offset:1024 sc1
  v_mfma_f32_16x16x32_bf16 v[40:43], a[68:71], a[40:43], v[40:43]
  v_mfma_f32_16x16x32_bf16 v[44:47], a[68:71], a[44:47], v[44:47]
  v_mfma_f32_16x16x32_bf16 v[48:51], a[72:75], a[40:43], v[48:51]
  v_mfma_f32_16x16x32_bf16 v[52:55], a[72:75], a[44:47], v[52:55]
  buffer_load_dwordx4 a[28:31], v9, s[12:15], s17 offen offset:1024 sc1
  s_add_u32 s17, s17, 2048
  v_mfma_f32_16x16x32_bf16 v[56:59], a[76:79], a[40:43], v[56:59]
  v_mfma_f32_16x16x32_bf16 v[60:63], a[76:79], a[44:47], v[60:63]
  s_waitcnt lgkmcnt(0)
  v_mfma_f32_16x16x32_bf16 v[64:67], a[80:83], a[40:43], v[64:67]
  s_waitcnt vmcnt(16) lgkmcnt(0)
  s_barrier
  v_mfma_f32_16x16x32_bf16 v[68:71], a[80:83], a[44:47], v[68:71]
  ds_read_b128 a[64:67], v2 offset:49152
  s_add_u32 m0, s18, 32768
  v_mfma_f32_16x16x32_bf16 v[72:75], a[84:87], a[40:43], v[72:75]
  ds_read_b128 a[68:71], v2 offset:50176
  buffer_load_dwordx4 v4, s[8:11], s16 offen offset:0  lds
  v_mfma_f32_16x16x32_bf16 v[76:79], a[84:87], a[44:47], v[76:79]
  v_mfma_f32_16x16x32_bf16 v[80:83], a[88:91], a[40:43], v[80:83]
  ds_read_b128 a[72:75], v2 offset:51200
  v_mfma_f32_16x16x32_bf16 v[84:87], a[88:91], a[44:47], v[84:87]
  ds_read_b128 a[76:79], v2 offset:52224
  v_mfma_f32_16x16x32_bf16 v[88:91], a[92:95], a[40:43], v[88:91]
  buffer_load_dwordx4 v4, s[8:11], s16 offen offset:1024  lds
  v_mfma_f32_16x16x32_bf16 v[92:95], a[92:95], a[44:47], v[92:95]
  ds_read_b128 a[80:83], v2 offset:53248
  s_waitcnt lgkmcnt(3)
  v_mfma_f32_16x16x32_bf16 v[32:35], a[64:67], a[48:51], v[32:35]
  v_mfma_f32_16x16x32_bf16 v[36:39], a[64:67], a[52:55], v[36:39]
  ds_read_b128 a[84:87], v2 offset:54272
  v_mfma_f32_16x16x32_bf16 v[40:43], a[68:71], a[48:51], v[40:43]
  ds_read_b128 a[88:91], v2 offset:55296
  buffer_load_dwordx4 v4, s[8:11], s16 offen offset:2048  lds
  v_mfma_f32_16x16x32_bf16 v[44:47], a[68:71], a[52:55], v[44:47]
  s_waitcnt lgkmcnt(2)
  v_mfma_f32_16x16x32_bf16 v[48:51], a[72:75], a[48:51], v[48:51]
  ds_read_b128 a[92:95], v2 offset:56320
  v_mfma_f32_16x16x32_bf16 v[52:55], a[72:75], a[52:55], v[52:55]
  v_mfma_f32_16x16x32_bf16 v[56:59], a[76:79], a[48:51], v[56:59]
  ds_read_b128 a[64:67], v2 offset:57344
  buffer_load_dwordx4 v4, s[8:11], s16 offen offset:3072  lds
  s_add_u32 s16, s16, 16384
  v_mfma_f32_16x16x32_bf16 v[60:63], a[76:79], a[52:55], v[60:63]
  ds_read_b128 a[68:71], v2 offset:58368
  v_mfma_f32_16x16x32_bf16 v[64:67], a[80:83], a[48:51], v[64:67]
  v_mfma_f32_16x16x32_bf16 v[68:71], a[80:83], a[52:55], v[68:71]
  ds_read_b128 a[72:75], v2 offset:59392
  buffer_load_dwordx4 a[32:35], v8, s[12:15], s17 offen offset:0 sc1
  s_waitcnt lgkmcnt(3)
  v_mfma_f32_16x16x32_bf16 v[72:75], a[84:87], a[48:51], v[72:75]
  ds_read_b128 a[76:79], v2 offset:60416
  v_mfma_f32_16x16x32_bf16 v[76:79], a[84:87], a[52:55], v[76:79]
  v_mfma_f32_16x16x32_bf16 v[80:83], a[88:91], a[48:51], v[80:83]
  ds_read_b128 a[80:83], v2 offset:61440
  v_mfma_f32_16x16x32_bf16 v[84:87], a[88:91], a[52:55], v[84:87]
  buffer_load_dwordx4 a[36:39], v9, s[12:15], s17 offen offset:0 sc1
  v_mfma_f32_16x16x32_bf16 v[88:91], a[92:95], a[48:51], v[88:91]
  ds_read_b128 a[84:87], v2 offset:62464
  v_mfma_f32_16x16x32_bf16 v[92:95], a[92:95], a[52:55], v[92:95]
  ds_read_b128 a[88:91], v2 offset:63488
  s_waitcnt lgkmcnt(3)
  v_mfma_f32_16x16x32_bf16 v[32:35], a[64:67], a[56:59], v[32:35]
  v_mfma_f32_16x16x32_bf16 v[36:39], a[64:67], a[60:63], v[36:39]
  ds_read_b128 a[92:95], v2 offset:64512
  buffer_load_dwordx4 a[40:43], v8, s[12:15], s17 offen offset:1024 sc1
  v_mfma_f32_16x16x32_bf16 v[40:43], a[68:71], a[56:59], v[40:43]
  v_mfma_f32_16x16x32_bf16 v[44:47], a[68:71], a[60:63], v[44:47]
  v_mfma_f32_16x16x32_bf16 v[48:51], a[72:75], a[56:59], v[48:51]
  v_mfma_f32_16x16x32_bf16 v[52:55], a[72:75], a[60:63], v[52:55]
  buffer_load_dwordx4 a[44:47], v9, s[12:15], s17 offen offset:1024 sc1
  s_add_u32 s17, s17, 2048
  v_mfma_f32_16x16x32_bf16 v[56:59], a[76:79], a[56:59], v[56:59]
  v_mfma_f32_16x16x32_bf16 v[60:63], a[76:79], a[60:63], v[60:63]
  s_waitcnt lgkmcnt(0)
  v_mfma_f32_16x16x32_bf16 v[64:67], a[80:83], a[56:59], v[64:67]
  s_waitcnt vmcnt(16) lgkmcnt(0)
  s_barrier
  v_mfma_f32_16x16x32_bf16 v[68:71], a[80:83], a[60:63], v[68:71]
  ds_read_b128 a[64:67], v2 offset:0
  s_add_u32 m0, s18, 49152
  v_mfma_f32_16x16x32_bf16 v[72:75], a[84:87], a[56:59], v[72:75]
  ds_read_b128 a[68:71], v2 offset:1024
  buffer_load_dwordx4 v4, s[8:11], s16 offen offset:0  lds
  v_mfma_f32_16x16x32_bf16 v[76:79], a[84:87], a[60:63], v[76:79]
  v_mfma_f32_16x16x32_bf16 v[80:83], a[88:91], a[56:59], v[80:83]
  ds_read_b128 a[72:75], v2 offset:2048
  v_mfma_f32_16x16x32_bf16 v[84:87], a[88:91], a[60:63], v[84:87]
  ds_read_b128 a[76:79], v2 offset:3072
  v_mfma_f32_16x16x32_bf16 v[88:91], a[92:95], a[56:59], v[88:91]
  buffer_load_dwordx4 v4, s[8:11], s16 offen offset:1024  lds
  v_mfma_f32_16x16x32_bf16 v[92:95], a[92:95], a[60:63], v[92:95]
  ds_read_b128 a[80:83], v2 offset:4096
  s_sub_u32 s19, s19, 1
  s_cmp_lg_u32 s19, 0
  s_cbranch_scc1 L_gemm_40
  s_waitcnt lgkmcnt(3)
  v_mfma_f32_16x16x32_bf16 v[32:35], a[64:67], a[0:3], v[32:35]
  v_add_f32 v16, v16, v17
  v_mfma_f32_16x16x32_bf16 v[36:39], a[64:67], a[4:7], v[36:39]
  ds_read_b128 a[84:87], v2 offset:5120
  v_add_f32 v18, v18, v19
  v_mfma_f32_16x16x32_bf16 v[40:43], a[68:71], a[0:3], v[40:43]
  ds_read_b128 a[88:91], v2 offset:6144
  buffer_load_dwordx4 v4, s[8:11], s16 offen offset:2048  lds
  v_add_f32 v16, v16, v18
  v_mfma_f32_16x16x32_bf16 v[44:47], a[68:71], a[4:7], v[44:47]
  v_cvt_pk_bf16_f32 v16, v16, v16
  s_waitcnt lgkmcnt(2)
  v_mfma_f32_16x16x32_bf16 v[48:51], a[72:75], a[0:3], v[48:51]
  ds_read_b128 a[92:95], v2 offset:7168
  v_lshlrev_b32 v16, 16, v16
  v_mfma_f32_16x16x32_bf16 v[52:55], a[72:75], a[4:7], v[52:55]
  ds_write_b32 v29, v16
  v_mfma_f32_16x16x32_bf16 v[56:59], a[76:79], a[0:3], v[56:59]
  ds_read_b128 a[64:67], v2 offset:8192
  buffer_load_dwordx4 v4, s[8:11], s16 offen offset:3072  lds
  s_add_u32 s16, s16, 16384
  ds_read_b128 v[112:115], v23
  v_mfma_f32_16x16x32_bf16 v[60:63], a[76:79], a[4:7], v[60:63]
  ds_read_b128 a[68:71], v2 offset:9216
  ds_read_b128 v[116:119], v23 offset:64
  v_mfma_f32_16x16x32_bf16 v[64:67], a[80:83], a[0:3], v[64:67]
  ds_read_b128 v[120:123], v23 offset:128
  v_mfma_f32_16x16x32_bf16 v[68:71], a[80:83], a[4:7], v[68:71]
  ds_read_b128 a[72:75], v2 offset:10240
  buffer_load_dwordx4 a[48:51], v8, s[12:15], s17 offen offset:0 sc1
  ds_read_b128 v[124:127], v23 offset:192
  s_waitcnt lgkmcnt(7)
  v_mfma_f32_16x16x32_bf16 v[72:75], a[84:87], a[0:3], v[72:75]
  ds_read_b128 a[76:79], v2 offset:11264
  v_mfma_f32_16x16x32_bf16 v[76:79], a[84:87], a[4:7], v[76:79]
  v_accvgpr_read_b32 v96, a212
  v_mfma_f32_16x16x32_bf16 v[80:83], a[88:91], a[0:3], v[80:83]
  ds_read_b128 a[80:83], v2 offset:12288
  v_accvgpr_read_b32 v97, a213
  v_mfma_f32_16x16x32_bf16 v[84:87], a[88:91], a[4:7], v[84:87]
  buffer_load_dwordx4 a[52:55], v9, s[12:15], s17 offen offset:0 sc1
  v_accvgpr_read_b32 v98, a214
  v_mfma_f32_16x16x32_bf16 v[88:91], a[92:95], a[0:3], v[88:91]
  ds_read_b128 a[84:87], v2 offset:13312
  v_accvgpr_read_b32 v99, a215
  v_mfma_f32_16x16x32_bf16 v[92:95], a[92:95], a[4:7], v[92:95]
  ds_read_b128 a[88:91], v2 offset:14336
  v_accvgpr_read_b32 v100, a216
  s_waitcnt lgkmcnt(3)
  v_mfma_f32_16x16x32_bf16 v[32:35], a[64:67], a[8:11], v[32:35]
  v_accvgpr_read_b32 v101, a217
  v_mfma_f32_16x16x32_bf16 v[36:39], a[64:67], a[12:15], v[36:39]
  ds_read_b128 a[92:95], v2 offset:15360
  buffer_load_dwordx4 a[56:59], v8, s[12:15], s17 offen offset:1024 sc1
  v_accvgpr_read_b32 v102, a218
  v_mfma_f32_16x16x32_bf16 v[40:43], a[68:71], a[8:11], v[40:43]
  v_accvgpr_read_b32 v103, a219
  v_mfma_f32_16x16x32_bf16 v[44:47], a[68:71], a[12:15], v[44:47]
  v_accvgpr_read_b32 v104, a220
  v_mfma_f32_16x16x32_bf16 v[48:51], a[72:75], a[8:11], v[48:51]
  v_accvgpr_read_b32 v105, a221
  v_mfma_f32_16x16x32_bf16 v[52:55], a[72:75], a[12:15], v[52:55]
  buffer_load_dwordx4 a[60:63], v9, s[12:15], s17 offen offset:1024 sc1
  s_add_u32 s17, s17, 2048
  v_mfma_f32_16x16x32_bf16 v[56:59], a[76:79], a[8:11], v[56:59]
  v_accvgpr_read_b32 v106, a222
  v_mfma_f32_16x16x32_bf16 v[60:63], a[76:79], a[12:15], v[60:63]
  v_accvgpr_read_b32 v107, a223
  s_waitcnt lgkmcnt(0)
  v_mfma_f32_16x16x32_bf16 v[64:67], a[80:83], a[8:11], v[64:67]
  v_accvgpr_read_b32 v108, a224
  s_waitcnt vmcnt(16) lgkmcnt(0)
  s_barrier
  v_mfma_f32_16x16x32_bf16 v[68:71], a[80:83], a[12:15], v[68:71]
  ds_read_b128 a[64:67], v2 offset:16384
  v_accvgpr_read_b32 v109, a225
  v_mfma_f32_16x16x32_bf16 v[72:75], a[84:87], a[8:11], v[72:75]
  ds_read_b128 a[68:71], v2 offset:17408
  v_accvgpr_read_b32 v110, a226
  v_mfma_f32_16x16x32_bf16 v[76:79], a[84:87], a[12:15], v[76:79]
  v_accvgpr_read_b32 v111, a227
  v_mfma_f32_16x16x32_bf16 v[80:83], a[88:91], a[8:11], v[80:83]
  ds_read_b128 a[72:75], v2 offset:18432
  v_lshlrev_b32 v160, 16, v96
  v_mfma_f32_16x16x32_bf16 v[84:87], a[88:91], a[12:15], v[84:87]
  ds_read_b128 a[76:79], v2 offset:19456
  v_and_b32 v161, 0xffff0000, v96
  v_mfma_f32_16x16x32_bf16 v[88:91], a[92:95], a[8:11], v[88:91]
  v_lshlrev_b32 v162, 16, v97
  v_mfma_f32_16x16x32_bf16 v[92:95], a[92:95], a[12:15], v[92:95]
  ds_read_b128 a[80:83], v2 offset:20480
  s_waitcnt lgkmcnt(3)
  v_mfma_f32_16x16x32_bf16 v[32:35], a[64:67], a[16:19], v[32:35]
  v_and_b32 v163, 0xffff0000, v97
  v_mfma_f32_16x16x32_bf16 v[36:39], a[64:67], a[20:23], v[36:39]
  ds_read_b128 a[84:87], v2 offset:21504
  v_lshlrev_b32 v168, 16, v98
  v_mfma_f32_16x16x32_bf16 v[40:43], a[68:71], a[16:19], v[40:43]
  ds_read_b128 a[88:91], v2 offset:22528
  v_and_b32 v169, 0xffff0000, v98
  v_mfma_f32_16x16x32_bf16 v[44:47], a[68:71], a[20:23], v[44:47]
  v_lshlrev_b32 v170, 16, v99
  s_waitcnt lgkmcnt(2)
  v_mfma_f32_16x16x32_bf16 v[48:51], a[72:75], a[16:19], v[48:51]
  ds_read_b128 a[92:95], v2 offset:23552
  v_and_b32 v171, 0xffff0000, v99
  v_mfma_f32_16x16x32_bf16 v[52:55], a[72:75], a[20:23], v[52:55]
  v_lshlrev_b32 v176, 16, v100
  v_mfma_f32_16x16x32_bf16 v[56:59], a[76:79], a[16:19], v[56:59]
  ds_read_b128 a[64:67], v2 offset:24576
  v_and_b32 v177, 0xffff0000, v100
  v_mfma_f32_16x16x32_bf16 v[60:63], a[76:79], a[20:23], v[60:63]
  ds_read_b128 a[68:71], v2 offset:25600
  v_lshlrev_b32 v178, 16, v101
  v_mfma_f32_16x16x32_bf16 v[64:67], a[80:83], a[16:19], v[64:67]
  v_and_b32 v179, 0xffff0000, v101
  v_mfma_f32_16x16x32_bf16 v[68:71], a[80:83], a[20:23], v[68:71]
  ds_read_b128 a[72:75], v2 offset:26624
  v_lshlrev_b32 v184, 16, v102
  s_waitcnt lgkmcnt(3)
  v_mfma_f32_16x16x32_bf16 v[72:75], a[84:87], a[16:19], v[72:75]
  ds_read_b128 a[76:79], v2 offset:27648
  v_mfma_f32_16x16x32_bf16 v[76:79], a[84:87], a[20:23], v[76:79]
  v_and_b32 v185, 0xffff0000, v102
  v_mfma_f32_16x16x32_bf16 v[80:83], a[88:91], a[16:19], v[80:83]
  ds_read_b128 a[80:83], v2 offset:28672
  v_lshlrev_b32 v186, 16, v103
  v_mfma_f32_16x16x32_bf16 v[84:87], a[88:91], a[20:23], v[84:87]
  v_and_b32 v187, 0xffff0000, v103
  v_mfma_f32_16x16x32_bf16 v[88:91], a[92:95], a[16:19], v[88:91]
  ds_read_b128 a[84:87], v2 offset:29696
  v_lshlrev_b32 v164, 16, v104
  v_mfma_f32_16x16x32_bf16 v[92:95], a[92:95], a[20:23], v[92:95]
  ds_read_b128 a[88:91], v2 offset:30720
  v_and_b32 v165, 0xffff0000, v104
  s_waitcnt lgkmcnt(3)
  v_mfma_f32_16x16x32_bf16 v[32:35], a[64:67], a[24:27], v[32:35]
  v_lshlrev_b32 v166, 16, v105
  v_mfma_f32_16x16x32_bf16 v[36:39], a[64:67], a[28:31], v[36:39]
  ds_read_b128 a[92:95], v2 offset:31744
  v_and_b32 v167, 0xffff0000, v105
  v_mfma_f32_16x16x32_bf16 v[40:43], a[68:71], a[24:27], v[40:43]
  v_lshlrev_b32 v172, 16, v106
  v_mfma_f32_16x16x32_bf16 v[44:47], a[68:71], a[28:31], v[44:47]
  v_and_b32 v173, 0xffff0000, v106
  v_mfma_f32_16x16x32_bf16 v[48:51], a[72:75], a[24:27], v[48:51]
  v_lshlrev_b32 v174, 16, v107
  v_mfma_f32_16x16x32_bf16 v[52:55], a[72:75], a[28:31], v[52:55]
  v_mfma_f32_16x16x32_bf16 v[56:59], a[76:79], a[24:27], v[56:59]
  v_and_b32 v175, 0xffff0000, v107
  v_mfma_f32_16x16x32_bf16 v[60:63], a[76:79], a[28:31], v[60:63]
  v_lshlrev_b32 v180, 16, v108
  s_waitcnt lgkmcnt(0)
  v_mfma_f32_16x16x32_bf16 v[64:67], a[80:83], a[24:27], v[64:67]
  v_and_b32 v181, 0xffff0000, v108
  s_waitcnt vmcnt(0) lgkmcnt(0)
  s_barrier
  v_mfma_f32_16x16x32_bf16 v[68:71], a[80:83], a[28:31], v[68:71]
  ds_read_b128 a[64:67], v2 offset:36864
  v_lshlrev_b32 v182, 16, v109
  v_mfma_f32_16x16x32_bf16 v[72:75], a[84:87], a[24:27], v[72:75]
  v_and_b32 v183, 0xffff0000, v109
  v_mfma_f32_16x16x32_bf16 v[76:79], a[84:87], a[28:31], v[76:79]
  ds_read_b128 a[68:71], v2 offset:37888
  v_lshlrev_b32 v188, 16, v110
  v_mfma_f32_16x16x32_bf16 v[80:83], a[88:91], a[24:27], v[80:83]
  v_and_b32 v189, 0xffff0000, v110
  v_mfma_f32_16x16x32_bf16 v[84:87], a[88:91], a[28:31], v[84:87]
  ds_read_b128 a[72:75], v2 offset:38912
  v_lshlrev_b32 v190, 16, v111
  v_mfma_f32_16x16x32_bf16 v[88:91], a[92:95], a[24:27], v[88:91]
  v_and_b32 v191, 0xffff0000, v111
  v_mfma_f32_16x16x32_bf16 v[92:95], a[92:95], a[28:31], v[92:95]
  ds_read_b128 a[76:79], v2 offset:39936
  s_waitcnt lgkmcnt(2)
  v_mfma_f32_16x16x32_bf16 v[64:67], a[64:67], a[32:35], v[64:67]
  v_mfma_f32_16x16x32_bf16 v[68:71], a[64:67], a[36:39], v[68:71]
  ds_read_b128 a[80:83], v2 offset:45056
  v_mfma_f32_16x16x32_bf16 v[72:75], a[68:71], a[32:35], v[72:75]
  v_mfma_f32_16x16x32_bf16 v[76:79], a[68:71], a[36:39], v[76:79]
  ds_read_b128 a[84:87], v2 offset:46080
  s_waitcnt lgkmcnt(2)
  v_mfma_f32_16x16x32_bf16 v[80:83], a[72:75], a[32:35], v[80:83]
  v_mfma_f32_16x16x32_bf16 v[84:87], a[72:75], a[36:39], v[84:87]
  ds_read_b128 a[88:91], v2 offset:47104
  v_mfma_f32_16x16x32_bf16 v[88:91], a[76:79], a[32:35], v[88:91]
  v_mfma_f32_16x16x32_bf16 v[92:95], a[76:79], a[36:39], v[92:95]
  ds_read_b128 a[92:95], v2 offset:48128
  s_waitcnt lgkmcnt(2)
  v_mfma_f32_16x16x32_bf16 v[64:67], a[80:83], a[40:43], v[64:67]
  v_mfma_f32_16x16x32_bf16 v[68:71], a[80:83], a[44:47], v[68:71]
  ds_read_b128 a[64:67], v2 offset:53248
  v_mfma_f32_16x16x32_bf16 v[72:75], a[84:87], a[40:43], v[72:75]
  v_mfma_f32_16x16x32_bf16 v[76:79], a[84:87], a[44:47], v[76:79]
  ds_read_b128 a[68:71], v2 offset:54272
  s_waitcnt lgkmcnt(2)
  v_mfma_f32_16x16x32_bf16 v[80:83], a[88:91], a[40:43], v[80:83]
  v_mfma_f32_16x16x32_bf16 v[84:87], a[88:91], a[44:47], v[84:87]
  ds_read_b128 a[72:75], v2 offset:55296
  v_mfma_f32_16x16x32_bf16 v[88:91], a[92:95], a[40:43], v[88:91]
  v_mfma_f32_16x16x32_bf16 v[92:95], a[92:95], a[44:47], v[92:95]
  ds_read_b128 a[76:79], v2 offset:56320
  s_waitcnt lgkmcnt(2)
  v_mfma_f32_16x16x32_bf16 v[64:67], a[64:67], a[48:51], v[64:67]
  v_mfma_f32_16x16x32_bf16 v[68:71], a[64:67], a[52:55], v[68:71]
  ds_read_b128 a[80:83], v2 offset:61440
  v_mfma_f32_16x16x32_bf16 v[72:75], a[68:71], a[48:51], v[72:75]
  v_mfma_f32_16x16x32_bf16 v[76:79], a[68:71], a[52:55], v[76:79]
  ds_read_b128 a[84:87], v2 offset:62464
  s_waitcnt lgkmcnt(2)
  v_mfma_f32_16x16x32_bf16 v[80:83], a[72:75], a[48:51], v[80:83]
  v_mfma_f32_16x16x32_bf16 v[84:87], a[72:75], a[52:55], v[84:87]
  ds_read_b128 a[88:91], v2 offset:63488
  v_mfma_f32_16x16x32_bf16 v[88:91], a[76:79], a[48:51], v[88:91]
  v_mfma_f32_16x16x32_bf16 v[92:95], a[76:79], a[52:55], v[92:95]
  ds_read_b128 a[92:95], v2 offset:64512
  s_waitcnt lgkmcnt(2)
  v_mfma_f32_16x16x32_bf16 v[64:67], a[80:83], a[56:59], v[64:67]
  v_mfma_f32_16x16x32_bf16 v[68:71], a[80:83], a[60:63], v[68:71]
  ds_read_b128 a[64:67], v2 offset:32768
  v_mfma_f32_16x16x32_bf16 v[72:75], a[84:87], a[56:59], v[72:75]
  v_mfma_f32_16x16x32_bf16 v[76:79], a[84:87], a[60:63], v[76:79]
  ds_read_b128 a[68:71], v2 offset:33792
  s_waitcnt lgkmcnt(2)
  v_mfma_f32_16x16x32_bf16 v[80:83], a[88:91], a[56:59], v[80:83]
  v_mfma_f32_16x16x32_bf16 v[84:87], a[88:91], a[60:63], v[84:87]
  ds_read_b128 a[72:75], v2 offset:34816
  v_mfma_f32_16x16x32_bf16 v[88:91], a[92:95], a[56:59], v[88:91]
  v_mfma_f32_16x16x32_bf16 v[92:95], a[92:95], a[60:63], v[92:95]
  ds_read_b128 a[76:79], v2 offset:35840
  s_waitcnt lgkmcnt(2)
  v_mfma_f32_16x16x32_bf16 v[32:35], a[64:67], a[32:35], v[32:35]
  v_mfma_f32_16x16x32_bf16 v[36:39], a[64:67], a[36:39], v[36:39]
  ds_read_b128 a[80:83], v2 offset:40960
  v_mfma_f32_16x16x32_bf16 v[40:43], a[68:71], a[32:35], v[40:43]
  v_mfma_f32_16x16x32_bf16 v[44:47], a[68:71], a[36:39], v[44:47]
  ds_read_b128 a[84:87], v2 offset:41984
  s_waitcnt lgkmcnt(2)
  v_mfma_f32_16x16x32_bf16 v[48:51], a[72:75], a[32:35], v[48:51]
  v_mfma_f32_16x16x32_bf16 v[52:55], a[72:75], a[36:39], v[52:55]
  ds_read_b128 a[88:91], v2 offset:43008
  v_mfma_f32_16x16x32_bf16 v[56:59], a[76:79], a[32:35], v[56:59]
  v_mfma_f32_16x16x32_bf16 v[60:63], a[76:79], a[36:39], v[60:63]
  ds_read_b128 a[92:95], v2 offset:44032
  s_waitcnt lgkmcnt(2)
  v_mfma_f32_16x16x32_bf16 v[32:35], a[80:83], a[40:43], v[32:35]
  v_cvt_pk_bf16_f32 v128, v64, v65
  v_mfma_f32_16x16x32_bf16 v[36:39], a[80:83], a[44:47], v[36:39]
  ds_read_b128 a[64:67], v2 offset:49152
  v_cvt_pk_bf16_f32 v129, v66, v67
  v_mfma_f32_16x16x32_bf16 v[40:43], a[84:87], a[40:43], v[40:43]
  v_cvt_pk_bf16_f32 v130, v68, v69
  v_mfma_f32_16x16x32_bf16 v[44:47], a[84:87], a[44:47], v[44:47]
  ds_read_b128 a[68:71], v2 offset:50176
  v_cvt_pk_bf16_f32 v131, v70, v71
  s_waitcnt lgkmcnt(2)
  v_mfma_f32_16x16x32_bf16 v[48:51], a[88:91], a[40:43], v[48:51]
  buffer_store_dwordx4 v[128:131], v2, s[44:47], s52 offen offset:0 sc1
  v_mfma_f32_16x16x32_bf16 v[52:55], a[88:91], a[44:47], v[52:55]
  ds_read_b128 a[72:75], v2 offset:51200
  v_mfma_f32_16x16x32_bf16 v[56:59], a[92:95], a[40:43], v[56:59]
  v_cvt_pk_bf16_f32 v132, v72, v73
  v_mfma_f32_16x16x32_bf16 v[60:63], a[92:95], a[44:47], v[60:63]
  ds_read_b128 a[76:79], v2 offset:52224
  v_cvt_pk_bf16_f32 v133, v74, v75
  s_waitcnt lgkmcnt(2)
  v_mfma_f32_16x16x32_bf16 v[32:35], a[64:67], a[48:51], v[32:35]
  v_cvt_pk_bf16_f32 v134, v76, v77
  v_mfma_f32_16x16x32_bf16 v[36:39], a[64:67], a[52:55], v[36:39]
  ds_read_b128 a[80:83], v2 offset:57344
  v_cvt_pk_bf16_f32 v135, v78, v79
  v_mfma_f32_16x16x32_bf16 v[40:43], a[68:71], a[48:51], v[40:43]
  buffer_store_dwordx4 v[132:135], v2, s[44:47], s52 offen offset:1024 sc1
  v_mfma_f32_16x16x32_bf16 v[44:47], a[68:71], a[52:55], v[44:47]
  ds_read_b128 a[84:87], v2 offset:58368
  s_waitcnt lgkmcnt(2)
  v_mfma_f32_16x16x32_bf16 v[48:51], a[72:75], a[48:51], v[48:51]
  v_cvt_pk_bf16_f32 v136, v80, v81
  v_mfma_f32_16x16x32_bf16 v[52:55], a[72:75], a[52:55], v[52:55]
  ds_read_b128 a[88:91], v2 offset:59392
  v_cvt_pk_bf16_f32 v137, v82, v83
  v_mfma_f32_16x16x32_bf16 v[56:59], a[76:79], a[48:51], v[56:59]
  v_cvt_pk_bf16_f32 v138, v84, v85
  v_mfma_f32_16x16x32_bf16 v[60:63], a[76:79], a[52:55], v[60:63]
  ds_read_b128 a[92:95], v2 offset:60416
  v_cvt_pk_bf16_f32 v139, v86, v87
  s_waitcnt lgkmcnt(2)
  v_mfma_f32_16x16x32_bf16 v[32:35], a[80:83], a[56:59], v[32:35]
  buffer_store_dwordx4 v[136:139], v2, s[44:47], s52 offen offset:2048 sc1
  v_mfma_f32_16x16x32_bf16 v[36:39], a[80:83], a[60:63], v[36:39]
  v_mfma_f32_16x16x32_bf16 v[40:43], a[84:87], a[56:59], v[40:43]
  v_cvt_pk_bf16_f32 v140, v88, v89
  v_mfma_f32_16x16x32_bf16 v[44:47], a[84:87], a[60:63], v[44:47]
  v_cvt_pk_bf16_f32 v141, v90, v91
  s_waitcnt lgkmcnt(0)
  v_mfma_f32_16x16x32_bf16 v[48:51], a[88:91], a[56:59], v[48:51]
  v_cvt_pk_bf16_f32 v142, v92, v93
  v_mfma_f32_16x16x32_bf16 v[52:55], a[88:91], a[60:63], v[52:55]
  v_cvt_pk_bf16_f32 v143, v94, v95
  v_mfma_f32_16x16x32_bf16 v[56:59], a[92:95], a[56:59], v[56:59]
  buffer_store_dwordx4 v[140:143], v2, s[44:47], s52 offen offset:3072 sc1
  v_mfma_f32_16x16x32_bf16 v[60:63], a[92:95], a[60:63], v[60:63]
  s_nop 7
  s_waitcnt vmcnt(0)
  buffer_store_dword v26, v25, s[48:51], s56 offen sc1
  s_mov_b32 s64, 0x100000
  v_pk_fma_f32 v[32:33], v[32:33], v[112:113], v[160:161]
  v_pk_fma_f32 v[34:35], v[34:35], v[114:115], v[162:163]
  v_pk_fma_f32 v[36:37], v[36:37], v[112:113], v[164:165]
  v_pk_fma_f32 v[38:39], v[38:39], v[114:115], v[166:167]
  v_pk_fma_f32 v[40:41], v[40:41], v[116:117], v[168:169]
  v_pk_fma_f32 v[42:43], v[42:43], v[118:119], v[170:171]
  v_pk_fma_f32 v[44:45], v[44:45], v[116:117], v[172:173]
  v_pk_fma_f32 v[46:47], v[46:47], v[118:119], v[174:175]
  v_pk_fma_f32 v[48:49], v[48:49], v[120:121], v[176:177]
  v_pk_fma_f32 v[50:51], v[50:51], v[122:123], v[178:179]
  v_pk_fma_f32 v[52:53], v[52:53], v[120:121], v[180:181]
  v_pk_fma_f32 v[54:55], v[54:55], v[122:123], v[182:183]
  v_pk_fma_f32 v[56:57], v[56:57], v[124:125], v[184:185]
  v_pk_fma_f32 v[58:59], v[58:59], v[126:127], v[186:187]
  v_pk_fma_f32 v[60:61], v[60:61], v[124:125], v[188:189]
  v_pk_fma_f32 v[62:63], v[62:63], v[126:127], v[190:191]
L_spin_41:
  buffer_load_dword v27, v25, s[48:51], s57 offen sc1
  s_sub_u32 s64, s64, 1
  s_cselect_b32 s65, 1, 0
  s_waitcnt vmcnt(0)
  v_readfirstlane_b32 s25, v27
  s_nop 3
  s_or_b32 s25, s25, s65
  s_cmp_eq_u32 s25, 1
  s_cbranch_scc0 L_spin_41
  buffer_load_dwordx4 v[128:131], v2, s[44:47], s54 offen offset:0 sc1
  buffer_load_dwordx4 v[132:135], v2, s[44:47], s54 offen offset:1024 sc1
  buffer_load_dwordx4 v[136:139], v2, s[44:47], s54 offen offset:2048 sc1
  buffer_load_dwordx4 v[140:143], v2, s[44:47], s54 offen offset:3072 sc1
  s_waitcnt vmcnt(3)
  v_lshlrev_b32 v64, 16, v128
  v_and_b32 v65, 0xffff0000, v128
  v_lshlrev_b32 v66, 16, v129
  v_and_b32 v67, 0xffff0000, v129
  v_lshlrev_b32 v68, 16, v130
  v_and_b32 v69, 0xffff0000, v130
  v_lshlrev_b32 v70, 16, v131
  v_and_b32 v71, 0xffff0000, v131
  v_pk_fma_f32 v[32:33], v[64:65], v[112:113], v[32:33]
  v_pk_fma_f32 v[34:35], v[66:67], v[114:115], v[34:35]
  v_pk_fma_f32 v[36:37], v[68:69], v[112:113], v[36:37]
  v_pk_fma_f32 v[38:39], v[70:71], v[114:115], v[38:39]
  v_cvt_pk_bf16_f32 v96, v32, v33
  v_cvt_pk_bf16_f32 v97, v34, v35
  v_cvt_pk_bf16_f32 v104, v36, v37
  v_cvt_pk_bf16_f32 v105, v38, v39
  s_waitcnt vmcnt(2)
  v_lshlrev_b32 v72, 16, v132
  v_and_b32 v73, 0xffff0000, v132
  v_lshlrev_b32 v74, 16, v133
  v_and_b32 v75, 0xffff0000, v133
  v_lshlrev_b32 v76, 16, v134
  v_and_b32 v77, 0xffff0000, v134
  v_lshlrev_b32 v78, 16, v135
  v_and_b32 v79, 0xffff0000, v135
  v_pk_fma_f32 v[40:41], v[72:73], v[116:117], v[40:41]
  v_pk_fma_f32 v[42:43], v[74:75], v[118:119], v[42:43]
  v_pk_fma_f32 v[44:45], v[76:77], v[116:117], v[44:45]
  v_pk_fma_f32 v[46:47], v[78:79], v[118:119], v[46:47]
  v_cvt_pk_bf16_f32 v98, v40, v41
  v_cvt_pk_bf16_f32 v99, v42, v43
  v_cvt_pk_bf16_f32 v106, v44, v45
  v_cvt_pk_bf16_f32 v107, v46, v47
  s_waitcnt vmcnt(1)
  v_lshlrev_b32 v80, 16, v136
  v_and_b32 v81, 0xffff0000, v136
  v_lshlrev_b32 v82, 16, v137
  v_and_b32 v83, 0xffff0000, v137
  v_lshlrev_b32 v84, 16, v138
  v_and_b32 v85, 0xffff0000, v138
  v_lshlrev_b32 v86, 16, v139
  v_and_b32 v87, 0xffff0000, v139
  v_pk_fma_f32 v[48:49], v[80:81], v[120:121], v[48:49]
  v_pk_fma_f32 v[50:51], v[82:83], v[122:123], v[50:51]
  v_pk_fma_f32 v[52:53], v[84:85], v[120:121], v[52:53]
  v_pk_fma_f32 v[54:55], v[86:87], v[122:123], v[54:55]
  v_cvt_pk_bf16_f32 v100, v48, v49
  v_cvt_pk_bf16_f32 v101, v50, v51
  v_cvt_pk_bf16_f32 v108, v52, v53
  v_cvt_pk_bf16_f32 v109, v54, v55
  s_waitcnt vmcnt(0)
  v_lshlrev_b32 v88, 16, v140
  v_and_b32 v89, 0xffff0000, v140
  v_lshlrev_b32 v90, 16, v141
  v_and_b32 v91, 0xffff0000, v141
  v_lshlrev_b32 v92, 16, v142
  v_and_b32 v93, 0xffff0000, v142
  v_lshlrev_b32 v94, 16, v143
  v_and_b32 v95, 0xffff0000, v143
  v_pk_fma_f32 v[56:57], v[88:89], v[124:125], v[56:57]
  v_pk_fma_f32 v[58:59], v[90:91], v[126:127], v[58:59]
  v_pk_fma_f32 v[60:61], v[92:93], v[124:125], v[60:61]
  v_pk_fma_f32 v[62:63], v[94:95], v[126:127], v[62:63]
  v_cvt_pk_bf16_f32 v102, v56, v57
  v_cvt_pk_bf16_f32 v103, v58, v59
  v_cvt_pk_bf16_f32 v110, v60, v61
  v_cvt_pk_bf16_f32 v111, v62, v63
  s_nop 1
  v_permlane16_swap_b32 v96, v98
  v_permlane16_swap_b32 v97, v99
  v_permlane16_swap_b32 v100, v102
  v_permlane16_swap_b32 v101, v103
  v_permlane16_swap_b32 v104, v106
  v_permlane16_swap_b32 v105, v107
  v_permlane16_swap_b32 v108, v110
  v_permlane16_swap_b32 v109, v111
  s_nop 1
  buffer_store_dwordx4 v[96:99], v22, s[28:31], s62 offen offset:0 sc1
  buffer_store_dwordx4 v[100:103], v22, s[28:31], s62 offen offset:64 sc1
  buffer_store_dwordx4 v[104:107], v22, s[28:31], s63 offen offset:0 sc1
  buffer_store_dwordx4 v[108:111], v22, s[28:31], s63 offen offset:64 sc1
L_end_34:
  s_endpgm
L_code_end:
.section .rodata,"a"
.p2align 6
.amdhsa_kernel front_kernel
  .amdhsa_next_free_vgpr 80
  .amdhsa_next_free_sgpr 72
  .amdhsa_accum_offset 80
  .amdhsa_group_segment_fixed_size 0
  .amdhsa_kernarg_size 96
  .amdhsa_user_sgpr_count 2
  .amdhsa_user_sgpr_kernarg_segment_ptr 1
  .amdhsa_system_sgpr_workgroup_id_x 1
  .amdhsa_float_denorm_mode_32 3
  .amdhsa_float_denorm_mode_16_64 3
.end_amdhsa_kernel
.section .rodata,"a"
.p2align 6
.amdhsa_kernel qkv_kernel
  .amdhsa_next_free_vgpr 272
  .amdhsa_next_free_sgpr 48
  .amdhsa_accum_offset 144
  .amdhsa_group_segment_fixed_size 0
  .amdhsa_kernarg_size 96
  .amdhsa_user_sgpr_count 2
  .amdhsa_user_sgpr_kernarg_segment_ptr 1
  .amdhsa_system_sgpr_workgroup_id_x 1
  .amdhsa_float_denorm_mode_32 3
  .amdhsa_float_denorm_mode_16_64 3
.end_amdhsa_kernel
.section .rodata,"a"
.p2align 6
.amdhsa_kernel attn_kernel
  .amdhsa_next_free_vgpr 244
  .amdhsa_next_free_sgpr 80
  .amdhsa_accum_offset 192
  .amdhsa_group_segment_fixed_size 0
  .amdhsa_kernarg_size 96
  .amdhsa_user_sgpr_count 2
  .amdhsa_user_sgpr_kernarg_segment_ptr 1
  .amdhsa_system_sgpr_workgroup_id_x 1
  .amdhsa_float_denorm_mode_32 3
  .amdhsa_float_denorm_mode_16_64 3
.end_amdhsa_kernel
.section .rodata,"a"
.p2align 6
.amdhsa_kernel wo_kernel
  .amdhsa_next_free_vgpr 484
  .amdhsa_next_free_sgpr 80
  .amdhsa_accum_offset 256
  .amdhsa_group_segment_fixed_size 0
  .amdhsa_kernarg_size 96
  .amdhsa_user_sgpr_count 2
  .amdhsa_user_sgpr_kernarg_segment_ptr 1
  .amdhsa_system_sgpr_workgroup_id_x 1
  .amdhsa_float_denorm_mode_32 3
  .amdhsa_float_denorm_mode_16_64 3
.end_amdhsa_kernel
```
